```python
import torch

def _softmax(x, axis=-1):
    return torch.softmax(x, dim=axis)

def _gelu(x):
    return torch.nn.functional.gelu(x, approximate='tanh')

def _silu(x):
    return torch.nn.functional.silu(x)

def _sigmoid(x):
    return torch.sigmoid(x)

def _layernorm(x, axis=-1, eps=1e-05):
    m = x.mean(dim=axis, keepdim=True)
    v = x.var(dim=axis, keepdim=True, unbiased=False)
    return (x - m) / torch.sqrt(v + eps)

def _scatter_add(tgt, idx, src, axis=0):
    return tgt.clone().index_add_(axis, idx, src)

def _segment_sum(src, seg, n):
    out = torch.zeros((n,) + src.shape[1:], dtype=src.dtype)
    return out.index_add_(0, seg, src)

def _pad(x, pw):
    flat = tuple((v for pair in reversed(pw) for v in pair))
    return torch.nn.functional.pad(x, flat)
kernel_name = 'parallel_sum__memory_aug_recurrent_mem_tr__moe_arch_mod__prompt'

def setup_inputs():

    _w = lambda a: (lambda t: t.to(torch.bfloat16) if t.is_floating_point() else t)(torch.as_tensor(a))

    def _A_setup():
        B, S, Dm = (1, 2048, 640)
        H, Dh = (32, 128)
        M, seg = (8, 32)
        seg = min(seg, S)
        S = S // seg * seg
        return {'x': _w((lambda *s: torch.randn(*s, dtype=torch.bfloat16) * 0.05)(B, S, Dm)), 'mem0': _w((lambda *s: torch.randn(*s, dtype=torch.bfloat16) * 1.6)(B, M, Dm)), 'Wq': _w((lambda *s: torch.randn(*s, dtype=torch.bfloat16) * 0.8)(Dm, H, Dh) * Dm ** (-0.5)), 'Wk': _w((lambda *s: torch.randn(*s, dtype=torch.bfloat16) * 0.8)(Dm, H, Dh) * Dm ** (-0.5)), 'Wv': _w((lambda *s: torch.randn(*s, dtype=torch.bfloat16) * 1.6)(Dm, H, Dh) * Dm ** (-0.5)), 'Wo': _w((lambda *s: torch.randn(*s, dtype=torch.bfloat16) * 1.6)(H, Dh, Dm) * (H * Dh) ** (-0.5)), 'seg_len': seg}
    _A_in = _A_setup()

    def _B_setup():
        B, S, D, F, C = (1, 2048, 640, 1728, 8)
        return {'x': _w((lambda *s: torch.randn(*s, dtype=torch.bfloat16) * 0.05)(B, S, D)), 'w_r': _w((lambda *s: torch.randn(*s, dtype=torch.bfloat16) * 0.05)(D)), 'w_gate': _w((lambda *s: torch.randn(*s, dtype=torch.bfloat16) * 0.05)(D, F)), 'w_up': _w((lambda *s: torch.randn(*s, dtype=torch.bfloat16) * 0.05)(D, F)), 'w_down': _w((lambda *s: torch.randn(*s, dtype=torch.bfloat16) * 0.05)(F, D))}
    _B_in = _B_setup()
    return {'A_x': _A_in['x'], 'A_mem0': _A_in['mem0'], 'A_Wq': _A_in['Wq'], 'A_Wk': _A_in['Wk'], 'A_Wv': _A_in['Wv'], 'A_Wo': _A_in['Wo'], 'A_seg_len': _A_in['seg_len'], 'B_x': _B_in['x'], 'B_w_r': _B_in['w_r'], 'B_w_gate': _B_in['w_gate'], 'B_w_up': _B_in['w_up'], 'B_w_down': _B_in['w_down']}

def reference(A_x, A_mem0, A_Wq, A_Wk, A_Wv, A_Wo, A_seg_len, B_x, B_w_r, B_w_gate, B_w_up, B_w_down):

    def _A_ref(x, mem0, Wq, Wk, Wv, Wo, seg_len):
        B, S, Dm = x.shape
        H, Dh = (Wq.shape[1], Wq.shape[2])
        M = mem0.shape[1]
        scale = Dh ** (-0.5)
        n_seg = S // seg_len
        L = M + seg_len
        idx = torch.arange(L)
        mask = (idx[:, None] < M) | (idx[:, None] >= idx[None, :])
        mem = mem0
        outs = []
        for s in range(n_seg):
            xs = x[:, s * seg_len:(s + 1) * seg_len, :].clone()
            h = torch.concatenate([mem, xs], axis=1)
            q = torch.einsum('btd,dhe->bhte', h, Wq)
            k = torch.einsum('btd,dhe->bhte', h, Wk)
            v = torch.einsum('btd,dhe->bhte', h, Wv)
            scores = torch.einsum('bhqe,bhke->bhqk', q, k) * scale
            scores = torch.where(mask[None, None], scores, -1000000000.0)
            p = _softmax(scores, axis=-1)
            o = torch.einsum('bhqk,bhke->bhqe', p, v)
            o = torch.einsum('bhte,hed->btd', o, Wo)
            mem = o[:, :M, :].clone()
            outs.append(o[:, M:, :])
        return torch.concatenate(outs, axis=1)

    def _B_ref(x, w_r, w_gate, w_up, w_down):
        B, S, D = x.shape
        C = 8
        r = x @ w_r
        idx = torch.argsort(-r, axis=-1)[:, :C]
        idx_e = (lambda x, n, axis: torch.repeat_interleave(x, n, dim=axis))(idx.reshape(B, C, 1), D, axis=2)
        x_sel = (lambda x, i, axis: torch.take_along_dim(x, i, dim=axis))(x, idx_e, axis=1)
        g = _silu(x_sel @ w_gate)
        u = x_sel @ w_up
        y = g * u @ w_down
        r_sel = _sigmoid((lambda x, i, axis: torch.take_along_dim(x, i, dim=axis))(r, idx, axis=1))
        y = y * r_sel.reshape(B, C, 1)
        b_off = (torch.arange(B) * S).reshape(B, 1)
        flat_idx = (idx + b_off).reshape(B * C)
        zero = (x * 0.0).reshape(B * S, D)
        upd = _scatter_add(zero, flat_idx, y.reshape(B * C, D), axis=0)
        return x + upd.reshape(B, S, D)
    x = A_x
    xn = _layernorm(x, axis=-1)
    return x + _A_ref(xn, A_mem0, A_Wq, A_Wk, A_Wv, A_Wo, A_seg_len) + _B_ref(xn, B_w_r, B_w_gate, B_w_up, B_w_down)
```

```asm
; @launch kernel=prep_kernel grid=(705,1,1) block=(256,1,1) lds=0
; @launch kernel=chain_kernel grid=(243,1,1) block=(256,1,1) lds=159744
; @launch kernel=final_kernel grid=(128,1,1) block=(256,1,1) lds=0
.amdgcn_target "amdgcn-amd-amdhsa--gfx950"
.text
.globl prep_kernel
.p2align 8
.type prep_kernel,@function
prep_kernel:
    s_cmp_ge_u32 s2, 705
    s_cbranch_scc1 prep_done
    s_load_dwordx2 s[4:5], s[0:1], 0
    s_load_dwordx2 s[6:7], s[0:1], 8
    s_load_dwordx2 s[8:9], s[0:1], 40
    s_load_dwordx2 s[10:11], s[0:1], 64
    s_load_dwordx2 s[12:13], s[0:1], 112
    s_waitcnt lgkmcnt(0)
    s_mov_b32 s16, s4
    s_and_b32 s17, s5, 0xffff
    s_mov_b32 s18, 2621440
    s_mov_b32 s19, 0x00020000
    s_mov_b32 s20, s6
    s_and_b32 s21, s7, 0xffff
    s_mov_b32 s22, 10240
    s_mov_b32 s23, 0x00020000
    s_mov_b32 s24, s8
    s_and_b32 s25, s9, 0xffff
    s_mov_b32 s26, 5242880
    s_mov_b32 s27, 0x00020000
    s_mov_b32 s28, s10
    s_and_b32 s29, s11, 0xffff
    s_mov_b32 s30, 1280
    s_mov_b32 s31, 0x00020000
    s_mov_b32 s32, s12
    s_and_b32 s33, s13, 0xffff
    s_mov_b32 s34, 268435456
    s_mov_b32 s35, 0x00020000
    v_and_b32 v1, 63, v0
    v_lshrrev_b32 v2, 6, v0
    s_nop 0
    v_readfirstlane_b32 s3, v2
    s_cmp_ge_u32 s2, 512
    s_nop 3
    s_cbranch_scc1 prep_not_ln
    s_lshl_b32 s36, s2, 2
    s_add_u32 s36, s36, s3
    s_mul_i32 s37, s36, 1280
    v_lshlrev_b32 v3, 2, v1
    buffer_load_dword v10, v3, s[16:19], s37 offen offset:0
    buffer_load_dword v11, v3, s[16:19], s37 offen offset:256
    buffer_load_dword v12, v3, s[16:19], s37 offen offset:512
    buffer_load_dword v13, v3, s[16:19], s37 offen offset:768
    buffer_load_dword v14, v3, s[16:19], s37 offen offset:1024
    buffer_load_dword v40, v3, s[28:31], 0 offen offset:0
    buffer_load_dword v41, v3, s[28:31], 0 offen offset:256
    buffer_load_dword v42, v3, s[28:31], 0 offen offset:512
    buffer_load_dword v43, v3, s[28:31], 0 offen offset:768
    buffer_load_dword v44, v3, s[28:31], 0 offen offset:1024
    s_waitcnt vmcnt(5)
    v_lshlrev_b32 v20, 16, v10
    v_and_b32 v21, 0xffff0000, v10
    v_lshlrev_b32 v22, 16, v11
    v_and_b32 v23, 0xffff0000, v11
    v_lshlrev_b32 v24, 16, v12
    v_and_b32 v25, 0xffff0000, v12
    v_lshlrev_b32 v26, 16, v13
    v_and_b32 v27, 0xffff0000, v13
    v_lshlrev_b32 v28, 16, v14
    v_and_b32 v29, 0xffff0000, v14
    v_add_f32 v4, v20, v21
    v_add_f32 v4, v4, v22
    v_add_f32 v4, v4, v23
    v_add_f32 v4, v4, v24
    v_add_f32 v4, v4, v25
    v_add_f32 v4, v4, v26
    v_add_f32 v4, v4, v27
    v_add_f32 v4, v4, v28
    v_add_f32 v4, v4, v29
    s_nop 1
    v_add_f32_dpp v4, v4, v4 row_shr:1 row_mask:0xf bank_mask:0xf bound_ctrl:0
    s_nop 1
    v_add_f32_dpp v4, v4, v4 row_shr:2 row_mask:0xf bank_mask:0xf bound_ctrl:0
    s_nop 1
    v_add_f32_dpp v4, v4, v4 row_shr:4 row_mask:0xf bank_mask:0xf bound_ctrl:0
    s_nop 1
    v_add_f32_dpp v4, v4, v4 row_shr:8 row_mask:0xf bank_mask:0xf bound_ctrl:0
    s_nop 1
    v_add_f32_dpp v4, v4, v4 row_bcast:15 row_mask:0xa bank_mask:0xf
    s_nop 1
    v_add_f32_dpp v4, v4, v4 row_bcast:31 row_mask:0xc bank_mask:0xf
    s_nop 0
    v_readlane_b32 s38, v4, 63
    s_mov_b32 s39, 0x3acccccd
    s_nop 0
    v_mov_b32 v5, s38
    v_mul_f32 v5, s39, v5
    v_sub_f32 v6, v20, v5
    v_mul_f32 v4, v6, v6
    v_sub_f32 v6, v21, v5
    v_fmac_f32 v4, v6, v6
    v_sub_f32 v6, v22, v5
    v_fmac_f32 v4, v6, v6
    v_sub_f32 v6, v23, v5
    v_fmac_f32 v4, v6, v6
    v_sub_f32 v6, v24, v5
    v_fmac_f32 v4, v6, v6
    v_sub_f32 v6, v25, v5
    v_fmac_f32 v4, v6, v6
    v_sub_f32 v6, v26, v5
    v_fmac_f32 v4, v6, v6
    v_sub_f32 v6, v27, v5
    v_fmac_f32 v4, v6, v6
    v_sub_f32 v6, v28, v5
    v_fmac_f32 v4, v6, v6
    v_sub_f32 v6, v29, v5
    v_fmac_f32 v4, v6, v6
    s_nop 1
    v_add_f32_dpp v4, v4, v4 row_shr:1 row_mask:0xf bank_mask:0xf bound_ctrl:0
    s_nop 1
    v_add_f32_dpp v4, v4, v4 row_shr:2 row_mask:0xf bank_mask:0xf bound_ctrl:0
    s_nop 1
    v_add_f32_dpp v4, v4, v4 row_shr:4 row_mask:0xf bank_mask:0xf bound_ctrl:0
    s_nop 1
    v_add_f32_dpp v4, v4, v4 row_shr:8 row_mask:0xf bank_mask:0xf bound_ctrl:0
    s_nop 1
    v_add_f32_dpp v4, v4, v4 row_bcast:15 row_mask:0xa bank_mask:0xf
    s_nop 1
    v_add_f32_dpp v4, v4, v4 row_bcast:31 row_mask:0xc bank_mask:0xf
    s_nop 0
    v_readlane_b32 s38, v4, 63
    s_nop 1
    v_mov_b32 v6, s38
    v_mul_f32 v6, s39, v6
    v_cvt_pk_bf16_f32 v5, v5, v5
    v_lshlrev_b32 v5, 16, v5
    v_cvt_pk_bf16_f32 v6, v6, v6
    v_lshlrev_b32 v6, 16, v6
    v_add_f32 v6, 0x3727c5ac, v6
    v_cvt_pk_bf16_f32 v6, v6, v6
    v_lshlrev_b32 v6, 16, v6
    v_sqrt_f32 v6, v6
    s_nop 0
    v_cvt_pk_bf16_f32 v6, v6, v6
    v_lshlrev_b32 v6, 16, v6
    v_rcp_f32 v7, v6
    v_sub_f32 v20, v20, v5
    v_cvt_pk_bf16_f32 v20, v20, v20
    v_lshlrev_b32 v20, 16, v20
    v_mul_f32 v8, v20, v7
    v_fma_f32 v9, -v8, v6, v20
    v_fma_f32 v20, v9, v7, v8
    v_sub_f32 v21, v21, v5
    v_cvt_pk_bf16_f32 v21, v21, v21
    v_lshlrev_b32 v21, 16, v21
    v_mul_f32 v8, v21, v7
    v_fma_f32 v9, -v8, v6, v21
    v_fma_f32 v21, v9, v7, v8
    v_sub_f32 v22, v22, v5
    v_cvt_pk_bf16_f32 v22, v22, v22
    v_lshlrev_b32 v22, 16, v22
    v_mul_f32 v8, v22, v7
    v_fma_f32 v9, -v8, v6, v22
    v_fma_f32 v22, v9, v7, v8
    v_sub_f32 v23, v23, v5
    v_cvt_pk_bf16_f32 v23, v23, v23
    v_lshlrev_b32 v23, 16, v23
    v_mul_f32 v8, v23, v7
    v_fma_f32 v9, -v8, v6, v23
    v_fma_f32 v23, v9, v7, v8
    v_sub_f32 v24, v24, v5
    v_cvt_pk_bf16_f32 v24, v24, v24
    v_lshlrev_b32 v24, 16, v24
    v_mul_f32 v8, v24, v7
    v_fma_f32 v9, -v8, v6, v24
    v_fma_f32 v24, v9, v7, v8
    v_sub_f32 v25, v25, v5
    v_cvt_pk_bf16_f32 v25, v25, v25
    v_lshlrev_b32 v25, 16, v25
    v_mul_f32 v8, v25, v7
    v_fma_f32 v9, -v8, v6, v25
    v_fma_f32 v25, v9, v7, v8
    v_sub_f32 v26, v26, v5
    v_cvt_pk_bf16_f32 v26, v26, v26
    v_lshlrev_b32 v26, 16, v26
    v_mul_f32 v8, v26, v7
    v_fma_f32 v9, -v8, v6, v26
    v_fma_f32 v26, v9, v7, v8
    v_sub_f32 v27, v27, v5
    v_cvt_pk_bf16_f32 v27, v27, v27
    v_lshlrev_b32 v27, 16, v27
    v_mul_f32 v8, v27, v7
    v_fma_f32 v9, -v8, v6, v27
    v_fma_f32 v27, v9, v7, v8
    v_sub_f32 v28, v28, v5
    v_cvt_pk_bf16_f32 v28, v28, v28
    v_lshlrev_b32 v28, 16, v28
    v_mul_f32 v8, v28, v7
    v_fma_f32 v9, -v8, v6, v28
    v_fma_f32 v28, v9, v7, v8
    v_sub_f32 v29, v29, v5
    v_cvt_pk_bf16_f32 v29, v29, v29
    v_lshlrev_b32 v29, 16, v29
    v_mul_f32 v8, v29, v7
    v_fma_f32 v9, -v8, v6, v29
    v_fma_f32 v29, v9, v7, v8
    v_cvt_pk_bf16_f32 v10, v20, v21
    v_cvt_pk_bf16_f32 v11, v22, v23
    v_cvt_pk_bf16_f32 v12, v24, v25
    v_cvt_pk_bf16_f32 v13, v26, v27
    v_cvt_pk_bf16_f32 v14, v28, v29
    s_add_u32 s40, s37, 0
    buffer_store_dword v10, v3, s[32:35], s40 offen offset:0
    buffer_store_dword v11, v3, s[32:35], s40 offen offset:256
    buffer_store_dword v12, v3, s[32:35], s40 offen offset:512
    buffer_store_dword v13, v3, s[32:35], s40 offen offset:768
    buffer_store_dword v14, v3, s[32:35], s40 offen offset:1024
    s_waitcnt vmcnt(5)
    v_mov_b32 v4, 0
    v_lshlrev_b32 v8, 16, v10
    v_lshlrev_b32 v9, 16, v40
    v_fmac_f32 v4, v8, v9
    v_and_b32 v8, 0xffff0000, v10
    v_and_b32 v9, 0xffff0000, v40
    v_fmac_f32 v4, v8, v9
    v_lshlrev_b32 v8, 16, v11
    v_lshlrev_b32 v9, 16, v41
    v_fmac_f32 v4, v8, v9
    v_and_b32 v8, 0xffff0000, v11
    v_and_b32 v9, 0xffff0000, v41
    v_fmac_f32 v4, v8, v9
    v_lshlrev_b32 v8, 16, v12
    v_lshlrev_b32 v9, 16, v42
    v_fmac_f32 v4, v8, v9
    v_and_b32 v8, 0xffff0000, v12
    v_and_b32 v9, 0xffff0000, v42
    v_fmac_f32 v4, v8, v9
    v_lshlrev_b32 v8, 16, v13
    v_lshlrev_b32 v9, 16, v43
    v_fmac_f32 v4, v8, v9
    v_and_b32 v8, 0xffff0000, v13
    v_and_b32 v9, 0xffff0000, v43
    v_fmac_f32 v4, v8, v9
    v_lshlrev_b32 v8, 16, v14
    v_lshlrev_b32 v9, 16, v44
    v_fmac_f32 v4, v8, v9
    v_and_b32 v8, 0xffff0000, v14
    v_and_b32 v9, 0xffff0000, v44
    v_fmac_f32 v4, v8, v9
    s_nop 1
    v_add_f32_dpp v4, v4, v4 row_shr:1 row_mask:0xf bank_mask:0xf bound_ctrl:0
    s_nop 1
    v_add_f32_dpp v4, v4, v4 row_shr:2 row_mask:0xf bank_mask:0xf bound_ctrl:0
    s_nop 1
    v_add_f32_dpp v4, v4, v4 row_shr:4 row_mask:0xf bank_mask:0xf bound_ctrl:0
    s_nop 1
    v_add_f32_dpp v4, v4, v4 row_shr:8 row_mask:0xf bank_mask:0xf bound_ctrl:0
    s_nop 1
    v_add_f32_dpp v4, v4, v4 row_bcast:15 row_mask:0xa bank_mask:0xf
    s_nop 1
    v_add_f32_dpp v4, v4, v4 row_bcast:31 row_mask:0xc bank_mask:0xf
    v_cvt_pk_bf16_f32 v4, v4, v4
    v_lshlrev_b32 v4, 16, v4
    s_lshl_b32 s40, s36, 2
    s_add_u32 s40, s40, 3145728
    v_cmp_eq_u32 vcc, 63, v1
    s_nop 0
    s_and_saveexec_b64 s[42:43], vcc
    v_mov_b32 v5, 0
    buffer_store_dword v4, v5, s[32:35], s40 offen
    s_nop 3
    s_endpgm
prep_not_ln:
    s_cmp_ge_u32 s2, 576
    s_cbranch_scc1 prep_not_sent
    s_sub_u32 s36, s2, 512
    v_mov_b32 v4, 4294967295
    v_mov_b32 v5, v4
    v_mov_b32 v6, v4
    v_mov_b32 v7, v4
    v_lshrrev_b32 v3, 5, v0
    v_and_b32 v8, 31, v0
    v_lshlrev_b32 v8, 4, v8
    s_mov_b32 s39, 512
    v_mul_lo_u32 v9, v3, s39
    v_add_u32 v9, v9, v8
    s_mov_b32 s39, 512
    v_mul_lo_u32 v3, v3, s39
    v_add_u32 v3, v3, v8
    s_mul_i32 s37, s36, 65536
    s_add_u32 s37, s37, 150994944
    buffer_store_dwordx4 v[4:7], v9, s[32:35], s37 offen sc1
    s_add_u32 s37, s37, 4096
    buffer_store_dwordx4 v[4:7], v9, s[32:35], s37 offen sc1
    s_add_u32 s37, s37, 4096
    buffer_store_dwordx4 v[4:7], v9, s[32:35], s37 offen sc1
    s_add_u32 s37, s37, 4096
    buffer_store_dwordx4 v[4:7], v9, s[32:35], s37 offen sc1
    s_add_u32 s37, s37, 4096
    buffer_store_dwordx4 v[4:7], v9, s[32:35], s37 offen sc1
    s_add_u32 s37, s37, 4096
    buffer_store_dwordx4 v[4:7], v9, s[32:35], s37 offen sc1
    s_add_u32 s37, s37, 4096
    buffer_store_dwordx4 v[4:7], v9, s[32:35], s37 offen sc1
    s_add_u32 s37, s37, 4096
    buffer_store_dwordx4 v[4:7], v9, s[32:35], s37 offen sc1
    s_add_u32 s37, s37, 4096
    buffer_store_dwordx4 v[4:7], v9, s[32:35], s37 offen sc1
    s_add_u32 s37, s37, 4096
    buffer_store_dwordx4 v[4:7], v9, s[32:35], s37 offen sc1
    s_add_u32 s37, s37, 4096
    buffer_store_dwordx4 v[4:7], v9, s[32:35], s37 offen sc1
    s_add_u32 s37, s37, 4096
    buffer_store_dwordx4 v[4:7], v9, s[32:35], s37 offen sc1
    s_add_u32 s37, s37, 4096
    buffer_store_dwordx4 v[4:7], v9, s[32:35], s37 offen sc1
    s_add_u32 s37, s37, 4096
    buffer_store_dwordx4 v[4:7], v9, s[32:35], s37 offen sc1
    s_add_u32 s37, s37, 4096
    buffer_store_dwordx4 v[4:7], v9, s[32:35], s37 offen sc1
    s_add_u32 s37, s37, 4096
    buffer_store_dwordx4 v[4:7], v9, s[32:35], s37 offen sc1
    s_add_u32 s37, s37, 4096
    s_mul_i32 s37, s36, 10240
    s_add_u32 s37, s37, 117450752
    buffer_store_dwordx4 v[4:7], v3, s[32:35], s37 offen sc1
    s_add_u32 s37, s37, 4096
    buffer_store_dwordx4 v[4:7], v3, s[32:35], s37 offen sc1
    s_add_u32 s37, s37, 4096
    buffer_store_dwordx4 v[4:7], v3, s[32:35], s37 offen sc1
    s_add_u32 s37, s37, 4096
    s_mul_i32 s37, s36, 10240
    s_add_u32 s37, s37, 119547904
    buffer_store_dwordx4 v[4:7], v3, s[32:35], s37 offen sc1
    s_add_u32 s37, s37, 4096
    buffer_store_dwordx4 v[4:7], v3, s[32:35], s37 offen sc1
    s_add_u32 s37, s37, 4096
    buffer_store_dwordx4 v[4:7], v3, s[32:35], s37 offen sc1
    s_add_u32 s37, s37, 4096
    s_mul_i32 s37, s36, 10240
    s_add_u32 s37, s37, 121645056
    buffer_store_dwordx4 v[4:7], v3, s[32:35], s37 offen sc1
    s_add_u32 s37, s37, 4096
    buffer_store_dwordx4 v[4:7], v3, s[32:35], s37 offen sc1
    s_add_u32 s37, s37, 4096
    buffer_store_dwordx4 v[4:7], v3, s[32:35], s37 offen sc1
    s_add_u32 s37, s37, 4096
    s_mul_i32 s37, s36, 10240
    s_add_u32 s37, s37, 123742208
    buffer_store_dwordx4 v[4:7], v3, s[32:35], s37 offen sc1
    s_add_u32 s37, s37, 4096
    buffer_store_dwordx4 v[4:7], v3, s[32:35], s37 offen sc1
    s_add_u32 s37, s37, 4096
    buffer_store_dwordx4 v[4:7], v3, s[32:35], s37 offen sc1
    s_add_u32 s37, s37, 4096
    s_mul_i32 s37, s36, 10240
    s_add_u32 s37, s37, 125839360
    buffer_store_dwordx4 v[4:7], v3, s[32:35], s37 offen sc1
    s_add_u32 s37, s37, 4096
    buffer_store_dwordx4 v[4:7], v3, s[32:35], s37 offen sc1
    s_add_u32 s37, s37, 4096
    buffer_store_dwordx4 v[4:7], v3, s[32:35], s37 offen sc1
    s_add_u32 s37, s37, 4096
    s_mul_i32 s37, s36, 10240
    s_add_u32 s37, s37, 127936512
    buffer_store_dwordx4 v[4:7], v3, s[32:35], s37 offen sc1
    s_add_u32 s37, s37, 4096
    buffer_store_dwordx4 v[4:7], v3, s[32:35], s37 offen sc1
    s_add_u32 s37, s37, 4096
    buffer_store_dwordx4 v[4:7], v3, s[32:35], s37 offen sc1
    s_add_u32 s37, s37, 4096
    s_mul_i32 s37, s36, 10240
    s_add_u32 s37, s37, 130033664
    buffer_store_dwordx4 v[4:7], v3, s[32:35], s37 offen sc1
    s_add_u32 s37, s37, 4096
    buffer_store_dwordx4 v[4:7], v3, s[32:35], s37 offen sc1
    s_add_u32 s37, s37, 4096
    buffer_store_dwordx4 v[4:7], v3, s[32:35], s37 offen sc1
    s_add_u32 s37, s37, 4096
    s_mul_i32 s37, s36, 10240
    s_add_u32 s37, s37, 132130816
    buffer_store_dwordx4 v[4:7], v3, s[32:35], s37 offen sc1
    s_add_u32 s37, s37, 4096
    buffer_store_dwordx4 v[4:7], v3, s[32:35], s37 offen sc1
    s_add_u32 s37, s37, 4096
    buffer_store_dwordx4 v[4:7], v3, s[32:35], s37 offen sc1
    s_add_u32 s37, s37, 4096
    s_nop 0
    v_mov_b32 v4, 0
    v_mov_b32 v5, 0
    v_mov_b32 v6, 0
    v_mov_b32 v7, 0
    v_lshlrev_b32 v3, 4, v0
    s_mul_i32 s37, s36, 81920
    s_add_u32 s37, s37, 10485760
    buffer_store_dwordx4 v[4:7], v3, s[32:35], s37 offen
    s_add_u32 s37, s37, 4096
    buffer_store_dwordx4 v[4:7], v3, s[32:35], s37 offen
    s_add_u32 s37, s37, 4096
    buffer_store_dwordx4 v[4:7], v3, s[32:35], s37 offen
    s_add_u32 s37, s37, 4096
    buffer_store_dwordx4 v[4:7], v3, s[32:35], s37 offen
    s_add_u32 s37, s37, 4096
    buffer_store_dwordx4 v[4:7], v3, s[32:35], s37 offen
    s_add_u32 s37, s37, 4096
    buffer_store_dwordx4 v[4:7], v3, s[32:35], s37 offen
    s_add_u32 s37, s37, 4096
    buffer_store_dwordx4 v[4:7], v3, s[32:35], s37 offen
    s_add_u32 s37, s37, 4096
    buffer_store_dwordx4 v[4:7], v3, s[32:35], s37 offen
    s_add_u32 s37, s37, 4096
    buffer_store_dwordx4 v[4:7], v3, s[32:35], s37 offen
    s_add_u32 s37, s37, 4096
    buffer_store_dwordx4 v[4:7], v3, s[32:35], s37 offen
    s_add_u32 s37, s37, 4096
    buffer_store_dwordx4 v[4:7], v3, s[32:35], s37 offen
    s_add_u32 s37, s37, 4096
    buffer_store_dwordx4 v[4:7], v3, s[32:35], s37 offen
    s_add_u32 s37, s37, 4096
    buffer_store_dwordx4 v[4:7], v3, s[32:35], s37 offen
    s_add_u32 s37, s37, 4096
    buffer_store_dwordx4 v[4:7], v3, s[32:35], s37 offen
    s_add_u32 s37, s37, 4096
    buffer_store_dwordx4 v[4:7], v3, s[32:35], s37 offen
    s_add_u32 s37, s37, 4096
    buffer_store_dwordx4 v[4:7], v3, s[32:35], s37 offen
    s_add_u32 s37, s37, 4096
    buffer_store_dwordx4 v[4:7], v3, s[32:35], s37 offen
    s_add_u32 s37, s37, 4096
    buffer_store_dwordx4 v[4:7], v3, s[32:35], s37 offen
    s_add_u32 s37, s37, 4096
    buffer_store_dwordx4 v[4:7], v3, s[32:35], s37 offen
    s_add_u32 s37, s37, 4096
    buffer_store_dwordx4 v[4:7], v3, s[32:35], s37 offen
    s_add_u32 s37, s37, 4096
    s_nop 0
    s_endpgm
prep_not_sent:
    s_cmp_gt_u32 s2, 576
    s_cbranch_scc1 prep_pack
    v_mov_b32 v4, 0
    v_mov_b32 v5, 0
    v_mov_b32 v6, 0
    v_mov_b32 v7, 0
    v_lshlrev_b32 v3, 4, v0
    s_mov_b32 s37, 3342336
    buffer_store_dwordx4 v[4:7], v3, s[32:35], s37 offen sc1
    s_add_u32 s37, s37, 4096
    buffer_store_dwordx4 v[4:7], v3, s[32:35], s37 offen sc1
    s_add_u32 s37, s37, 4096
    buffer_store_dwordx4 v[4:7], v3, s[32:35], s37 offen sc1
    s_add_u32 s37, s37, 4096
    buffer_store_dwordx4 v[4:7], v3, s[32:35], s37 offen sc1
    s_add_u32 s37, s37, 4096
    buffer_store_dwordx4 v[4:7], v3, s[32:35], s37 offen sc1
    s_add_u32 s37, s37, 4096
    buffer_store_dwordx4 v[4:7], v3, s[32:35], s37 offen sc1
    s_add_u32 s37, s37, 4096
    buffer_store_dwordx4 v[4:7], v3, s[32:35], s37 offen sc1
    s_add_u32 s37, s37, 4096
    buffer_store_dwordx4 v[4:7], v3, s[32:35], s37 offen sc1
    s_add_u32 s37, s37, 4096
    buffer_store_dwordx4 v[4:7], v3, s[32:35], s37 offen sc1
    s_add_u32 s37, s37, 4096
    buffer_store_dwordx4 v[4:7], v3, s[32:35], s37 offen sc1
    s_add_u32 s37, s37, 4096
    v_add_u32 v3, 0, v0
    v_lshrrev_b32 v4, 5, v3
    v_bfe_u32 v5, v3, 3, 2
    v_and_b32 v6, 7, v3
    v_mul_u32_u24 v6, 1280, v6
    v_lshl_add_u32 v6, v4, 6, v6
    v_lshl_add_u32 v6, v5, 3, v6
    buffer_load_dwordx2 v[8:9], v6, s[20:23], 0 offen
    buffer_load_dwordx2 v[10:11], v6, s[20:23], 0 offen offset:32
    v_and_b32 v7, 31, v3
    v_lshlrev_b32 v7, 4, v7
    s_mov_b32 s39, 512
    v_mul_lo_u32 v14, v4, s39
    v_add_u32 v7, v7, v14
    v_mov_b32 v12, 4294967295
    v_mov_b32 v13, 0x7fc07fc0
    s_waitcnt vmcnt(0)
    v_cmp_eq_u32 vcc, v12, v8
    s_nop 1
    v_cndmask_b32 v8, v8, v13, vcc
    v_cmp_eq_u32 vcc, v12, v9
    s_nop 1
    v_cndmask_b32 v9, v9, v13, vcc
    v_cmp_eq_u32 vcc, v12, v10
    s_nop 1
    v_cndmask_b32 v10, v10, v13, vcc
    v_cmp_eq_u32 vcc, v12, v11
    s_nop 1
    v_cndmask_b32 v11, v11, v13, vcc
    v_cmp_gt_u32 vcc, 640, v3
    s_nop 0
    s_and_saveexec_b64 s[42:43], vcc
    s_mov_b32 s37, 117440512
    buffer_store_dwordx4 v[8:11], v7, s[32:35], s37 offen
    s_mov_b32 s37, 119537664
    buffer_store_dwordx4 v[8:11], v7, s[32:35], s37 offen
    s_mov_b32 s37, 121634816
    buffer_store_dwordx4 v[8:11], v7, s[32:35], s37 offen
    s_mov_b32 s37, 123731968
    buffer_store_dwordx4 v[8:11], v7, s[32:35], s37 offen
    s_mov_b32 s37, 125829120
    buffer_store_dwordx4 v[8:11], v7, s[32:35], s37 offen
    s_mov_b32 s37, 127926272
    buffer_store_dwordx4 v[8:11], v7, s[32:35], s37 offen
    s_mov_b32 s37, 130023424
    buffer_store_dwordx4 v[8:11], v7, s[32:35], s37 offen
    s_mov_b32 s37, 132120576
    buffer_store_dwordx4 v[8:11], v7, s[32:35], s37 offen
    s_mov_b64 exec, s[42:43]
    v_add_u32 v3, 256, v0
    v_lshrrev_b32 v4, 5, v3
    v_bfe_u32 v5, v3, 3, 2
    v_and_b32 v6, 7, v3
    v_mul_u32_u24 v6, 1280, v6
    v_lshl_add_u32 v6, v4, 6, v6
    v_lshl_add_u32 v6, v5, 3, v6
    buffer_load_dwordx2 v[8:9], v6, s[20:23], 0 offen
    buffer_load_dwordx2 v[10:11], v6, s[20:23], 0 offen offset:32
    v_and_b32 v7, 31, v3
    v_lshlrev_b32 v7, 4, v7
    s_mov_b32 s39, 512
    v_mul_lo_u32 v14, v4, s39
    v_add_u32 v7, v7, v14
    v_mov_b32 v12, 4294967295
    v_mov_b32 v13, 0x7fc07fc0
    s_waitcnt vmcnt(0)
    v_cmp_eq_u32 vcc, v12, v8
    s_nop 1
    v_cndmask_b32 v8, v8, v13, vcc
    v_cmp_eq_u32 vcc, v12, v9
    s_nop 1
    v_cndmask_b32 v9, v9, v13, vcc
    v_cmp_eq_u32 vcc, v12, v10
    s_nop 1
    v_cndmask_b32 v10, v10, v13, vcc
    v_cmp_eq_u32 vcc, v12, v11
    s_nop 1
    v_cndmask_b32 v11, v11, v13, vcc
    v_cmp_gt_u32 vcc, 640, v3
    s_nop 0
    s_and_saveexec_b64 s[42:43], vcc
    s_mov_b32 s37, 117440512
    buffer_store_dwordx4 v[8:11], v7, s[32:35], s37 offen
    s_mov_b32 s37, 119537664
    buffer_store_dwordx4 v[8:11], v7, s[32:35], s37 offen
    s_mov_b32 s37, 121634816
    buffer_store_dwordx4 v[8:11], v7, s[32:35], s37 offen
    s_mov_b32 s37, 123731968
    buffer_store_dwordx4 v[8:11], v7, s[32:35], s37 offen
    s_mov_b32 s37, 125829120
    buffer_store_dwordx4 v[8:11], v7, s[32:35], s37 offen
    s_mov_b32 s37, 127926272
    buffer_store_dwordx4 v[8:11], v7, s[32:35], s37 offen
    s_mov_b32 s37, 130023424
    buffer_store_dwordx4 v[8:11], v7, s[32:35], s37 offen
    s_mov_b32 s37, 132120576
    buffer_store_dwordx4 v[8:11], v7, s[32:35], s37 offen
    s_mov_b64 exec, s[42:43]
    v_add_u32 v3, 512, v0
    v_lshrrev_b32 v4, 5, v3
    v_bfe_u32 v5, v3, 3, 2
    v_and_b32 v6, 7, v3
    v_mul_u32_u24 v6, 1280, v6
    v_lshl_add_u32 v6, v4, 6, v6
    v_lshl_add_u32 v6, v5, 3, v6
    buffer_load_dwordx2 v[8:9], v6, s[20:23], 0 offen
    buffer_load_dwordx2 v[10:11], v6, s[20:23], 0 offen offset:32
    v_and_b32 v7, 31, v3
    v_lshlrev_b32 v7, 4, v7
    s_mov_b32 s39, 512
    v_mul_lo_u32 v14, v4, s39
    v_add_u32 v7, v7, v14
    v_mov_b32 v12, 4294967295
    v_mov_b32 v13, 0x7fc07fc0
    s_waitcnt vmcnt(0)
    v_cmp_eq_u32 vcc, v12, v8
    s_nop 1
    v_cndmask_b32 v8, v8, v13, vcc
    v_cmp_eq_u32 vcc, v12, v9
    s_nop 1
    v_cndmask_b32 v9, v9, v13, vcc
    v_cmp_eq_u32 vcc, v12, v10
    s_nop 1
    v_cndmask_b32 v10, v10, v13, vcc
    v_cmp_eq_u32 vcc, v12, v11
    s_nop 1
    v_cndmask_b32 v11, v11, v13, vcc
    v_cmp_gt_u32 vcc, 640, v3
    s_nop 0
    s_and_saveexec_b64 s[42:43], vcc
    s_mov_b32 s37, 117440512
    buffer_store_dwordx4 v[8:11], v7, s[32:35], s37 offen
    s_mov_b32 s37, 119537664
    buffer_store_dwordx4 v[8:11], v7, s[32:35], s37 offen
    s_mov_b32 s37, 121634816
    buffer_store_dwordx4 v[8:11], v7, s[32:35], s37 offen
    s_mov_b32 s37, 123731968
    buffer_store_dwordx4 v[8:11], v7, s[32:35], s37 offen
    s_mov_b32 s37, 125829120
    buffer_store_dwordx4 v[8:11], v7, s[32:35], s37 offen
    s_mov_b32 s37, 127926272
    buffer_store_dwordx4 v[8:11], v7, s[32:35], s37 offen
    s_mov_b32 s37, 130023424
    buffer_store_dwordx4 v[8:11], v7, s[32:35], s37 offen
    s_mov_b32 s37, 132120576
    buffer_store_dwordx4 v[8:11], v7, s[32:35], s37 offen
    s_mov_b64 exec, s[42:43]
    s_nop 0
    s_endpgm
prep_pack:
    s_cmp_ge_u32 s2, 705
    s_cbranch_scc1 prep_pq
    s_sub_u32 s36, s2, 577
    s_lshr_b32 s37, s36, 2
    s_and_b32 s38, s36, 3
    v_lshrrev_b32 v2, 4, v1
    v_and_b32 v3, 15, v1
    s_lshl_b32 s39, s37, 7
    s_lshr_b32 s40, s38, 1
    s_lshl_b32 s40, s40, 6
    s_add_u32 s39, s39, s40
    s_and_b32 s40, s38, 1
    s_lshl_b32 s40, s40, 1
    s_add_u32 s39, s39, s40
    v_lshlrev_b32 v4, 4, v2
    v_add_u32 v4, s39, v4
    v_mul_u32_u24 v4, 1280, v4
    v_lshl_add_u32 v4, v3, 1, v4
    s_mul_i32 s40, s3, 320
    v_add_u32 v4, s40, v4
    v_add_u32 v10, 0, v4
    v_add_u32 v11, 5120, v4
    v_add_u32 v12, 10240, v4
    v_add_u32 v13, 15360, v4
    v_add_u32 v14, 1280, v4
    v_add_u32 v15, 6400, v4
    v_add_u32 v16, 11520, v4
    v_add_u32 v17, 16640, v4
    s_mul_i32 s40, s3, 10
    s_lshl_b32 s40, s40, 7
    s_add_u32 s40, s40, s36
    s_lshl_b32 s40, s40, 10
    s_add_u32 s40, s40, 16777216
    v_lshlrev_b32 v5, 4, v1
    buffer_load_ushort v30, v10, s[24:27], 0 offen offset:0
    buffer_load_ushort v31, v11, s[24:27], 0 offen offset:0
    buffer_load_ushort v32, v12, s[24:27], 0 offen offset:0
    buffer_load_ushort v33, v13, s[24:27], 0 offen offset:0
    buffer_load_ushort v34, v14, s[24:27], 0 offen offset:0
    buffer_load_ushort v35, v15, s[24:27], 0 offen offset:0
    buffer_load_ushort v36, v16, s[24:27], 0 offen offset:0
    buffer_load_ushort v37, v17, s[24:27], 0 offen offset:0
    s_waitcnt vmcnt(0)
    v_lshl_or_b32 v20, v31, 16, v30
    v_lshl_or_b32 v21, v33, 16, v32
    v_lshl_or_b32 v22, v35, 16, v34
    v_lshl_or_b32 v23, v37, 16, v36
    buffer_store_dwordx4 v[20:23], v5, s[32:35], s40 offen
    s_add_u32 s40, s40, 131072
    buffer_load_ushort v30, v10, s[24:27], 0 offen offset:32
    buffer_load_ushort v31, v11, s[24:27], 0 offen offset:32
    buffer_load_ushort v32, v12, s[24:27], 0 offen offset:32
    buffer_load_ushort v33, v13, s[24:27], 0 offen offset:32
    buffer_load_ushort v34, v14, s[24:27], 0 offen offset:32
    buffer_load_ushort v35, v15, s[24:27], 0 offen offset:32
    buffer_load_ushort v36, v16, s[24:27], 0 offen offset:32
    buffer_load_ushort v37, v17, s[24:27], 0 offen offset:32
    s_waitcnt vmcnt(0)
    v_lshl_or_b32 v24, v31, 16, v30
    v_lshl_or_b32 v25, v33, 16, v32
    v_lshl_or_b32 v26, v35, 16, v34
    v_lshl_or_b32 v27, v37, 16, v36
    buffer_store_dwordx4 v[24:27], v5, s[32:35], s40 offen
    s_add_u32 s40, s40, 131072
    buffer_load_ushort v30, v10, s[24:27], 0 offen offset:64
    buffer_load_ushort v31, v11, s[24:27], 0 offen offset:64
    buffer_load_ushort v32, v12, s[24:27], 0 offen offset:64
    buffer_load_ushort v33, v13, s[24:27], 0 offen offset:64
    buffer_load_ushort v34, v14, s[24:27], 0 offen offset:64
    buffer_load_ushort v35, v15, s[24:27], 0 offen offset:64
    buffer_load_ushort v36, v16, s[24:27], 0 offen offset:64
    buffer_load_ushort v37, v17, s[24:27], 0 offen offset:64
    s_waitcnt vmcnt(0)
    v_lshl_or_b32 v20, v31, 16, v30
    v_lshl_or_b32 v21, v33, 16, v32
    v_lshl_or_b32 v22, v35, 16, v34
    v_lshl_or_b32 v23, v37, 16, v36
    buffer_store_dwordx4 v[20:23], v5, s[32:35], s40 offen
    s_add_u32 s40, s40, 131072
    buffer_load_ushort v30, v10, s[24:27], 0 offen offset:96
    buffer_load_ushort v31, v11, s[24:27], 0 offen offset:96
    buffer_load_ushort v32, v12, s[24:27], 0 offen offset:96
    buffer_load_ushort v33, v13, s[24:27], 0 offen offset:96
    buffer_load_ushort v34, v14, s[24:27], 0 offen offset:96
    buffer_load_ushort v35, v15, s[24:27], 0 offen offset:96
    buffer_load_ushort v36, v16, s[24:27], 0 offen offset:96
    buffer_load_ushort v37, v17, s[24:27], 0 offen offset:96
    s_waitcnt vmcnt(0)
    v_lshl_or_b32 v24, v31, 16, v30
    v_lshl_or_b32 v25, v33, 16, v32
    v_lshl_or_b32 v26, v35, 16, v34
    v_lshl_or_b32 v27, v37, 16, v36
    buffer_store_dwordx4 v[24:27], v5, s[32:35], s40 offen
    s_add_u32 s40, s40, 131072
    buffer_load_ushort v30, v10, s[24:27], 0 offen offset:128
    buffer_load_ushort v31, v11, s[24:27], 0 offen offset:128
    buffer_load_ushort v32, v12, s[24:27], 0 offen offset:128
    buffer_load_ushort v33, v13, s[24:27], 0 offen offset:128
    buffer_load_ushort v34, v14, s[24:27], 0 offen offset:128
    buffer_load_ushort v35, v15, s[24:27], 0 offen offset:128
    buffer_load_ushort v36, v16, s[24:27], 0 offen offset:128
    buffer_load_ushort v37, v17, s[24:27], 0 offen offset:128
    s_waitcnt vmcnt(0)
    v_lshl_or_b32 v20, v31, 16, v30
    v_lshl_or_b32 v21, v33, 16, v32
    v_lshl_or_b32 v22, v35, 16, v34
    v_lshl_or_b32 v23, v37, 16, v36
    buffer_store_dwordx4 v[20:23], v5, s[32:35], s40 offen
    s_add_u32 s40, s40, 131072
    buffer_load_ushort v30, v10, s[24:27], 0 offen offset:160
    buffer_load_ushort v31, v11, s[24:27], 0 offen offset:160
    buffer_load_ushort v32, v12, s[24:27], 0 offen offset:160
    buffer_load_ushort v33, v13, s[24:27], 0 offen offset:160
    buffer_load_ushort v34, v14, s[24:27], 0 offen offset:160
    buffer_load_ushort v35, v15, s[24:27], 0 offen offset:160
    buffer_load_ushort v36, v16, s[24:27], 0 offen offset:160
    buffer_load_ushort v37, v17, s[24:27], 0 offen offset:160
    s_waitcnt vmcnt(0)
    v_lshl_or_b32 v24, v31, 16, v30
    v_lshl_or_b32 v25, v33, 16, v32
    v_lshl_or_b32 v26, v35, 16, v34
    v_lshl_or_b32 v27, v37, 16, v36
    buffer_store_dwordx4 v[24:27], v5, s[32:35], s40 offen
    s_add_u32 s40, s40, 131072
    buffer_load_ushort v30, v10, s[24:27], 0 offen offset:192
    buffer_load_ushort v31, v11, s[24:27], 0 offen offset:192
    buffer_load_ushort v32, v12, s[24:27], 0 offen offset:192
    buffer_load_ushort v33, v13, s[24:27], 0 offen offset:192
    buffer_load_ushort v34, v14, s[24:27], 0 offen offset:192
    buffer_load_ushort v35, v15, s[24:27], 0 offen offset:192
    buffer_load_ushort v36, v16, s[24:27], 0 offen offset:192
    buffer_load_ushort v37, v17, s[24:27], 0 offen offset:192
    s_waitcnt vmcnt(0)
    v_lshl_or_b32 v20, v31, 16, v30
    v_lshl_or_b32 v21, v33, 16, v32
    v_lshl_or_b32 v22, v35, 16, v34
    v_lshl_or_b32 v23, v37, 16, v36
    buffer_store_dwordx4 v[20:23], v5, s[32:35], s40 offen
    s_add_u32 s40, s40, 131072
    buffer_load_ushort v30, v10, s[24:27], 0 offen offset:224
    buffer_load_ushort v31, v11, s[24:27], 0 offen offset:224
    buffer_load_ushort v32, v12, s[24:27], 0 offen offset:224
    buffer_load_ushort v33, v13, s[24:27], 0 offen offset:224
    buffer_load_ushort v34, v14, s[24:27], 0 offen offset:224
    buffer_load_ushort v35, v15, s[24:27], 0 offen offset:224
    buffer_load_ushort v36, v16, s[24:27], 0 offen offset:224
    buffer_load_ushort v37, v17, s[24:27], 0 offen offset:224
    s_waitcnt vmcnt(0)
    v_lshl_or_b32 v24, v31, 16, v30
    v_lshl_or_b32 v25, v33, 16, v32
    v_lshl_or_b32 v26, v35, 16, v34
    v_lshl_or_b32 v27, v37, 16, v36
    buffer_store_dwordx4 v[24:27], v5, s[32:35], s40 offen
    s_add_u32 s40, s40, 131072
    buffer_load_ushort v30, v10, s[24:27], 0 offen offset:256
    buffer_load_ushort v31, v11, s[24:27], 0 offen offset:256
    buffer_load_ushort v32, v12, s[24:27], 0 offen offset:256
    buffer_load_ushort v33, v13, s[24:27], 0 offen offset:256
    buffer_load_ushort v34, v14, s[24:27], 0 offen offset:256
    buffer_load_ushort v35, v15, s[24:27], 0 offen offset:256
    buffer_load_ushort v36, v16, s[24:27], 0 offen offset:256
    buffer_load_ushort v37, v17, s[24:27], 0 offen offset:256
    s_waitcnt vmcnt(0)
    v_lshl_or_b32 v20, v31, 16, v30
    v_lshl_or_b32 v21, v33, 16, v32
    v_lshl_or_b32 v22, v35, 16, v34
    v_lshl_or_b32 v23, v37, 16, v36
    buffer_store_dwordx4 v[20:23], v5, s[32:35], s40 offen
    s_add_u32 s40, s40, 131072
    buffer_load_ushort v30, v10, s[24:27], 0 offen offset:288
    buffer_load_ushort v31, v11, s[24:27], 0 offen offset:288
    buffer_load_ushort v32, v12, s[24:27], 0 offen offset:288
    buffer_load_ushort v33, v13, s[24:27], 0 offen offset:288
    buffer_load_ushort v34, v14, s[24:27], 0 offen offset:288
    buffer_load_ushort v35, v15, s[24:27], 0 offen offset:288
    buffer_load_ushort v36, v16, s[24:27], 0 offen offset:288
    buffer_load_ushort v37, v17, s[24:27], 0 offen offset:288
    s_waitcnt vmcnt(0)
    v_lshl_or_b32 v24, v31, 16, v30
    v_lshl_or_b32 v25, v33, 16, v32
    v_lshl_or_b32 v26, v35, 16, v34
    v_lshl_or_b32 v27, v37, 16, v36
    buffer_store_dwordx4 v[24:27], v5, s[32:35], s40 offen
    s_add_u32 s40, s40, 131072
    s_nop 2
    s_endpgm
prep_pq:
    s_load_dwordx2 s[4:5], s[0:1], 16
    s_load_dwordx2 s[6:7], s[0:1], 24
    s_load_dwordx2 s[8:9], s[0:1], 32
    s_sub_u32 s36, s2, 705
    s_mul_i32 s37, s36, 410
    s_lshr_b32 s37, s37, 16
    s_mul_i32 s38, s37, 160
    s_sub_u32 s38, s36, s38
    s_mul_i32 s39, s38, 13108
    s_lshr_b32 s39, s39, 16
    s_mul_i32 s40, s39, 5
    s_sub_u32 s40, s38, s40
    s_waitcnt lgkmcnt(0)
    s_cmp_eq_u32 s37, 1
    s_cselect_b32 s4, s6, s4
    s_cselect_b32 s5, s7, s5
    s_cmp_eq_u32 s37, 2
    s_cselect_b32 s4, s8, s4
    s_cselect_b32 s5, s9, s5
    s_mov_b32 s24, s4
    s_and_b32 s25, s5, 0xffff
    s_mov_b32 s26, 5242880
    s_mov_b32 s27, 0x00020000
    v_lshrrev_b32 v2, 4, v1
    v_and_b32 v3, 15, v1
    s_lshr_b32 s41, s3, 1
    s_lshl_b32 s41, s41, 7
    s_and_b32 s42, s3, 1
    s_lshl_b32 s42, s42, 2
    s_add_u32 s41, s41, s42
    s_lshl_b32 s42, s39, 8
    s_add_u32 s41, s41, s42
    s_lshl_b32 s42, s40, 20
    s_add_u32 s41, s41, s42
    v_lshlrev_b32 v4, 15, v2
    v_lshl_add_u32 v4, v3, 3, v4
    v_add_u32 v4, s41, v4
    s_mov_b32 s46, 0x05040100
    s_mov_b32 s47, 0x07060302
    s_lshl_b32 s42, s37, 5
    s_add_u32 s42, s42, s39
    s_lshl_b32 s42, s42, 2
    s_add_u32 s42, s42, s3
    s_mul_i32 s42, s42, 20
    s_lshl_b32 s43, s40, 2
    s_add_u32 s42, s42, s43
    s_lshl_b32 s42, s42, 11
    s_add_u32 s42, s42, 201326592
    v_lshlrev_b32 v5, 4, v1
    s_mov_b32 s43, 0
    buffer_load_dword v10, v4, s[24:27], s43 offen
    s_mov_b32 s43, 8192
    buffer_load_dword v11, v4, s[24:27], s43 offen
    s_mov_b32 s43, 16384
    buffer_load_dword v12, v4, s[24:27], s43 offen
    s_mov_b32 s43, 24576
    buffer_load_dword v13, v4, s[24:27], s43 offen
    s_mov_b32 s43, 131072
    buffer_load_dword v14, v4, s[24:27], s43 offen
    s_mov_b32 s43, 139264
    buffer_load_dword v15, v4, s[24:27], s43 offen
    s_mov_b32 s43, 147456
    buffer_load_dword v16, v4, s[24:27], s43 offen
    s_mov_b32 s43, 155648
    buffer_load_dword v17, v4, s[24:27], s43 offen
    s_mov_b32 s43, 262144
    buffer_load_dword v18, v4, s[24:27], s43 offen
    s_mov_b32 s43, 270336
    buffer_load_dword v19, v4, s[24:27], s43 offen
    s_mov_b32 s43, 278528
    buffer_load_dword v20, v4, s[24:27], s43 offen
    s_mov_b32 s43, 286720
    buffer_load_dword v21, v4, s[24:27], s43 offen
    s_mov_b32 s43, 393216
    buffer_load_dword v22, v4, s[24:27], s43 offen
    s_mov_b32 s43, 401408
    buffer_load_dword v23, v4, s[24:27], s43 offen
    s_mov_b32 s43, 409600
    buffer_load_dword v24, v4, s[24:27], s43 offen
    s_mov_b32 s43, 417792
    buffer_load_dword v25, v4, s[24:27], s43 offen
    s_mov_b32 s43, 524288
    buffer_load_dword v26, v4, s[24:27], s43 offen
    s_mov_b32 s43, 532480
    buffer_load_dword v27, v4, s[24:27], s43 offen
    s_mov_b32 s43, 540672
    buffer_load_dword v28, v4, s[24:27], s43 offen
    s_mov_b32 s43, 548864
    buffer_load_dword v29, v4, s[24:27], s43 offen
    s_mov_b32 s43, 655360
    buffer_load_dword v30, v4, s[24:27], s43 offen
    s_mov_b32 s43, 663552
    buffer_load_dword v31, v4, s[24:27], s43 offen
    s_mov_b32 s43, 671744
    buffer_load_dword v32, v4, s[24:27], s43 offen
    s_mov_b32 s43, 679936
    buffer_load_dword v33, v4, s[24:27], s43 offen
    s_mov_b32 s43, 786432
    buffer_load_dword v34, v4, s[24:27], s43 offen
    s_mov_b32 s43, 794624
    buffer_load_dword v35, v4, s[24:27], s43 offen
    s_mov_b32 s43, 802816
    buffer_load_dword v36, v4, s[24:27], s43 offen
    s_mov_b32 s43, 811008
    buffer_load_dword v37, v4, s[24:27], s43 offen
    s_mov_b32 s43, 917504
    buffer_load_dword v38, v4, s[24:27], s43 offen
    s_mov_b32 s43, 925696
    buffer_load_dword v39, v4, s[24:27], s43 offen
    s_mov_b32 s43, 933888
    buffer_load_dword v40, v4, s[24:27], s43 offen
    s_mov_b32 s43, 942080
    buffer_load_dword v41, v4, s[24:27], s43 offen
    s_waitcnt vmcnt(24)
    v_perm_b32 v44, v11, v10, s46
    v_perm_b32 v45, v13, v12, s46
    v_perm_b32 v46, v15, v14, s46
    v_perm_b32 v47, v17, v16, s46
    v_perm_b32 v48, v11, v10, s47
    v_perm_b32 v49, v13, v12, s47
    v_perm_b32 v50, v15, v14, s47
    v_perm_b32 v51, v17, v16, s47
    buffer_store_dwordx4 v[44:47], v5, s[32:35], s42 offen offset:0
    buffer_store_dwordx4 v[48:51], v5, s[32:35], s42 offen offset:1024
    s_waitcnt vmcnt(18)
    v_perm_b32 v52, v19, v18, s46
    v_perm_b32 v53, v21, v20, s46
    v_perm_b32 v54, v23, v22, s46
    v_perm_b32 v55, v25, v24, s46
    v_perm_b32 v56, v19, v18, s47
    v_perm_b32 v57, v21, v20, s47
    v_perm_b32 v58, v23, v22, s47
    v_perm_b32 v59, v25, v24, s47
    buffer_store_dwordx4 v[52:55], v5, s[32:35], s42 offen offset:2048
    buffer_store_dwordx4 v[56:59], v5, s[32:35], s42 offen offset:3072
    s_add_u32 s42, s42, 4096
    s_waitcnt vmcnt(12)
    v_perm_b32 v44, v27, v26, s46
    v_perm_b32 v45, v29, v28, s46
    v_perm_b32 v46, v31, v30, s46
    v_perm_b32 v47, v33, v32, s46
    v_perm_b32 v48, v27, v26, s47
    v_perm_b32 v49, v29, v28, s47
    v_perm_b32 v50, v31, v30, s47
    v_perm_b32 v51, v33, v32, s47
    buffer_store_dwordx4 v[44:47], v5, s[32:35], s42 offen offset:0
    buffer_store_dwordx4 v[48:51], v5, s[32:35], s42 offen offset:1024
    s_waitcnt vmcnt(6)
    v_perm_b32 v52, v35, v34, s46
    v_perm_b32 v53, v37, v36, s46
    v_perm_b32 v54, v39, v38, s46
    v_perm_b32 v55, v41, v40, s46
    v_perm_b32 v56, v35, v34, s47
    v_perm_b32 v57, v37, v36, s47
    v_perm_b32 v58, v39, v38, s47
    v_perm_b32 v59, v41, v40, s47
    buffer_store_dwordx4 v[52:55], v5, s[32:35], s42 offen offset:2048
    buffer_store_dwordx4 v[56:59], v5, s[32:35], s42 offen offset:3072
    s_nop 2
prep_done:
    s_endpgm
.globl chain_kernel
.p2align 8
.type chain_kernel,@function
chain_kernel:
    s_cmp_ge_u32 s2, 243
    s_cbranch_scc1 ch_done
    s_cmp_ge_u32 s2, 72
    s_cbranch_scc1 ch_gemm
    s_load_dwordx2 s[4:5], s[0:1], 16
    s_load_dwordx2 s[6:7], s[0:1], 24
    s_load_dwordx2 s[8:9], s[0:1], 32
    s_load_dwordx2 s[12:13], s[0:1], 112
    v_and_b32 v1, 63, v0
    v_lshrrev_b32 v2, 6, v0
    s_nop 0
    v_readfirstlane_b32 s3, v2
    v_lshrrev_b32 v2, 4, v1
    v_and_b32 v3, 15, v1
    s_waitcnt lgkmcnt(0)
    s_mov_b32 s20, s4
    s_and_b32 s21, s5, 0xffff
    s_mov_b32 s22, 5242880
    s_mov_b32 s23, 0x00020000
    s_mov_b32 s24, s6
    s_and_b32 s25, s7, 0xffff
    s_mov_b32 s26, 5242880
    s_mov_b32 s27, 0x00020000
    s_mov_b32 s28, s8
    s_and_b32 s29, s9, 0xffff
    s_mov_b32 s30, 5242880
    s_mov_b32 s31, 0x00020000
    s_mov_b32 s32, s12
    s_and_b32 s33, s13, 0xffff
    s_mov_b32 s34, 268435456
    s_mov_b32 s35, 0x00020000
    s_mov_b32 s40, 0
    s_cmp_ge_u32 s2, 32
    s_cbranch_scc1 ch_red
    s_lshr_b32 s36, s3, 1
    s_lshl_b32 s36, s36, 7
    s_and_b32 s37, s3, 1
    s_lshl_b32 s37, s37, 2
    s_add_u32 s36, s36, s37
    s_lshl_b32 s37, s2, 8
    s_add_u32 s36, s36, s37
    v_lshlrev_b32 v11, 15, v2
    v_lshl_add_u32 v11, v3, 3, v11
    v_add_u32 v11, s36, v11
    s_mov_b32 s50, 0x05040100
    s_mov_b32 s51, 0x07060302
    v_lshlrev_b32 v4, 4, v1
    s_mul_i32 s37, s3, 31744
    s_add_u32 s37, s37, 32768
    v_add_u32 v8, s37, v4
    s_mov_b32 s47, 0
    buffer_load_dword v12, v11, s[20:23], s47 offen
    s_mov_b32 s47, 8192
    buffer_load_dword v13, v11, s[20:23], s47 offen
    s_mov_b32 s47, 16384
    buffer_load_dword v14, v11, s[20:23], s47 offen
    s_mov_b32 s47, 24576
    buffer_load_dword v15, v11, s[20:23], s47 offen
    s_mov_b32 s47, 131072
    buffer_load_dword v16, v11, s[20:23], s47 offen
    s_mov_b32 s47, 139264
    buffer_load_dword v17, v11, s[20:23], s47 offen
    s_mov_b32 s47, 147456
    buffer_load_dword v18, v11, s[20:23], s47 offen
    s_mov_b32 s47, 155648
    buffer_load_dword v19, v11, s[20:23], s47 offen
    s_mov_b32 s47, 262144
    buffer_load_dword v20, v11, s[20:23], s47 offen
    s_mov_b32 s47, 270336
    buffer_load_dword v21, v11, s[20:23], s47 offen
    s_mov_b32 s47, 278528
    buffer_load_dword v22, v11, s[20:23], s47 offen
    s_mov_b32 s47, 286720
    buffer_load_dword v23, v11, s[20:23], s47 offen
    s_mov_b32 s47, 393216
    buffer_load_dword v24, v11, s[20:23], s47 offen
    s_mov_b32 s47, 401408
    buffer_load_dword v25, v11, s[20:23], s47 offen
    s_mov_b32 s47, 409600
    buffer_load_dword v26, v11, s[20:23], s47 offen
    s_mov_b32 s47, 417792
    buffer_load_dword v27, v11, s[20:23], s47 offen
    s_mov_b32 s47, 524288
    buffer_load_dword v28, v11, s[20:23], s47 offen
    s_mov_b32 s47, 532480
    buffer_load_dword v29, v11, s[20:23], s47 offen
    s_mov_b32 s47, 540672
    buffer_load_dword v30, v11, s[20:23], s47 offen
    s_mov_b32 s47, 548864
    buffer_load_dword v31, v11, s[20:23], s47 offen
    s_mov_b32 s47, 655360
    buffer_load_dword v32, v11, s[20:23], s47 offen
    s_mov_b32 s47, 663552
    buffer_load_dword v33, v11, s[20:23], s47 offen
    s_mov_b32 s47, 671744
    buffer_load_dword v34, v11, s[20:23], s47 offen
    s_mov_b32 s47, 679936
    buffer_load_dword v35, v11, s[20:23], s47 offen
    s_mov_b32 s47, 786432
    buffer_load_dword v36, v11, s[20:23], s47 offen
    s_mov_b32 s47, 794624
    buffer_load_dword v37, v11, s[20:23], s47 offen
    s_mov_b32 s47, 802816
    buffer_load_dword v38, v11, s[20:23], s47 offen
    s_mov_b32 s47, 811008
    buffer_load_dword v39, v11, s[20:23], s47 offen
    s_mov_b32 s47, 917504
    buffer_load_dword v40, v11, s[20:23], s47 offen
    s_mov_b32 s47, 925696
    buffer_load_dword v41, v11, s[20:23], s47 offen
    s_mov_b32 s47, 933888
    buffer_load_dword v42, v11, s[20:23], s47 offen
    s_mov_b32 s47, 942080
    buffer_load_dword v43, v11, s[20:23], s47 offen
    s_mov_b32 s47, 1048576
    buffer_load_dword v44, v11, s[20:23], s47 offen
    s_mov_b32 s47, 1056768
    buffer_load_dword v45, v11, s[20:23], s47 offen
    s_mov_b32 s47, 1064960
    buffer_load_dword v46, v11, s[20:23], s47 offen
    s_mov_b32 s47, 1073152
    buffer_load_dword v47, v11, s[20:23], s47 offen
    s_mov_b32 s47, 1179648
    buffer_load_dword v48, v11, s[20:23], s47 offen
    s_mov_b32 s47, 1187840
    buffer_load_dword v49, v11, s[20:23], s47 offen
    s_mov_b32 s47, 1196032
    buffer_load_dword v50, v11, s[20:23], s47 offen
    s_mov_b32 s47, 1204224
    buffer_load_dword v51, v11, s[20:23], s47 offen
    s_mov_b32 s47, 1310720
    buffer_load_dword v52, v11, s[20:23], s47 offen
    s_mov_b32 s47, 1318912
    buffer_load_dword v53, v11, s[20:23], s47 offen
    s_mov_b32 s47, 1327104
    buffer_load_dword v54, v11, s[20:23], s47 offen
    s_mov_b32 s47, 1335296
    buffer_load_dword v55, v11, s[20:23], s47 offen
    s_mov_b32 s47, 1441792
    buffer_load_dword v56, v11, s[20:23], s47 offen
    s_mov_b32 s47, 1449984
    buffer_load_dword v57, v11, s[20:23], s47 offen
    s_mov_b32 s47, 1458176
    buffer_load_dword v58, v11, s[20:23], s47 offen
    s_mov_b32 s47, 1466368
    buffer_load_dword v59, v11, s[20:23], s47 offen
    s_mov_b32 s47, 1572864
    buffer_load_dword v60, v11, s[20:23], s47 offen
    s_mov_b32 s47, 1581056
    buffer_load_dword v61, v11, s[20:23], s47 offen
    s_mov_b32 s47, 1589248
    buffer_load_dword v62, v11, s[20:23], s47 offen
    s_mov_b32 s47, 1597440
    buffer_load_dword v63, v11, s[20:23], s47 offen
    s_mov_b32 s47, 1703936
    buffer_load_dword v64, v11, s[20:23], s47 offen
    s_mov_b32 s47, 1712128
    buffer_load_dword v65, v11, s[20:23], s47 offen
    s_mov_b32 s47, 1720320
    buffer_load_dword v66, v11, s[20:23], s47 offen
    s_mov_b32 s47, 1728512
    buffer_load_dword v67, v11, s[20:23], s47 offen
    s_waitcnt vmcnt(48)
    v_perm_b32 v100, v13, v12, s50
    v_accvgpr_write_b32 a0, v100
    v_perm_b32 v100, v15, v14, s50
    v_accvgpr_write_b32 a1, v100
    v_perm_b32 v100, v17, v16, s50
    v_accvgpr_write_b32 a2, v100
    v_perm_b32 v100, v19, v18, s50
    v_accvgpr_write_b32 a3, v100
    v_perm_b32 v100, v13, v12, s51
    v_accvgpr_write_b32 a4, v100
    v_perm_b32 v100, v15, v14, s51
    v_accvgpr_write_b32 a5, v100
    v_perm_b32 v100, v17, v16, s51
    v_accvgpr_write_b32 a6, v100
    v_perm_b32 v100, v19, v18, s51
    v_accvgpr_write_b32 a7, v100
    s_mov_b32 s47, 1835008
    buffer_load_dword v68, v11, s[20:23], s47 offen
    s_mov_b32 s47, 1843200
    buffer_load_dword v69, v11, s[20:23], s47 offen
    s_mov_b32 s47, 1851392
    buffer_load_dword v70, v11, s[20:23], s47 offen
    s_mov_b32 s47, 1859584
    buffer_load_dword v71, v11, s[20:23], s47 offen
    s_mov_b32 s47, 1966080
    buffer_load_dword v72, v11, s[20:23], s47 offen
    s_mov_b32 s47, 1974272
    buffer_load_dword v73, v11, s[20:23], s47 offen
    s_mov_b32 s47, 1982464
    buffer_load_dword v74, v11, s[20:23], s47 offen
    s_mov_b32 s47, 1990656
    buffer_load_dword v75, v11, s[20:23], s47 offen
    s_waitcnt vmcnt(48)
    v_perm_b32 v100, v21, v20, s50
    v_accvgpr_write_b32 a8, v100
    v_perm_b32 v100, v23, v22, s50
    v_accvgpr_write_b32 a9, v100
    v_perm_b32 v100, v25, v24, s50
    v_accvgpr_write_b32 a10, v100
    v_perm_b32 v100, v27, v26, s50
    v_accvgpr_write_b32 a11, v100
    v_perm_b32 v100, v21, v20, s51
    v_accvgpr_write_b32 a12, v100
    v_perm_b32 v100, v23, v22, s51
    v_accvgpr_write_b32 a13, v100
    v_perm_b32 v100, v25, v24, s51
    v_accvgpr_write_b32 a14, v100
    v_perm_b32 v100, v27, v26, s51
    v_accvgpr_write_b32 a15, v100
    s_mov_b32 s47, 2097152
    buffer_load_dword v12, v11, s[20:23], s47 offen
    s_mov_b32 s47, 2105344
    buffer_load_dword v13, v11, s[20:23], s47 offen
    s_mov_b32 s47, 2113536
    buffer_load_dword v14, v11, s[20:23], s47 offen
    s_mov_b32 s47, 2121728
    buffer_load_dword v15, v11, s[20:23], s47 offen
    s_mov_b32 s47, 2228224
    buffer_load_dword v16, v11, s[20:23], s47 offen
    s_mov_b32 s47, 2236416
    buffer_load_dword v17, v11, s[20:23], s47 offen
    s_mov_b32 s47, 2244608
    buffer_load_dword v18, v11, s[20:23], s47 offen
    s_mov_b32 s47, 2252800
    buffer_load_dword v19, v11, s[20:23], s47 offen
    s_waitcnt vmcnt(48)
    v_perm_b32 v100, v29, v28, s50
    v_accvgpr_write_b32 a16, v100
    v_perm_b32 v100, v31, v30, s50
    v_accvgpr_write_b32 a17, v100
    v_perm_b32 v100, v33, v32, s50
    v_accvgpr_write_b32 a18, v100
    v_perm_b32 v100, v35, v34, s50
    v_accvgpr_write_b32 a19, v100
    v_perm_b32 v100, v29, v28, s51
    v_accvgpr_write_b32 a20, v100
    v_perm_b32 v100, v31, v30, s51
    v_accvgpr_write_b32 a21, v100
    v_perm_b32 v100, v33, v32, s51
    v_accvgpr_write_b32 a22, v100
    v_perm_b32 v100, v35, v34, s51
    v_accvgpr_write_b32 a23, v100
    s_mov_b32 s47, 2359296
    buffer_load_dword v20, v11, s[20:23], s47 offen
    s_mov_b32 s47, 2367488
    buffer_load_dword v21, v11, s[20:23], s47 offen
    s_mov_b32 s47, 2375680
    buffer_load_dword v22, v11, s[20:23], s47 offen
    s_mov_b32 s47, 2383872
    buffer_load_dword v23, v11, s[20:23], s47 offen
    s_mov_b32 s47, 2490368
    buffer_load_dword v24, v11, s[20:23], s47 offen
    s_mov_b32 s47, 2498560
    buffer_load_dword v25, v11, s[20:23], s47 offen
    s_mov_b32 s47, 2506752
    buffer_load_dword v26, v11, s[20:23], s47 offen
    s_mov_b32 s47, 2514944
    buffer_load_dword v27, v11, s[20:23], s47 offen
    s_waitcnt vmcnt(48)
    v_perm_b32 v100, v37, v36, s50
    v_accvgpr_write_b32 a24, v100
    v_perm_b32 v100, v39, v38, s50
    v_accvgpr_write_b32 a25, v100
    v_perm_b32 v100, v41, v40, s50
    v_accvgpr_write_b32 a26, v100
    v_perm_b32 v100, v43, v42, s50
    v_accvgpr_write_b32 a27, v100
    v_perm_b32 v100, v37, v36, s51
    v_accvgpr_write_b32 a28, v100
    v_perm_b32 v100, v39, v38, s51
    v_accvgpr_write_b32 a29, v100
    v_perm_b32 v100, v41, v40, s51
    v_accvgpr_write_b32 a30, v100
    v_perm_b32 v100, v43, v42, s51
    v_accvgpr_write_b32 a31, v100
    s_mov_b32 s47, 2621440
    buffer_load_dword v28, v11, s[20:23], s47 offen
    s_mov_b32 s47, 2629632
    buffer_load_dword v29, v11, s[20:23], s47 offen
    s_mov_b32 s47, 2637824
    buffer_load_dword v30, v11, s[20:23], s47 offen
    s_mov_b32 s47, 2646016
    buffer_load_dword v31, v11, s[20:23], s47 offen
    s_mov_b32 s47, 2752512
    buffer_load_dword v32, v11, s[20:23], s47 offen
    s_mov_b32 s47, 2760704
    buffer_load_dword v33, v11, s[20:23], s47 offen
    s_mov_b32 s47, 2768896
    buffer_load_dword v34, v11, s[20:23], s47 offen
    s_mov_b32 s47, 2777088
    buffer_load_dword v35, v11, s[20:23], s47 offen
    s_waitcnt vmcnt(48)
    v_perm_b32 v100, v45, v44, s50
    v_accvgpr_write_b32 a32, v100
    v_perm_b32 v100, v47, v46, s50
    v_accvgpr_write_b32 a33, v100
    v_perm_b32 v100, v49, v48, s50
    v_accvgpr_write_b32 a34, v100
    v_perm_b32 v100, v51, v50, s50
    v_accvgpr_write_b32 a35, v100
    v_perm_b32 v100, v45, v44, s51
    v_accvgpr_write_b32 a36, v100
    v_perm_b32 v100, v47, v46, s51
    v_accvgpr_write_b32 a37, v100
    v_perm_b32 v100, v49, v48, s51
    v_accvgpr_write_b32 a38, v100
    v_perm_b32 v100, v51, v50, s51
    v_accvgpr_write_b32 a39, v100
    s_mov_b32 s47, 2883584
    buffer_load_dword v36, v11, s[20:23], s47 offen
    s_mov_b32 s47, 2891776
    buffer_load_dword v37, v11, s[20:23], s47 offen
    s_mov_b32 s47, 2899968
    buffer_load_dword v38, v11, s[20:23], s47 offen
    s_mov_b32 s47, 2908160
    buffer_load_dword v39, v11, s[20:23], s47 offen
    s_mov_b32 s47, 3014656
    buffer_load_dword v40, v11, s[20:23], s47 offen
    s_mov_b32 s47, 3022848
    buffer_load_dword v41, v11, s[20:23], s47 offen
    s_mov_b32 s47, 3031040
    buffer_load_dword v42, v11, s[20:23], s47 offen
    s_mov_b32 s47, 3039232
    buffer_load_dword v43, v11, s[20:23], s47 offen
    s_waitcnt vmcnt(48)
    v_perm_b32 v100, v53, v52, s50
    v_accvgpr_write_b32 a40, v100
    v_perm_b32 v100, v55, v54, s50
    v_accvgpr_write_b32 a41, v100
    v_perm_b32 v100, v57, v56, s50
    v_accvgpr_write_b32 a42, v100
    v_perm_b32 v100, v59, v58, s50
    v_accvgpr_write_b32 a43, v100
    v_perm_b32 v100, v53, v52, s51
    v_accvgpr_write_b32 a44, v100
    v_perm_b32 v100, v55, v54, s51
    v_accvgpr_write_b32 a45, v100
    v_perm_b32 v100, v57, v56, s51
    v_accvgpr_write_b32 a46, v100
    v_perm_b32 v100, v59, v58, s51
    v_accvgpr_write_b32 a47, v100
    s_mov_b32 s47, 3145728
    buffer_load_dword v44, v11, s[20:23], s47 offen
    s_mov_b32 s47, 3153920
    buffer_load_dword v45, v11, s[20:23], s47 offen
    s_mov_b32 s47, 3162112
    buffer_load_dword v46, v11, s[20:23], s47 offen
    s_mov_b32 s47, 3170304
    buffer_load_dword v47, v11, s[20:23], s47 offen
    s_mov_b32 s47, 3276800
    buffer_load_dword v48, v11, s[20:23], s47 offen
    s_mov_b32 s47, 3284992
    buffer_load_dword v49, v11, s[20:23], s47 offen
    s_mov_b32 s47, 3293184
    buffer_load_dword v50, v11, s[20:23], s47 offen
    s_mov_b32 s47, 3301376
    buffer_load_dword v51, v11, s[20:23], s47 offen
    s_waitcnt vmcnt(48)
    v_perm_b32 v100, v61, v60, s50
    v_accvgpr_write_b32 a48, v100
    v_perm_b32 v100, v63, v62, s50
    v_accvgpr_write_b32 a49, v100
    v_perm_b32 v100, v65, v64, s50
    v_accvgpr_write_b32 a50, v100
    v_perm_b32 v100, v67, v66, s50
    v_accvgpr_write_b32 a51, v100
    v_perm_b32 v100, v61, v60, s51
    v_accvgpr_write_b32 a52, v100
    v_perm_b32 v100, v63, v62, s51
    v_accvgpr_write_b32 a53, v100
    v_perm_b32 v100, v65, v64, s51
    v_accvgpr_write_b32 a54, v100
    v_perm_b32 v100, v67, v66, s51
    v_accvgpr_write_b32 a55, v100
    s_mov_b32 s47, 3407872
    buffer_load_dword v52, v11, s[20:23], s47 offen
    s_mov_b32 s47, 3416064
    buffer_load_dword v53, v11, s[20:23], s47 offen
    s_mov_b32 s47, 3424256
    buffer_load_dword v54, v11, s[20:23], s47 offen
    s_mov_b32 s47, 3432448
    buffer_load_dword v55, v11, s[20:23], s47 offen
    s_mov_b32 s47, 3538944
    buffer_load_dword v56, v11, s[20:23], s47 offen
    s_mov_b32 s47, 3547136
    buffer_load_dword v57, v11, s[20:23], s47 offen
    s_mov_b32 s47, 3555328
    buffer_load_dword v58, v11, s[20:23], s47 offen
    s_mov_b32 s47, 3563520
    buffer_load_dword v59, v11, s[20:23], s47 offen
    s_waitcnt vmcnt(48)
    v_perm_b32 v100, v69, v68, s50
    v_accvgpr_write_b32 a56, v100
    v_perm_b32 v100, v71, v70, s50
    v_accvgpr_write_b32 a57, v100
    v_perm_b32 v100, v73, v72, s50
    v_accvgpr_write_b32 a58, v100
    v_perm_b32 v100, v75, v74, s50
    v_accvgpr_write_b32 a59, v100
    v_perm_b32 v100, v69, v68, s51
    v_accvgpr_write_b32 a60, v100
    v_perm_b32 v100, v71, v70, s51
    v_accvgpr_write_b32 a61, v100
    v_perm_b32 v100, v73, v72, s51
    v_accvgpr_write_b32 a62, v100
    v_perm_b32 v100, v75, v74, s51
    v_accvgpr_write_b32 a63, v100
    s_mov_b32 s47, 3670016
    buffer_load_dword v60, v11, s[20:23], s47 offen
    s_mov_b32 s47, 3678208
    buffer_load_dword v61, v11, s[20:23], s47 offen
    s_mov_b32 s47, 3686400
    buffer_load_dword v62, v11, s[20:23], s47 offen
    s_mov_b32 s47, 3694592
    buffer_load_dword v63, v11, s[20:23], s47 offen
    s_mov_b32 s47, 3801088
    buffer_load_dword v64, v11, s[20:23], s47 offen
    s_mov_b32 s47, 3809280
    buffer_load_dword v65, v11, s[20:23], s47 offen
    s_mov_b32 s47, 3817472
    buffer_load_dword v66, v11, s[20:23], s47 offen
    s_mov_b32 s47, 3825664
    buffer_load_dword v67, v11, s[20:23], s47 offen
    s_waitcnt vmcnt(48)
    v_perm_b32 v100, v13, v12, s50
    v_accvgpr_write_b32 a64, v100
    v_perm_b32 v100, v15, v14, s50
    v_accvgpr_write_b32 a65, v100
    v_perm_b32 v100, v17, v16, s50
    v_accvgpr_write_b32 a66, v100
    v_perm_b32 v100, v19, v18, s50
    v_accvgpr_write_b32 a67, v100
    v_perm_b32 v100, v13, v12, s51
    v_accvgpr_write_b32 a68, v100
    v_perm_b32 v100, v15, v14, s51
    v_accvgpr_write_b32 a69, v100
    v_perm_b32 v100, v17, v16, s51
    v_accvgpr_write_b32 a70, v100
    v_perm_b32 v100, v19, v18, s51
    v_accvgpr_write_b32 a71, v100
    s_mov_b32 s47, 3932160
    buffer_load_dword v68, v11, s[20:23], s47 offen
    s_mov_b32 s47, 3940352
    buffer_load_dword v69, v11, s[20:23], s47 offen
    s_mov_b32 s47, 3948544
    buffer_load_dword v70, v11, s[20:23], s47 offen
    s_mov_b32 s47, 3956736
    buffer_load_dword v71, v11, s[20:23], s47 offen
    s_mov_b32 s47, 4063232
    buffer_load_dword v72, v11, s[20:23], s47 offen
    s_mov_b32 s47, 4071424
    buffer_load_dword v73, v11, s[20:23], s47 offen
    s_mov_b32 s47, 4079616
    buffer_load_dword v74, v11, s[20:23], s47 offen
    s_mov_b32 s47, 4087808
    buffer_load_dword v75, v11, s[20:23], s47 offen
    s_waitcnt vmcnt(48)
    v_perm_b32 v100, v21, v20, s50
    v_accvgpr_write_b32 a72, v100
    v_perm_b32 v100, v23, v22, s50
    v_accvgpr_write_b32 a73, v100
    v_perm_b32 v100, v25, v24, s50
    v_accvgpr_write_b32 a74, v100
    v_perm_b32 v100, v27, v26, s50
    v_accvgpr_write_b32 a75, v100
    v_perm_b32 v100, v21, v20, s51
    v_accvgpr_write_b32 a76, v100
    v_perm_b32 v100, v23, v22, s51
    v_accvgpr_write_b32 a77, v100
    v_perm_b32 v100, v25, v24, s51
    v_accvgpr_write_b32 a78, v100
    v_perm_b32 v100, v27, v26, s51
    v_accvgpr_write_b32 a79, v100
    s_mov_b32 s47, 4194304
    buffer_load_dword v12, v11, s[20:23], s47 offen
    s_mov_b32 s47, 4202496
    buffer_load_dword v13, v11, s[20:23], s47 offen
    s_mov_b32 s47, 4210688
    buffer_load_dword v14, v11, s[20:23], s47 offen
    s_mov_b32 s47, 4218880
    buffer_load_dword v15, v11, s[20:23], s47 offen
    s_mov_b32 s47, 4325376
    buffer_load_dword v16, v11, s[20:23], s47 offen
    s_mov_b32 s47, 4333568
    buffer_load_dword v17, v11, s[20:23], s47 offen
    s_mov_b32 s47, 4341760
    buffer_load_dword v18, v11, s[20:23], s47 offen
    s_mov_b32 s47, 4349952
    buffer_load_dword v19, v11, s[20:23], s47 offen
    s_waitcnt vmcnt(48)
    v_perm_b32 v100, v29, v28, s50
    v_accvgpr_write_b32 a80, v100
    v_perm_b32 v100, v31, v30, s50
    v_accvgpr_write_b32 a81, v100
    v_perm_b32 v100, v33, v32, s50
    v_accvgpr_write_b32 a82, v100
    v_perm_b32 v100, v35, v34, s50
    v_accvgpr_write_b32 a83, v100
    v_perm_b32 v100, v29, v28, s51
    v_accvgpr_write_b32 a84, v100
    v_perm_b32 v100, v31, v30, s51
    v_accvgpr_write_b32 a85, v100
    v_perm_b32 v100, v33, v32, s51
    v_accvgpr_write_b32 a86, v100
    v_perm_b32 v100, v35, v34, s51
    v_accvgpr_write_b32 a87, v100
    s_mov_b32 s47, 4456448
    buffer_load_dword v20, v11, s[20:23], s47 offen
    s_mov_b32 s47, 4464640
    buffer_load_dword v21, v11, s[20:23], s47 offen
    s_mov_b32 s47, 4472832
    buffer_load_dword v22, v11, s[20:23], s47 offen
    s_mov_b32 s47, 4481024
    buffer_load_dword v23, v11, s[20:23], s47 offen
    s_mov_b32 s47, 4587520
    buffer_load_dword v24, v11, s[20:23], s47 offen
    s_mov_b32 s47, 4595712
    buffer_load_dword v25, v11, s[20:23], s47 offen
    s_mov_b32 s47, 4603904
    buffer_load_dword v26, v11, s[20:23], s47 offen
    s_mov_b32 s47, 4612096
    buffer_load_dword v27, v11, s[20:23], s47 offen
    s_waitcnt vmcnt(48)
    v_perm_b32 v100, v37, v36, s50
    v_accvgpr_write_b32 a88, v100
    v_perm_b32 v100, v39, v38, s50
    v_accvgpr_write_b32 a89, v100
    v_perm_b32 v100, v41, v40, s50
    v_accvgpr_write_b32 a90, v100
    v_perm_b32 v100, v43, v42, s50
    v_accvgpr_write_b32 a91, v100
    v_perm_b32 v100, v37, v36, s51
    v_accvgpr_write_b32 a92, v100
    v_perm_b32 v100, v39, v38, s51
    v_accvgpr_write_b32 a93, v100
    v_perm_b32 v100, v41, v40, s51
    v_accvgpr_write_b32 a94, v100
    v_perm_b32 v100, v43, v42, s51
    v_accvgpr_write_b32 a95, v100
    s_mov_b32 s47, 4718592
    buffer_load_dword v28, v11, s[20:23], s47 offen
    s_mov_b32 s47, 4726784
    buffer_load_dword v29, v11, s[20:23], s47 offen
    s_mov_b32 s47, 4734976
    buffer_load_dword v30, v11, s[20:23], s47 offen
    s_mov_b32 s47, 4743168
    buffer_load_dword v31, v11, s[20:23], s47 offen
    s_mov_b32 s47, 4849664
    buffer_load_dword v32, v11, s[20:23], s47 offen
    s_mov_b32 s47, 4857856
    buffer_load_dword v33, v11, s[20:23], s47 offen
    s_mov_b32 s47, 4866048
    buffer_load_dword v34, v11, s[20:23], s47 offen
    s_mov_b32 s47, 4874240
    buffer_load_dword v35, v11, s[20:23], s47 offen
    s_waitcnt vmcnt(48)
    v_perm_b32 v100, v45, v44, s50
    v_accvgpr_write_b32 a96, v100
    v_perm_b32 v100, v47, v46, s50
    v_accvgpr_write_b32 a97, v100
    v_perm_b32 v100, v49, v48, s50
    v_accvgpr_write_b32 a98, v100
    v_perm_b32 v100, v51, v50, s50
    v_accvgpr_write_b32 a99, v100
    v_perm_b32 v100, v45, v44, s51
    v_accvgpr_write_b32 a100, v100
    v_perm_b32 v100, v47, v46, s51
    v_accvgpr_write_b32 a101, v100
    v_perm_b32 v100, v49, v48, s51
    v_accvgpr_write_b32 a102, v100
    v_perm_b32 v100, v51, v50, s51
    v_accvgpr_write_b32 a103, v100
    s_mov_b32 s47, 4980736
    buffer_load_dword v36, v11, s[20:23], s47 offen
    s_mov_b32 s47, 4988928
    buffer_load_dword v37, v11, s[20:23], s47 offen
    s_mov_b32 s47, 4997120
    buffer_load_dword v38, v11, s[20:23], s47 offen
    s_mov_b32 s47, 5005312
    buffer_load_dword v39, v11, s[20:23], s47 offen
    s_mov_b32 s47, 5111808
    buffer_load_dword v40, v11, s[20:23], s47 offen
    s_mov_b32 s47, 5120000
    buffer_load_dword v41, v11, s[20:23], s47 offen
    s_mov_b32 s47, 5128192
    buffer_load_dword v42, v11, s[20:23], s47 offen
    s_mov_b32 s47, 5136384
    buffer_load_dword v43, v11, s[20:23], s47 offen
    s_waitcnt vmcnt(48)
    v_perm_b32 v100, v53, v52, s50
    v_accvgpr_write_b32 a104, v100
    v_perm_b32 v100, v55, v54, s50
    v_accvgpr_write_b32 a105, v100
    v_perm_b32 v100, v57, v56, s50
    v_accvgpr_write_b32 a106, v100
    v_perm_b32 v100, v59, v58, s50
    v_accvgpr_write_b32 a107, v100
    v_perm_b32 v100, v53, v52, s51
    v_accvgpr_write_b32 a108, v100
    v_perm_b32 v100, v55, v54, s51
    v_accvgpr_write_b32 a109, v100
    v_perm_b32 v100, v57, v56, s51
    v_accvgpr_write_b32 a110, v100
    v_perm_b32 v100, v59, v58, s51
    v_accvgpr_write_b32 a111, v100
    s_mov_b32 s47, 0
    buffer_load_dword v44, v11, s[24:27], s47 offen
    s_mov_b32 s47, 8192
    buffer_load_dword v45, v11, s[24:27], s47 offen
    s_mov_b32 s47, 16384
    buffer_load_dword v46, v11, s[24:27], s47 offen
    s_mov_b32 s47, 24576
    buffer_load_dword v47, v11, s[24:27], s47 offen
    s_mov_b32 s47, 131072
    buffer_load_dword v48, v11, s[24:27], s47 offen
    s_mov_b32 s47, 139264
    buffer_load_dword v49, v11, s[24:27], s47 offen
    s_mov_b32 s47, 147456
    buffer_load_dword v50, v11, s[24:27], s47 offen
    s_mov_b32 s47, 155648
    buffer_load_dword v51, v11, s[24:27], s47 offen
    s_waitcnt vmcnt(48)
    v_perm_b32 v100, v61, v60, s50
    v_accvgpr_write_b32 a112, v100
    v_perm_b32 v100, v63, v62, s50
    v_accvgpr_write_b32 a113, v100
    v_perm_b32 v100, v65, v64, s50
    v_accvgpr_write_b32 a114, v100
    v_perm_b32 v100, v67, v66, s50
    v_accvgpr_write_b32 a115, v100
    v_perm_b32 v100, v61, v60, s51
    v_accvgpr_write_b32 a116, v100
    v_perm_b32 v100, v63, v62, s51
    v_accvgpr_write_b32 a117, v100
    v_perm_b32 v100, v65, v64, s51
    v_accvgpr_write_b32 a118, v100
    v_perm_b32 v100, v67, v66, s51
    v_accvgpr_write_b32 a119, v100
    s_mov_b32 s47, 262144
    buffer_load_dword v52, v11, s[24:27], s47 offen
    s_mov_b32 s47, 270336
    buffer_load_dword v53, v11, s[24:27], s47 offen
    s_mov_b32 s47, 278528
    buffer_load_dword v54, v11, s[24:27], s47 offen
    s_mov_b32 s47, 286720
    buffer_load_dword v55, v11, s[24:27], s47 offen
    s_mov_b32 s47, 393216
    buffer_load_dword v56, v11, s[24:27], s47 offen
    s_mov_b32 s47, 401408
    buffer_load_dword v57, v11, s[24:27], s47 offen
    s_mov_b32 s47, 409600
    buffer_load_dword v58, v11, s[24:27], s47 offen
    s_mov_b32 s47, 417792
    buffer_load_dword v59, v11, s[24:27], s47 offen
    s_waitcnt vmcnt(48)
    v_perm_b32 v100, v69, v68, s50
    v_accvgpr_write_b32 a120, v100
    v_perm_b32 v100, v71, v70, s50
    v_accvgpr_write_b32 a121, v100
    v_perm_b32 v100, v73, v72, s50
    v_accvgpr_write_b32 a122, v100
    v_perm_b32 v100, v75, v74, s50
    v_accvgpr_write_b32 a123, v100
    v_perm_b32 v100, v69, v68, s51
    v_accvgpr_write_b32 a124, v100
    v_perm_b32 v100, v71, v70, s51
    v_accvgpr_write_b32 a125, v100
    v_perm_b32 v100, v73, v72, s51
    v_accvgpr_write_b32 a126, v100
    v_perm_b32 v100, v75, v74, s51
    v_accvgpr_write_b32 a127, v100
    s_mov_b32 s47, 524288
    buffer_load_dword v60, v11, s[24:27], s47 offen
    s_mov_b32 s47, 532480
    buffer_load_dword v61, v11, s[24:27], s47 offen
    s_mov_b32 s47, 540672
    buffer_load_dword v62, v11, s[24:27], s47 offen
    s_mov_b32 s47, 548864
    buffer_load_dword v63, v11, s[24:27], s47 offen
    s_mov_b32 s47, 655360
    buffer_load_dword v64, v11, s[24:27], s47 offen
    s_mov_b32 s47, 663552
    buffer_load_dword v65, v11, s[24:27], s47 offen
    s_mov_b32 s47, 671744
    buffer_load_dword v66, v11, s[24:27], s47 offen
    s_mov_b32 s47, 679936
    buffer_load_dword v67, v11, s[24:27], s47 offen
    s_waitcnt vmcnt(48)
    v_perm_b32 v100, v13, v12, s50
    v_accvgpr_write_b32 a128, v100
    v_perm_b32 v100, v15, v14, s50
    v_accvgpr_write_b32 a129, v100
    v_perm_b32 v100, v17, v16, s50
    v_accvgpr_write_b32 a130, v100
    v_perm_b32 v100, v19, v18, s50
    v_accvgpr_write_b32 a131, v100
    v_perm_b32 v100, v13, v12, s51
    v_accvgpr_write_b32 a132, v100
    v_perm_b32 v100, v15, v14, s51
    v_accvgpr_write_b32 a133, v100
    v_perm_b32 v100, v17, v16, s51
    v_accvgpr_write_b32 a134, v100
    v_perm_b32 v100, v19, v18, s51
    v_accvgpr_write_b32 a135, v100
    s_mov_b32 s47, 786432
    buffer_load_dword v68, v11, s[24:27], s47 offen
    s_mov_b32 s47, 794624
    buffer_load_dword v69, v11, s[24:27], s47 offen
    s_mov_b32 s47, 802816
    buffer_load_dword v70, v11, s[24:27], s47 offen
    s_mov_b32 s47, 811008
    buffer_load_dword v71, v11, s[24:27], s47 offen
    s_mov_b32 s47, 917504
    buffer_load_dword v72, v11, s[24:27], s47 offen
    s_mov_b32 s47, 925696
    buffer_load_dword v73, v11, s[24:27], s47 offen
    s_mov_b32 s47, 933888
    buffer_load_dword v74, v11, s[24:27], s47 offen
    s_mov_b32 s47, 942080
    buffer_load_dword v75, v11, s[24:27], s47 offen
    s_waitcnt vmcnt(48)
    v_perm_b32 v100, v21, v20, s50
    v_accvgpr_write_b32 a136, v100
    v_perm_b32 v100, v23, v22, s50
    v_accvgpr_write_b32 a137, v100
    v_perm_b32 v100, v25, v24, s50
    v_accvgpr_write_b32 a138, v100
    v_perm_b32 v100, v27, v26, s50
    v_accvgpr_write_b32 a139, v100
    v_perm_b32 v100, v21, v20, s51
    v_accvgpr_write_b32 a140, v100
    v_perm_b32 v100, v23, v22, s51
    v_accvgpr_write_b32 a141, v100
    v_perm_b32 v100, v25, v24, s51
    v_accvgpr_write_b32 a142, v100
    v_perm_b32 v100, v27, v26, s51
    v_accvgpr_write_b32 a143, v100
    s_mov_b32 s47, 1048576
    buffer_load_dword v12, v11, s[24:27], s47 offen
    s_mov_b32 s47, 1056768
    buffer_load_dword v13, v11, s[24:27], s47 offen
    s_mov_b32 s47, 1064960
    buffer_load_dword v14, v11, s[24:27], s47 offen
    s_mov_b32 s47, 1073152
    buffer_load_dword v15, v11, s[24:27], s47 offen
    s_mov_b32 s47, 1179648
    buffer_load_dword v16, v11, s[24:27], s47 offen
    s_mov_b32 s47, 1187840
    buffer_load_dword v17, v11, s[24:27], s47 offen
    s_mov_b32 s47, 1196032
    buffer_load_dword v18, v11, s[24:27], s47 offen
    s_mov_b32 s47, 1204224
    buffer_load_dword v19, v11, s[24:27], s47 offen
    s_waitcnt vmcnt(48)
    v_perm_b32 v100, v29, v28, s50
    v_accvgpr_write_b32 a144, v100
    v_perm_b32 v100, v31, v30, s50
    v_accvgpr_write_b32 a145, v100
    v_perm_b32 v100, v33, v32, s50
    v_accvgpr_write_b32 a146, v100
    v_perm_b32 v100, v35, v34, s50
    v_accvgpr_write_b32 a147, v100
    v_perm_b32 v100, v29, v28, s51
    v_accvgpr_write_b32 a148, v100
    v_perm_b32 v100, v31, v30, s51
    v_accvgpr_write_b32 a149, v100
    v_perm_b32 v100, v33, v32, s51
    v_accvgpr_write_b32 a150, v100
    v_perm_b32 v100, v35, v34, s51
    v_accvgpr_write_b32 a151, v100
    s_mov_b32 s47, 1310720
    buffer_load_dword v20, v11, s[24:27], s47 offen
    s_mov_b32 s47, 1318912
    buffer_load_dword v21, v11, s[24:27], s47 offen
    s_mov_b32 s47, 1327104
    buffer_load_dword v22, v11, s[24:27], s47 offen
    s_mov_b32 s47, 1335296
    buffer_load_dword v23, v11, s[24:27], s47 offen
    s_mov_b32 s47, 1441792
    buffer_load_dword v24, v11, s[24:27], s47 offen
    s_mov_b32 s47, 1449984
    buffer_load_dword v25, v11, s[24:27], s47 offen
    s_mov_b32 s47, 1458176
    buffer_load_dword v26, v11, s[24:27], s47 offen
    s_mov_b32 s47, 1466368
    buffer_load_dword v27, v11, s[24:27], s47 offen
    s_waitcnt vmcnt(48)
    v_perm_b32 v100, v37, v36, s50
    v_accvgpr_write_b32 a152, v100
    v_perm_b32 v100, v39, v38, s50
    v_accvgpr_write_b32 a153, v100
    v_perm_b32 v100, v41, v40, s50
    v_accvgpr_write_b32 a154, v100
    v_perm_b32 v100, v43, v42, s50
    v_accvgpr_write_b32 a155, v100
    v_perm_b32 v100, v37, v36, s51
    v_accvgpr_write_b32 a156, v100
    v_perm_b32 v100, v39, v38, s51
    v_accvgpr_write_b32 a157, v100
    v_perm_b32 v100, v41, v40, s51
    v_accvgpr_write_b32 a158, v100
    v_perm_b32 v100, v43, v42, s51
    v_accvgpr_write_b32 a159, v100
    s_mov_b32 s47, 1572864
    buffer_load_dword v28, v11, s[24:27], s47 offen
    s_mov_b32 s47, 1581056
    buffer_load_dword v29, v11, s[24:27], s47 offen
    s_mov_b32 s47, 1589248
    buffer_load_dword v30, v11, s[24:27], s47 offen
    s_mov_b32 s47, 1597440
    buffer_load_dword v31, v11, s[24:27], s47 offen
    s_mov_b32 s47, 1703936
    buffer_load_dword v32, v11, s[24:27], s47 offen
    s_mov_b32 s47, 1712128
    buffer_load_dword v33, v11, s[24:27], s47 offen
    s_mov_b32 s47, 1720320
    buffer_load_dword v34, v11, s[24:27], s47 offen
    s_mov_b32 s47, 1728512
    buffer_load_dword v35, v11, s[24:27], s47 offen
    s_waitcnt vmcnt(48)
    v_perm_b32 v100, v45, v44, s50
    v_accvgpr_write_b32 a160, v100
    v_perm_b32 v100, v47, v46, s50
    v_accvgpr_write_b32 a161, v100
    v_perm_b32 v100, v49, v48, s50
    v_accvgpr_write_b32 a162, v100
    v_perm_b32 v100, v51, v50, s50
    v_accvgpr_write_b32 a163, v100
    v_perm_b32 v100, v45, v44, s51
    v_accvgpr_write_b32 a164, v100
    v_perm_b32 v100, v47, v46, s51
    v_accvgpr_write_b32 a165, v100
    v_perm_b32 v100, v49, v48, s51
    v_accvgpr_write_b32 a166, v100
    v_perm_b32 v100, v51, v50, s51
    v_accvgpr_write_b32 a167, v100
    s_mov_b32 s47, 1835008
    buffer_load_dword v36, v11, s[24:27], s47 offen
    s_mov_b32 s47, 1843200
    buffer_load_dword v37, v11, s[24:27], s47 offen
    s_mov_b32 s47, 1851392
    buffer_load_dword v38, v11, s[24:27], s47 offen
    s_mov_b32 s47, 1859584
    buffer_load_dword v39, v11, s[24:27], s47 offen
    s_mov_b32 s47, 1966080
    buffer_load_dword v40, v11, s[24:27], s47 offen
    s_mov_b32 s47, 1974272
    buffer_load_dword v41, v11, s[24:27], s47 offen
    s_mov_b32 s47, 1982464
    buffer_load_dword v42, v11, s[24:27], s47 offen
    s_mov_b32 s47, 1990656
    buffer_load_dword v43, v11, s[24:27], s47 offen
    s_waitcnt vmcnt(48)
    v_perm_b32 v100, v53, v52, s50
    v_accvgpr_write_b32 a168, v100
    v_perm_b32 v100, v55, v54, s50
    v_accvgpr_write_b32 a169, v100
    v_perm_b32 v100, v57, v56, s50
    v_accvgpr_write_b32 a170, v100
    v_perm_b32 v100, v59, v58, s50
    v_accvgpr_write_b32 a171, v100
    v_perm_b32 v100, v53, v52, s51
    v_accvgpr_write_b32 a172, v100
    v_perm_b32 v100, v55, v54, s51
    v_accvgpr_write_b32 a173, v100
    v_perm_b32 v100, v57, v56, s51
    v_accvgpr_write_b32 a174, v100
    v_perm_b32 v100, v59, v58, s51
    v_accvgpr_write_b32 a175, v100
    s_mov_b32 s47, 2097152
    buffer_load_dword v44, v11, s[24:27], s47 offen
    s_mov_b32 s47, 2105344
    buffer_load_dword v45, v11, s[24:27], s47 offen
    s_mov_b32 s47, 2113536
    buffer_load_dword v46, v11, s[24:27], s47 offen
    s_mov_b32 s47, 2121728
    buffer_load_dword v47, v11, s[24:27], s47 offen
    s_mov_b32 s47, 2228224
    buffer_load_dword v48, v11, s[24:27], s47 offen
    s_mov_b32 s47, 2236416
    buffer_load_dword v49, v11, s[24:27], s47 offen
    s_mov_b32 s47, 2244608
    buffer_load_dword v50, v11, s[24:27], s47 offen
    s_mov_b32 s47, 2252800
    buffer_load_dword v51, v11, s[24:27], s47 offen
    s_waitcnt vmcnt(48)
    v_perm_b32 v100, v61, v60, s50
    v_accvgpr_write_b32 a176, v100
    v_perm_b32 v100, v63, v62, s50
    v_accvgpr_write_b32 a177, v100
    v_perm_b32 v100, v65, v64, s50
    v_accvgpr_write_b32 a178, v100
    v_perm_b32 v100, v67, v66, s50
    v_accvgpr_write_b32 a179, v100
    v_perm_b32 v100, v61, v60, s51
    v_accvgpr_write_b32 a180, v100
    v_perm_b32 v100, v63, v62, s51
    v_accvgpr_write_b32 a181, v100
    v_perm_b32 v100, v65, v64, s51
    v_accvgpr_write_b32 a182, v100
    v_perm_b32 v100, v67, v66, s51
    v_accvgpr_write_b32 a183, v100
    s_mov_b32 s47, 2359296
    buffer_load_dword v52, v11, s[24:27], s47 offen
    s_mov_b32 s47, 2367488
    buffer_load_dword v53, v11, s[24:27], s47 offen
    s_mov_b32 s47, 2375680
    buffer_load_dword v54, v11, s[24:27], s47 offen
    s_mov_b32 s47, 2383872
    buffer_load_dword v55, v11, s[24:27], s47 offen
    s_mov_b32 s47, 2490368
    buffer_load_dword v56, v11, s[24:27], s47 offen
    s_mov_b32 s47, 2498560
    buffer_load_dword v57, v11, s[24:27], s47 offen
    s_mov_b32 s47, 2506752
    buffer_load_dword v58, v11, s[24:27], s47 offen
    s_mov_b32 s47, 2514944
    buffer_load_dword v59, v11, s[24:27], s47 offen
    s_waitcnt vmcnt(48)
    v_perm_b32 v100, v69, v68, s50
    v_accvgpr_write_b32 a184, v100
    v_perm_b32 v100, v71, v70, s50
    v_accvgpr_write_b32 a185, v100
    v_perm_b32 v100, v73, v72, s50
    v_accvgpr_write_b32 a186, v100
    v_perm_b32 v100, v75, v74, s50
    v_accvgpr_write_b32 a187, v100
    v_perm_b32 v100, v69, v68, s51
    v_accvgpr_write_b32 a188, v100
    v_perm_b32 v100, v71, v70, s51
    v_accvgpr_write_b32 a189, v100
    v_perm_b32 v100, v73, v72, s51
    v_accvgpr_write_b32 a190, v100
    v_perm_b32 v100, v75, v74, s51
    v_accvgpr_write_b32 a191, v100
    s_mov_b32 s47, 2621440
    buffer_load_dword v60, v11, s[24:27], s47 offen
    s_mov_b32 s47, 2629632
    buffer_load_dword v61, v11, s[24:27], s47 offen
    s_mov_b32 s47, 2637824
    buffer_load_dword v62, v11, s[24:27], s47 offen
    s_mov_b32 s47, 2646016
    buffer_load_dword v63, v11, s[24:27], s47 offen
    s_mov_b32 s47, 2752512
    buffer_load_dword v64, v11, s[24:27], s47 offen
    s_mov_b32 s47, 2760704
    buffer_load_dword v65, v11, s[24:27], s47 offen
    s_mov_b32 s47, 2768896
    buffer_load_dword v66, v11, s[24:27], s47 offen
    s_mov_b32 s47, 2777088
    buffer_load_dword v67, v11, s[24:27], s47 offen
    s_waitcnt vmcnt(48)
    v_perm_b32 v100, v13, v12, s50
    v_accvgpr_write_b32 a192, v100
    v_perm_b32 v100, v15, v14, s50
    v_accvgpr_write_b32 a193, v100
    v_perm_b32 v100, v17, v16, s50
    v_accvgpr_write_b32 a194, v100
    v_perm_b32 v100, v19, v18, s50
    v_accvgpr_write_b32 a195, v100
    v_perm_b32 v100, v13, v12, s51
    v_accvgpr_write_b32 a196, v100
    v_perm_b32 v100, v15, v14, s51
    v_accvgpr_write_b32 a197, v100
    v_perm_b32 v100, v17, v16, s51
    v_accvgpr_write_b32 a198, v100
    v_perm_b32 v100, v19, v18, s51
    v_accvgpr_write_b32 a199, v100
    s_mov_b32 s47, 2883584
    buffer_load_dword v68, v11, s[24:27], s47 offen
    s_mov_b32 s47, 2891776
    buffer_load_dword v69, v11, s[24:27], s47 offen
    s_mov_b32 s47, 2899968
    buffer_load_dword v70, v11, s[24:27], s47 offen
    s_mov_b32 s47, 2908160
    buffer_load_dword v71, v11, s[24:27], s47 offen
    s_mov_b32 s47, 3014656
    buffer_load_dword v72, v11, s[24:27], s47 offen
    s_mov_b32 s47, 3022848
    buffer_load_dword v73, v11, s[24:27], s47 offen
    s_mov_b32 s47, 3031040
    buffer_load_dword v74, v11, s[24:27], s47 offen
    s_mov_b32 s47, 3039232
    buffer_load_dword v75, v11, s[24:27], s47 offen
    s_waitcnt vmcnt(48)
    v_perm_b32 v100, v21, v20, s50
    v_accvgpr_write_b32 a200, v100
    v_perm_b32 v100, v23, v22, s50
    v_accvgpr_write_b32 a201, v100
    v_perm_b32 v100, v25, v24, s50
    v_accvgpr_write_b32 a202, v100
    v_perm_b32 v100, v27, v26, s50
    v_accvgpr_write_b32 a203, v100
    v_perm_b32 v100, v21, v20, s51
    v_accvgpr_write_b32 a204, v100
    v_perm_b32 v100, v23, v22, s51
    v_accvgpr_write_b32 a205, v100
    v_perm_b32 v100, v25, v24, s51
    v_accvgpr_write_b32 a206, v100
    v_perm_b32 v100, v27, v26, s51
    v_accvgpr_write_b32 a207, v100
    s_mov_b32 s47, 3145728
    buffer_load_dword v12, v11, s[24:27], s47 offen
    s_mov_b32 s47, 3153920
    buffer_load_dword v13, v11, s[24:27], s47 offen
    s_mov_b32 s47, 3162112
    buffer_load_dword v14, v11, s[24:27], s47 offen
    s_mov_b32 s47, 3170304
    buffer_load_dword v15, v11, s[24:27], s47 offen
    s_mov_b32 s47, 3276800
    buffer_load_dword v16, v11, s[24:27], s47 offen
    s_mov_b32 s47, 3284992
    buffer_load_dword v17, v11, s[24:27], s47 offen
    s_mov_b32 s47, 3293184
    buffer_load_dword v18, v11, s[24:27], s47 offen
    s_mov_b32 s47, 3301376
    buffer_load_dword v19, v11, s[24:27], s47 offen
    s_waitcnt vmcnt(48)
    v_perm_b32 v100, v29, v28, s50
    v_accvgpr_write_b32 a208, v100
    v_perm_b32 v100, v31, v30, s50
    v_accvgpr_write_b32 a209, v100
    v_perm_b32 v100, v33, v32, s50
    v_accvgpr_write_b32 a210, v100
    v_perm_b32 v100, v35, v34, s50
    v_accvgpr_write_b32 a211, v100
    v_perm_b32 v100, v29, v28, s51
    v_accvgpr_write_b32 a212, v100
    v_perm_b32 v100, v31, v30, s51
    v_accvgpr_write_b32 a213, v100
    v_perm_b32 v100, v33, v32, s51
    v_accvgpr_write_b32 a214, v100
    v_perm_b32 v100, v35, v34, s51
    v_accvgpr_write_b32 a215, v100
    s_mov_b32 s47, 3407872
    buffer_load_dword v20, v11, s[24:27], s47 offen
    s_mov_b32 s47, 3416064
    buffer_load_dword v21, v11, s[24:27], s47 offen
    s_mov_b32 s47, 3424256
    buffer_load_dword v22, v11, s[24:27], s47 offen
    s_mov_b32 s47, 3432448
    buffer_load_dword v23, v11, s[24:27], s47 offen
    s_mov_b32 s47, 3538944
    buffer_load_dword v24, v11, s[24:27], s47 offen
    s_mov_b32 s47, 3547136
    buffer_load_dword v25, v11, s[24:27], s47 offen
    s_mov_b32 s47, 3555328
    buffer_load_dword v26, v11, s[24:27], s47 offen
    s_mov_b32 s47, 3563520
    buffer_load_dword v27, v11, s[24:27], s47 offen
    s_waitcnt vmcnt(48)
    v_perm_b32 v100, v37, v36, s50
    v_accvgpr_write_b32 a216, v100
    v_perm_b32 v100, v39, v38, s50
    v_accvgpr_write_b32 a217, v100
    v_perm_b32 v100, v41, v40, s50
    v_accvgpr_write_b32 a218, v100
    v_perm_b32 v100, v43, v42, s50
    v_accvgpr_write_b32 a219, v100
    v_perm_b32 v100, v37, v36, s51
    v_accvgpr_write_b32 a220, v100
    v_perm_b32 v100, v39, v38, s51
    v_accvgpr_write_b32 a221, v100
    v_perm_b32 v100, v41, v40, s51
    v_accvgpr_write_b32 a222, v100
    v_perm_b32 v100, v43, v42, s51
    v_accvgpr_write_b32 a223, v100
    s_mov_b32 s47, 3670016
    buffer_load_dword v28, v11, s[24:27], s47 offen
    s_mov_b32 s47, 3678208
    buffer_load_dword v29, v11, s[24:27], s47 offen
    s_mov_b32 s47, 3686400
    buffer_load_dword v30, v11, s[24:27], s47 offen
    s_mov_b32 s47, 3694592
    buffer_load_dword v31, v11, s[24:27], s47 offen
    s_mov_b32 s47, 3801088
    buffer_load_dword v32, v11, s[24:27], s47 offen
    s_mov_b32 s47, 3809280
    buffer_load_dword v33, v11, s[24:27], s47 offen
    s_mov_b32 s47, 3817472
    buffer_load_dword v34, v11, s[24:27], s47 offen
    s_mov_b32 s47, 3825664
    buffer_load_dword v35, v11, s[24:27], s47 offen
    s_waitcnt vmcnt(48)
    v_perm_b32 v100, v45, v44, s50
    v_accvgpr_write_b32 a224, v100
    v_perm_b32 v100, v47, v46, s50
    v_accvgpr_write_b32 a225, v100
    v_perm_b32 v100, v49, v48, s50
    v_accvgpr_write_b32 a226, v100
    v_perm_b32 v100, v51, v50, s50
    v_accvgpr_write_b32 a227, v100
    v_perm_b32 v100, v45, v44, s51
    v_accvgpr_write_b32 a228, v100
    v_perm_b32 v100, v47, v46, s51
    v_accvgpr_write_b32 a229, v100
    v_perm_b32 v100, v49, v48, s51
    v_accvgpr_write_b32 a230, v100
    v_perm_b32 v100, v51, v50, s51
    v_accvgpr_write_b32 a231, v100
    s_mov_b32 s47, 3932160
    buffer_load_dword v36, v11, s[24:27], s47 offen
    s_mov_b32 s47, 3940352
    buffer_load_dword v37, v11, s[24:27], s47 offen
    s_mov_b32 s47, 3948544
    buffer_load_dword v38, v11, s[24:27], s47 offen
    s_mov_b32 s47, 3956736
    buffer_load_dword v39, v11, s[24:27], s47 offen
    s_mov_b32 s47, 4063232
    buffer_load_dword v40, v11, s[24:27], s47 offen
    s_mov_b32 s47, 4071424
    buffer_load_dword v41, v11, s[24:27], s47 offen
    s_mov_b32 s47, 4079616
    buffer_load_dword v42, v11, s[24:27], s47 offen
    s_mov_b32 s47, 4087808
    buffer_load_dword v43, v11, s[24:27], s47 offen
    s_waitcnt vmcnt(48)
    v_perm_b32 v100, v53, v52, s50
    v_accvgpr_write_b32 a232, v100
    v_perm_b32 v100, v55, v54, s50
    v_accvgpr_write_b32 a233, v100
    v_perm_b32 v100, v57, v56, s50
    v_accvgpr_write_b32 a234, v100
    v_perm_b32 v100, v59, v58, s50
    v_accvgpr_write_b32 a235, v100
    v_perm_b32 v100, v53, v52, s51
    v_accvgpr_write_b32 a236, v100
    v_perm_b32 v100, v55, v54, s51
    v_accvgpr_write_b32 a237, v100
    v_perm_b32 v100, v57, v56, s51
    v_accvgpr_write_b32 a238, v100
    v_perm_b32 v100, v59, v58, s51
    v_accvgpr_write_b32 a239, v100
    s_mov_b32 s47, 4194304
    buffer_load_dword v44, v11, s[24:27], s47 offen
    s_mov_b32 s47, 4202496
    buffer_load_dword v45, v11, s[24:27], s47 offen
    s_mov_b32 s47, 4210688
    buffer_load_dword v46, v11, s[24:27], s47 offen
    s_mov_b32 s47, 4218880
    buffer_load_dword v47, v11, s[24:27], s47 offen
    s_mov_b32 s47, 4325376
    buffer_load_dword v48, v11, s[24:27], s47 offen
    s_mov_b32 s47, 4333568
    buffer_load_dword v49, v11, s[24:27], s47 offen
    s_mov_b32 s47, 4341760
    buffer_load_dword v50, v11, s[24:27], s47 offen
    s_mov_b32 s47, 4349952
    buffer_load_dword v51, v11, s[24:27], s47 offen
    s_waitcnt vmcnt(48)
    v_perm_b32 v100, v61, v60, s50
    v_accvgpr_write_b32 a240, v100
    v_perm_b32 v100, v63, v62, s50
    v_accvgpr_write_b32 a241, v100
    v_perm_b32 v100, v65, v64, s50
    v_accvgpr_write_b32 a242, v100
    v_perm_b32 v100, v67, v66, s50
    v_accvgpr_write_b32 a243, v100
    v_perm_b32 v100, v61, v60, s51
    v_accvgpr_write_b32 a244, v100
    v_perm_b32 v100, v63, v62, s51
    v_accvgpr_write_b32 a245, v100
    v_perm_b32 v100, v65, v64, s51
    v_accvgpr_write_b32 a246, v100
    v_perm_b32 v100, v67, v66, s51
    v_accvgpr_write_b32 a247, v100
    s_mov_b32 s47, 4456448
    buffer_load_dword v52, v11, s[24:27], s47 offen
    s_mov_b32 s47, 4464640
    buffer_load_dword v53, v11, s[24:27], s47 offen
    s_mov_b32 s47, 4472832
    buffer_load_dword v54, v11, s[24:27], s47 offen
    s_mov_b32 s47, 4481024
    buffer_load_dword v55, v11, s[24:27], s47 offen
    s_mov_b32 s47, 4587520
    buffer_load_dword v56, v11, s[24:27], s47 offen
    s_mov_b32 s47, 4595712
    buffer_load_dword v57, v11, s[24:27], s47 offen
    s_mov_b32 s47, 4603904
    buffer_load_dword v58, v11, s[24:27], s47 offen
    s_mov_b32 s47, 4612096
    buffer_load_dword v59, v11, s[24:27], s47 offen
    s_waitcnt vmcnt(48)
    v_perm_b32 v100, v69, v68, s50
    v_accvgpr_write_b32 a248, v100
    v_perm_b32 v100, v71, v70, s50
    v_accvgpr_write_b32 a249, v100
    v_perm_b32 v100, v73, v72, s50
    v_accvgpr_write_b32 a250, v100
    v_perm_b32 v100, v75, v74, s50
    v_accvgpr_write_b32 a251, v100
    v_perm_b32 v100, v69, v68, s51
    v_accvgpr_write_b32 a252, v100
    v_perm_b32 v100, v71, v70, s51
    v_accvgpr_write_b32 a253, v100
    v_perm_b32 v100, v73, v72, s51
    v_accvgpr_write_b32 a254, v100
    v_perm_b32 v100, v75, v74, s51
    v_accvgpr_write_b32 a255, v100
    s_mov_b32 s47, 4718592
    buffer_load_dword v60, v11, s[24:27], s47 offen
    s_mov_b32 s47, 4726784
    buffer_load_dword v61, v11, s[24:27], s47 offen
    s_mov_b32 s47, 4734976
    buffer_load_dword v62, v11, s[24:27], s47 offen
    s_mov_b32 s47, 4743168
    buffer_load_dword v63, v11, s[24:27], s47 offen
    s_mov_b32 s47, 4849664
    buffer_load_dword v64, v11, s[24:27], s47 offen
    s_mov_b32 s47, 4857856
    buffer_load_dword v65, v11, s[24:27], s47 offen
    s_mov_b32 s47, 4866048
    buffer_load_dword v66, v11, s[24:27], s47 offen
    s_mov_b32 s47, 4874240
    buffer_load_dword v67, v11, s[24:27], s47 offen
    s_waitcnt vmcnt(48)
    v_perm_b32 v156, v13, v12, s50
    v_perm_b32 v157, v15, v14, s50
    v_perm_b32 v158, v17, v16, s50
    v_perm_b32 v159, v19, v18, s50
    v_perm_b32 v160, v13, v12, s51
    v_perm_b32 v161, v15, v14, s51
    v_perm_b32 v162, v17, v16, s51
    v_perm_b32 v163, v19, v18, s51
    s_mov_b32 s47, 4980736
    buffer_load_dword v68, v11, s[24:27], s47 offen
    s_mov_b32 s47, 4988928
    buffer_load_dword v69, v11, s[24:27], s47 offen
    s_mov_b32 s47, 4997120
    buffer_load_dword v70, v11, s[24:27], s47 offen
    s_mov_b32 s47, 5005312
    buffer_load_dword v71, v11, s[24:27], s47 offen
    s_mov_b32 s47, 5111808
    buffer_load_dword v72, v11, s[24:27], s47 offen
    s_mov_b32 s47, 5120000
    buffer_load_dword v73, v11, s[24:27], s47 offen
    s_mov_b32 s47, 5128192
    buffer_load_dword v74, v11, s[24:27], s47 offen
    s_mov_b32 s47, 5136384
    buffer_load_dword v75, v11, s[24:27], s47 offen
    s_waitcnt vmcnt(48)
    v_perm_b32 v164, v21, v20, s50
    v_perm_b32 v165, v23, v22, s50
    v_perm_b32 v166, v25, v24, s50
    v_perm_b32 v167, v27, v26, s50
    v_perm_b32 v168, v21, v20, s51
    v_perm_b32 v169, v23, v22, s51
    v_perm_b32 v170, v25, v24, s51
    v_perm_b32 v171, v27, v26, s51
    s_mov_b32 s47, 0
    buffer_load_dword v12, v11, s[28:31], s47 offen
    s_mov_b32 s47, 8192
    buffer_load_dword v13, v11, s[28:31], s47 offen
    s_mov_b32 s47, 16384
    buffer_load_dword v14, v11, s[28:31], s47 offen
    s_mov_b32 s47, 24576
    buffer_load_dword v15, v11, s[28:31], s47 offen
    s_mov_b32 s47, 131072
    buffer_load_dword v16, v11, s[28:31], s47 offen
    s_mov_b32 s47, 139264
    buffer_load_dword v17, v11, s[28:31], s47 offen
    s_mov_b32 s47, 147456
    buffer_load_dword v18, v11, s[28:31], s47 offen
    s_mov_b32 s47, 155648
    buffer_load_dword v19, v11, s[28:31], s47 offen
    s_waitcnt vmcnt(48)
    v_perm_b32 v172, v29, v28, s50
    v_perm_b32 v173, v31, v30, s50
    v_perm_b32 v174, v33, v32, s50
    v_perm_b32 v175, v35, v34, s50
    v_perm_b32 v176, v29, v28, s51
    v_perm_b32 v177, v31, v30, s51
    v_perm_b32 v178, v33, v32, s51
    v_perm_b32 v179, v35, v34, s51
    s_mov_b32 s47, 262144
    buffer_load_dword v20, v11, s[28:31], s47 offen
    s_mov_b32 s47, 270336
    buffer_load_dword v21, v11, s[28:31], s47 offen
    s_mov_b32 s47, 278528
    buffer_load_dword v22, v11, s[28:31], s47 offen
    s_mov_b32 s47, 286720
    buffer_load_dword v23, v11, s[28:31], s47 offen
    s_mov_b32 s47, 393216
    buffer_load_dword v24, v11, s[28:31], s47 offen
    s_mov_b32 s47, 401408
    buffer_load_dword v25, v11, s[28:31], s47 offen
    s_mov_b32 s47, 409600
    buffer_load_dword v26, v11, s[28:31], s47 offen
    s_mov_b32 s47, 417792
    buffer_load_dword v27, v11, s[28:31], s47 offen
    s_waitcnt vmcnt(48)
    v_perm_b32 v180, v37, v36, s50
    v_perm_b32 v181, v39, v38, s50
    v_perm_b32 v182, v41, v40, s50
    v_perm_b32 v183, v43, v42, s50
    v_perm_b32 v184, v37, v36, s51
    v_perm_b32 v185, v39, v38, s51
    v_perm_b32 v186, v41, v40, s51
    v_perm_b32 v187, v43, v42, s51
    s_mov_b32 s47, 524288
    buffer_load_dword v28, v11, s[28:31], s47 offen
    s_mov_b32 s47, 532480
    buffer_load_dword v29, v11, s[28:31], s47 offen
    s_mov_b32 s47, 540672
    buffer_load_dword v30, v11, s[28:31], s47 offen
    s_mov_b32 s47, 548864
    buffer_load_dword v31, v11, s[28:31], s47 offen
    s_mov_b32 s47, 655360
    buffer_load_dword v32, v11, s[28:31], s47 offen
    s_mov_b32 s47, 663552
    buffer_load_dword v33, v11, s[28:31], s47 offen
    s_mov_b32 s47, 671744
    buffer_load_dword v34, v11, s[28:31], s47 offen
    s_mov_b32 s47, 679936
    buffer_load_dword v35, v11, s[28:31], s47 offen
    s_waitcnt vmcnt(48)
    v_perm_b32 v188, v45, v44, s50
    v_perm_b32 v189, v47, v46, s50
    v_perm_b32 v190, v49, v48, s50
    v_perm_b32 v191, v51, v50, s50
    v_perm_b32 v192, v45, v44, s51
    v_perm_b32 v193, v47, v46, s51
    v_perm_b32 v194, v49, v48, s51
    v_perm_b32 v195, v51, v50, s51
    s_mov_b32 s47, 786432
    buffer_load_dword v36, v11, s[28:31], s47 offen
    s_mov_b32 s47, 794624
    buffer_load_dword v37, v11, s[28:31], s47 offen
    s_mov_b32 s47, 802816
    buffer_load_dword v38, v11, s[28:31], s47 offen
    s_mov_b32 s47, 811008
    buffer_load_dword v39, v11, s[28:31], s47 offen
    s_mov_b32 s47, 917504
    buffer_load_dword v40, v11, s[28:31], s47 offen
    s_mov_b32 s47, 925696
    buffer_load_dword v41, v11, s[28:31], s47 offen
    s_mov_b32 s47, 933888
    buffer_load_dword v42, v11, s[28:31], s47 offen
    s_mov_b32 s47, 942080
    buffer_load_dword v43, v11, s[28:31], s47 offen
    s_waitcnt vmcnt(48)
    v_perm_b32 v196, v53, v52, s50
    v_perm_b32 v197, v55, v54, s50
    v_perm_b32 v198, v57, v56, s50
    v_perm_b32 v199, v59, v58, s50
    v_perm_b32 v200, v53, v52, s51
    v_perm_b32 v201, v55, v54, s51
    v_perm_b32 v202, v57, v56, s51
    v_perm_b32 v203, v59, v58, s51
    s_mov_b32 s47, 1048576
    buffer_load_dword v44, v11, s[28:31], s47 offen
    s_mov_b32 s47, 1056768
    buffer_load_dword v45, v11, s[28:31], s47 offen
    s_mov_b32 s47, 1064960
    buffer_load_dword v46, v11, s[28:31], s47 offen
    s_mov_b32 s47, 1073152
    buffer_load_dword v47, v11, s[28:31], s47 offen
    s_mov_b32 s47, 1179648
    buffer_load_dword v48, v11, s[28:31], s47 offen
    s_mov_b32 s47, 1187840
    buffer_load_dword v49, v11, s[28:31], s47 offen
    s_mov_b32 s47, 1196032
    buffer_load_dword v50, v11, s[28:31], s47 offen
    s_mov_b32 s47, 1204224
    buffer_load_dword v51, v11, s[28:31], s47 offen
    s_waitcnt vmcnt(48)
    v_perm_b32 v204, v61, v60, s50
    v_perm_b32 v205, v63, v62, s50
    v_perm_b32 v206, v65, v64, s50
    v_perm_b32 v207, v67, v66, s50
    v_perm_b32 v208, v61, v60, s51
    v_perm_b32 v209, v63, v62, s51
    v_perm_b32 v210, v65, v64, s51
    v_perm_b32 v211, v67, v66, s51
    s_mov_b32 s47, 1310720
    buffer_load_dword v52, v11, s[28:31], s47 offen
    s_mov_b32 s47, 1318912
    buffer_load_dword v53, v11, s[28:31], s47 offen
    s_mov_b32 s47, 1327104
    buffer_load_dword v54, v11, s[28:31], s47 offen
    s_mov_b32 s47, 1335296
    buffer_load_dword v55, v11, s[28:31], s47 offen
    s_mov_b32 s47, 1441792
    buffer_load_dword v56, v11, s[28:31], s47 offen
    s_mov_b32 s47, 1449984
    buffer_load_dword v57, v11, s[28:31], s47 offen
    s_mov_b32 s47, 1458176
    buffer_load_dword v58, v11, s[28:31], s47 offen
    s_mov_b32 s47, 1466368
    buffer_load_dword v59, v11, s[28:31], s47 offen
    s_waitcnt vmcnt(48)
    v_perm_b32 v212, v69, v68, s50
    v_perm_b32 v213, v71, v70, s50
    v_perm_b32 v214, v73, v72, s50
    v_perm_b32 v215, v75, v74, s50
    v_perm_b32 v216, v69, v68, s51
    v_perm_b32 v217, v71, v70, s51
    v_perm_b32 v218, v73, v72, s51
    v_perm_b32 v219, v75, v74, s51
    s_mov_b32 s47, 1572864
    buffer_load_dword v60, v11, s[28:31], s47 offen
    s_mov_b32 s47, 1581056
    buffer_load_dword v61, v11, s[28:31], s47 offen
    s_mov_b32 s47, 1589248
    buffer_load_dword v62, v11, s[28:31], s47 offen
    s_mov_b32 s47, 1597440
    buffer_load_dword v63, v11, s[28:31], s47 offen
    s_mov_b32 s47, 1703936
    buffer_load_dword v64, v11, s[28:31], s47 offen
    s_mov_b32 s47, 1712128
    buffer_load_dword v65, v11, s[28:31], s47 offen
    s_mov_b32 s47, 1720320
    buffer_load_dword v66, v11, s[28:31], s47 offen
    s_mov_b32 s47, 1728512
    buffer_load_dword v67, v11, s[28:31], s47 offen
    s_waitcnt vmcnt(48)
    v_perm_b32 v220, v13, v12, s50
    v_perm_b32 v221, v15, v14, s50
    v_perm_b32 v222, v17, v16, s50
    v_perm_b32 v223, v19, v18, s50
    v_perm_b32 v224, v13, v12, s51
    v_perm_b32 v225, v15, v14, s51
    v_perm_b32 v226, v17, v16, s51
    v_perm_b32 v227, v19, v18, s51
    s_mov_b32 s47, 1835008
    buffer_load_dword v68, v11, s[28:31], s47 offen
    s_mov_b32 s47, 1843200
    buffer_load_dword v69, v11, s[28:31], s47 offen
    s_mov_b32 s47, 1851392
    buffer_load_dword v70, v11, s[28:31], s47 offen
    s_mov_b32 s47, 1859584
    buffer_load_dword v71, v11, s[28:31], s47 offen
    s_mov_b32 s47, 1966080
    buffer_load_dword v72, v11, s[28:31], s47 offen
    s_mov_b32 s47, 1974272
    buffer_load_dword v73, v11, s[28:31], s47 offen
    s_mov_b32 s47, 1982464
    buffer_load_dword v74, v11, s[28:31], s47 offen
    s_mov_b32 s47, 1990656
    buffer_load_dword v75, v11, s[28:31], s47 offen
    s_waitcnt vmcnt(48)
    v_perm_b32 v228, v21, v20, s50
    v_perm_b32 v229, v23, v22, s50
    v_perm_b32 v230, v25, v24, s50
    v_perm_b32 v231, v27, v26, s50
    v_perm_b32 v232, v21, v20, s51
    v_perm_b32 v233, v23, v22, s51
    v_perm_b32 v234, v25, v24, s51
    v_perm_b32 v235, v27, v26, s51
    s_mov_b32 s47, 2097152
    buffer_load_dword v12, v11, s[28:31], s47 offen
    s_mov_b32 s47, 2105344
    buffer_load_dword v13, v11, s[28:31], s47 offen
    s_mov_b32 s47, 2113536
    buffer_load_dword v14, v11, s[28:31], s47 offen
    s_mov_b32 s47, 2121728
    buffer_load_dword v15, v11, s[28:31], s47 offen
    s_mov_b32 s47, 2228224
    buffer_load_dword v16, v11, s[28:31], s47 offen
    s_mov_b32 s47, 2236416
    buffer_load_dword v17, v11, s[28:31], s47 offen
    s_mov_b32 s47, 2244608
    buffer_load_dword v18, v11, s[28:31], s47 offen
    s_mov_b32 s47, 2252800
    buffer_load_dword v19, v11, s[28:31], s47 offen
    s_waitcnt vmcnt(48)
    v_perm_b32 v236, v29, v28, s50
    v_perm_b32 v237, v31, v30, s50
    v_perm_b32 v238, v33, v32, s50
    v_perm_b32 v239, v35, v34, s50
    v_perm_b32 v240, v29, v28, s51
    v_perm_b32 v241, v31, v30, s51
    v_perm_b32 v242, v33, v32, s51
    v_perm_b32 v243, v35, v34, s51
    s_mov_b32 s47, 2359296
    buffer_load_dword v20, v11, s[28:31], s47 offen
    s_mov_b32 s47, 2367488
    buffer_load_dword v21, v11, s[28:31], s47 offen
    s_mov_b32 s47, 2375680
    buffer_load_dword v22, v11, s[28:31], s47 offen
    s_mov_b32 s47, 2383872
    buffer_load_dword v23, v11, s[28:31], s47 offen
    s_mov_b32 s47, 2490368
    buffer_load_dword v24, v11, s[28:31], s47 offen
    s_mov_b32 s47, 2498560
    buffer_load_dword v25, v11, s[28:31], s47 offen
    s_mov_b32 s47, 2506752
    buffer_load_dword v26, v11, s[28:31], s47 offen
    s_mov_b32 s47, 2514944
    buffer_load_dword v27, v11, s[28:31], s47 offen
    s_waitcnt vmcnt(48)
    v_perm_b32 v244, v37, v36, s50
    v_perm_b32 v245, v39, v38, s50
    v_perm_b32 v246, v41, v40, s50
    v_perm_b32 v247, v43, v42, s50
    v_perm_b32 v248, v37, v36, s51
    v_perm_b32 v249, v39, v38, s51
    v_perm_b32 v250, v41, v40, s51
    v_perm_b32 v251, v43, v42, s51
    s_mov_b32 s47, 2621440
    buffer_load_dword v28, v11, s[28:31], s47 offen
    s_mov_b32 s47, 2629632
    buffer_load_dword v29, v11, s[28:31], s47 offen
    s_mov_b32 s47, 2637824
    buffer_load_dword v30, v11, s[28:31], s47 offen
    s_mov_b32 s47, 2646016
    buffer_load_dword v31, v11, s[28:31], s47 offen
    s_mov_b32 s47, 2752512
    buffer_load_dword v32, v11, s[28:31], s47 offen
    s_mov_b32 s47, 2760704
    buffer_load_dword v33, v11, s[28:31], s47 offen
    s_mov_b32 s47, 2768896
    buffer_load_dword v34, v11, s[28:31], s47 offen
    s_mov_b32 s47, 2777088
    buffer_load_dword v35, v11, s[28:31], s47 offen
    s_waitcnt vmcnt(48)
    v_perm_b32 v252, v45, v44, s50
    v_perm_b32 v253, v47, v46, s50
    v_perm_b32 v254, v49, v48, s50
    v_perm_b32 v255, v51, v50, s50
    v_perm_b32 v108, v45, v44, s51
    v_perm_b32 v109, v47, v46, s51
    v_perm_b32 v110, v49, v48, s51
    v_perm_b32 v111, v51, v50, s51
    ds_write_b128 v8, v[108:111] offset:0
    s_mov_b32 s47, 2883584
    buffer_load_dword v36, v11, s[28:31], s47 offen
    s_mov_b32 s47, 2891776
    buffer_load_dword v37, v11, s[28:31], s47 offen
    s_mov_b32 s47, 2899968
    buffer_load_dword v38, v11, s[28:31], s47 offen
    s_mov_b32 s47, 2908160
    buffer_load_dword v39, v11, s[28:31], s47 offen
    s_mov_b32 s47, 3014656
    buffer_load_dword v40, v11, s[28:31], s47 offen
    s_mov_b32 s47, 3022848
    buffer_load_dword v41, v11, s[28:31], s47 offen
    s_mov_b32 s47, 3031040
    buffer_load_dword v42, v11, s[28:31], s47 offen
    s_mov_b32 s47, 3039232
    buffer_load_dword v43, v11, s[28:31], s47 offen
    s_waitcnt vmcnt(48)
    v_perm_b32 v104, v53, v52, s50
    v_perm_b32 v105, v55, v54, s50
    v_perm_b32 v106, v57, v56, s50
    v_perm_b32 v107, v59, v58, s50
    ds_write_b128 v8, v[104:107] offset:1024
    v_perm_b32 v108, v53, v52, s51
    v_perm_b32 v109, v55, v54, s51
    v_perm_b32 v110, v57, v56, s51
    v_perm_b32 v111, v59, v58, s51
    ds_write_b128 v8, v[108:111] offset:2048
    s_mov_b32 s47, 3145728
    buffer_load_dword v44, v11, s[28:31], s47 offen
    s_mov_b32 s47, 3153920
    buffer_load_dword v45, v11, s[28:31], s47 offen
    s_mov_b32 s47, 3162112
    buffer_load_dword v46, v11, s[28:31], s47 offen
    s_mov_b32 s47, 3170304
    buffer_load_dword v47, v11, s[28:31], s47 offen
    s_mov_b32 s47, 3276800
    buffer_load_dword v48, v11, s[28:31], s47 offen
    s_mov_b32 s47, 3284992
    buffer_load_dword v49, v11, s[28:31], s47 offen
    s_mov_b32 s47, 3293184
    buffer_load_dword v50, v11, s[28:31], s47 offen
    s_mov_b32 s47, 3301376
    buffer_load_dword v51, v11, s[28:31], s47 offen
    s_waitcnt vmcnt(48)
    v_perm_b32 v104, v61, v60, s50
    v_perm_b32 v105, v63, v62, s50
    v_perm_b32 v106, v65, v64, s50
    v_perm_b32 v107, v67, v66, s50
    ds_write_b128 v8, v[104:107] offset:3072
    v_perm_b32 v108, v61, v60, s51
    v_perm_b32 v109, v63, v62, s51
    v_perm_b32 v110, v65, v64, s51
    v_perm_b32 v111, v67, v66, s51
    ds_write_b128 v8, v[108:111] offset:4096
    s_mov_b32 s47, 3407872
    buffer_load_dword v52, v11, s[28:31], s47 offen
    s_mov_b32 s47, 3416064
    buffer_load_dword v53, v11, s[28:31], s47 offen
    s_mov_b32 s47, 3424256
    buffer_load_dword v54, v11, s[28:31], s47 offen
    s_mov_b32 s47, 3432448
    buffer_load_dword v55, v11, s[28:31], s47 offen
    s_mov_b32 s47, 3538944
    buffer_load_dword v56, v11, s[28:31], s47 offen
    s_mov_b32 s47, 3547136
    buffer_load_dword v57, v11, s[28:31], s47 offen
    s_mov_b32 s47, 3555328
    buffer_load_dword v58, v11, s[28:31], s47 offen
    s_mov_b32 s47, 3563520
    buffer_load_dword v59, v11, s[28:31], s47 offen
    s_waitcnt vmcnt(48)
    v_perm_b32 v104, v69, v68, s50
    v_perm_b32 v105, v71, v70, s50
    v_perm_b32 v106, v73, v72, s50
    v_perm_b32 v107, v75, v74, s50
    ds_write_b128 v8, v[104:107] offset:5120
    v_perm_b32 v108, v69, v68, s51
    v_perm_b32 v109, v71, v70, s51
    v_perm_b32 v110, v73, v72, s51
    v_perm_b32 v111, v75, v74, s51
    ds_write_b128 v8, v[108:111] offset:6144
    s_mov_b32 s47, 3670016
    buffer_load_dword v60, v11, s[28:31], s47 offen
    s_mov_b32 s47, 3678208
    buffer_load_dword v61, v11, s[28:31], s47 offen
    s_mov_b32 s47, 3686400
    buffer_load_dword v62, v11, s[28:31], s47 offen
    s_mov_b32 s47, 3694592
    buffer_load_dword v63, v11, s[28:31], s47 offen
    s_mov_b32 s47, 3801088
    buffer_load_dword v64, v11, s[28:31], s47 offen
    s_mov_b32 s47, 3809280
    buffer_load_dword v65, v11, s[28:31], s47 offen
    s_mov_b32 s47, 3817472
    buffer_load_dword v66, v11, s[28:31], s47 offen
    s_mov_b32 s47, 3825664
    buffer_load_dword v67, v11, s[28:31], s47 offen
    s_waitcnt vmcnt(48)
    v_perm_b32 v104, v13, v12, s50
    v_perm_b32 v105, v15, v14, s50
    v_perm_b32 v106, v17, v16, s50
    v_perm_b32 v107, v19, v18, s50
    ds_write_b128 v8, v[104:107] offset:7168
    v_perm_b32 v108, v13, v12, s51
    v_perm_b32 v109, v15, v14, s51
    v_perm_b32 v110, v17, v16, s51
    v_perm_b32 v111, v19, v18, s51
    ds_write_b128 v8, v[108:111] offset:8192
    s_mov_b32 s47, 3932160
    buffer_load_dword v68, v11, s[28:31], s47 offen
    s_mov_b32 s47, 3940352
    buffer_load_dword v69, v11, s[28:31], s47 offen
    s_mov_b32 s47, 3948544
    buffer_load_dword v70, v11, s[28:31], s47 offen
    s_mov_b32 s47, 3956736
    buffer_load_dword v71, v11, s[28:31], s47 offen
    s_mov_b32 s47, 4063232
    buffer_load_dword v72, v11, s[28:31], s47 offen
    s_mov_b32 s47, 4071424
    buffer_load_dword v73, v11, s[28:31], s47 offen
    s_mov_b32 s47, 4079616
    buffer_load_dword v74, v11, s[28:31], s47 offen
    s_mov_b32 s47, 4087808
    buffer_load_dword v75, v11, s[28:31], s47 offen
    s_waitcnt vmcnt(48)
    v_perm_b32 v104, v21, v20, s50
    v_perm_b32 v105, v23, v22, s50
    v_perm_b32 v106, v25, v24, s50
    v_perm_b32 v107, v27, v26, s50
    ds_write_b128 v8, v[104:107] offset:9216
    v_perm_b32 v108, v21, v20, s51
    v_perm_b32 v109, v23, v22, s51
    v_perm_b32 v110, v25, v24, s51
    v_perm_b32 v111, v27, v26, s51
    ds_write_b128 v8, v[108:111] offset:10240
    s_mov_b32 s47, 4194304
    buffer_load_dword v12, v11, s[28:31], s47 offen
    s_mov_b32 s47, 4202496
    buffer_load_dword v13, v11, s[28:31], s47 offen
    s_mov_b32 s47, 4210688
    buffer_load_dword v14, v11, s[28:31], s47 offen
    s_mov_b32 s47, 4218880
    buffer_load_dword v15, v11, s[28:31], s47 offen
    s_mov_b32 s47, 4325376
    buffer_load_dword v16, v11, s[28:31], s47 offen
    s_mov_b32 s47, 4333568
    buffer_load_dword v17, v11, s[28:31], s47 offen
    s_mov_b32 s47, 4341760
    buffer_load_dword v18, v11, s[28:31], s47 offen
    s_mov_b32 s47, 4349952
    buffer_load_dword v19, v11, s[28:31], s47 offen
    s_waitcnt vmcnt(48)
    v_perm_b32 v104, v29, v28, s50
    v_perm_b32 v105, v31, v30, s50
    v_perm_b32 v106, v33, v32, s50
    v_perm_b32 v107, v35, v34, s50
    ds_write_b128 v8, v[104:107] offset:11264
    v_perm_b32 v108, v29, v28, s51
    v_perm_b32 v109, v31, v30, s51
    v_perm_b32 v110, v33, v32, s51
    v_perm_b32 v111, v35, v34, s51
    ds_write_b128 v8, v[108:111] offset:12288
    s_mov_b32 s47, 4456448
    buffer_load_dword v20, v11, s[28:31], s47 offen
    s_mov_b32 s47, 4464640
    buffer_load_dword v21, v11, s[28:31], s47 offen
    s_mov_b32 s47, 4472832
    buffer_load_dword v22, v11, s[28:31], s47 offen
    s_mov_b32 s47, 4481024
    buffer_load_dword v23, v11, s[28:31], s47 offen
    s_mov_b32 s47, 4587520
    buffer_load_dword v24, v11, s[28:31], s47 offen
    s_mov_b32 s47, 4595712
    buffer_load_dword v25, v11, s[28:31], s47 offen
    s_mov_b32 s47, 4603904
    buffer_load_dword v26, v11, s[28:31], s47 offen
    s_mov_b32 s47, 4612096
    buffer_load_dword v27, v11, s[28:31], s47 offen
    s_waitcnt vmcnt(48)
    v_perm_b32 v104, v37, v36, s50
    v_perm_b32 v105, v39, v38, s50
    v_perm_b32 v106, v41, v40, s50
    v_perm_b32 v107, v43, v42, s50
    ds_write_b128 v8, v[104:107] offset:13312
    v_perm_b32 v108, v37, v36, s51
    v_perm_b32 v109, v39, v38, s51
    v_perm_b32 v110, v41, v40, s51
    v_perm_b32 v111, v43, v42, s51
    ds_write_b128 v8, v[108:111] offset:14336
    s_mov_b32 s47, 4718592
    buffer_load_dword v28, v11, s[28:31], s47 offen
    s_mov_b32 s47, 4726784
    buffer_load_dword v29, v11, s[28:31], s47 offen
    s_mov_b32 s47, 4734976
    buffer_load_dword v30, v11, s[28:31], s47 offen
    s_mov_b32 s47, 4743168
    buffer_load_dword v31, v11, s[28:31], s47 offen
    s_mov_b32 s47, 4849664
    buffer_load_dword v32, v11, s[28:31], s47 offen
    s_mov_b32 s47, 4857856
    buffer_load_dword v33, v11, s[28:31], s47 offen
    s_mov_b32 s47, 4866048
    buffer_load_dword v34, v11, s[28:31], s47 offen
    s_mov_b32 s47, 4874240
    buffer_load_dword v35, v11, s[28:31], s47 offen
    s_waitcnt vmcnt(48)
    v_perm_b32 v104, v45, v44, s50
    v_perm_b32 v105, v47, v46, s50
    v_perm_b32 v106, v49, v48, s50
    v_perm_b32 v107, v51, v50, s50
    ds_write_b128 v8, v[104:107] offset:15360
    v_perm_b32 v108, v45, v44, s51
    v_perm_b32 v109, v47, v46, s51
    v_perm_b32 v110, v49, v48, s51
    v_perm_b32 v111, v51, v50, s51
    ds_write_b128 v8, v[108:111] offset:16384
    s_mov_b32 s47, 4980736
    buffer_load_dword v36, v11, s[28:31], s47 offen
    s_mov_b32 s47, 4988928
    buffer_load_dword v37, v11, s[28:31], s47 offen
    s_mov_b32 s47, 4997120
    buffer_load_dword v38, v11, s[28:31], s47 offen
    s_mov_b32 s47, 5005312
    buffer_load_dword v39, v11, s[28:31], s47 offen
    s_mov_b32 s47, 5111808
    buffer_load_dword v40, v11, s[28:31], s47 offen
    s_mov_b32 s47, 5120000
    buffer_load_dword v41, v11, s[28:31], s47 offen
    s_mov_b32 s47, 5128192
    buffer_load_dword v42, v11, s[28:31], s47 offen
    s_mov_b32 s47, 5136384
    buffer_load_dword v43, v11, s[28:31], s47 offen
    s_waitcnt vmcnt(48)
    v_perm_b32 v104, v53, v52, s50
    v_perm_b32 v105, v55, v54, s50
    v_perm_b32 v106, v57, v56, s50
    v_perm_b32 v107, v59, v58, s50
    ds_write_b128 v8, v[104:107] offset:17408
    v_perm_b32 v108, v53, v52, s51
    v_perm_b32 v109, v55, v54, s51
    v_perm_b32 v110, v57, v56, s51
    v_perm_b32 v111, v59, v58, s51
    ds_write_b128 v8, v[108:111] offset:18432
    s_waitcnt vmcnt(40)
    v_perm_b32 v104, v61, v60, s50
    v_perm_b32 v105, v63, v62, s50
    v_perm_b32 v106, v65, v64, s50
    v_perm_b32 v107, v67, v66, s50
    ds_write_b128 v8, v[104:107] offset:19456
    v_perm_b32 v108, v61, v60, s51
    v_perm_b32 v109, v63, v62, s51
    v_perm_b32 v110, v65, v64, s51
    v_perm_b32 v111, v67, v66, s51
    ds_write_b128 v8, v[108:111] offset:20480
    s_waitcnt vmcnt(32)
    v_perm_b32 v104, v69, v68, s50
    v_perm_b32 v105, v71, v70, s50
    v_perm_b32 v106, v73, v72, s50
    v_perm_b32 v107, v75, v74, s50
    ds_write_b128 v8, v[104:107] offset:21504
    v_perm_b32 v108, v69, v68, s51
    v_perm_b32 v109, v71, v70, s51
    v_perm_b32 v110, v73, v72, s51
    v_perm_b32 v111, v75, v74, s51
    ds_write_b128 v8, v[108:111] offset:22528
    s_waitcnt vmcnt(24)
    v_perm_b32 v104, v13, v12, s50
    v_perm_b32 v105, v15, v14, s50
    v_perm_b32 v106, v17, v16, s50
    v_perm_b32 v107, v19, v18, s50
    ds_write_b128 v8, v[104:107] offset:23552
    v_perm_b32 v108, v13, v12, s51
    v_perm_b32 v109, v15, v14, s51
    v_perm_b32 v110, v17, v16, s51
    v_perm_b32 v111, v19, v18, s51
    ds_write_b128 v8, v[108:111] offset:24576
    s_waitcnt vmcnt(16)
    v_perm_b32 v104, v21, v20, s50
    v_perm_b32 v105, v23, v22, s50
    v_perm_b32 v106, v25, v24, s50
    v_perm_b32 v107, v27, v26, s50
    ds_write_b128 v8, v[104:107] offset:25600
    v_perm_b32 v108, v21, v20, s51
    v_perm_b32 v109, v23, v22, s51
    v_perm_b32 v110, v25, v24, s51
    v_perm_b32 v111, v27, v26, s51
    ds_write_b128 v8, v[108:111] offset:26624
    s_waitcnt vmcnt(8)
    v_perm_b32 v104, v29, v28, s50
    v_perm_b32 v105, v31, v30, s50
    v_perm_b32 v106, v33, v32, s50
    v_perm_b32 v107, v35, v34, s50
    ds_write_b128 v8, v[104:107] offset:27648
    v_perm_b32 v108, v29, v28, s51
    v_perm_b32 v109, v31, v30, s51
    v_perm_b32 v110, v33, v32, s51
    v_perm_b32 v111, v35, v34, s51
    ds_write_b128 v8, v[108:111] offset:28672
    s_waitcnt vmcnt(0)
    v_perm_b32 v104, v37, v36, s50
    v_perm_b32 v105, v39, v38, s50
    v_perm_b32 v106, v41, v40, s50
    v_perm_b32 v107, v43, v42, s50
    ds_write_b128 v8, v[104:107] offset:29696
    v_perm_b32 v108, v37, v36, s51
    v_perm_b32 v109, v39, v38, s51
    v_perm_b32 v110, v41, v40, s51
    v_perm_b32 v111, v43, v42, s51
    ds_write_b128 v8, v[108:111] offset:30720
    v_mov_b32 v9, v8
    v_and_b32 v5, 7, v3
    v_lshlrev_b32 v5, 4, v5
    v_lshl_add_u32 v5, v2, 7, v5
    s_lshl_b32 s37, s2, 2
    s_add_u32 s37, s37, s3
    s_mul_i32 s38, s37, 512
    v_add_u32 v6, s38, v5
    s_mul_i32 s38, s3, 2560
    v_add_u32 v5, s38, v5
    s_mul_i32 s38, s3, 3072
    s_add_u32 s38, s38, 20480
    v_add_u32 v7, s38, v4
    v_and_b32 v8, 7, v3
    v_lshlrev_b32 v8, 4, v8
    v_lshl_add_u32 v154, v2, 7, v8
    s_mul_i32 s38, s3, 2560
    v_add_u32 v8, s38, v154
    s_lshl_b32 s38, s2, 13
    s_lshl_b32 s39, s3, 11
    s_add_u32 s38, s38, s39
    v_add_u32 v10, s38, v4
    s_lshl_b32 s38, s2, 12
    s_lshl_b32 s39, s3, 10
    s_add_u32 s38, s38, s39
    v_add_u32 v11, s38, v4
    v_lshlrev_b32 v2, 3, v1
    v_add_u32 v2, s38, v2
    v_cmp_gt_u32 s[52:53], 32, v1
    v_cmp_gt_u32 s[54:55], 8, v3
    s_mov_b32 s40, 0
    s_and_b32 s41, s2, 7
    s_mul_i32 s41, s41, 2097152
    s_add_u32 s41, s41, 117440512
    s_mov_b32 s42, 150994944
    s_mov_b32 s43, 50331648
    s_mov_b32 s44, 83886080
    s_mov_b32 s56, 0x3db504f3
    s_mov_b32 s57, 0x3db504f3
    s_mov_b32 s58, 0x3fb8aa3b
    s_mov_b32 s59, 10240
    s_lshr_b32 s38, s2, 1
    s_add_u32 s38, s38, 16
    s_lshl_b32 s38, s38, 9
    s_add_u32 s38, s38, 3342336
    v_and_b32 v155, 1, v1
    v_lshlrev_b32 v155, 13, v155
    v_bfe_u32 v148, v1, 1, 1
    v_lshl_add_u32 v155, v148, 2, v155
    v_add_u32 v155, s38, v155
    s_waitcnt lgkmcnt(0)
    s_barrier
    s_mov_b32 s46, 400000
    s_lshl_b32 s45, s40, 3
    s_nop 0
hd_flp:
    buffer_load_dword v148, v155, s[32:35], s45 offen sc1
    s_waitcnt vmcnt(0)
    v_cmp_eq_u32 vcc, 0, v148
    s_nop 4
    s_cbranch_vccz hd_fl_okp
    s_sleep 8
    s_sub_u32 s46, s46, 1
    s_cmp_lg_u32 s46, 0
    s_cbranch_scc1 hd_flp
hd_fl_okp:
    s_add_u32 s45, s43, 16777216
    buffer_load_dwordx4 v[88:91], v10, s[32:35], s43 offen sc1
    buffer_load_dwordx4 v[92:95], v10, s[32:35], s43 offen offset:1024 sc1
    buffer_load_dwordx4 v[96:99], v10, s[32:35], s45 offen sc1
    buffer_load_dwordx4 v[100:103], v10, s[32:35], s45 offen offset:1024 sc1
hd_step:
    s_mov_b32 s46, 400000
    s_mov_b64 exec, s[54:55]
    s_sleep 16
    s_add_u32 s45, s41, 0
    buffer_load_dwordx4 v[12:15], v5, s[32:35], s45 offen sc1
    s_add_u32 s45, s41, 512
    buffer_load_dwordx4 v[16:19], v5, s[32:35], s45 offen sc1
    s_add_u32 s45, s41, 1024
    buffer_load_dwordx4 v[20:23], v5, s[32:35], s45 offen sc1
    s_add_u32 s45, s41, 1536
    buffer_load_dwordx4 v[24:27], v5, s[32:35], s45 offen sc1
    s_add_u32 s45, s41, 2048
    buffer_load_dwordx4 v[28:31], v5, s[32:35], s45 offen sc1
hd_poll:
    s_waitcnt vmcnt(0)
    v_max_u32 v148, v12, v13
    v_max3_u32 v148, v148, v14, v15
    v_max3_u32 v148, v148, v16, v17
    v_max3_u32 v148, v148, v18, v19
    v_max3_u32 v148, v148, v20, v21
    v_max3_u32 v148, v148, v22, v23
    v_max3_u32 v148, v148, v24, v25
    v_max3_u32 v148, v148, v26, v27
    v_max3_u32 v148, v148, v28, v29
    v_max3_u32 v148, v148, v30, v31
    v_cmp_eq_u32 vcc, -1, v148
    s_nop 4
    s_cbranch_vccz hd_use0
    s_add_u32 s45, s41, 0
    buffer_load_dwordx4 v[12:15], v5, s[32:35], s45 offen sc1
    s_add_u32 s45, s41, 512
    buffer_load_dwordx4 v[16:19], v5, s[32:35], s45 offen sc1
    s_add_u32 s45, s41, 1024
    buffer_load_dwordx4 v[20:23], v5, s[32:35], s45 offen sc1
    s_add_u32 s45, s41, 1536
    buffer_load_dwordx4 v[24:27], v5, s[32:35], s45 offen sc1
    s_add_u32 s45, s41, 2048
    buffer_load_dwordx4 v[28:31], v5, s[32:35], s45 offen sc1
    s_sub_u32 s46, s46, 1
    s_cmp_lg_u32 s46, 0
    s_cbranch_scc1 hd_poll
    s_waitcnt vmcnt(0)
hd_use0:
    ds_write_b128 v8, v[12:15] offset:0
    ds_write_b128 v8, v[16:19] offset:512
    ds_write_b128 v8, v[20:23] offset:1024
    ds_write_b128 v8, v[24:27] offset:1536
    ds_write_b128 v8, v[28:31] offset:2048
hd_poll_ok:
    s_mov_b64 exec, -1
    s_waitcnt lgkmcnt(0)
    s_barrier
    s_cmp_lg_u32 s3, 0
    s_cbranch_scc1 hd_nohf
    v_mov_b32 v148, s40
    v_mov_b32 v149, 0
    s_lshl_b32 s45, s2, 2
    s_add_u32 s45, s45, 3375104
    buffer_store_dword v148, v149, s[32:35], s45 offen sc1
    s_nop 1
hd_nohf:
    ds_read_b128 v[32:35], v154 offset:0
    ds_read_b128 v[36:39], v154 offset:512
    ds_read_b128 v[40:43], v154 offset:1024
    ds_read_b128 v[44:47], v154 offset:1536
    s_waitcnt lgkmcnt(3)
    v_mfma_f32_16x16x32_bf16 v[64:67], a[0:3], v[32:35], 0
    v_mfma_f32_16x16x32_bf16 v[72:75], a[160:163], v[32:35], 0
    v_mfma_f32_16x16x32_bf16 v[68:71], a[4:7], v[32:35], 0
    v_mfma_f32_16x16x32_bf16 v[76:79], a[164:167], v[32:35], 0
    ds_read_b128 v[32:35], v154 offset:2048
    s_waitcnt lgkmcnt(3)
    v_mfma_f32_16x16x32_bf16 v[64:67], a[8:11], v[36:39], v[64:67]
    v_mfma_f32_16x16x32_bf16 v[72:75], a[168:171], v[36:39], v[72:75]
    v_mfma_f32_16x16x32_bf16 v[68:71], a[12:15], v[36:39], v[68:71]
    v_mfma_f32_16x16x32_bf16 v[76:79], a[172:175], v[36:39], v[76:79]
    ds_read_b128 v[36:39], v154 offset:2560
    s_waitcnt lgkmcnt(3)
    v_mfma_f32_16x16x32_bf16 v[64:67], a[16:19], v[40:43], v[64:67]
    v_mfma_f32_16x16x32_bf16 v[72:75], a[176:179], v[40:43], v[72:75]
    v_mfma_f32_16x16x32_bf16 v[68:71], a[20:23], v[40:43], v[68:71]
    v_mfma_f32_16x16x32_bf16 v[76:79], a[180:183], v[40:43], v[76:79]
    ds_read_b128 v[40:43], v154 offset:3072
    s_waitcnt lgkmcnt(3)
    v_mfma_f32_16x16x32_bf16 v[64:67], a[24:27], v[44:47], v[64:67]
    v_mfma_f32_16x16x32_bf16 v[72:75], a[184:187], v[44:47], v[72:75]
    v_mfma_f32_16x16x32_bf16 v[68:71], a[28:31], v[44:47], v[68:71]
    v_mfma_f32_16x16x32_bf16 v[76:79], a[188:191], v[44:47], v[76:79]
    ds_read_b128 v[44:47], v154 offset:3584
    s_waitcnt lgkmcnt(3)
    v_mfma_f32_16x16x32_bf16 v[64:67], a[32:35], v[32:35], v[64:67]
    v_mfma_f32_16x16x32_bf16 v[72:75], a[192:195], v[32:35], v[72:75]
    v_mfma_f32_16x16x32_bf16 v[68:71], a[36:39], v[32:35], v[68:71]
    v_mfma_f32_16x16x32_bf16 v[76:79], a[196:199], v[32:35], v[76:79]
    ds_read_b128 v[32:35], v154 offset:4096
    s_waitcnt lgkmcnt(3)
    v_mfma_f32_16x16x32_bf16 v[64:67], a[40:43], v[36:39], v[64:67]
    v_mfma_f32_16x16x32_bf16 v[72:75], a[200:203], v[36:39], v[72:75]
    v_mfma_f32_16x16x32_bf16 v[68:71], a[44:47], v[36:39], v[68:71]
    v_mfma_f32_16x16x32_bf16 v[76:79], a[204:207], v[36:39], v[76:79]
    ds_read_b128 v[36:39], v154 offset:4608
    s_waitcnt lgkmcnt(3)
    v_mfma_f32_16x16x32_bf16 v[64:67], a[48:51], v[40:43], v[64:67]
    v_mfma_f32_16x16x32_bf16 v[72:75], a[208:211], v[40:43], v[72:75]
    v_mfma_f32_16x16x32_bf16 v[68:71], a[52:55], v[40:43], v[68:71]
    v_mfma_f32_16x16x32_bf16 v[76:79], a[212:215], v[40:43], v[76:79]
    ds_read_b128 v[40:43], v154 offset:5120
    s_waitcnt lgkmcnt(3)
    v_mfma_f32_16x16x32_bf16 v[64:67], a[56:59], v[44:47], v[64:67]
    v_mfma_f32_16x16x32_bf16 v[72:75], a[216:219], v[44:47], v[72:75]
    v_mfma_f32_16x16x32_bf16 v[68:71], a[60:63], v[44:47], v[68:71]
    v_mfma_f32_16x16x32_bf16 v[76:79], a[220:223], v[44:47], v[76:79]
    ds_read_b128 v[44:47], v154 offset:5632
    s_waitcnt lgkmcnt(3)
    v_mfma_f32_16x16x32_bf16 v[64:67], a[64:67], v[32:35], v[64:67]
    v_mfma_f32_16x16x32_bf16 v[72:75], a[224:227], v[32:35], v[72:75]
    v_mfma_f32_16x16x32_bf16 v[68:71], a[68:71], v[32:35], v[68:71]
    v_mfma_f32_16x16x32_bf16 v[76:79], a[228:231], v[32:35], v[76:79]
    ds_read_b128 v[32:35], v154 offset:6144
    s_waitcnt lgkmcnt(3)
    v_mfma_f32_16x16x32_bf16 v[64:67], a[72:75], v[36:39], v[64:67]
    v_mfma_f32_16x16x32_bf16 v[72:75], a[232:235], v[36:39], v[72:75]
    v_mfma_f32_16x16x32_bf16 v[68:71], a[76:79], v[36:39], v[68:71]
    v_mfma_f32_16x16x32_bf16 v[76:79], a[236:239], v[36:39], v[76:79]
    ds_read_b128 v[36:39], v154 offset:6656
    s_waitcnt lgkmcnt(3)
    v_mfma_f32_16x16x32_bf16 v[64:67], a[80:83], v[40:43], v[64:67]
    v_mfma_f32_16x16x32_bf16 v[72:75], a[240:243], v[40:43], v[72:75]
    v_mfma_f32_16x16x32_bf16 v[68:71], a[84:87], v[40:43], v[68:71]
    v_mfma_f32_16x16x32_bf16 v[76:79], a[244:247], v[40:43], v[76:79]
    ds_read_b128 v[40:43], v154 offset:7168
    s_waitcnt lgkmcnt(3)
    v_mfma_f32_16x16x32_bf16 v[64:67], a[88:91], v[44:47], v[64:67]
    v_mfma_f32_16x16x32_bf16 v[72:75], a[248:251], v[44:47], v[72:75]
    v_mfma_f32_16x16x32_bf16 v[68:71], a[92:95], v[44:47], v[68:71]
    v_mfma_f32_16x16x32_bf16 v[76:79], a[252:255], v[44:47], v[76:79]
    ds_read_b128 v[44:47], v154 offset:7680
    s_waitcnt lgkmcnt(3)
    v_mfma_f32_16x16x32_bf16 v[64:67], a[96:99], v[32:35], v[64:67]
    v_mfma_f32_16x16x32_bf16 v[72:75], v[156:159], v[32:35], v[72:75]
    v_mfma_f32_16x16x32_bf16 v[68:71], a[100:103], v[32:35], v[68:71]
    v_mfma_f32_16x16x32_bf16 v[76:79], v[160:163], v[32:35], v[76:79]
    ds_read_b128 v[32:35], v154 offset:8192
    s_waitcnt lgkmcnt(3)
    v_mfma_f32_16x16x32_bf16 v[64:67], a[104:107], v[36:39], v[64:67]
    v_mfma_f32_16x16x32_bf16 v[72:75], v[164:167], v[36:39], v[72:75]
    v_mfma_f32_16x16x32_bf16 v[68:71], a[108:111], v[36:39], v[68:71]
    v_mfma_f32_16x16x32_bf16 v[76:79], v[168:171], v[36:39], v[76:79]
    ds_read_b128 v[36:39], v154 offset:8704
    s_waitcnt lgkmcnt(3)
    v_mfma_f32_16x16x32_bf16 v[64:67], a[112:115], v[40:43], v[64:67]
    v_mfma_f32_16x16x32_bf16 v[72:75], v[172:175], v[40:43], v[72:75]
    v_mfma_f32_16x16x32_bf16 v[68:71], a[116:119], v[40:43], v[68:71]
    v_mfma_f32_16x16x32_bf16 v[76:79], v[176:179], v[40:43], v[76:79]
    ds_read_b128 v[40:43], v154 offset:9216
    s_waitcnt lgkmcnt(3)
    v_mfma_f32_16x16x32_bf16 v[64:67], a[120:123], v[44:47], v[64:67]
    v_mfma_f32_16x16x32_bf16 v[72:75], v[180:183], v[44:47], v[72:75]
    v_mfma_f32_16x16x32_bf16 v[68:71], a[124:127], v[44:47], v[68:71]
    v_mfma_f32_16x16x32_bf16 v[76:79], v[184:187], v[44:47], v[76:79]
    ds_read_b128 v[44:47], v154 offset:9728
    s_waitcnt lgkmcnt(3)
    v_mfma_f32_16x16x32_bf16 v[64:67], a[128:131], v[32:35], v[64:67]
    v_mfma_f32_16x16x32_bf16 v[72:75], v[188:191], v[32:35], v[72:75]
    v_mfma_f32_16x16x32_bf16 v[68:71], a[132:135], v[32:35], v[68:71]
    v_mfma_f32_16x16x32_bf16 v[76:79], v[192:195], v[32:35], v[76:79]
    s_waitcnt lgkmcnt(2)
    v_mfma_f32_16x16x32_bf16 v[64:67], a[136:139], v[36:39], v[64:67]
    v_mfma_f32_16x16x32_bf16 v[72:75], v[196:199], v[36:39], v[72:75]
    v_mfma_f32_16x16x32_bf16 v[68:71], a[140:143], v[36:39], v[68:71]
    v_mfma_f32_16x16x32_bf16 v[76:79], v[200:203], v[36:39], v[76:79]
    s_waitcnt lgkmcnt(1)
    v_mfma_f32_16x16x32_bf16 v[64:67], a[144:147], v[40:43], v[64:67]
    v_mfma_f32_16x16x32_bf16 v[72:75], v[204:207], v[40:43], v[72:75]
    v_mfma_f32_16x16x32_bf16 v[68:71], a[148:151], v[40:43], v[68:71]
    v_mfma_f32_16x16x32_bf16 v[76:79], v[208:211], v[40:43], v[76:79]
    s_waitcnt lgkmcnt(0)
    v_mfma_f32_16x16x32_bf16 v[64:67], a[152:155], v[44:47], v[64:67]
    v_mfma_f32_16x16x32_bf16 v[72:75], v[212:215], v[44:47], v[72:75]
    v_mfma_f32_16x16x32_bf16 v[68:71], a[156:159], v[44:47], v[68:71]
    v_mfma_f32_16x16x32_bf16 v[76:79], v[216:219], v[44:47], v[76:79]
    s_nop 4
    v_cvt_pk_bf16_f32 v104, v64, v65
    v_cvt_pk_bf16_f32 v105, v66, v67
    v_cvt_pk_bf16_f32 v108, v72, v73
    v_cvt_pk_bf16_f32 v109, v74, v75
    v_cvt_pk_bf16_f32 v106, v68, v69
    v_cvt_pk_bf16_f32 v107, v70, v71
    v_cvt_pk_bf16_f32 v110, v76, v77
    v_cvt_pk_bf16_f32 v111, v78, v79
    s_nop 1
    v_mfma_f32_16x16x32_bf16 v[116:119], v[108:111], v[104:107], 0
    v_mfma_f32_16x16x32_bf16 v[120:123], v[88:91], v[104:107], 0
    v_mfma_f32_16x16x32_bf16 v[124:127], v[92:95], v[104:107], 0
    buffer_store_dwordx4 v[108:111], v11, s[32:35], s44 offen sc1
    s_nop 4
    ds_write_b128 v7, v[116:119] offset:0
    ds_write_b128 v7, v[120:123] offset:1024
    ds_write_b128 v7, v[124:127] offset:2048
    s_waitcnt lgkmcnt(0)
    s_barrier
    ds_read_b128 v[116:119], v4 offset:20480
    ds_read_b128 v[120:123], v4 offset:21504
    ds_read_b128 v[124:127], v4 offset:22528
    ds_read_b128 v[12:15], v4 offset:23552
    ds_read_b128 v[16:19], v4 offset:24576
    ds_read_b128 v[20:23], v4 offset:25600
    ds_read_b128 v[32:35], v4 offset:26624
    ds_read_b128 v[36:39], v4 offset:27648
    ds_read_b128 v[40:43], v4 offset:28672
    ds_read_b128 v[48:51], v4 offset:29696
    ds_read_b128 v[52:55], v4 offset:30720
    ds_read_b128 v[56:59], v4 offset:31744
    s_waitcnt lgkmcnt(6)
    v_pk_add_f32 v[116:117], v[116:117], v[12:13]
    v_pk_add_f32 v[118:119], v[118:119], v[14:15]
    v_pk_add_f32 v[120:121], v[120:121], v[16:17]
    v_pk_add_f32 v[122:123], v[122:123], v[18:19]
    v_pk_add_f32 v[124:125], v[124:125], v[20:21]
    v_pk_add_f32 v[126:127], v[126:127], v[22:23]
    s_waitcnt lgkmcnt(3)
    v_pk_add_f32 v[116:117], v[116:117], v[32:33]
    v_pk_add_f32 v[118:119], v[118:119], v[34:35]
    v_pk_add_f32 v[120:121], v[120:121], v[36:37]
    v_pk_add_f32 v[122:123], v[122:123], v[38:39]
    v_pk_add_f32 v[124:125], v[124:125], v[40:41]
    v_pk_add_f32 v[126:127], v[126:127], v[42:43]
    s_waitcnt lgkmcnt(0)
    v_pk_add_f32 v[116:117], v[116:117], v[48:49]
    v_pk_add_f32 v[118:119], v[118:119], v[50:51]
    v_pk_add_f32 v[120:121], v[120:121], v[52:53]
    v_pk_add_f32 v[122:123], v[122:123], v[54:55]
    v_pk_add_f32 v[124:125], v[124:125], v[56:57]
    v_pk_add_f32 v[126:127], v[126:127], v[58:59]
    ds_read_b128 v[32:35], v154 offset:0
    ds_read_b128 v[36:39], v154 offset:512
    ds_read_b128 v[40:43], v154 offset:1024
    v_cvt_pk_bf16_f32 v128, v116, v117
    v_cvt_pk_bf16_f32 v129, v118, v119
    v_cvt_pk_bf16_f32 v130, v120, v121
    v_cvt_pk_bf16_f32 v131, v122, v123
    v_cvt_pk_bf16_f32 v132, v124, v125
    v_cvt_pk_bf16_f32 v133, v126, v127
    ds_read_b128 v[44:47], v154 offset:1536
    s_waitcnt lgkmcnt(3)
    v_mfma_f32_16x16x32_bf16 v[80:83], v[32:35], v[220:223], 0
    v_mfma_f32_16x16x32_bf16 v[84:87], v[32:35], v[224:227], 0
    v_lshlrev_b32 v116, 16, v128
    v_and_b32 v117, 0xffff0000, v128
    v_lshlrev_b32 v118, 16, v129
    v_and_b32 v119, 0xffff0000, v129
    v_lshlrev_b32 v120, 16, v130
    v_and_b32 v121, 0xffff0000, v130
    ds_read_b128 v[32:35], v154 offset:2048
    ds_read_b128 v[52:55], v9 offset:0
    s_waitcnt lgkmcnt(4)
    v_mfma_f32_16x16x32_bf16 v[80:83], v[36:39], v[228:231], v[80:83]
    v_mfma_f32_16x16x32_bf16 v[84:87], v[36:39], v[232:235], v[84:87]
    v_lshlrev_b32 v122, 16, v131
    v_and_b32 v123, 0xffff0000, v131
    v_lshlrev_b32 v124, 16, v132
    v_and_b32 v125, 0xffff0000, v132
    v_lshlrev_b32 v126, 16, v133
    v_and_b32 v127, 0xffff0000, v133
    ds_read_b128 v[36:39], v154 offset:2560
    ds_read_b128 v[56:59], v9 offset:1024
    ds_read_b128 v[60:63], v9 offset:2048
    s_waitcnt lgkmcnt(6)
    v_mfma_f32_16x16x32_bf16 v[80:83], v[40:43], v[236:239], v[80:83]
    v_mfma_f32_16x16x32_bf16 v[84:87], v[40:43], v[240:243], v[84:87]
    v_pk_mul_f32 v[116:117], v[116:117], s[56:57]
    v_pk_mul_f32 v[118:119], v[118:119], s[56:57]
    v_pk_mul_f32 v[120:121], v[120:121], s[56:57]
    v_pk_mul_f32 v[122:123], v[122:123], s[56:57]
    v_pk_mul_f32 v[124:125], v[124:125], s[56:57]
    v_pk_mul_f32 v[126:127], v[126:127], s[56:57]
    ds_read_b128 v[40:43], v154 offset:3072
    ds_read_b128 v[12:15], v9 offset:3072
    ds_read_b128 v[16:19], v9 offset:4096
    s_waitcnt lgkmcnt(8)
    v_mfma_f32_16x16x32_bf16 v[80:83], v[44:47], v[244:247], v[80:83]
    v_mfma_f32_16x16x32_bf16 v[84:87], v[44:47], v[248:251], v[84:87]
    v_cvt_pk_bf16_f32 v128, v116, v117
    v_cvt_pk_bf16_f32 v129, v118, v119
    v_cvt_pk_bf16_f32 v130, v120, v121
    v_cvt_pk_bf16_f32 v131, v122, v123
    v_cvt_pk_bf16_f32 v132, v124, v125
    v_cvt_pk_bf16_f32 v133, v126, v127
    ds_read_b128 v[44:47], v154 offset:3584
    ds_read_b128 v[20:23], v9 offset:5120
    ds_read_b128 v[24:27], v9 offset:6144
    s_waitcnt lgkmcnt(9)
    v_mfma_f32_16x16x32_bf16 v[80:83], v[32:35], v[252:255], v[80:83]
    v_mfma_f32_16x16x32_bf16 v[84:87], v[32:35], v[52:55], v[84:87]
    v_lshlrev_b32 v116, 16, v128
    v_and_b32 v117, 0xffff0000, v128
    v_lshlrev_b32 v118, 16, v129
    v_and_b32 v119, 0xffff0000, v129
    v_lshlrev_b32 v120, 16, v130
    v_and_b32 v121, 0xffff0000, v130
    ds_read_b128 v[32:35], v154 offset:4096
    ds_read_b128 v[48:51], v9 offset:7168
    ds_read_b128 v[52:55], v9 offset:8192
    s_waitcnt lgkmcnt(9)
    v_mfma_f32_16x16x32_bf16 v[80:83], v[36:39], v[56:59], v[80:83]
    v_mfma_f32_16x16x32_bf16 v[84:87], v[36:39], v[60:63], v[84:87]
    v_lshlrev_b32 v122, 16, v131
    v_and_b32 v123, 0xffff0000, v131
    v_lshlrev_b32 v124, 16, v132
    v_and_b32 v125, 0xffff0000, v132
    v_lshlrev_b32 v126, 16, v133
    v_and_b32 v127, 0xffff0000, v133
    ds_read_b128 v[36:39], v154 offset:4608
    ds_read_b128 v[56:59], v9 offset:9216
    ds_read_b128 v[60:63], v9 offset:10240
    s_waitcnt lgkmcnt(9)
    v_mfma_f32_16x16x32_bf16 v[80:83], v[40:43], v[12:15], v[80:83]
    v_mfma_f32_16x16x32_bf16 v[84:87], v[40:43], v[16:19], v[84:87]
    v_mov_b32 v148, 0xff800000
    v_cndmask_b32 v116, v148, v116, s[52:53]
    v_cndmask_b32 v117, v148, v117, s[52:53]
    v_cndmask_b32 v118, v148, v118, s[52:53]
    v_cndmask_b32 v119, v148, v119, s[52:53]
    v_max3_f32 v148, v116, v117, v118
    ds_read_b128 v[40:43], v154 offset:5120
    ds_read_b128 v[12:15], v9 offset:11264
    ds_read_b128 v[16:19], v9 offset:12288
    s_waitcnt lgkmcnt(9)
    v_mfma_f32_16x16x32_bf16 v[80:83], v[44:47], v[20:23], v[80:83]
    v_mfma_f32_16x16x32_bf16 v[84:87], v[44:47], v[24:27], v[84:87]
    v_max3_f32 v149, v119, v120, v121
    v_max3_f32 v150, v122, v123, v124
    v_max3_f32 v151, v125, v126, v127
    v_max_f32 v148, v148, v149
    v_max3_f32 v148, v148, v150, v151
    v_mov_b32 v149, v148
    ds_read_b128 v[44:47], v154 offset:5632
    ds_read_b128 v[20:23], v9 offset:13312
    ds_read_b128 v[24:27], v9 offset:14336
    s_waitcnt lgkmcnt(9)
    v_mfma_f32_16x16x32_bf16 v[80:83], v[32:35], v[48:51], v[80:83]
    v_mfma_f32_16x16x32_bf16 v[84:87], v[32:35], v[52:55], v[84:87]
    v_mov_b32 v150, v148
    s_nop 1
    v_permlane16_swap_b32 v149, v150
    v_max_f32 v148, v149, v150
    v_mov_b32 v149, v148
    v_mov_b32 v150, v148
    s_nop 1
    v_permlane32_swap_b32 v149, v150
    ds_read_b128 v[32:35], v154 offset:6144
    ds_read_b128 v[48:51], v9 offset:15360
    ds_read_b128 v[52:55], v9 offset:16384
    s_waitcnt lgkmcnt(9)
    v_mfma_f32_16x16x32_bf16 v[80:83], v[36:39], v[56:59], v[80:83]
    v_mfma_f32_16x16x32_bf16 v[84:87], v[36:39], v[60:63], v[84:87]
    v_max_f32 v148, v149, v150
    v_mul_f32 v148, s58, v148
    v_fma_f32 v116, v116, s58, -v148
    v_fma_f32 v117, v117, s58, -v148
    v_fma_f32 v118, v118, s58, -v148
    v_fma_f32 v119, v119, s58, -v148
    ds_read_b128 v[36:39], v154 offset:6656
    ds_read_b128 v[56:59], v9 offset:17408
    ds_read_b128 v[60:63], v9 offset:18432
    s_waitcnt lgkmcnt(9)
    v_mfma_f32_16x16x32_bf16 v[80:83], v[40:43], v[12:15], v[80:83]
    v_mfma_f32_16x16x32_bf16 v[84:87], v[40:43], v[16:19], v[84:87]
    v_fma_f32 v120, v120, s58, -v148
    v_fma_f32 v121, v121, s58, -v148
    v_fma_f32 v122, v122, s58, -v148
    v_fma_f32 v123, v123, s58, -v148
    v_fma_f32 v124, v124, s58, -v148
    v_fma_f32 v125, v125, s58, -v148
    ds_read_b128 v[40:43], v154 offset:7168
    ds_read_b128 v[12:15], v9 offset:19456
    ds_read_b128 v[16:19], v9 offset:20480
    s_waitcnt lgkmcnt(9)
    v_mfma_f32_16x16x32_bf16 v[80:83], v[44:47], v[20:23], v[80:83]
    v_mfma_f32_16x16x32_bf16 v[84:87], v[44:47], v[24:27], v[84:87]
    v_fma_f32 v126, v126, s58, -v148
    v_fma_f32 v127, v127, s58, -v148
    v_exp_f32 v116, v116
    v_exp_f32 v117, v117
    v_exp_f32 v118, v118
    v_exp_f32 v119, v119
    ds_read_b128 v[44:47], v154 offset:7680
    ds_read_b128 v[20:23], v9 offset:21504
    ds_read_b128 v[24:27], v9 offset:22528
    s_waitcnt lgkmcnt(9)
    v_mfma_f32_16x16x32_bf16 v[80:83], v[32:35], v[48:51], v[80:83]
    v_mfma_f32_16x16x32_bf16 v[84:87], v[32:35], v[52:55], v[84:87]
    v_exp_f32 v120, v120
    v_exp_f32 v121, v121
    v_exp_f32 v122, v122
    v_exp_f32 v123, v123
    v_exp_f32 v124, v124
    v_exp_f32 v125, v125
    ds_read_b128 v[32:35], v154 offset:8192
    ds_read_b128 v[48:51], v9 offset:23552
    ds_read_b128 v[52:55], v9 offset:24576
    s_waitcnt lgkmcnt(9)
    v_mfma_f32_16x16x32_bf16 v[80:83], v[36:39], v[56:59], v[80:83]
    v_mfma_f32_16x16x32_bf16 v[84:87], v[36:39], v[60:63], v[84:87]
    v_exp_f32 v126, v126
    v_exp_f32 v127, v127
    v_pk_add_f32 v[148:149], v[116:117], v[118:119]
    v_pk_add_f32 v[150:151], v[120:121], v[122:123]
    v_pk_add_f32 v[148:149], v[148:149], v[124:125]
    v_pk_add_f32 v[150:151], v[150:151], v[126:127]
    ds_read_b128 v[36:39], v154 offset:8704
    ds_read_b128 v[56:59], v9 offset:25600
    ds_read_b128 v[60:63], v9 offset:26624
    s_waitcnt lgkmcnt(9)
    v_mfma_f32_16x16x32_bf16 v[80:83], v[40:43], v[12:15], v[80:83]
    v_mfma_f32_16x16x32_bf16 v[84:87], v[40:43], v[16:19], v[84:87]
    v_pk_add_f32 v[148:149], v[148:149], v[150:151]
    v_add_f32 v148, v148, v149
    v_mov_b32 v149, v148
    v_mov_b32 v150, v148
    s_nop 1
    v_permlane16_swap_b32 v149, v150
    v_add_f32 v148, v149, v150
    ds_read_b128 v[40:43], v154 offset:9216
    ds_read_b128 v[12:15], v9 offset:27648
    ds_read_b128 v[16:19], v9 offset:28672
    s_waitcnt lgkmcnt(9)
    v_mfma_f32_16x16x32_bf16 v[80:83], v[44:47], v[20:23], v[80:83]
    v_mfma_f32_16x16x32_bf16 v[84:87], v[44:47], v[24:27], v[84:87]
    v_mov_b32 v149, v148
    v_mov_b32 v150, v148
    s_nop 1
    v_permlane32_swap_b32 v149, v150
    v_add_f32 v148, v149, v150
    v_rcp_f32 v150, v148
    s_nop 0
    v_fma_f32 v149, -v148, v150, 1.0
    ds_read_b128 v[44:47], v154 offset:9728
    ds_read_b128 v[20:23], v9 offset:29696
    ds_read_b128 v[24:27], v9 offset:30720
    s_waitcnt lgkmcnt(9)
    v_mfma_f32_16x16x32_bf16 v[80:83], v[32:35], v[48:51], v[80:83]
    v_mfma_f32_16x16x32_bf16 v[84:87], v[32:35], v[52:55], v[84:87]
    v_fma_f32 v150, v149, v150, v150
    v_mov_b32 v151, v150
    v_pk_mul_f32 v[116:117], v[116:117], v[150:151]
    v_pk_mul_f32 v[118:119], v[118:119], v[150:151]
    v_pk_mul_f32 v[120:121], v[120:121], v[150:151]
    v_pk_mul_f32 v[122:123], v[122:123], v[150:151]
    s_waitcnt lgkmcnt(6)
    v_mfma_f32_16x16x32_bf16 v[80:83], v[36:39], v[56:59], v[80:83]
    v_mfma_f32_16x16x32_bf16 v[84:87], v[36:39], v[60:63], v[84:87]
    v_pk_mul_f32 v[124:125], v[124:125], v[150:151]
    v_pk_mul_f32 v[126:127], v[126:127], v[150:151]
    v_cvt_pk_bf16_f32 v132, v116, v117
    v_cvt_pk_bf16_f32 v133, v118, v119
    v_cvt_pk_bf16_f32 v128, v120, v121
    v_cvt_pk_bf16_f32 v129, v122, v123
    s_waitcnt lgkmcnt(3)
    v_mfma_f32_16x16x32_bf16 v[80:83], v[40:43], v[12:15], v[80:83]
    v_mfma_f32_16x16x32_bf16 v[84:87], v[40:43], v[16:19], v[84:87]
    v_cvt_pk_bf16_f32 v130, v124, v125
    v_cvt_pk_bf16_f32 v131, v126, v127
    s_waitcnt lgkmcnt(0)
    v_mfma_f32_16x16x32_bf16 v[80:83], v[44:47], v[20:23], v[80:83]
    v_mfma_f32_16x16x32_bf16 v[84:87], v[44:47], v[24:27], v[84:87]
    s_nop 6
    v_cvt_pk_bf16_f32 v112, v80, v81
    v_cvt_pk_bf16_f32 v113, v82, v83
    v_cvt_pk_bf16_f32 v114, v84, v85
    v_cvt_pk_bf16_f32 v115, v86, v87
    v_mfma_f32_16x16x32_bf16 v[136:139], v[96:99], v[128:131], 0
    v_mfma_f32_16x16x32_bf16 v[140:143], v[100:103], v[128:131], 0
    s_nop 6
    v_mfma_f32_16x16x16_bf16 v[136:139], v[112:113], v[132:133], v[136:139]
    v_mfma_f32_16x16x16_bf16 v[140:143], v[114:115], v[132:133], v[140:143]
    s_add_u32 s45, s44, 16777216
    buffer_store_dwordx2 v[112:113], v2, s[32:35], s45 offen sc1
    buffer_store_dwordx2 v[114:115], v2, s[32:35], s45 offen offset:512 sc1
    s_nop 3
    v_cvt_pk_bf16_f32 v144, v136, v137
    v_cvt_pk_bf16_f32 v145, v138, v139
    v_cvt_pk_bf16_f32 v146, v140, v141
    v_cvt_pk_bf16_f32 v147, v142, v143
    v_min_u32 v144, -2, v144
    v_min_u32 v145, -2, v145
    v_min_u32 v146, -2, v146
    v_min_u32 v147, -2, v147
    s_mov_b64 exec, s[54:55]
    s_add_u32 s45, s42, 0
    buffer_store_dwordx4 v[144:147], v6, s[32:35], s45 offen sc1
    s_mov_b64 exec, -1
    s_add_u32 s40, s40, 1
    v_add_u32 v154, s59, v154
    v_add_u32 v8, s59, v8
    s_sub_u32 s59, 0, s59
    s_add_u32 s41, s41, 10240
    s_add_u32 s42, s42, 65536
    s_add_u32 s43, s43, 262144
    s_add_u32 s44, s44, 131072
    s_cmp_ge_u32 s40, 64
    s_cbranch_scc1 hd_end
    s_mov_b32 s46, 400000
    s_lshl_b32 s45, s40, 3
hd_fll:
    buffer_load_dword v148, v155, s[32:35], s45 offen sc1
    s_waitcnt vmcnt(0)
    v_cmp_eq_u32 vcc, 0, v148
    s_nop 4
    s_cbranch_vccz hd_fl_okl
    s_sleep 8
    s_sub_u32 s46, s46, 1
    s_cmp_lg_u32 s46, 0
    s_cbranch_scc1 hd_fll
hd_fl_okl:
    s_add_u32 s45, s43, 16777216
    buffer_load_dwordx4 v[88:91], v10, s[32:35], s43 offen sc1
    buffer_load_dwordx4 v[92:95], v10, s[32:35], s43 offen offset:1024 sc1
    buffer_load_dwordx4 v[96:99], v10, s[32:35], s45 offen sc1
    buffer_load_dwordx4 v[100:103], v10, s[32:35], s45 offen offset:1024 sc1
    s_branch hd_step
hd_end:
    s_waitcnt vmcnt(0)
    s_barrier
    s_cmp_lg_u32 s3, 0
    s_cbranch_scc1 ch_done
    v_mov_b32 v148, s40
    v_mov_b32 v149, 0
    s_lshl_b32 s45, s2, 2
    s_add_u32 s45, s45, 3375104
    buffer_store_dword v148, v149, s[32:35], s45 offen sc1
    s_nop 1
    s_endpgm
ch_red:
    s_sub_u32 s36, s2, 32
    s_and_b32 s39, s36, 0
    s_lshr_b32 s36, s36, 0
    v_lshlrev_b32 v4, 4, v1
    s_lshl_b32 s37, s36, 7
    s_lshl_b32 s38, s3, 5
    s_add_u32 s37, s37, s38
    s_lshl_b32 s37, s37, 10
    s_add_u32 s37, s37, 16777216
    buffer_load_dwordx4 a[0:3], v4, s[32:35], s37 offen offset:0
    buffer_load_dwordx4 a[4:7], v4, s[32:35], s37 offen offset:1024
    buffer_load_dwordx4 a[8:11], v4, s[32:35], s37 offen offset:2048
    buffer_load_dwordx4 a[12:15], v4, s[32:35], s37 offen offset:3072
    s_add_u32 s37, s37, 4096
    buffer_load_dwordx4 a[16:19], v4, s[32:35], s37 offen offset:0
    buffer_load_dwordx4 a[20:23], v4, s[32:35], s37 offen offset:1024
    buffer_load_dwordx4 a[24:27], v4, s[32:35], s37 offen offset:2048
    buffer_load_dwordx4 a[28:31], v4, s[32:35], s37 offen offset:3072
    s_add_u32 s37, s37, 4096
    buffer_load_dwordx4 a[32:35], v4, s[32:35], s37 offen offset:0
    buffer_load_dwordx4 a[36:39], v4, s[32:35], s37 offen offset:1024
    buffer_load_dwordx4 a[40:43], v4, s[32:35], s37 offen offset:2048
    buffer_load_dwordx4 a[44:47], v4, s[32:35], s37 offen offset:3072
    s_add_u32 s37, s37, 4096
    buffer_load_dwordx4 a[48:51], v4, s[32:35], s37 offen offset:0
    buffer_load_dwordx4 a[52:55], v4, s[32:35], s37 offen offset:1024
    buffer_load_dwordx4 a[56:59], v4, s[32:35], s37 offen offset:2048
    buffer_load_dwordx4 a[60:63], v4, s[32:35], s37 offen offset:3072
    s_add_u32 s37, s37, 4096
    buffer_load_dwordx4 a[64:67], v4, s[32:35], s37 offen offset:0
    buffer_load_dwordx4 a[68:71], v4, s[32:35], s37 offen offset:1024
    buffer_load_dwordx4 a[72:75], v4, s[32:35], s37 offen offset:2048
    buffer_load_dwordx4 a[76:79], v4, s[32:35], s37 offen offset:3072
    s_add_u32 s37, s37, 4096
    buffer_load_dwordx4 a[80:83], v4, s[32:35], s37 offen offset:0
    buffer_load_dwordx4 a[84:87], v4, s[32:35], s37 offen offset:1024
    buffer_load_dwordx4 a[88:91], v4, s[32:35], s37 offen offset:2048
    buffer_load_dwordx4 a[92:95], v4, s[32:35], s37 offen offset:3072
    s_add_u32 s37, s37, 4096
    buffer_load_dwordx4 a[96:99], v4, s[32:35], s37 offen offset:0
    buffer_load_dwordx4 a[100:103], v4, s[32:35], s37 offen offset:1024
    buffer_load_dwordx4 a[104:107], v4, s[32:35], s37 offen offset:2048
    buffer_load_dwordx4 a[108:111], v4, s[32:35], s37 offen offset:3072
    s_add_u32 s37, s37, 4096
    buffer_load_dwordx4 a[112:115], v4, s[32:35], s37 offen offset:0
    buffer_load_dwordx4 a[116:119], v4, s[32:35], s37 offen offset:1024
    buffer_load_dwordx4 a[120:123], v4, s[32:35], s37 offen offset:2048
    buffer_load_dwordx4 a[124:127], v4, s[32:35], s37 offen offset:3072
    s_add_u32 s37, s37, 4096
    v_and_b32 v5, 7, v3
    s_mul_i32 s39, s39, 8
    v_add_u32 v5, s39, v5
    v_lshlrev_b32 v5, 4, v5
    v_lshl_add_u32 v5, v2, 7, v5
    v_mov_b32 v6, v5
    s_mul_i32 s38, s3, 16384
    v_add_u32 v5, s38, v5
    v_lshrrev_b32 v8, 3, v3
    v_mul_u32_u24 v8, 8192, v8
    v_add_u32 v5, v5, v8
    s_lshr_b32 s38, s36, 1
    s_mul_i32 s38, s38, 512
    s_and_b32 s39, s36, 1
    s_lshl_b32 s39, s39, 3
    s_add_u32 s38, s38, s39
    v_add_u32 v6, s38, v6
    s_lshl_b32 s38, s3, 10
    v_add_u32 v7, s38, v4
    v_cmp_gt_u32 s[54:55], 8, v3
    s_mov_b32 s40, 0
    s_mov_b32 s41, 150994944
    s_mov_b32 s42, 117450752
    s_waitcnt vmcnt(0)
    s_nop 0
rd_step0:
    s_mov_b32 s46, 400000
    s_sleep 114
rd_poll0:
    s_mov_b32 s43, s41
    buffer_load_dwordx4 v[48:51], v5, s[32:35], s43 offen sc1
    s_add_u32 s43, s43, 512
    buffer_load_dwordx4 v[52:55], v5, s[32:35], s43 offen sc1
    s_add_u32 s43, s43, 512
    buffer_load_dwordx4 v[56:59], v5, s[32:35], s43 offen sc1
    s_add_u32 s43, s43, 512
    buffer_load_dwordx4 v[60:63], v5, s[32:35], s43 offen sc1
    s_add_u32 s43, s43, 512
    buffer_load_dwordx4 v[64:67], v5, s[32:35], s43 offen sc1
    s_add_u32 s43, s43, 512
    buffer_load_dwordx4 v[68:71], v5, s[32:35], s43 offen sc1
    s_add_u32 s43, s43, 512
    buffer_load_dwordx4 v[72:75], v5, s[32:35], s43 offen sc1
    s_add_u32 s43, s43, 512
    buffer_load_dwordx4 v[76:79], v5, s[32:35], s43 offen sc1
    s_add_u32 s43, s43, 512
    buffer_load_dwordx4 v[80:83], v5, s[32:35], s43 offen sc1
    s_add_u32 s43, s43, 512
    buffer_load_dwordx4 v[84:87], v5, s[32:35], s43 offen sc1
    s_add_u32 s43, s43, 512
    buffer_load_dwordx4 v[88:91], v5, s[32:35], s43 offen sc1
    s_add_u32 s43, s43, 512
    buffer_load_dwordx4 v[92:95], v5, s[32:35], s43 offen sc1
    s_add_u32 s43, s43, 512
    buffer_load_dwordx4 v[96:99], v5, s[32:35], s43 offen sc1
    s_add_u32 s43, s43, 512
    buffer_load_dwordx4 v[100:103], v5, s[32:35], s43 offen sc1
    s_add_u32 s43, s43, 512
    buffer_load_dwordx4 v[104:107], v5, s[32:35], s43 offen sc1
    s_add_u32 s43, s43, 512
    buffer_load_dwordx4 v[108:111], v5, s[32:35], s43 offen sc1
    s_waitcnt vmcnt(15)
    v_mfma_f32_16x16x32_bf16 v[12:15], a[0:3], v[48:51], 0
    v_mfma_f32_16x16x32_bf16 v[16:19], a[64:67], v[48:51], 0
    s_waitcnt vmcnt(14)
    v_mfma_f32_16x16x32_bf16 v[12:15], a[4:7], v[52:55], v[12:15]
    v_mfma_f32_16x16x32_bf16 v[16:19], a[68:71], v[52:55], v[16:19]
    s_waitcnt vmcnt(13)
    v_mfma_f32_16x16x32_bf16 v[12:15], a[8:11], v[56:59], v[12:15]
    v_mfma_f32_16x16x32_bf16 v[16:19], a[72:75], v[56:59], v[16:19]
    s_waitcnt vmcnt(12)
    v_mfma_f32_16x16x32_bf16 v[12:15], a[12:15], v[60:63], v[12:15]
    v_mfma_f32_16x16x32_bf16 v[16:19], a[76:79], v[60:63], v[16:19]
    s_waitcnt vmcnt(11)
    v_mfma_f32_16x16x32_bf16 v[12:15], a[16:19], v[64:67], v[12:15]
    v_mfma_f32_16x16x32_bf16 v[16:19], a[80:83], v[64:67], v[16:19]
    s_waitcnt vmcnt(10)
    v_mfma_f32_16x16x32_bf16 v[12:15], a[20:23], v[68:71], v[12:15]
    v_mfma_f32_16x16x32_bf16 v[16:19], a[84:87], v[68:71], v[16:19]
    s_waitcnt vmcnt(9)
    v_mfma_f32_16x16x32_bf16 v[12:15], a[24:27], v[72:75], v[12:15]
    v_mfma_f32_16x16x32_bf16 v[16:19], a[88:91], v[72:75], v[16:19]
    s_waitcnt vmcnt(8)
    v_mfma_f32_16x16x32_bf16 v[12:15], a[28:31], v[76:79], v[12:15]
    v_mfma_f32_16x16x32_bf16 v[16:19], a[92:95], v[76:79], v[16:19]
    s_waitcnt vmcnt(7)
    v_mfma_f32_16x16x32_bf16 v[12:15], a[32:35], v[80:83], v[12:15]
    v_mfma_f32_16x16x32_bf16 v[16:19], a[96:99], v[80:83], v[16:19]
    s_waitcnt vmcnt(6)
    v_mfma_f32_16x16x32_bf16 v[12:15], a[36:39], v[84:87], v[12:15]
    v_mfma_f32_16x16x32_bf16 v[16:19], a[100:103], v[84:87], v[16:19]
    s_waitcnt vmcnt(5)
    v_mfma_f32_16x16x32_bf16 v[12:15], a[40:43], v[88:91], v[12:15]
    v_mfma_f32_16x16x32_bf16 v[16:19], a[104:107], v[88:91], v[16:19]
    s_waitcnt vmcnt(4)
    v_mfma_f32_16x16x32_bf16 v[12:15], a[44:47], v[92:95], v[12:15]
    v_mfma_f32_16x16x32_bf16 v[16:19], a[108:111], v[92:95], v[16:19]
    s_waitcnt vmcnt(3)
    v_mfma_f32_16x16x32_bf16 v[12:15], a[48:51], v[96:99], v[12:15]
    v_mfma_f32_16x16x32_bf16 v[16:19], a[112:115], v[96:99], v[16:19]
    s_waitcnt vmcnt(2)
    v_mfma_f32_16x16x32_bf16 v[12:15], a[52:55], v[100:103], v[12:15]
    v_mfma_f32_16x16x32_bf16 v[16:19], a[116:119], v[100:103], v[16:19]
    s_waitcnt vmcnt(1)
    v_mfma_f32_16x16x32_bf16 v[12:15], a[56:59], v[104:107], v[12:15]
    v_mfma_f32_16x16x32_bf16 v[16:19], a[120:123], v[104:107], v[16:19]
    s_waitcnt vmcnt(0)
    v_mfma_f32_16x16x32_bf16 v[12:15], a[60:63], v[108:111], v[12:15]
    v_mfma_f32_16x16x32_bf16 v[16:19], a[124:127], v[108:111], v[16:19]
    s_nop 7
    v_mov_b32_dpp v16, v16 row_shl:8 row_mask:0xf bank_mask:0xf
    v_mov_b32_dpp v17, v17 row_shl:8 row_mask:0xf bank_mask:0xf
    v_mov_b32_dpp v18, v18 row_shl:8 row_mask:0xf bank_mask:0xf
    v_mov_b32_dpp v19, v19 row_shl:8 row_mask:0xf bank_mask:0xf
    v_add_f32 v12, v12, v16
    v_add_f32 v13, v13, v17
    v_add_f32 v14, v14, v18
    v_add_f32 v15, v15, v19
    v_add_f32 v8, v12, v13
    v_add_f32 v10, v14, v15
    v_add_f32 v8, v8, v10
    v_cmp_u_f32 vcc, v8, v8
    s_nop 0
    s_and_b64 s[58:59], vcc, s[54:55]
    s_nop 2
    s_cbranch_scc0 rd_ok0
    s_sub_u32 s46, s46, 1
    s_cmp_lg_u32 s46, 0
    s_cbranch_scc1 rd_poll0
rd_ok0:
    ds_write_b128 v7, v[12:15] offset:0
    s_waitcnt lgkmcnt(0)
    s_barrier
    s_cmp_lg_u32 s3, 0
    s_cbranch_scc1 rd_next0
    ds_read_b128 v[20:23], v4 offset:1024
    ds_read_b128 v[24:27], v4 offset:2048
    ds_read_b128 v[28:31], v4 offset:3072
    s_waitcnt lgkmcnt(2)
    v_add_f32 v12, v12, v20
    v_add_f32 v13, v13, v21
    v_add_f32 v14, v14, v22
    v_add_f32 v15, v15, v23
    s_waitcnt lgkmcnt(1)
    v_add_f32 v12, v12, v24
    v_add_f32 v13, v13, v25
    v_add_f32 v14, v14, v26
    v_add_f32 v15, v15, v27
    s_waitcnt lgkmcnt(0)
    v_add_f32 v12, v12, v28
    v_add_f32 v13, v13, v29
    v_add_f32 v14, v14, v30
    v_add_f32 v15, v15, v31
    v_cvt_pk_bf16_f32 v10, v12, v13
    v_cvt_pk_bf16_f32 v11, v14, v15
    v_min_u32 v10, -2, v10
    v_min_u32 v11, -2, v11
    s_mov_b64 exec, s[54:55]
    s_add_u32 s43, s42, 0
    buffer_store_dwordx2 v[10:11], v6, s[32:35], s43 offen sc1
    s_add_u32 s43, s42, 2097152
    buffer_store_dwordx2 v[10:11], v6, s[32:35], s43 offen sc1
    s_add_u32 s43, s42, 4194304
    buffer_store_dwordx2 v[10:11], v6, s[32:35], s43 offen sc1
    s_add_u32 s43, s42, 6291456
    buffer_store_dwordx2 v[10:11], v6, s[32:35], s43 offen sc1
    s_add_u32 s43, s42, 8388608
    buffer_store_dwordx2 v[10:11], v6, s[32:35], s43 offen sc1
    s_add_u32 s43, s42, 10485760
    buffer_store_dwordx2 v[10:11], v6, s[32:35], s43 offen sc1
    s_add_u32 s43, s42, 12582912
    buffer_store_dwordx2 v[10:11], v6, s[32:35], s43 offen sc1
    s_add_u32 s43, s42, 14680064
    buffer_store_dwordx2 v[10:11], v6, s[32:35], s43 offen sc1
    s_mov_b64 exec, -1
rd_next0:
    s_add_u32 s40, s40, 1
    s_add_u32 s41, s41, 65536
    s_add_u32 s42, s42, 10240
    s_cmp_ge_u32 s40, 63
    s_cbranch_scc1 ch_done
rd_step1:
    s_mov_b32 s46, 400000
    s_sleep 114
rd_poll1:
    s_mov_b32 s43, s41
    buffer_load_dwordx4 v[48:51], v5, s[32:35], s43 offen sc1
    s_add_u32 s43, s43, 512
    buffer_load_dwordx4 v[52:55], v5, s[32:35], s43 offen sc1
    s_add_u32 s43, s43, 512
    buffer_load_dwordx4 v[56:59], v5, s[32:35], s43 offen sc1
    s_add_u32 s43, s43, 512
    buffer_load_dwordx4 v[60:63], v5, s[32:35], s43 offen sc1
    s_add_u32 s43, s43, 512
    buffer_load_dwordx4 v[64:67], v5, s[32:35], s43 offen sc1
    s_add_u32 s43, s43, 512
    buffer_load_dwordx4 v[68:71], v5, s[32:35], s43 offen sc1
    s_add_u32 s43, s43, 512
    buffer_load_dwordx4 v[72:75], v5, s[32:35], s43 offen sc1
    s_add_u32 s43, s43, 512
    buffer_load_dwordx4 v[76:79], v5, s[32:35], s43 offen sc1
    s_add_u32 s43, s43, 512
    buffer_load_dwordx4 v[80:83], v5, s[32:35], s43 offen sc1
    s_add_u32 s43, s43, 512
    buffer_load_dwordx4 v[84:87], v5, s[32:35], s43 offen sc1
    s_add_u32 s43, s43, 512
    buffer_load_dwordx4 v[88:91], v5, s[32:35], s43 offen sc1
    s_add_u32 s43, s43, 512
    buffer_load_dwordx4 v[92:95], v5, s[32:35], s43 offen sc1
    s_add_u32 s43, s43, 512
    buffer_load_dwordx4 v[96:99], v5, s[32:35], s43 offen sc1
    s_add_u32 s43, s43, 512
    buffer_load_dwordx4 v[100:103], v5, s[32:35], s43 offen sc1
    s_add_u32 s43, s43, 512
    buffer_load_dwordx4 v[104:107], v5, s[32:35], s43 offen sc1
    s_add_u32 s43, s43, 512
    buffer_load_dwordx4 v[108:111], v5, s[32:35], s43 offen sc1
    s_waitcnt vmcnt(15)
    v_mfma_f32_16x16x32_bf16 v[12:15], a[0:3], v[48:51], 0
    v_mfma_f32_16x16x32_bf16 v[16:19], a[64:67], v[48:51], 0
    s_waitcnt vmcnt(14)
    v_mfma_f32_16x16x32_bf16 v[12:15], a[4:7], v[52:55], v[12:15]
    v_mfma_f32_16x16x32_bf16 v[16:19], a[68:71], v[52:55], v[16:19]
    s_waitcnt vmcnt(13)
    v_mfma_f32_16x16x32_bf16 v[12:15], a[8:11], v[56:59], v[12:15]
    v_mfma_f32_16x16x32_bf16 v[16:19], a[72:75], v[56:59], v[16:19]
    s_waitcnt vmcnt(12)
    v_mfma_f32_16x16x32_bf16 v[12:15], a[12:15], v[60:63], v[12:15]
    v_mfma_f32_16x16x32_bf16 v[16:19], a[76:79], v[60:63], v[16:19]
    s_waitcnt vmcnt(11)
    v_mfma_f32_16x16x32_bf16 v[12:15], a[16:19], v[64:67], v[12:15]
    v_mfma_f32_16x16x32_bf16 v[16:19], a[80:83], v[64:67], v[16:19]
    s_waitcnt vmcnt(10)
    v_mfma_f32_16x16x32_bf16 v[12:15], a[20:23], v[68:71], v[12:15]
    v_mfma_f32_16x16x32_bf16 v[16:19], a[84:87], v[68:71], v[16:19]
    s_waitcnt vmcnt(9)
    v_mfma_f32_16x16x32_bf16 v[12:15], a[24:27], v[72:75], v[12:15]
    v_mfma_f32_16x16x32_bf16 v[16:19], a[88:91], v[72:75], v[16:19]
    s_waitcnt vmcnt(8)
    v_mfma_f32_16x16x32_bf16 v[12:15], a[28:31], v[76:79], v[12:15]
    v_mfma_f32_16x16x32_bf16 v[16:19], a[92:95], v[76:79], v[16:19]
    s_waitcnt vmcnt(7)
    v_mfma_f32_16x16x32_bf16 v[12:15], a[32:35], v[80:83], v[12:15]
    v_mfma_f32_16x16x32_bf16 v[16:19], a[96:99], v[80:83], v[16:19]
    s_waitcnt vmcnt(6)
    v_mfma_f32_16x16x32_bf16 v[12:15], a[36:39], v[84:87], v[12:15]
    v_mfma_f32_16x16x32_bf16 v[16:19], a[100:103], v[84:87], v[16:19]
    s_waitcnt vmcnt(5)
    v_mfma_f32_16x16x32_bf16 v[12:15], a[40:43], v[88:91], v[12:15]
    v_mfma_f32_16x16x32_bf16 v[16:19], a[104:107], v[88:91], v[16:19]
    s_waitcnt vmcnt(4)
    v_mfma_f32_16x16x32_bf16 v[12:15], a[44:47], v[92:95], v[12:15]
    v_mfma_f32_16x16x32_bf16 v[16:19], a[108:111], v[92:95], v[16:19]
    s_waitcnt vmcnt(3)
    v_mfma_f32_16x16x32_bf16 v[12:15], a[48:51], v[96:99], v[12:15]
    v_mfma_f32_16x16x32_bf16 v[16:19], a[112:115], v[96:99], v[16:19]
    s_waitcnt vmcnt(2)
    v_mfma_f32_16x16x32_bf16 v[12:15], a[52:55], v[100:103], v[12:15]
    v_mfma_f32_16x16x32_bf16 v[16:19], a[116:119], v[100:103], v[16:19]
    s_waitcnt vmcnt(1)
    v_mfma_f32_16x16x32_bf16 v[12:15], a[56:59], v[104:107], v[12:15]
    v_mfma_f32_16x16x32_bf16 v[16:19], a[120:123], v[104:107], v[16:19]
    s_waitcnt vmcnt(0)
    v_mfma_f32_16x16x32_bf16 v[12:15], a[60:63], v[108:111], v[12:15]
    v_mfma_f32_16x16x32_bf16 v[16:19], a[124:127], v[108:111], v[16:19]
    s_nop 7
    v_mov_b32_dpp v16, v16 row_shl:8 row_mask:0xf bank_mask:0xf
    v_mov_b32_dpp v17, v17 row_shl:8 row_mask:0xf bank_mask:0xf
    v_mov_b32_dpp v18, v18 row_shl:8 row_mask:0xf bank_mask:0xf
    v_mov_b32_dpp v19, v19 row_shl:8 row_mask:0xf bank_mask:0xf
    v_add_f32 v12, v12, v16
    v_add_f32 v13, v13, v17
    v_add_f32 v14, v14, v18
    v_add_f32 v15, v15, v19
    v_add_f32 v8, v12, v13
    v_add_f32 v10, v14, v15
    v_add_f32 v8, v8, v10
    v_cmp_u_f32 vcc, v8, v8
    s_nop 0
    s_and_b64 s[58:59], vcc, s[54:55]
    s_nop 2
    s_cbranch_scc0 rd_ok1
    s_sub_u32 s46, s46, 1
    s_cmp_lg_u32 s46, 0
    s_cbranch_scc1 rd_poll1
rd_ok1:
    ds_write_b128 v7, v[12:15] offset:4096
    s_waitcnt lgkmcnt(0)
    s_barrier
    s_cmp_lg_u32 s3, 0
    s_cbranch_scc1 rd_next1
    ds_read_b128 v[20:23], v4 offset:5120
    ds_read_b128 v[24:27], v4 offset:6144
    ds_read_b128 v[28:31], v4 offset:7168
    s_waitcnt lgkmcnt(2)
    v_add_f32 v12, v12, v20
    v_add_f32 v13, v13, v21
    v_add_f32 v14, v14, v22
    v_add_f32 v15, v15, v23
    s_waitcnt lgkmcnt(1)
    v_add_f32 v12, v12, v24
    v_add_f32 v13, v13, v25
    v_add_f32 v14, v14, v26
    v_add_f32 v15, v15, v27
    s_waitcnt lgkmcnt(0)
    v_add_f32 v12, v12, v28
    v_add_f32 v13, v13, v29
    v_add_f32 v14, v14, v30
    v_add_f32 v15, v15, v31
    v_cvt_pk_bf16_f32 v10, v12, v13
    v_cvt_pk_bf16_f32 v11, v14, v15
    v_min_u32 v10, -2, v10
    v_min_u32 v11, -2, v11
    s_mov_b64 exec, s[54:55]
    s_add_u32 s43, s42, 0
    buffer_store_dwordx2 v[10:11], v6, s[32:35], s43 offen sc1
    s_add_u32 s43, s42, 2097152
    buffer_store_dwordx2 v[10:11], v6, s[32:35], s43 offen sc1
    s_add_u32 s43, s42, 4194304
    buffer_store_dwordx2 v[10:11], v6, s[32:35], s43 offen sc1
    s_add_u32 s43, s42, 6291456
    buffer_store_dwordx2 v[10:11], v6, s[32:35], s43 offen sc1
    s_add_u32 s43, s42, 8388608
    buffer_store_dwordx2 v[10:11], v6, s[32:35], s43 offen sc1
    s_add_u32 s43, s42, 10485760
    buffer_store_dwordx2 v[10:11], v6, s[32:35], s43 offen sc1
    s_add_u32 s43, s42, 12582912
    buffer_store_dwordx2 v[10:11], v6, s[32:35], s43 offen sc1
    s_add_u32 s43, s42, 14680064
    buffer_store_dwordx2 v[10:11], v6, s[32:35], s43 offen sc1
    s_mov_b64 exec, -1
rd_next1:
    s_add_u32 s40, s40, 1
    s_add_u32 s41, s41, 65536
    s_add_u32 s42, s42, 10240
    s_cmp_ge_u32 s40, 63
    s_cbranch_scc0 rd_step0
    s_endpgm
ch_done:
    s_endpgm
ch_gemm:
    s_sub_u32 s2, s2, 72
    s_load_dwordx2 s[4:5], s[0:1], 16
    s_load_dwordx2 s[6:7], s[0:1], 24
    s_load_dwordx2 s[8:9], s[0:1], 32
    s_load_dwordx2 s[10:11], s[0:1], 72
    s_load_dwordx2 s[12:13], s[0:1], 112
    s_load_dwordx2 s[14:15], s[0:1], 80
    v_and_b32 v1, 63, v0
    v_lshrrev_b32 v2, 6, v0
    s_nop 0
    v_readfirstlane_b32 s3, v2
    v_lshrrev_b32 v8, 4, v1
    v_and_b32 v9, 15, v1
    s_waitcnt lgkmcnt(0)
    s_mov_b32 s32, s12
    s_and_b32 s33, s13, 0xffff
    s_mov_b32 s34, 268435456
    s_mov_b32 s35, 0x00020000
    s_cmp_ge_u32 s2, 144
    s_cbranch_scc1 moe1_start
    s_mul_i32 s36, s2, 1366
    s_lshr_b32 s36, s36, 16
    s_mul_i32 s37, s36, 48
    s_sub_u32 s37, s2, s37
    s_lshr_b32 s38, s37, 4
    s_and_b32 s39, s37, 15
    s_cmp_eq_u32 s38, 1
    s_cselect_b32 s4, s6, s4
    s_cselect_b32 s5, s7, s5
    s_cmp_eq_u32 s38, 2
    s_cselect_b32 s4, s8, s4
    s_cselect_b32 s5, s9, s5
    s_mov_b32 s28, s4
    s_and_b32 s29, s5, 0xffff
    s_mov_b32 s30, 5242880
    s_mov_b32 s31, 0x00020000
    s_cmp_eq_u32 s38, 0
    s_cselect_b32 s47, 1, s36
    s_cmp_eq_u32 s47, 0
    s_cbranch_scc1 g1_urgent
g1_urgent:
    s_mul_i32 s42, s36, 43
    s_add_u32 s46, s42, 43
    s_min_u32 s46, s46, 128
    s_mov_b32 s49, s42
    s_lshl_b32 s52, s37, 9
    s_add_u32 s52, s52, 3342332
    v_mov_b32 v11, 1
    v_mov_b32 v12, 0
    s_lshl_b32 s44, s39, 1
    s_lshr_b32 s45, s3, 1
    s_add_u32 s44, s44, s45
    s_and_b32 s45, s3, 1
    s_lshl_b32 s47, s44, 8
    s_lshl_b32 s48, s45, 7
    s_add_u32 s47, s47, s48
    v_lshlrev_b32 v7, 16, v8
    v_lshl_add_u32 v7, v9, 3, v7
    v_add_u32 v7, s47, v7
    s_lshl_b32 s44, s44, 13
    s_lshl_b32 s47, s38, 24
    s_add_u32 s44, s44, s47
    s_add_u32 s44, s44, 33554432
    s_lshl_b32 s47, s45, 12
    v_lshlrev_b32 v6, 4, v1
    v_add_u32 v6, s47, v6
    v_mul_u32_u24 v3, 1280, v9
    v_lshl_add_u32 v3, v8, 4, v3
    s_mul_i32 s47, s3, 320
    v_add_u32 v3, s47, v3
    v_lshlrev_b32 v5, 4, v1
    s_mul_i32 s47, s3, 5120
    v_add_u32 v4, s47, v5
    s_mul_i32 s40, s42, 20480
    buffer_load_dwordx4 v[32:35], v3, s[32:35], s40 offen offset:0
    buffer_load_dwordx4 v[36:39], v3, s[32:35], s40 offen offset:64
    buffer_load_dwordx4 v[40:43], v3, s[32:35], s40 offen offset:128
    buffer_load_dwordx4 v[44:47], v3, s[32:35], s40 offen offset:192
    buffer_load_dwordx4 v[48:51], v3, s[32:35], s40 offen offset:256
    s_mov_b32 s50, 0x05040100
    s_mov_b32 s51, 0x07060302
    s_mov_b32 s47, 0
    buffer_load_dwordx2 v[96:97], v7, s[28:31], s47 offen
    s_mov_b32 s47, 8192
    buffer_load_dwordx2 v[98:99], v7, s[28:31], s47 offen
    s_mov_b32 s47, 16384
    buffer_load_dwordx2 v[100:101], v7, s[28:31], s47 offen
    s_mov_b32 s47, 24576
    buffer_load_dwordx2 v[102:103], v7, s[28:31], s47 offen
    s_mov_b32 s47, 32768
    buffer_load_dwordx2 v[104:105], v7, s[28:31], s47 offen
    s_mov_b32 s47, 40960
    buffer_load_dwordx2 v[106:107], v7, s[28:31], s47 offen
    s_mov_b32 s47, 49152
    buffer_load_dwordx2 v[108:109], v7, s[28:31], s47 offen
    s_mov_b32 s47, 57344
    buffer_load_dwordx2 v[110:111], v7, s[28:31], s47 offen
    s_mov_b32 s47, 262144
    buffer_load_dwordx2 v[112:113], v7, s[28:31], s47 offen
    s_mov_b32 s47, 270336
    buffer_load_dwordx2 v[114:115], v7, s[28:31], s47 offen
    s_mov_b32 s47, 278528
    buffer_load_dwordx2 v[116:117], v7, s[28:31], s47 offen
    s_mov_b32 s47, 286720
    buffer_load_dwordx2 v[118:119], v7, s[28:31], s47 offen
    s_mov_b32 s47, 294912
    buffer_load_dwordx2 v[120:121], v7, s[28:31], s47 offen
    s_mov_b32 s47, 303104
    buffer_load_dwordx2 v[122:123], v7, s[28:31], s47 offen
    s_mov_b32 s47, 311296
    buffer_load_dwordx2 v[124:125], v7, s[28:31], s47 offen
    s_mov_b32 s47, 319488
    buffer_load_dwordx2 v[126:127], v7, s[28:31], s47 offen
    s_mov_b32 s47, 524288
    buffer_load_dwordx2 v[128:129], v7, s[28:31], s47 offen
    s_mov_b32 s47, 532480
    buffer_load_dwordx2 v[130:131], v7, s[28:31], s47 offen
    s_mov_b32 s47, 540672
    buffer_load_dwordx2 v[132:133], v7, s[28:31], s47 offen
    s_mov_b32 s47, 548864
    buffer_load_dwordx2 v[134:135], v7, s[28:31], s47 offen
    s_mov_b32 s47, 557056
    buffer_load_dwordx2 v[136:137], v7, s[28:31], s47 offen
    s_mov_b32 s47, 565248
    buffer_load_dwordx2 v[138:139], v7, s[28:31], s47 offen
    s_mov_b32 s47, 573440
    buffer_load_dwordx2 v[140:141], v7, s[28:31], s47 offen
    s_mov_b32 s47, 581632
    buffer_load_dwordx2 v[142:143], v7, s[28:31], s47 offen
    s_mov_b32 s47, 786432
    buffer_load_dwordx2 v[144:145], v7, s[28:31], s47 offen
    s_mov_b32 s47, 794624
    buffer_load_dwordx2 v[146:147], v7, s[28:31], s47 offen
    s_mov_b32 s47, 802816
    buffer_load_dwordx2 v[148:149], v7, s[28:31], s47 offen
    s_mov_b32 s47, 811008
    buffer_load_dwordx2 v[150:151], v7, s[28:31], s47 offen
    s_mov_b32 s47, 819200
    buffer_load_dwordx2 v[152:153], v7, s[28:31], s47 offen
    s_mov_b32 s47, 827392
    buffer_load_dwordx2 v[154:155], v7, s[28:31], s47 offen
    s_mov_b32 s47, 835584
    buffer_load_dwordx2 v[156:157], v7, s[28:31], s47 offen
    s_mov_b32 s47, 843776
    buffer_load_dwordx2 v[158:159], v7, s[28:31], s47 offen
    s_waitcnt vmcnt(24)
    v_perm_b32 v10, v98, v96, s50
    v_accvgpr_write_b32 a0, v10
    v_perm_b32 v10, v102, v100, s50
    v_accvgpr_write_b32 a1, v10
    v_perm_b32 v10, v106, v104, s50
    v_accvgpr_write_b32 a2, v10
    v_perm_b32 v10, v110, v108, s50
    v_accvgpr_write_b32 a3, v10
    v_perm_b32 v10, v98, v96, s51
    v_accvgpr_write_b32 a4, v10
    v_perm_b32 v10, v102, v100, s51
    v_accvgpr_write_b32 a5, v10
    v_perm_b32 v10, v106, v104, s51
    v_accvgpr_write_b32 a6, v10
    v_perm_b32 v10, v110, v108, s51
    v_accvgpr_write_b32 a7, v10
    v_perm_b32 v10, v99, v97, s50
    v_accvgpr_write_b32 a8, v10
    v_perm_b32 v10, v103, v101, s50
    v_accvgpr_write_b32 a9, v10
    v_perm_b32 v10, v107, v105, s50
    v_accvgpr_write_b32 a10, v10
    v_perm_b32 v10, v111, v109, s50
    v_accvgpr_write_b32 a11, v10
    v_perm_b32 v10, v99, v97, s51
    v_accvgpr_write_b32 a12, v10
    v_perm_b32 v10, v103, v101, s51
    v_accvgpr_write_b32 a13, v10
    v_perm_b32 v10, v107, v105, s51
    v_accvgpr_write_b32 a14, v10
    v_perm_b32 v10, v111, v109, s51
    v_accvgpr_write_b32 a15, v10
    s_mov_b32 s47, 1048576
    buffer_load_dwordx2 v[96:97], v7, s[28:31], s47 offen
    s_mov_b32 s47, 1056768
    buffer_load_dwordx2 v[98:99], v7, s[28:31], s47 offen
    s_mov_b32 s47, 1064960
    buffer_load_dwordx2 v[100:101], v7, s[28:31], s47 offen
    s_mov_b32 s47, 1073152
    buffer_load_dwordx2 v[102:103], v7, s[28:31], s47 offen
    s_mov_b32 s47, 1081344
    buffer_load_dwordx2 v[104:105], v7, s[28:31], s47 offen
    s_mov_b32 s47, 1089536
    buffer_load_dwordx2 v[106:107], v7, s[28:31], s47 offen
    s_mov_b32 s47, 1097728
    buffer_load_dwordx2 v[108:109], v7, s[28:31], s47 offen
    s_mov_b32 s47, 1105920
    buffer_load_dwordx2 v[110:111], v7, s[28:31], s47 offen
    s_waitcnt vmcnt(24)
    v_perm_b32 v10, v114, v112, s50
    v_accvgpr_write_b32 a16, v10
    v_perm_b32 v10, v118, v116, s50
    v_accvgpr_write_b32 a17, v10
    v_perm_b32 v10, v122, v120, s50
    v_accvgpr_write_b32 a18, v10
    v_perm_b32 v10, v126, v124, s50
    v_accvgpr_write_b32 a19, v10
    v_perm_b32 v10, v114, v112, s51
    v_accvgpr_write_b32 a20, v10
    v_perm_b32 v10, v118, v116, s51
    v_accvgpr_write_b32 a21, v10
    v_perm_b32 v10, v122, v120, s51
    v_accvgpr_write_b32 a22, v10
    v_perm_b32 v10, v126, v124, s51
    v_accvgpr_write_b32 a23, v10
    v_perm_b32 v10, v115, v113, s50
    v_accvgpr_write_b32 a24, v10
    v_perm_b32 v10, v119, v117, s50
    v_accvgpr_write_b32 a25, v10
    v_perm_b32 v10, v123, v121, s50
    v_accvgpr_write_b32 a26, v10
    v_perm_b32 v10, v127, v125, s50
    v_accvgpr_write_b32 a27, v10
    v_perm_b32 v10, v115, v113, s51
    v_accvgpr_write_b32 a28, v10
    v_perm_b32 v10, v119, v117, s51
    v_accvgpr_write_b32 a29, v10
    v_perm_b32 v10, v123, v121, s51
    v_accvgpr_write_b32 a30, v10
    v_perm_b32 v10, v127, v125, s51
    v_accvgpr_write_b32 a31, v10
    s_mov_b32 s47, 1310720
    buffer_load_dwordx2 v[112:113], v7, s[28:31], s47 offen
    s_mov_b32 s47, 1318912
    buffer_load_dwordx2 v[114:115], v7, s[28:31], s47 offen
    s_mov_b32 s47, 1327104
    buffer_load_dwordx2 v[116:117], v7, s[28:31], s47 offen
    s_mov_b32 s47, 1335296
    buffer_load_dwordx2 v[118:119], v7, s[28:31], s47 offen
    s_mov_b32 s47, 1343488
    buffer_load_dwordx2 v[120:121], v7, s[28:31], s47 offen
    s_mov_b32 s47, 1351680
    buffer_load_dwordx2 v[122:123], v7, s[28:31], s47 offen
    s_mov_b32 s47, 1359872
    buffer_load_dwordx2 v[124:125], v7, s[28:31], s47 offen
    s_mov_b32 s47, 1368064
    buffer_load_dwordx2 v[126:127], v7, s[28:31], s47 offen
    s_waitcnt vmcnt(24)
    v_perm_b32 v10, v130, v128, s50
    v_accvgpr_write_b32 a32, v10
    v_perm_b32 v10, v134, v132, s50
    v_accvgpr_write_b32 a33, v10
    v_perm_b32 v10, v138, v136, s50
    v_accvgpr_write_b32 a34, v10
    v_perm_b32 v10, v142, v140, s50
    v_accvgpr_write_b32 a35, v10
    v_perm_b32 v10, v130, v128, s51
    v_accvgpr_write_b32 a36, v10
    v_perm_b32 v10, v134, v132, s51
    v_accvgpr_write_b32 a37, v10
    v_perm_b32 v10, v138, v136, s51
    v_accvgpr_write_b32 a38, v10
    v_perm_b32 v10, v142, v140, s51
    v_accvgpr_write_b32 a39, v10
    v_perm_b32 v10, v131, v129, s50
    v_accvgpr_write_b32 a40, v10
    v_perm_b32 v10, v135, v133, s50
    v_accvgpr_write_b32 a41, v10
    v_perm_b32 v10, v139, v137, s50
    v_accvgpr_write_b32 a42, v10
    v_perm_b32 v10, v143, v141, s50
    v_accvgpr_write_b32 a43, v10
    v_perm_b32 v10, v131, v129, s51
    v_accvgpr_write_b32 a44, v10
    v_perm_b32 v10, v135, v133, s51
    v_accvgpr_write_b32 a45, v10
    v_perm_b32 v10, v139, v137, s51
    v_accvgpr_write_b32 a46, v10
    v_perm_b32 v10, v143, v141, s51
    v_accvgpr_write_b32 a47, v10
    s_mov_b32 s47, 1572864
    buffer_load_dwordx2 v[128:129], v7, s[28:31], s47 offen
    s_mov_b32 s47, 1581056
    buffer_load_dwordx2 v[130:131], v7, s[28:31], s47 offen
    s_mov_b32 s47, 1589248
    buffer_load_dwordx2 v[132:133], v7, s[28:31], s47 offen
    s_mov_b32 s47, 1597440
    buffer_load_dwordx2 v[134:135], v7, s[28:31], s47 offen
    s_mov_b32 s47, 1605632
    buffer_load_dwordx2 v[136:137], v7, s[28:31], s47 offen
    s_mov_b32 s47, 1613824
    buffer_load_dwordx2 v[138:139], v7, s[28:31], s47 offen
    s_mov_b32 s47, 1622016
    buffer_load_dwordx2 v[140:141], v7, s[28:31], s47 offen
    s_mov_b32 s47, 1630208
    buffer_load_dwordx2 v[142:143], v7, s[28:31], s47 offen
    s_waitcnt vmcnt(24)
    v_perm_b32 v10, v146, v144, s50
    v_accvgpr_write_b32 a48, v10
    v_perm_b32 v10, v150, v148, s50
    v_accvgpr_write_b32 a49, v10
    v_perm_b32 v10, v154, v152, s50
    v_accvgpr_write_b32 a50, v10
    v_perm_b32 v10, v158, v156, s50
    v_accvgpr_write_b32 a51, v10
    v_perm_b32 v10, v146, v144, s51
    v_accvgpr_write_b32 a52, v10
    v_perm_b32 v10, v150, v148, s51
    v_accvgpr_write_b32 a53, v10
    v_perm_b32 v10, v154, v152, s51
    v_accvgpr_write_b32 a54, v10
    v_perm_b32 v10, v158, v156, s51
    v_accvgpr_write_b32 a55, v10
    v_perm_b32 v10, v147, v145, s50
    v_accvgpr_write_b32 a56, v10
    v_perm_b32 v10, v151, v149, s50
    v_accvgpr_write_b32 a57, v10
    v_perm_b32 v10, v155, v153, s50
    v_accvgpr_write_b32 a58, v10
    v_perm_b32 v10, v159, v157, s50
    v_accvgpr_write_b32 a59, v10
    v_perm_b32 v10, v147, v145, s51
    v_accvgpr_write_b32 a60, v10
    v_perm_b32 v10, v151, v149, s51
    v_accvgpr_write_b32 a61, v10
    v_perm_b32 v10, v155, v153, s51
    v_accvgpr_write_b32 a62, v10
    v_perm_b32 v10, v159, v157, s51
    v_accvgpr_write_b32 a63, v10
    s_mov_b32 s47, 1835008
    buffer_load_dwordx2 v[144:145], v7, s[28:31], s47 offen
    s_mov_b32 s47, 1843200
    buffer_load_dwordx2 v[146:147], v7, s[28:31], s47 offen
    s_mov_b32 s47, 1851392
    buffer_load_dwordx2 v[148:149], v7, s[28:31], s47 offen
    s_mov_b32 s47, 1859584
    buffer_load_dwordx2 v[150:151], v7, s[28:31], s47 offen
    s_mov_b32 s47, 1867776
    buffer_load_dwordx2 v[152:153], v7, s[28:31], s47 offen
    s_mov_b32 s47, 1875968
    buffer_load_dwordx2 v[154:155], v7, s[28:31], s47 offen
    s_mov_b32 s47, 1884160
    buffer_load_dwordx2 v[156:157], v7, s[28:31], s47 offen
    s_mov_b32 s47, 1892352
    buffer_load_dwordx2 v[158:159], v7, s[28:31], s47 offen
    s_waitcnt vmcnt(24)
    v_perm_b32 v10, v98, v96, s50
    v_accvgpr_write_b32 a64, v10
    v_perm_b32 v10, v102, v100, s50
    v_accvgpr_write_b32 a65, v10
    v_perm_b32 v10, v106, v104, s50
    v_accvgpr_write_b32 a66, v10
    v_perm_b32 v10, v110, v108, s50
    v_accvgpr_write_b32 a67, v10
    v_perm_b32 v10, v98, v96, s51
    v_accvgpr_write_b32 a68, v10
    v_perm_b32 v10, v102, v100, s51
    v_accvgpr_write_b32 a69, v10
    v_perm_b32 v10, v106, v104, s51
    v_accvgpr_write_b32 a70, v10
    v_perm_b32 v10, v110, v108, s51
    v_accvgpr_write_b32 a71, v10
    v_perm_b32 v10, v99, v97, s50
    v_accvgpr_write_b32 a72, v10
    v_perm_b32 v10, v103, v101, s50
    v_accvgpr_write_b32 a73, v10
    v_perm_b32 v10, v107, v105, s50
    v_accvgpr_write_b32 a74, v10
    v_perm_b32 v10, v111, v109, s50
    v_accvgpr_write_b32 a75, v10
    v_perm_b32 v10, v99, v97, s51
    v_accvgpr_write_b32 a76, v10
    v_perm_b32 v10, v103, v101, s51
    v_accvgpr_write_b32 a77, v10
    v_perm_b32 v10, v107, v105, s51
    v_accvgpr_write_b32 a78, v10
    v_perm_b32 v10, v111, v109, s51
    v_accvgpr_write_b32 a79, v10
    s_mov_b32 s47, 2097152
    buffer_load_dwordx2 v[96:97], v7, s[28:31], s47 offen
    s_mov_b32 s47, 2105344
    buffer_load_dwordx2 v[98:99], v7, s[28:31], s47 offen
    s_mov_b32 s47, 2113536
    buffer_load_dwordx2 v[100:101], v7, s[28:31], s47 offen
    s_mov_b32 s47, 2121728
    buffer_load_dwordx2 v[102:103], v7, s[28:31], s47 offen
    s_mov_b32 s47, 2129920
    buffer_load_dwordx2 v[104:105], v7, s[28:31], s47 offen
    s_mov_b32 s47, 2138112
    buffer_load_dwordx2 v[106:107], v7, s[28:31], s47 offen
    s_mov_b32 s47, 2146304
    buffer_load_dwordx2 v[108:109], v7, s[28:31], s47 offen
    s_mov_b32 s47, 2154496
    buffer_load_dwordx2 v[110:111], v7, s[28:31], s47 offen
    s_waitcnt vmcnt(24)
    v_perm_b32 v10, v114, v112, s50
    v_accvgpr_write_b32 a80, v10
    v_perm_b32 v10, v118, v116, s50
    v_accvgpr_write_b32 a81, v10
    v_perm_b32 v10, v122, v120, s50
    v_accvgpr_write_b32 a82, v10
    v_perm_b32 v10, v126, v124, s50
    v_accvgpr_write_b32 a83, v10
    v_perm_b32 v10, v114, v112, s51
    v_accvgpr_write_b32 a84, v10
    v_perm_b32 v10, v118, v116, s51
    v_accvgpr_write_b32 a85, v10
    v_perm_b32 v10, v122, v120, s51
    v_accvgpr_write_b32 a86, v10
    v_perm_b32 v10, v126, v124, s51
    v_accvgpr_write_b32 a87, v10
    v_perm_b32 v10, v115, v113, s50
    v_accvgpr_write_b32 a88, v10
    v_perm_b32 v10, v119, v117, s50
    v_accvgpr_write_b32 a89, v10
    v_perm_b32 v10, v123, v121, s50
    v_accvgpr_write_b32 a90, v10
    v_perm_b32 v10, v127, v125, s50
    v_accvgpr_write_b32 a91, v10
    v_perm_b32 v10, v115, v113, s51
    v_accvgpr_write_b32 a92, v10
    v_perm_b32 v10, v119, v117, s51
    v_accvgpr_write_b32 a93, v10
    v_perm_b32 v10, v123, v121, s51
    v_accvgpr_write_b32 a94, v10
    v_perm_b32 v10, v127, v125, s51
    v_accvgpr_write_b32 a95, v10
    s_mov_b32 s47, 2359296
    buffer_load_dwordx2 v[112:113], v7, s[28:31], s47 offen
    s_mov_b32 s47, 2367488
    buffer_load_dwordx2 v[114:115], v7, s[28:31], s47 offen
    s_mov_b32 s47, 2375680
    buffer_load_dwordx2 v[116:117], v7, s[28:31], s47 offen
    s_mov_b32 s47, 2383872
    buffer_load_dwordx2 v[118:119], v7, s[28:31], s47 offen
    s_mov_b32 s47, 2392064
    buffer_load_dwordx2 v[120:121], v7, s[28:31], s47 offen
    s_mov_b32 s47, 2400256
    buffer_load_dwordx2 v[122:123], v7, s[28:31], s47 offen
    s_mov_b32 s47, 2408448
    buffer_load_dwordx2 v[124:125], v7, s[28:31], s47 offen
    s_mov_b32 s47, 2416640
    buffer_load_dwordx2 v[126:127], v7, s[28:31], s47 offen
    s_waitcnt vmcnt(24)
    v_perm_b32 v10, v130, v128, s50
    v_accvgpr_write_b32 a96, v10
    v_perm_b32 v10, v134, v132, s50
    v_accvgpr_write_b32 a97, v10
    v_perm_b32 v10, v138, v136, s50
    v_accvgpr_write_b32 a98, v10
    v_perm_b32 v10, v142, v140, s50
    v_accvgpr_write_b32 a99, v10
    v_perm_b32 v10, v130, v128, s51
    v_accvgpr_write_b32 a100, v10
    v_perm_b32 v10, v134, v132, s51
    v_accvgpr_write_b32 a101, v10
    v_perm_b32 v10, v138, v136, s51
    v_accvgpr_write_b32 a102, v10
    v_perm_b32 v10, v142, v140, s51
    v_accvgpr_write_b32 a103, v10
    v_perm_b32 v10, v131, v129, s50
    v_accvgpr_write_b32 a104, v10
    v_perm_b32 v10, v135, v133, s50
    v_accvgpr_write_b32 a105, v10
    v_perm_b32 v10, v139, v137, s50
    v_accvgpr_write_b32 a106, v10
    v_perm_b32 v10, v143, v141, s50
    v_accvgpr_write_b32 a107, v10
    v_perm_b32 v10, v131, v129, s51
    v_accvgpr_write_b32 a108, v10
    v_perm_b32 v10, v135, v133, s51
    v_accvgpr_write_b32 a109, v10
    v_perm_b32 v10, v139, v137, s51
    v_accvgpr_write_b32 a110, v10
    v_perm_b32 v10, v143, v141, s51
    v_accvgpr_write_b32 a111, v10
    s_mov_b32 s47, 2621440
    buffer_load_dwordx2 v[128:129], v7, s[28:31], s47 offen
    s_mov_b32 s47, 2629632
    buffer_load_dwordx2 v[130:131], v7, s[28:31], s47 offen
    s_mov_b32 s47, 2637824
    buffer_load_dwordx2 v[132:133], v7, s[28:31], s47 offen
    s_mov_b32 s47, 2646016
    buffer_load_dwordx2 v[134:135], v7, s[28:31], s47 offen
    s_mov_b32 s47, 2654208
    buffer_load_dwordx2 v[136:137], v7, s[28:31], s47 offen
    s_mov_b32 s47, 2662400
    buffer_load_dwordx2 v[138:139], v7, s[28:31], s47 offen
    s_mov_b32 s47, 2670592
    buffer_load_dwordx2 v[140:141], v7, s[28:31], s47 offen
    s_mov_b32 s47, 2678784
    buffer_load_dwordx2 v[142:143], v7, s[28:31], s47 offen
    s_waitcnt vmcnt(24)
    v_perm_b32 v10, v146, v144, s50
    v_accvgpr_write_b32 a112, v10
    v_perm_b32 v10, v150, v148, s50
    v_accvgpr_write_b32 a113, v10
    v_perm_b32 v10, v154, v152, s50
    v_accvgpr_write_b32 a114, v10
    v_perm_b32 v10, v158, v156, s50
    v_accvgpr_write_b32 a115, v10
    v_perm_b32 v10, v146, v144, s51
    v_accvgpr_write_b32 a116, v10
    v_perm_b32 v10, v150, v148, s51
    v_accvgpr_write_b32 a117, v10
    v_perm_b32 v10, v154, v152, s51
    v_accvgpr_write_b32 a118, v10
    v_perm_b32 v10, v158, v156, s51
    v_accvgpr_write_b32 a119, v10
    v_perm_b32 v10, v147, v145, s50
    v_accvgpr_write_b32 a120, v10
    v_perm_b32 v10, v151, v149, s50
    v_accvgpr_write_b32 a121, v10
    v_perm_b32 v10, v155, v153, s50
    v_accvgpr_write_b32 a122, v10
    v_perm_b32 v10, v159, v157, s50
    v_accvgpr_write_b32 a123, v10
    v_perm_b32 v10, v147, v145, s51
    v_accvgpr_write_b32 a124, v10
    v_perm_b32 v10, v151, v149, s51
    v_accvgpr_write_b32 a125, v10
    v_perm_b32 v10, v155, v153, s51
    v_accvgpr_write_b32 a126, v10
    v_perm_b32 v10, v159, v157, s51
    v_accvgpr_write_b32 a127, v10
    s_mov_b32 s47, 2883584
    buffer_load_dwordx2 v[144:145], v7, s[28:31], s47 offen
    s_mov_b32 s47, 2891776
    buffer_load_dwordx2 v[146:147], v7, s[28:31], s47 offen
    s_mov_b32 s47, 2899968
    buffer_load_dwordx2 v[148:149], v7, s[28:31], s47 offen
    s_mov_b32 s47, 2908160
    buffer_load_dwordx2 v[150:151], v7, s[28:31], s47 offen
    s_mov_b32 s47, 2916352
    buffer_load_dwordx2 v[152:153], v7, s[28:31], s47 offen
    s_mov_b32 s47, 2924544
    buffer_load_dwordx2 v[154:155], v7, s[28:31], s47 offen
    s_mov_b32 s47, 2932736
    buffer_load_dwordx2 v[156:157], v7, s[28:31], s47 offen
    s_mov_b32 s47, 2940928
    buffer_load_dwordx2 v[158:159], v7, s[28:31], s47 offen
    s_waitcnt vmcnt(24)
    v_perm_b32 v10, v98, v96, s50
    v_accvgpr_write_b32 a128, v10
    v_perm_b32 v10, v102, v100, s50
    v_accvgpr_write_b32 a129, v10
    v_perm_b32 v10, v106, v104, s50
    v_accvgpr_write_b32 a130, v10
    v_perm_b32 v10, v110, v108, s50
    v_accvgpr_write_b32 a131, v10
    v_perm_b32 v10, v98, v96, s51
    v_accvgpr_write_b32 a132, v10
    v_perm_b32 v10, v102, v100, s51
    v_accvgpr_write_b32 a133, v10
    v_perm_b32 v10, v106, v104, s51
    v_accvgpr_write_b32 a134, v10
    v_perm_b32 v10, v110, v108, s51
    v_accvgpr_write_b32 a135, v10
    v_perm_b32 v10, v99, v97, s50
    v_accvgpr_write_b32 a136, v10
    v_perm_b32 v10, v103, v101, s50
    v_accvgpr_write_b32 a137, v10
    v_perm_b32 v10, v107, v105, s50
    v_accvgpr_write_b32 a138, v10
    v_perm_b32 v10, v111, v109, s50
    v_accvgpr_write_b32 a139, v10
    v_perm_b32 v10, v99, v97, s51
    v_accvgpr_write_b32 a140, v10
    v_perm_b32 v10, v103, v101, s51
    v_accvgpr_write_b32 a141, v10
    v_perm_b32 v10, v107, v105, s51
    v_accvgpr_write_b32 a142, v10
    v_perm_b32 v10, v111, v109, s51
    v_accvgpr_write_b32 a143, v10
    s_mov_b32 s47, 3145728
    buffer_load_dwordx2 v[96:97], v7, s[28:31], s47 offen
    s_mov_b32 s47, 3153920
    buffer_load_dwordx2 v[98:99], v7, s[28:31], s47 offen
    s_mov_b32 s47, 3162112
    buffer_load_dwordx2 v[100:101], v7, s[28:31], s47 offen
    s_mov_b32 s47, 3170304
    buffer_load_dwordx2 v[102:103], v7, s[28:31], s47 offen
    s_mov_b32 s47, 3178496
    buffer_load_dwordx2 v[104:105], v7, s[28:31], s47 offen
    s_mov_b32 s47, 3186688
    buffer_load_dwordx2 v[106:107], v7, s[28:31], s47 offen
    s_mov_b32 s47, 3194880
    buffer_load_dwordx2 v[108:109], v7, s[28:31], s47 offen
    s_mov_b32 s47, 3203072
    buffer_load_dwordx2 v[110:111], v7, s[28:31], s47 offen
    s_waitcnt vmcnt(24)
    v_perm_b32 v10, v114, v112, s50
    v_accvgpr_write_b32 a144, v10
    v_perm_b32 v10, v118, v116, s50
    v_accvgpr_write_b32 a145, v10
    v_perm_b32 v10, v122, v120, s50
    v_accvgpr_write_b32 a146, v10
    v_perm_b32 v10, v126, v124, s50
    v_accvgpr_write_b32 a147, v10
    v_perm_b32 v10, v114, v112, s51
    v_accvgpr_write_b32 a148, v10
    v_perm_b32 v10, v118, v116, s51
    v_accvgpr_write_b32 a149, v10
    v_perm_b32 v10, v122, v120, s51
    v_accvgpr_write_b32 a150, v10
    v_perm_b32 v10, v126, v124, s51
    v_accvgpr_write_b32 a151, v10
    v_perm_b32 v10, v115, v113, s50
    v_accvgpr_write_b32 a152, v10
    v_perm_b32 v10, v119, v117, s50
    v_accvgpr_write_b32 a153, v10
    v_perm_b32 v10, v123, v121, s50
    v_accvgpr_write_b32 a154, v10
    v_perm_b32 v10, v127, v125, s50
    v_accvgpr_write_b32 a155, v10
    v_perm_b32 v10, v115, v113, s51
    v_accvgpr_write_b32 a156, v10
    v_perm_b32 v10, v119, v117, s51
    v_accvgpr_write_b32 a157, v10
    v_perm_b32 v10, v123, v121, s51
    v_accvgpr_write_b32 a158, v10
    v_perm_b32 v10, v127, v125, s51
    v_accvgpr_write_b32 a159, v10
    s_mov_b32 s47, 3407872
    buffer_load_dwordx2 v[112:113], v7, s[28:31], s47 offen
    s_mov_b32 s47, 3416064
    buffer_load_dwordx2 v[114:115], v7, s[28:31], s47 offen
    s_mov_b32 s47, 3424256
    buffer_load_dwordx2 v[116:117], v7, s[28:31], s47 offen
    s_mov_b32 s47, 3432448
    buffer_load_dwordx2 v[118:119], v7, s[28:31], s47 offen
    s_mov_b32 s47, 3440640
    buffer_load_dwordx2 v[120:121], v7, s[28:31], s47 offen
    s_mov_b32 s47, 3448832
    buffer_load_dwordx2 v[122:123], v7, s[28:31], s47 offen
    s_mov_b32 s47, 3457024
    buffer_load_dwordx2 v[124:125], v7, s[28:31], s47 offen
    s_mov_b32 s47, 3465216
    buffer_load_dwordx2 v[126:127], v7, s[28:31], s47 offen
    s_waitcnt vmcnt(24)
    v_perm_b32 v10, v130, v128, s50
    v_accvgpr_write_b32 a160, v10
    v_perm_b32 v10, v134, v132, s50
    v_accvgpr_write_b32 a161, v10
    v_perm_b32 v10, v138, v136, s50
    v_accvgpr_write_b32 a162, v10
    v_perm_b32 v10, v142, v140, s50
    v_accvgpr_write_b32 a163, v10
    v_perm_b32 v10, v130, v128, s51
    v_accvgpr_write_b32 a164, v10
    v_perm_b32 v10, v134, v132, s51
    v_accvgpr_write_b32 a165, v10
    v_perm_b32 v10, v138, v136, s51
    v_accvgpr_write_b32 a166, v10
    v_perm_b32 v10, v142, v140, s51
    v_accvgpr_write_b32 a167, v10
    v_perm_b32 v10, v131, v129, s50
    v_accvgpr_write_b32 a168, v10
    v_perm_b32 v10, v135, v133, s50
    v_accvgpr_write_b32 a169, v10
    v_perm_b32 v10, v139, v137, s50
    v_accvgpr_write_b32 a170, v10
    v_perm_b32 v10, v143, v141, s50
    v_accvgpr_write_b32 a171, v10
    v_perm_b32 v10, v131, v129, s51
    v_accvgpr_write_b32 a172, v10
    v_perm_b32 v10, v135, v133, s51
    v_accvgpr_write_b32 a173, v10
    v_perm_b32 v10, v139, v137, s51
    v_accvgpr_write_b32 a174, v10
    v_perm_b32 v10, v143, v141, s51
    v_accvgpr_write_b32 a175, v10
    s_mov_b32 s47, 3670016
    buffer_load_dwordx2 v[128:129], v7, s[28:31], s47 offen
    s_mov_b32 s47, 3678208
    buffer_load_dwordx2 v[130:131], v7, s[28:31], s47 offen
    s_mov_b32 s47, 3686400
    buffer_load_dwordx2 v[132:133], v7, s[28:31], s47 offen
    s_mov_b32 s47, 3694592
    buffer_load_dwordx2 v[134:135], v7, s[28:31], s47 offen
    s_mov_b32 s47, 3702784
    buffer_load_dwordx2 v[136:137], v7, s[28:31], s47 offen
    s_mov_b32 s47, 3710976
    buffer_load_dwordx2 v[138:139], v7, s[28:31], s47 offen
    s_mov_b32 s47, 3719168
    buffer_load_dwordx2 v[140:141], v7, s[28:31], s47 offen
    s_mov_b32 s47, 3727360
    buffer_load_dwordx2 v[142:143], v7, s[28:31], s47 offen
    s_waitcnt vmcnt(24)
    v_perm_b32 v10, v146, v144, s50
    v_accvgpr_write_b32 a176, v10
    v_perm_b32 v10, v150, v148, s50
    v_accvgpr_write_b32 a177, v10
    v_perm_b32 v10, v154, v152, s50
    v_accvgpr_write_b32 a178, v10
    v_perm_b32 v10, v158, v156, s50
    v_accvgpr_write_b32 a179, v10
    v_perm_b32 v10, v146, v144, s51
    v_accvgpr_write_b32 a180, v10
    v_perm_b32 v10, v150, v148, s51
    v_accvgpr_write_b32 a181, v10
    v_perm_b32 v10, v154, v152, s51
    v_accvgpr_write_b32 a182, v10
    v_perm_b32 v10, v158, v156, s51
    v_accvgpr_write_b32 a183, v10
    v_perm_b32 v10, v147, v145, s50
    v_accvgpr_write_b32 a184, v10
    v_perm_b32 v10, v151, v149, s50
    v_accvgpr_write_b32 a185, v10
    v_perm_b32 v10, v155, v153, s50
    v_accvgpr_write_b32 a186, v10
    v_perm_b32 v10, v159, v157, s50
    v_accvgpr_write_b32 a187, v10
    v_perm_b32 v10, v147, v145, s51
    v_accvgpr_write_b32 a188, v10
    v_perm_b32 v10, v151, v149, s51
    v_accvgpr_write_b32 a189, v10
    v_perm_b32 v10, v155, v153, s51
    v_accvgpr_write_b32 a190, v10
    v_perm_b32 v10, v159, v157, s51
    v_accvgpr_write_b32 a191, v10
    s_mov_b32 s47, 3932160
    buffer_load_dwordx2 v[144:145], v7, s[28:31], s47 offen
    s_mov_b32 s47, 3940352
    buffer_load_dwordx2 v[146:147], v7, s[28:31], s47 offen
    s_mov_b32 s47, 3948544
    buffer_load_dwordx2 v[148:149], v7, s[28:31], s47 offen
    s_mov_b32 s47, 3956736
    buffer_load_dwordx2 v[150:151], v7, s[28:31], s47 offen
    s_mov_b32 s47, 3964928
    buffer_load_dwordx2 v[152:153], v7, s[28:31], s47 offen
    s_mov_b32 s47, 3973120
    buffer_load_dwordx2 v[154:155], v7, s[28:31], s47 offen
    s_mov_b32 s47, 3981312
    buffer_load_dwordx2 v[156:157], v7, s[28:31], s47 offen
    s_mov_b32 s47, 3989504
    buffer_load_dwordx2 v[158:159], v7, s[28:31], s47 offen
    s_waitcnt vmcnt(24)
    v_perm_b32 v10, v98, v96, s50
    v_accvgpr_write_b32 a192, v10
    v_perm_b32 v10, v102, v100, s50
    v_accvgpr_write_b32 a193, v10
    v_perm_b32 v10, v106, v104, s50
    v_accvgpr_write_b32 a194, v10
    v_perm_b32 v10, v110, v108, s50
    v_accvgpr_write_b32 a195, v10
    v_perm_b32 v10, v98, v96, s51
    v_accvgpr_write_b32 a196, v10
    v_perm_b32 v10, v102, v100, s51
    v_accvgpr_write_b32 a197, v10
    v_perm_b32 v10, v106, v104, s51
    v_accvgpr_write_b32 a198, v10
    v_perm_b32 v10, v110, v108, s51
    v_accvgpr_write_b32 a199, v10
    v_perm_b32 v10, v99, v97, s50
    v_accvgpr_write_b32 a200, v10
    v_perm_b32 v10, v103, v101, s50
    v_accvgpr_write_b32 a201, v10
    v_perm_b32 v10, v107, v105, s50
    v_accvgpr_write_b32 a202, v10
    v_perm_b32 v10, v111, v109, s50
    v_accvgpr_write_b32 a203, v10
    v_perm_b32 v10, v99, v97, s51
    v_accvgpr_write_b32 a204, v10
    v_perm_b32 v10, v103, v101, s51
    v_accvgpr_write_b32 a205, v10
    v_perm_b32 v10, v107, v105, s51
    v_accvgpr_write_b32 a206, v10
    v_perm_b32 v10, v111, v109, s51
    v_accvgpr_write_b32 a207, v10
    s_mov_b32 s47, 4194304
    buffer_load_dwordx2 v[96:97], v7, s[28:31], s47 offen
    s_mov_b32 s47, 4202496
    buffer_load_dwordx2 v[98:99], v7, s[28:31], s47 offen
    s_mov_b32 s47, 4210688
    buffer_load_dwordx2 v[100:101], v7, s[28:31], s47 offen
    s_mov_b32 s47, 4218880
    buffer_load_dwordx2 v[102:103], v7, s[28:31], s47 offen
    s_mov_b32 s47, 4227072
    buffer_load_dwordx2 v[104:105], v7, s[28:31], s47 offen
    s_mov_b32 s47, 4235264
    buffer_load_dwordx2 v[106:107], v7, s[28:31], s47 offen
    s_mov_b32 s47, 4243456
    buffer_load_dwordx2 v[108:109], v7, s[28:31], s47 offen
    s_mov_b32 s47, 4251648
    buffer_load_dwordx2 v[110:111], v7, s[28:31], s47 offen
    s_waitcnt vmcnt(24)
    v_perm_b32 v10, v114, v112, s50
    v_accvgpr_write_b32 a208, v10
    v_perm_b32 v10, v118, v116, s50
    v_accvgpr_write_b32 a209, v10
    v_perm_b32 v10, v122, v120, s50
    v_accvgpr_write_b32 a210, v10
    v_perm_b32 v10, v126, v124, s50
    v_accvgpr_write_b32 a211, v10
    v_perm_b32 v10, v114, v112, s51
    v_accvgpr_write_b32 a212, v10
    v_perm_b32 v10, v118, v116, s51
    v_accvgpr_write_b32 a213, v10
    v_perm_b32 v10, v122, v120, s51
    v_accvgpr_write_b32 a214, v10
    v_perm_b32 v10, v126, v124, s51
    v_accvgpr_write_b32 a215, v10
    v_perm_b32 v10, v115, v113, s50
    v_accvgpr_write_b32 a216, v10
    v_perm_b32 v10, v119, v117, s50
    v_accvgpr_write_b32 a217, v10
    v_perm_b32 v10, v123, v121, s50
    v_accvgpr_write_b32 a218, v10
    v_perm_b32 v10, v127, v125, s50
    v_accvgpr_write_b32 a219, v10
    v_perm_b32 v10, v115, v113, s51
    v_accvgpr_write_b32 a220, v10
    v_perm_b32 v10, v119, v117, s51
    v_accvgpr_write_b32 a221, v10
    v_perm_b32 v10, v123, v121, s51
    v_accvgpr_write_b32 a222, v10
    v_perm_b32 v10, v127, v125, s51
    v_accvgpr_write_b32 a223, v10
    s_mov_b32 s47, 4456448
    buffer_load_dwordx2 v[112:113], v7, s[28:31], s47 offen
    s_mov_b32 s47, 4464640
    buffer_load_dwordx2 v[114:115], v7, s[28:31], s47 offen
    s_mov_b32 s47, 4472832
    buffer_load_dwordx2 v[116:117], v7, s[28:31], s47 offen
    s_mov_b32 s47, 4481024
    buffer_load_dwordx2 v[118:119], v7, s[28:31], s47 offen
    s_mov_b32 s47, 4489216
    buffer_load_dwordx2 v[120:121], v7, s[28:31], s47 offen
    s_mov_b32 s47, 4497408
    buffer_load_dwordx2 v[122:123], v7, s[28:31], s47 offen
    s_mov_b32 s47, 4505600
    buffer_load_dwordx2 v[124:125], v7, s[28:31], s47 offen
    s_mov_b32 s47, 4513792
    buffer_load_dwordx2 v[126:127], v7, s[28:31], s47 offen
    s_waitcnt vmcnt(24)
    v_perm_b32 v10, v130, v128, s50
    v_accvgpr_write_b32 a224, v10
    v_perm_b32 v10, v134, v132, s50
    v_accvgpr_write_b32 a225, v10
    v_perm_b32 v10, v138, v136, s50
    v_accvgpr_write_b32 a226, v10
    v_perm_b32 v10, v142, v140, s50
    v_accvgpr_write_b32 a227, v10
    v_perm_b32 v10, v130, v128, s51
    v_accvgpr_write_b32 a228, v10
    v_perm_b32 v10, v134, v132, s51
    v_accvgpr_write_b32 a229, v10
    v_perm_b32 v10, v138, v136, s51
    v_accvgpr_write_b32 a230, v10
    v_perm_b32 v10, v142, v140, s51
    v_accvgpr_write_b32 a231, v10
    v_perm_b32 v10, v131, v129, s50
    v_accvgpr_write_b32 a232, v10
    v_perm_b32 v10, v135, v133, s50
    v_accvgpr_write_b32 a233, v10
    v_perm_b32 v10, v139, v137, s50
    v_accvgpr_write_b32 a234, v10
    v_perm_b32 v10, v143, v141, s50
    v_accvgpr_write_b32 a235, v10
    v_perm_b32 v10, v131, v129, s51
    v_accvgpr_write_b32 a236, v10
    v_perm_b32 v10, v135, v133, s51
    v_accvgpr_write_b32 a237, v10
    v_perm_b32 v10, v139, v137, s51
    v_accvgpr_write_b32 a238, v10
    v_perm_b32 v10, v143, v141, s51
    v_accvgpr_write_b32 a239, v10
    s_mov_b32 s47, 4718592
    buffer_load_dwordx2 v[128:129], v7, s[28:31], s47 offen
    s_mov_b32 s47, 4726784
    buffer_load_dwordx2 v[130:131], v7, s[28:31], s47 offen
    s_mov_b32 s47, 4734976
    buffer_load_dwordx2 v[132:133], v7, s[28:31], s47 offen
    s_mov_b32 s47, 4743168
    buffer_load_dwordx2 v[134:135], v7, s[28:31], s47 offen
    s_mov_b32 s47, 4751360
    buffer_load_dwordx2 v[136:137], v7, s[28:31], s47 offen
    s_mov_b32 s47, 4759552
    buffer_load_dwordx2 v[138:139], v7, s[28:31], s47 offen
    s_mov_b32 s47, 4767744
    buffer_load_dwordx2 v[140:141], v7, s[28:31], s47 offen
    s_mov_b32 s47, 4775936
    buffer_load_dwordx2 v[142:143], v7, s[28:31], s47 offen
    s_waitcnt vmcnt(24)
    v_perm_b32 v10, v146, v144, s50
    v_accvgpr_write_b32 a240, v10
    v_perm_b32 v10, v150, v148, s50
    v_accvgpr_write_b32 a241, v10
    v_perm_b32 v10, v154, v152, s50
    v_accvgpr_write_b32 a242, v10
    v_perm_b32 v10, v158, v156, s50
    v_accvgpr_write_b32 a243, v10
    v_perm_b32 v10, v146, v144, s51
    v_accvgpr_write_b32 a244, v10
    v_perm_b32 v10, v150, v148, s51
    v_accvgpr_write_b32 a245, v10
    v_perm_b32 v10, v154, v152, s51
    v_accvgpr_write_b32 a246, v10
    v_perm_b32 v10, v158, v156, s51
    v_accvgpr_write_b32 a247, v10
    v_perm_b32 v10, v147, v145, s50
    v_accvgpr_write_b32 a248, v10
    v_perm_b32 v10, v151, v149, s50
    v_accvgpr_write_b32 a249, v10
    v_perm_b32 v10, v155, v153, s50
    v_accvgpr_write_b32 a250, v10
    v_perm_b32 v10, v159, v157, s50
    v_accvgpr_write_b32 a251, v10
    v_perm_b32 v10, v147, v145, s51
    v_accvgpr_write_b32 a252, v10
    v_perm_b32 v10, v151, v149, s51
    v_accvgpr_write_b32 a253, v10
    v_perm_b32 v10, v155, v153, s51
    v_accvgpr_write_b32 a254, v10
    v_perm_b32 v10, v159, v157, s51
    v_accvgpr_write_b32 a255, v10
    s_mov_b32 s47, 4980736
    buffer_load_dwordx2 v[144:145], v7, s[28:31], s47 offen
    s_mov_b32 s47, 4988928
    buffer_load_dwordx2 v[146:147], v7, s[28:31], s47 offen
    s_mov_b32 s47, 4997120
    buffer_load_dwordx2 v[148:149], v7, s[28:31], s47 offen
    s_mov_b32 s47, 5005312
    buffer_load_dwordx2 v[150:151], v7, s[28:31], s47 offen
    s_mov_b32 s47, 5013504
    buffer_load_dwordx2 v[152:153], v7, s[28:31], s47 offen
    s_mov_b32 s47, 5021696
    buffer_load_dwordx2 v[154:155], v7, s[28:31], s47 offen
    s_mov_b32 s47, 5029888
    buffer_load_dwordx2 v[156:157], v7, s[28:31], s47 offen
    s_mov_b32 s47, 5038080
    buffer_load_dwordx2 v[158:159], v7, s[28:31], s47 offen
    s_waitcnt vmcnt(24)
    v_perm_b32 v192, v98, v96, s50
    v_perm_b32 v193, v102, v100, s50
    v_perm_b32 v194, v106, v104, s50
    v_perm_b32 v195, v110, v108, s50
    v_perm_b32 v196, v98, v96, s51
    v_perm_b32 v197, v102, v100, s51
    v_perm_b32 v198, v106, v104, s51
    v_perm_b32 v199, v110, v108, s51
    v_perm_b32 v200, v99, v97, s50
    v_perm_b32 v201, v103, v101, s50
    v_perm_b32 v202, v107, v105, s50
    v_perm_b32 v203, v111, v109, s50
    v_perm_b32 v204, v99, v97, s51
    v_perm_b32 v205, v103, v101, s51
    v_perm_b32 v206, v107, v105, s51
    v_perm_b32 v207, v111, v109, s51
    s_waitcnt vmcnt(16)
    v_perm_b32 v208, v114, v112, s50
    v_perm_b32 v209, v118, v116, s50
    v_perm_b32 v210, v122, v120, s50
    v_perm_b32 v211, v126, v124, s50
    v_perm_b32 v212, v114, v112, s51
    v_perm_b32 v213, v118, v116, s51
    v_perm_b32 v214, v122, v120, s51
    v_perm_b32 v215, v126, v124, s51
    v_perm_b32 v216, v115, v113, s50
    v_perm_b32 v217, v119, v117, s50
    v_perm_b32 v218, v123, v121, s50
    v_perm_b32 v219, v127, v125, s50
    v_perm_b32 v220, v115, v113, s51
    v_perm_b32 v221, v119, v117, s51
    v_perm_b32 v222, v123, v121, s51
    v_perm_b32 v223, v127, v125, s51
    s_waitcnt vmcnt(8)
    v_perm_b32 v224, v130, v128, s50
    v_perm_b32 v225, v134, v132, s50
    v_perm_b32 v226, v138, v136, s50
    v_perm_b32 v227, v142, v140, s50
    v_perm_b32 v228, v130, v128, s51
    v_perm_b32 v229, v134, v132, s51
    v_perm_b32 v230, v138, v136, s51
    v_perm_b32 v231, v142, v140, s51
    v_perm_b32 v232, v131, v129, s50
    v_perm_b32 v233, v135, v133, s50
    v_perm_b32 v234, v139, v137, s50
    v_perm_b32 v235, v143, v141, s50
    v_perm_b32 v236, v131, v129, s51
    v_perm_b32 v237, v135, v133, s51
    v_perm_b32 v238, v139, v137, s51
    v_perm_b32 v239, v143, v141, s51
    s_waitcnt vmcnt(0)
    v_perm_b32 v240, v146, v144, s50
    v_perm_b32 v241, v150, v148, s50
    v_perm_b32 v242, v154, v152, s50
    v_perm_b32 v243, v158, v156, s50
    v_perm_b32 v244, v146, v144, s51
    v_perm_b32 v245, v150, v148, s51
    v_perm_b32 v246, v154, v152, s51
    v_perm_b32 v247, v158, v156, s51
    v_perm_b32 v248, v147, v145, s50
    v_perm_b32 v249, v151, v149, s50
    v_perm_b32 v250, v155, v153, s50
    v_perm_b32 v251, v159, v157, s50
    v_perm_b32 v252, v147, v145, s51
    v_perm_b32 v253, v151, v149, s51
    v_perm_b32 v254, v155, v153, s51
    v_perm_b32 v255, v159, v157, s51
    ds_write_b128 v4, v[32:35] offset:0
    ds_write_b128 v4, v[36:39] offset:1024
    ds_write_b128 v4, v[40:43] offset:2048
    ds_write_b128 v4, v[44:47] offset:3072
    ds_write_b128 v4, v[48:51] offset:4096
    s_waitcnt lgkmcnt(0)
    s_barrier
    s_cmp_eq_u32 s38, 2
    s_cbranch_scc1 g1_loop_v_entry
g1_loop_qk:
    s_add_u32 s41, s40, 20480
    buffer_load_dwordx4 v[32:35], v3, s[32:35], s41 offen offset:0
    buffer_load_dwordx4 v[36:39], v3, s[32:35], s41 offen offset:64
    buffer_load_dwordx4 v[40:43], v3, s[32:35], s41 offen offset:128
    buffer_load_dwordx4 v[44:47], v3, s[32:35], s41 offen offset:192
    buffer_load_dwordx4 v[48:51], v3, s[32:35], s41 offen offset:256
    ds_read_b128 v[52:55], v5 offset:0
    ds_read_b128 v[56:59], v5 offset:1024
    ds_read_b128 v[60:63], v5 offset:2048
    ds_read_b128 v[64:67], v5 offset:3072
    s_waitcnt lgkmcnt(3)
    v_mfma_f32_16x16x32_bf16 v[68:71], a[0:3], v[52:55], 0
    v_mfma_f32_16x16x32_bf16 v[72:75], a[4:7], v[52:55], 0
    v_mfma_f32_16x16x32_bf16 v[76:79], a[8:11], v[52:55], 0
    v_mfma_f32_16x16x32_bf16 v[80:83], a[12:15], v[52:55], 0
    ds_read_b128 v[52:55], v5 offset:4096
    s_waitcnt lgkmcnt(3)
    v_mfma_f32_16x16x32_bf16 v[68:71], a[16:19], v[56:59], v[68:71]
    v_mfma_f32_16x16x32_bf16 v[72:75], a[20:23], v[56:59], v[72:75]
    v_mfma_f32_16x16x32_bf16 v[76:79], a[24:27], v[56:59], v[76:79]
    v_mfma_f32_16x16x32_bf16 v[80:83], a[28:31], v[56:59], v[80:83]
    ds_read_b128 v[56:59], v5 offset:5120
    s_waitcnt lgkmcnt(3)
    v_mfma_f32_16x16x32_bf16 v[68:71], a[32:35], v[60:63], v[68:71]
    v_mfma_f32_16x16x32_bf16 v[72:75], a[36:39], v[60:63], v[72:75]
    v_mfma_f32_16x16x32_bf16 v[76:79], a[40:43], v[60:63], v[76:79]
    v_mfma_f32_16x16x32_bf16 v[80:83], a[44:47], v[60:63], v[80:83]
    ds_read_b128 v[60:63], v5 offset:6144
    s_waitcnt lgkmcnt(3)
    v_mfma_f32_16x16x32_bf16 v[68:71], a[48:51], v[64:67], v[68:71]
    v_mfma_f32_16x16x32_bf16 v[72:75], a[52:55], v[64:67], v[72:75]
    v_mfma_f32_16x16x32_bf16 v[76:79], a[56:59], v[64:67], v[76:79]
    v_mfma_f32_16x16x32_bf16 v[80:83], a[60:63], v[64:67], v[80:83]
    ds_read_b128 v[64:67], v5 offset:7168
    s_waitcnt lgkmcnt(3)
    v_mfma_f32_16x16x32_bf16 v[68:71], a[64:67], v[52:55], v[68:71]
    v_mfma_f32_16x16x32_bf16 v[72:75], a[68:71], v[52:55], v[72:75]
    v_mfma_f32_16x16x32_bf16 v[76:79], a[72:75], v[52:55], v[76:79]
    v_mfma_f32_16x16x32_bf16 v[80:83], a[76:79], v[52:55], v[80:83]
    ds_read_b128 v[52:55], v5 offset:8192
    s_waitcnt lgkmcnt(3)
    v_mfma_f32_16x16x32_bf16 v[68:71], a[80:83], v[56:59], v[68:71]
    v_mfma_f32_16x16x32_bf16 v[72:75], a[84:87], v[56:59], v[72:75]
    v_mfma_f32_16x16x32_bf16 v[76:79], a[88:91], v[56:59], v[76:79]
    v_mfma_f32_16x16x32_bf16 v[80:83], a[92:95], v[56:59], v[80:83]
    ds_read_b128 v[56:59], v5 offset:9216
    s_waitcnt lgkmcnt(3)
    v_mfma_f32_16x16x32_bf16 v[68:71], a[96:99], v[60:63], v[68:71]
    v_mfma_f32_16x16x32_bf16 v[72:75], a[100:103], v[60:63], v[72:75]
    v_mfma_f32_16x16x32_bf16 v[76:79], a[104:107], v[60:63], v[76:79]
    v_mfma_f32_16x16x32_bf16 v[80:83], a[108:111], v[60:63], v[80:83]
    ds_read_b128 v[60:63], v5 offset:10240
    s_waitcnt lgkmcnt(3)
    v_mfma_f32_16x16x32_bf16 v[68:71], a[112:115], v[64:67], v[68:71]
    v_mfma_f32_16x16x32_bf16 v[72:75], a[116:119], v[64:67], v[72:75]
    v_mfma_f32_16x16x32_bf16 v[76:79], a[120:123], v[64:67], v[76:79]
    v_mfma_f32_16x16x32_bf16 v[80:83], a[124:127], v[64:67], v[80:83]
    ds_read_b128 v[64:67], v5 offset:11264
    s_waitcnt lgkmcnt(3)
    v_mfma_f32_16x16x32_bf16 v[68:71], a[128:131], v[52:55], v[68:71]
    v_mfma_f32_16x16x32_bf16 v[72:75], a[132:135], v[52:55], v[72:75]
    v_mfma_f32_16x16x32_bf16 v[76:79], a[136:139], v[52:55], v[76:79]
    v_mfma_f32_16x16x32_bf16 v[80:83], a[140:143], v[52:55], v[80:83]
    ds_read_b128 v[52:55], v5 offset:12288
    s_waitcnt lgkmcnt(3)
    v_mfma_f32_16x16x32_bf16 v[68:71], a[144:147], v[56:59], v[68:71]
    v_mfma_f32_16x16x32_bf16 v[72:75], a[148:151], v[56:59], v[72:75]
    v_mfma_f32_16x16x32_bf16 v[76:79], a[152:155], v[56:59], v[76:79]
    v_mfma_f32_16x16x32_bf16 v[80:83], a[156:159], v[56:59], v[80:83]
    ds_read_b128 v[56:59], v5 offset:13312
    s_waitcnt lgkmcnt(3)
    v_mfma_f32_16x16x32_bf16 v[68:71], a[160:163], v[60:63], v[68:71]
    v_mfma_f32_16x16x32_bf16 v[72:75], a[164:167], v[60:63], v[72:75]
    v_mfma_f32_16x16x32_bf16 v[76:79], a[168:171], v[60:63], v[76:79]
    v_mfma_f32_16x16x32_bf16 v[80:83], a[172:175], v[60:63], v[80:83]
    ds_read_b128 v[60:63], v5 offset:14336
    s_waitcnt lgkmcnt(3)
    v_mfma_f32_16x16x32_bf16 v[68:71], a[176:179], v[64:67], v[68:71]
    v_mfma_f32_16x16x32_bf16 v[72:75], a[180:183], v[64:67], v[72:75]
    v_mfma_f32_16x16x32_bf16 v[76:79], a[184:187], v[64:67], v[76:79]
    v_mfma_f32_16x16x32_bf16 v[80:83], a[188:191], v[64:67], v[80:83]
    ds_read_b128 v[64:67], v5 offset:15360
    s_waitcnt lgkmcnt(3)
    v_mfma_f32_16x16x32_bf16 v[68:71], a[192:195], v[52:55], v[68:71]
    v_mfma_f32_16x16x32_bf16 v[72:75], a[196:199], v[52:55], v[72:75]
    v_mfma_f32_16x16x32_bf16 v[76:79], a[200:203], v[52:55], v[76:79]
    v_mfma_f32_16x16x32_bf16 v[80:83], a[204:207], v[52:55], v[80:83]
    ds_read_b128 v[52:55], v5 offset:16384
    s_waitcnt lgkmcnt(3)
    v_mfma_f32_16x16x32_bf16 v[68:71], a[208:211], v[56:59], v[68:71]
    v_mfma_f32_16x16x32_bf16 v[72:75], a[212:215], v[56:59], v[72:75]
    v_mfma_f32_16x16x32_bf16 v[76:79], a[216:219], v[56:59], v[76:79]
    v_mfma_f32_16x16x32_bf16 v[80:83], a[220:223], v[56:59], v[80:83]
    ds_read_b128 v[56:59], v5 offset:17408
    s_waitcnt lgkmcnt(3)
    v_mfma_f32_16x16x32_bf16 v[68:71], a[224:227], v[60:63], v[68:71]
    v_mfma_f32_16x16x32_bf16 v[72:75], a[228:231], v[60:63], v[72:75]
    v_mfma_f32_16x16x32_bf16 v[76:79], a[232:235], v[60:63], v[76:79]
    v_mfma_f32_16x16x32_bf16 v[80:83], a[236:239], v[60:63], v[80:83]
    ds_read_b128 v[60:63], v5 offset:18432
    s_waitcnt lgkmcnt(3)
    v_mfma_f32_16x16x32_bf16 v[68:71], a[240:243], v[64:67], v[68:71]
    v_mfma_f32_16x16x32_bf16 v[72:75], a[244:247], v[64:67], v[72:75]
    v_mfma_f32_16x16x32_bf16 v[76:79], a[248:251], v[64:67], v[76:79]
    v_mfma_f32_16x16x32_bf16 v[80:83], a[252:255], v[64:67], v[80:83]
    ds_read_b128 v[64:67], v5 offset:19456
    s_waitcnt lgkmcnt(3)
    v_mfma_f32_16x16x32_bf16 v[68:71], v[192:195], v[52:55], v[68:71]
    v_mfma_f32_16x16x32_bf16 v[72:75], v[196:199], v[52:55], v[72:75]
    v_mfma_f32_16x16x32_bf16 v[76:79], v[200:203], v[52:55], v[76:79]
    v_mfma_f32_16x16x32_bf16 v[80:83], v[204:207], v[52:55], v[80:83]
    s_waitcnt lgkmcnt(2)
    v_mfma_f32_16x16x32_bf16 v[68:71], v[208:211], v[56:59], v[68:71]
    v_mfma_f32_16x16x32_bf16 v[72:75], v[212:215], v[56:59], v[72:75]
    v_mfma_f32_16x16x32_bf16 v[76:79], v[216:219], v[56:59], v[76:79]
    v_mfma_f32_16x16x32_bf16 v[80:83], v[220:223], v[56:59], v[80:83]
    s_waitcnt lgkmcnt(1)
    v_mfma_f32_16x16x32_bf16 v[68:71], v[224:227], v[60:63], v[68:71]
    v_mfma_f32_16x16x32_bf16 v[72:75], v[228:231], v[60:63], v[72:75]
    v_mfma_f32_16x16x32_bf16 v[76:79], v[232:235], v[60:63], v[76:79]
    v_mfma_f32_16x16x32_bf16 v[80:83], v[236:239], v[60:63], v[80:83]
    s_waitcnt lgkmcnt(0)
    v_mfma_f32_16x16x32_bf16 v[68:71], v[240:243], v[64:67], v[68:71]
    v_mfma_f32_16x16x32_bf16 v[72:75], v[244:247], v[64:67], v[72:75]
    v_mfma_f32_16x16x32_bf16 v[76:79], v[248:251], v[64:67], v[76:79]
    v_mfma_f32_16x16x32_bf16 v[80:83], v[252:255], v[64:67], v[80:83]
    s_waitcnt vmcnt(0)
    ds_write_b128 v4, v[32:35] offset:20480
    ds_write_b128 v4, v[36:39] offset:21504
    ds_write_b128 v4, v[40:43] offset:22528
    ds_write_b128 v4, v[44:47] offset:23552
    ds_write_b128 v4, v[48:51] offset:24576
    s_lshr_b32 s43, s42, 1
    s_lshl_b32 s43, s43, 18
    s_add_u32 s43, s43, s44
    s_and_b32 s45, s42, 1
    s_lshl_b32 s45, s45, 10
    s_add_u32 s43, s43, s45
    v_cvt_pk_bf16_f32 v84, v68, v69
    v_cvt_pk_bf16_f32 v85, v70, v71
    v_cvt_pk_bf16_f32 v86, v72, v73
    v_cvt_pk_bf16_f32 v87, v74, v75
    v_cvt_pk_bf16_f32 v88, v76, v77
    v_cvt_pk_bf16_f32 v89, v78, v79
    v_cvt_pk_bf16_f32 v90, v80, v81
    v_cvt_pk_bf16_f32 v91, v82, v83
    buffer_store_dwordx4 v[84:87], v6, s[32:35], s43 offen offset:0 sc1
    buffer_store_dwordx4 v[88:91], v6, s[32:35], s43 offen offset:2048 sc1
    s_waitcnt lgkmcnt(0)
    s_barrier
    s_cmp_le_u32 s42, s49
    s_cbranch_scc1 g1_nf_1
    s_cmp_lg_u32 s3, 0
    s_cbranch_scc1 g1_nf_1
    s_lshl_b32 s43, s42, 2
    s_add_u32 s43, s43, s52
    buffer_store_dword v11, v12, s[32:35], s43 offen sc1
g1_nf_1:
    s_add_u32 s40, s40, 20480
    s_add_u32 s42, s42, 1
    s_cmp_ge_u32 s42, s46
    s_cbranch_scc1 g1_fin
    s_add_u32 s41, s40, 20480
    buffer_load_dwordx4 v[32:35], v3, s[32:35], s41 offen offset:0
    buffer_load_dwordx4 v[36:39], v3, s[32:35], s41 offen offset:64
    buffer_load_dwordx4 v[40:43], v3, s[32:35], s41 offen offset:128
    buffer_load_dwordx4 v[44:47], v3, s[32:35], s41 offen offset:192
    buffer_load_dwordx4 v[48:51], v3, s[32:35], s41 offen offset:256
    ds_read_b128 v[52:55], v5 offset:20480
    ds_read_b128 v[56:59], v5 offset:21504
    ds_read_b128 v[60:63], v5 offset:22528
    ds_read_b128 v[64:67], v5 offset:23552
    s_waitcnt lgkmcnt(3)
    v_mfma_f32_16x16x32_bf16 v[68:71], a[0:3], v[52:55], 0
    v_mfma_f32_16x16x32_bf16 v[72:75], a[4:7], v[52:55], 0
    v_mfma_f32_16x16x32_bf16 v[76:79], a[8:11], v[52:55], 0
    v_mfma_f32_16x16x32_bf16 v[80:83], a[12:15], v[52:55], 0
    ds_read_b128 v[52:55], v5 offset:24576
    s_waitcnt lgkmcnt(3)
    v_mfma_f32_16x16x32_bf16 v[68:71], a[16:19], v[56:59], v[68:71]
    v_mfma_f32_16x16x32_bf16 v[72:75], a[20:23], v[56:59], v[72:75]
    v_mfma_f32_16x16x32_bf16 v[76:79], a[24:27], v[56:59], v[76:79]
    v_mfma_f32_16x16x32_bf16 v[80:83], a[28:31], v[56:59], v[80:83]
    ds_read_b128 v[56:59], v5 offset:25600
    s_waitcnt lgkmcnt(3)
    v_mfma_f32_16x16x32_bf16 v[68:71], a[32:35], v[60:63], v[68:71]
    v_mfma_f32_16x16x32_bf16 v[72:75], a[36:39], v[60:63], v[72:75]
    v_mfma_f32_16x16x32_bf16 v[76:79], a[40:43], v[60:63], v[76:79]
    v_mfma_f32_16x16x32_bf16 v[80:83], a[44:47], v[60:63], v[80:83]
    ds_read_b128 v[60:63], v5 offset:26624
    s_waitcnt lgkmcnt(3)
    v_mfma_f32_16x16x32_bf16 v[68:71], a[48:51], v[64:67], v[68:71]
    v_mfma_f32_16x16x32_bf16 v[72:75], a[52:55], v[64:67], v[72:75]
    v_mfma_f32_16x16x32_bf16 v[76:79], a[56:59], v[64:67], v[76:79]
    v_mfma_f32_16x16x32_bf16 v[80:83], a[60:63], v[64:67], v[80:83]
    ds_read_b128 v[64:67], v5 offset:27648
    s_waitcnt lgkmcnt(3)
    v_mfma_f32_16x16x32_bf16 v[68:71], a[64:67], v[52:55], v[68:71]
    v_mfma_f32_16x16x32_bf16 v[72:75], a[68:71], v[52:55], v[72:75]
    v_mfma_f32_16x16x32_bf16 v[76:79], a[72:75], v[52:55], v[76:79]
    v_mfma_f32_16x16x32_bf16 v[80:83], a[76:79], v[52:55], v[80:83]
    ds_read_b128 v[52:55], v5 offset:28672
    s_waitcnt lgkmcnt(3)
    v_mfma_f32_16x16x32_bf16 v[68:71], a[80:83], v[56:59], v[68:71]
    v_mfma_f32_16x16x32_bf16 v[72:75], a[84:87], v[56:59], v[72:75]
    v_mfma_f32_16x16x32_bf16 v[76:79], a[88:91], v[56:59], v[76:79]
    v_mfma_f32_16x16x32_bf16 v[80:83], a[92:95], v[56:59], v[80:83]
    ds_read_b128 v[56:59], v5 offset:29696
    s_waitcnt lgkmcnt(3)
    v_mfma_f32_16x16x32_bf16 v[68:71], a[96:99], v[60:63], v[68:71]
    v_mfma_f32_16x16x32_bf16 v[72:75], a[100:103], v[60:63], v[72:75]
    v_mfma_f32_16x16x32_bf16 v[76:79], a[104:107], v[60:63], v[76:79]
    v_mfma_f32_16x16x32_bf16 v[80:83], a[108:111], v[60:63], v[80:83]
    ds_read_b128 v[60:63], v5 offset:30720
    s_waitcnt lgkmcnt(3)
    v_mfma_f32_16x16x32_bf16 v[68:71], a[112:115], v[64:67], v[68:71]
    v_mfma_f32_16x16x32_bf16 v[72:75], a[116:119], v[64:67], v[72:75]
    v_mfma_f32_16x16x32_bf16 v[76:79], a[120:123], v[64:67], v[76:79]
    v_mfma_f32_16x16x32_bf16 v[80:83], a[124:127], v[64:67], v[80:83]
    ds_read_b128 v[64:67], v5 offset:31744
    s_waitcnt lgkmcnt(3)
    v_mfma_f32_16x16x32_bf16 v[68:71], a[128:131], v[52:55], v[68:71]
    v_mfma_f32_16x16x32_bf16 v[72:75], a[132:135], v[52:55], v[72:75]
    v_mfma_f32_16x16x32_bf16 v[76:79], a[136:139], v[52:55], v[76:79]
    v_mfma_f32_16x16x32_bf16 v[80:83], a[140:143], v[52:55], v[80:83]
    ds_read_b128 v[52:55], v5 offset:32768
    s_waitcnt lgkmcnt(3)
    v_mfma_f32_16x16x32_bf16 v[68:71], a[144:147], v[56:59], v[68:71]
    v_mfma_f32_16x16x32_bf16 v[72:75], a[148:151], v[56:59], v[72:75]
    v_mfma_f32_16x16x32_bf16 v[76:79], a[152:155], v[56:59], v[76:79]
    v_mfma_f32_16x16x32_bf16 v[80:83], a[156:159], v[56:59], v[80:83]
    ds_read_b128 v[56:59], v5 offset:33792
    s_waitcnt lgkmcnt(3)
    v_mfma_f32_16x16x32_bf16 v[68:71], a[160:163], v[60:63], v[68:71]
    v_mfma_f32_16x16x32_bf16 v[72:75], a[164:167], v[60:63], v[72:75]
    v_mfma_f32_16x16x32_bf16 v[76:79], a[168:171], v[60:63], v[76:79]
    v_mfma_f32_16x16x32_bf16 v[80:83], a[172:175], v[60:63], v[80:83]
    ds_read_b128 v[60:63], v5 offset:34816
    s_waitcnt lgkmcnt(3)
    v_mfma_f32_16x16x32_bf16 v[68:71], a[176:179], v[64:67], v[68:71]
    v_mfma_f32_16x16x32_bf16 v[72:75], a[180:183], v[64:67], v[72:75]
    v_mfma_f32_16x16x32_bf16 v[76:79], a[184:187], v[64:67], v[76:79]
    v_mfma_f32_16x16x32_bf16 v[80:83], a[188:191], v[64:67], v[80:83]
    ds_read_b128 v[64:67], v5 offset:35840
    s_waitcnt lgkmcnt(3)
    v_mfma_f32_16x16x32_bf16 v[68:71], a[192:195], v[52:55], v[68:71]
    v_mfma_f32_16x16x32_bf16 v[72:75], a[196:199], v[52:55], v[72:75]
    v_mfma_f32_16x16x32_bf16 v[76:79], a[200:203], v[52:55], v[76:79]
    v_mfma_f32_16x16x32_bf16 v[80:83], a[204:207], v[52:55], v[80:83]
    ds_read_b128 v[52:55], v5 offset:36864
    s_waitcnt lgkmcnt(3)
    v_mfma_f32_16x16x32_bf16 v[68:71], a[208:211], v[56:59], v[68:71]
    v_mfma_f32_16x16x32_bf16 v[72:75], a[212:215], v[56:59], v[72:75]
    v_mfma_f32_16x16x32_bf16 v[76:79], a[216:219], v[56:59], v[76:79]
    v_mfma_f32_16x16x32_bf16 v[80:83], a[220:223], v[56:59], v[80:83]
    ds_read_b128 v[56:59], v5 offset:37888
    s_waitcnt lgkmcnt(3)
    v_mfma_f32_16x16x32_bf16 v[68:71], a[224:227], v[60:63], v[68:71]
    v_mfma_f32_16x16x32_bf16 v[72:75], a[228:231], v[60:63], v[72:75]
    v_mfma_f32_16x16x32_bf16 v[76:79], a[232:235], v[60:63], v[76:79]
    v_mfma_f32_16x16x32_bf16 v[80:83], a[236:239], v[60:63], v[80:83]
    ds_read_b128 v[60:63], v5 offset:38912
    s_waitcnt lgkmcnt(3)
    v_mfma_f32_16x16x32_bf16 v[68:71], a[240:243], v[64:67], v[68:71]
    v_mfma_f32_16x16x32_bf16 v[72:75], a[244:247], v[64:67], v[72:75]
    v_mfma_f32_16x16x32_bf16 v[76:79], a[248:251], v[64:67], v[76:79]
    v_mfma_f32_16x16x32_bf16 v[80:83], a[252:255], v[64:67], v[80:83]
    ds_read_b128 v[64:67], v5 offset:39936
    s_waitcnt lgkmcnt(3)
    v_mfma_f32_16x16x32_bf16 v[68:71], v[192:195], v[52:55], v[68:71]
    v_mfma_f32_16x16x32_bf16 v[72:75], v[196:199], v[52:55], v[72:75]
    v_mfma_f32_16x16x32_bf16 v[76:79], v[200:203], v[52:55], v[76:79]
    v_mfma_f32_16x16x32_bf16 v[80:83], v[204:207], v[52:55], v[80:83]
    s_waitcnt lgkmcnt(2)
    v_mfma_f32_16x16x32_bf16 v[68:71], v[208:211], v[56:59], v[68:71]
    v_mfma_f32_16x16x32_bf16 v[72:75], v[212:215], v[56:59], v[72:75]
    v_mfma_f32_16x16x32_bf16 v[76:79], v[216:219], v[56:59], v[76:79]
    v_mfma_f32_16x16x32_bf16 v[80:83], v[220:223], v[56:59], v[80:83]
    s_waitcnt lgkmcnt(1)
    v_mfma_f32_16x16x32_bf16 v[68:71], v[224:227], v[60:63], v[68:71]
    v_mfma_f32_16x16x32_bf16 v[72:75], v[228:231], v[60:63], v[72:75]
    v_mfma_f32_16x16x32_bf16 v[76:79], v[232:235], v[60:63], v[76:79]
    v_mfma_f32_16x16x32_bf16 v[80:83], v[236:239], v[60:63], v[80:83]
    s_waitcnt lgkmcnt(0)
    v_mfma_f32_16x16x32_bf16 v[68:71], v[240:243], v[64:67], v[68:71]
    v_mfma_f32_16x16x32_bf16 v[72:75], v[244:247], v[64:67], v[72:75]
    v_mfma_f32_16x16x32_bf16 v[76:79], v[248:251], v[64:67], v[76:79]
    v_mfma_f32_16x16x32_bf16 v[80:83], v[252:255], v[64:67], v[80:83]
    s_waitcnt vmcnt(0)
    ds_write_b128 v4, v[32:35] offset:0
    ds_write_b128 v4, v[36:39] offset:1024
    ds_write_b128 v4, v[40:43] offset:2048
    ds_write_b128 v4, v[44:47] offset:3072
    ds_write_b128 v4, v[48:51] offset:4096
    s_lshr_b32 s43, s42, 1
    s_lshl_b32 s43, s43, 18
    s_add_u32 s43, s43, s44
    s_and_b32 s45, s42, 1
    s_lshl_b32 s45, s45, 10
    s_add_u32 s43, s43, s45
    v_cvt_pk_bf16_f32 v84, v68, v69
    v_cvt_pk_bf16_f32 v85, v70, v71
    v_cvt_pk_bf16_f32 v86, v72, v73
    v_cvt_pk_bf16_f32 v87, v74, v75
    v_cvt_pk_bf16_f32 v88, v76, v77
    v_cvt_pk_bf16_f32 v89, v78, v79
    v_cvt_pk_bf16_f32 v90, v80, v81
    v_cvt_pk_bf16_f32 v91, v82, v83
    buffer_store_dwordx4 v[84:87], v6, s[32:35], s43 offen offset:0 sc1
    buffer_store_dwordx4 v[88:91], v6, s[32:35], s43 offen offset:2048 sc1
    s_waitcnt lgkmcnt(0)
    s_barrier
    s_cmp_le_u32 s42, s49
    s_cbranch_scc1 g1_nf_2
    s_cmp_lg_u32 s3, 0
    s_cbranch_scc1 g1_nf_2
    s_lshl_b32 s43, s42, 2
    s_add_u32 s43, s43, s52
    buffer_store_dword v11, v12, s[32:35], s43 offen sc1
g1_nf_2:
    s_add_u32 s40, s40, 20480
    s_add_u32 s42, s42, 1
    s_cmp_lt_u32 s42, s46
    s_cbranch_scc1 g1_loop_qk
    s_branch g1_fin
g1_loop_v_entry:
g1_loop_v:
    s_add_u32 s41, s40, 20480
    buffer_load_dwordx4 v[32:35], v3, s[32:35], s41 offen offset:0
    buffer_load_dwordx4 v[36:39], v3, s[32:35], s41 offen offset:64
    buffer_load_dwordx4 v[40:43], v3, s[32:35], s41 offen offset:128
    buffer_load_dwordx4 v[44:47], v3, s[32:35], s41 offen offset:192
    buffer_load_dwordx4 v[48:51], v3, s[32:35], s41 offen offset:256
    ds_read_b128 v[52:55], v5 offset:0
    ds_read_b128 v[56:59], v5 offset:1024
    ds_read_b128 v[60:63], v5 offset:2048
    ds_read_b128 v[64:67], v5 offset:3072
    s_waitcnt lgkmcnt(3)
    v_mfma_f32_16x16x32_bf16 v[68:71], v[52:55], a[0:3], 0
    v_mfma_f32_16x16x32_bf16 v[72:75], v[52:55], a[4:7], 0
    v_mfma_f32_16x16x32_bf16 v[76:79], v[52:55], a[8:11], 0
    v_mfma_f32_16x16x32_bf16 v[80:83], v[52:55], a[12:15], 0
    ds_read_b128 v[52:55], v5 offset:4096
    s_waitcnt lgkmcnt(3)
    v_mfma_f32_16x16x32_bf16 v[68:71], v[56:59], a[16:19], v[68:71]
    v_mfma_f32_16x16x32_bf16 v[72:75], v[56:59], a[20:23], v[72:75]
    v_mfma_f32_16x16x32_bf16 v[76:79], v[56:59], a[24:27], v[76:79]
    v_mfma_f32_16x16x32_bf16 v[80:83], v[56:59], a[28:31], v[80:83]
    ds_read_b128 v[56:59], v5 offset:5120
    s_waitcnt lgkmcnt(3)
    v_mfma_f32_16x16x32_bf16 v[68:71], v[60:63], a[32:35], v[68:71]
    v_mfma_f32_16x16x32_bf16 v[72:75], v[60:63], a[36:39], v[72:75]
    v_mfma_f32_16x16x32_bf16 v[76:79], v[60:63], a[40:43], v[76:79]
    v_mfma_f32_16x16x32_bf16 v[80:83], v[60:63], a[44:47], v[80:83]
    ds_read_b128 v[60:63], v5 offset:6144
    s_waitcnt lgkmcnt(3)
    v_mfma_f32_16x16x32_bf16 v[68:71], v[64:67], a[48:51], v[68:71]
    v_mfma_f32_16x16x32_bf16 v[72:75], v[64:67], a[52:55], v[72:75]
    v_mfma_f32_16x16x32_bf16 v[76:79], v[64:67], a[56:59], v[76:79]
    v_mfma_f32_16x16x32_bf16 v[80:83], v[64:67], a[60:63], v[80:83]
    ds_read_b128 v[64:67], v5 offset:7168
    s_waitcnt lgkmcnt(3)
    v_mfma_f32_16x16x32_bf16 v[68:71], v[52:55], a[64:67], v[68:71]
    v_mfma_f32_16x16x32_bf16 v[72:75], v[52:55], a[68:71], v[72:75]
    v_mfma_f32_16x16x32_bf16 v[76:79], v[52:55], a[72:75], v[76:79]
    v_mfma_f32_16x16x32_bf16 v[80:83], v[52:55], a[76:79], v[80:83]
    ds_read_b128 v[52:55], v5 offset:8192
    s_waitcnt lgkmcnt(3)
    v_mfma_f32_16x16x32_bf16 v[68:71], v[56:59], a[80:83], v[68:71]
    v_mfma_f32_16x16x32_bf16 v[72:75], v[56:59], a[84:87], v[72:75]
    v_mfma_f32_16x16x32_bf16 v[76:79], v[56:59], a[88:91], v[76:79]
    v_mfma_f32_16x16x32_bf16 v[80:83], v[56:59], a[92:95], v[80:83]
    ds_read_b128 v[56:59], v5 offset:9216
    s_waitcnt lgkmcnt(3)
    v_mfma_f32_16x16x32_bf16 v[68:71], v[60:63], a[96:99], v[68:71]
    v_mfma_f32_16x16x32_bf16 v[72:75], v[60:63], a[100:103], v[72:75]
    v_mfma_f32_16x16x32_bf16 v[76:79], v[60:63], a[104:107], v[76:79]
    v_mfma_f32_16x16x32_bf16 v[80:83], v[60:63], a[108:111], v[80:83]
    ds_read_b128 v[60:63], v5 offset:10240
    s_waitcnt lgkmcnt(3)
    v_mfma_f32_16x16x32_bf16 v[68:71], v[64:67], a[112:115], v[68:71]
    v_mfma_f32_16x16x32_bf16 v[72:75], v[64:67], a[116:119], v[72:75]
    v_mfma_f32_16x16x32_bf16 v[76:79], v[64:67], a[120:123], v[76:79]
    v_mfma_f32_16x16x32_bf16 v[80:83], v[64:67], a[124:127], v[80:83]
    ds_read_b128 v[64:67], v5 offset:11264
    s_waitcnt lgkmcnt(3)
    v_mfma_f32_16x16x32_bf16 v[68:71], v[52:55], a[128:131], v[68:71]
    v_mfma_f32_16x16x32_bf16 v[72:75], v[52:55], a[132:135], v[72:75]
    v_mfma_f32_16x16x32_bf16 v[76:79], v[52:55], a[136:139], v[76:79]
    v_mfma_f32_16x16x32_bf16 v[80:83], v[52:55], a[140:143], v[80:83]
    ds_read_b128 v[52:55], v5 offset:12288
    s_waitcnt lgkmcnt(3)
    v_mfma_f32_16x16x32_bf16 v[68:71], v[56:59], a[144:147], v[68:71]
    v_mfma_f32_16x16x32_bf16 v[72:75], v[56:59], a[148:151], v[72:75]
    v_mfma_f32_16x16x32_bf16 v[76:79], v[56:59], a[152:155], v[76:79]
    v_mfma_f32_16x16x32_bf16 v[80:83], v[56:59], a[156:159], v[80:83]
    ds_read_b128 v[56:59], v5 offset:13312
    s_waitcnt lgkmcnt(3)
    v_mfma_f32_16x16x32_bf16 v[68:71], v[60:63], a[160:163], v[68:71]
    v_mfma_f32_16x16x32_bf16 v[72:75], v[60:63], a[164:167], v[72:75]
    v_mfma_f32_16x16x32_bf16 v[76:79], v[60:63], a[168:171], v[76:79]
    v_mfma_f32_16x16x32_bf16 v[80:83], v[60:63], a[172:175], v[80:83]
    ds_read_b128 v[60:63], v5 offset:14336
    s_waitcnt lgkmcnt(3)
    v_mfma_f32_16x16x32_bf16 v[68:71], v[64:67], a[176:179], v[68:71]
    v_mfma_f32_16x16x32_bf16 v[72:75], v[64:67], a[180:183], v[72:75]
    v_mfma_f32_16x16x32_bf16 v[76:79], v[64:67], a[184:187], v[76:79]
    v_mfma_f32_16x16x32_bf16 v[80:83], v[64:67], a[188:191], v[80:83]
    ds_read_b128 v[64:67], v5 offset:15360
    s_waitcnt lgkmcnt(3)
    v_mfma_f32_16x16x32_bf16 v[68:71], v[52:55], a[192:195], v[68:71]
    v_mfma_f32_16x16x32_bf16 v[72:75], v[52:55], a[196:199], v[72:75]
    v_mfma_f32_16x16x32_bf16 v[76:79], v[52:55], a[200:203], v[76:79]
    v_mfma_f32_16x16x32_bf16 v[80:83], v[52:55], a[204:207], v[80:83]
    ds_read_b128 v[52:55], v5 offset:16384
    s_waitcnt lgkmcnt(3)
    v_mfma_f32_16x16x32_bf16 v[68:71], v[56:59], a[208:211], v[68:71]
    v_mfma_f32_16x16x32_bf16 v[72:75], v[56:59], a[212:215], v[72:75]
    v_mfma_f32_16x16x32_bf16 v[76:79], v[56:59], a[216:219], v[76:79]
    v_mfma_f32_16x16x32_bf16 v[80:83], v[56:59], a[220:223], v[80:83]
    ds_read_b128 v[56:59], v5 offset:17408
    s_waitcnt lgkmcnt(3)
    v_mfma_f32_16x16x32_bf16 v[68:71], v[60:63], a[224:227], v[68:71]
    v_mfma_f32_16x16x32_bf16 v[72:75], v[60:63], a[228:231], v[72:75]
    v_mfma_f32_16x16x32_bf16 v[76:79], v[60:63], a[232:235], v[76:79]
    v_mfma_f32_16x16x32_bf16 v[80:83], v[60:63], a[236:239], v[80:83]
    ds_read_b128 v[60:63], v5 offset:18432
    s_waitcnt lgkmcnt(3)
    v_mfma_f32_16x16x32_bf16 v[68:71], v[64:67], a[240:243], v[68:71]
    v_mfma_f32_16x16x32_bf16 v[72:75], v[64:67], a[244:247], v[72:75]
    v_mfma_f32_16x16x32_bf16 v[76:79], v[64:67], a[248:251], v[76:79]
    v_mfma_f32_16x16x32_bf16 v[80:83], v[64:67], a[252:255], v[80:83]
    ds_read_b128 v[64:67], v5 offset:19456
    s_waitcnt lgkmcnt(3)
    v_mfma_f32_16x16x32_bf16 v[68:71], v[52:55], v[192:195], v[68:71]
    v_mfma_f32_16x16x32_bf16 v[72:75], v[52:55], v[196:199], v[72:75]
    v_mfma_f32_16x16x32_bf16 v[76:79], v[52:55], v[200:203], v[76:79]
    v_mfma_f32_16x16x32_bf16 v[80:83], v[52:55], v[204:207], v[80:83]
    s_waitcnt lgkmcnt(2)
    v_mfma_f32_16x16x32_bf16 v[68:71], v[56:59], v[208:211], v[68:71]
    v_mfma_f32_16x16x32_bf16 v[72:75], v[56:59], v[212:215], v[72:75]
    v_mfma_f32_16x16x32_bf16 v[76:79], v[56:59], v[216:219], v[76:79]
    v_mfma_f32_16x16x32_bf16 v[80:83], v[56:59], v[220:223], v[80:83]
    s_waitcnt lgkmcnt(1)
    v_mfma_f32_16x16x32_bf16 v[68:71], v[60:63], v[224:227], v[68:71]
    v_mfma_f32_16x16x32_bf16 v[72:75], v[60:63], v[228:231], v[72:75]
    v_mfma_f32_16x16x32_bf16 v[76:79], v[60:63], v[232:235], v[76:79]
    v_mfma_f32_16x16x32_bf16 v[80:83], v[60:63], v[236:239], v[80:83]
    s_waitcnt lgkmcnt(0)
    v_mfma_f32_16x16x32_bf16 v[68:71], v[64:67], v[240:243], v[68:71]
    v_mfma_f32_16x16x32_bf16 v[72:75], v[64:67], v[244:247], v[72:75]
    v_mfma_f32_16x16x32_bf16 v[76:79], v[64:67], v[248:251], v[76:79]
    v_mfma_f32_16x16x32_bf16 v[80:83], v[64:67], v[252:255], v[80:83]
    s_waitcnt vmcnt(0)
    ds_write_b128 v4, v[32:35] offset:20480
    ds_write_b128 v4, v[36:39] offset:21504
    ds_write_b128 v4, v[40:43] offset:22528
    ds_write_b128 v4, v[44:47] offset:23552
    ds_write_b128 v4, v[48:51] offset:24576
    s_lshr_b32 s43, s42, 1
    s_lshl_b32 s43, s43, 18
    s_add_u32 s43, s43, s44
    s_and_b32 s45, s42, 1
    s_lshl_b32 s45, s45, 3
    s_add_u32 s43, s43, s45
    v_cvt_pk_bf16_f32 v84, v68, v69
    v_cvt_pk_bf16_f32 v85, v70, v71
    v_cvt_pk_bf16_f32 v86, v72, v73
    v_cvt_pk_bf16_f32 v87, v74, v75
    v_cvt_pk_bf16_f32 v88, v76, v77
    v_cvt_pk_bf16_f32 v89, v78, v79
    v_cvt_pk_bf16_f32 v90, v80, v81
    v_cvt_pk_bf16_f32 v91, v82, v83
    buffer_store_dwordx2 v[84:85], v6, s[32:35], s43 offen offset:0 sc1
    buffer_store_dwordx2 v[86:87], v6, s[32:35], s43 offen offset:1024 sc1
    buffer_store_dwordx2 v[88:89], v6, s[32:35], s43 offen offset:2048 sc1
    buffer_store_dwordx2 v[90:91], v6, s[32:35], s43 offen offset:3072 sc1
    s_waitcnt lgkmcnt(0)
    s_barrier
    s_cmp_le_u32 s42, s49
    s_cbranch_scc1 g1_nf_3
    s_cmp_lg_u32 s3, 0
    s_cbranch_scc1 g1_nf_3
    s_lshl_b32 s43, s42, 2
    s_add_u32 s43, s43, s52
    buffer_store_dword v11, v12, s[32:35], s43 offen sc1
g1_nf_3:
    s_add_u32 s40, s40, 20480
    s_add_u32 s42, s42, 1
    s_cmp_ge_u32 s42, s46
    s_cbranch_scc1 g1_fin
    s_add_u32 s41, s40, 20480
    buffer_load_dwordx4 v[32:35], v3, s[32:35], s41 offen offset:0
    buffer_load_dwordx4 v[36:39], v3, s[32:35], s41 offen offset:64
    buffer_load_dwordx4 v[40:43], v3, s[32:35], s41 offen offset:128
    buffer_load_dwordx4 v[44:47], v3, s[32:35], s41 offen offset:192
    buffer_load_dwordx4 v[48:51], v3, s[32:35], s41 offen offset:256
    ds_read_b128 v[52:55], v5 offset:20480
    ds_read_b128 v[56:59], v5 offset:21504
    ds_read_b128 v[60:63], v5 offset:22528
    ds_read_b128 v[64:67], v5 offset:23552
    s_waitcnt lgkmcnt(3)
    v_mfma_f32_16x16x32_bf16 v[68:71], v[52:55], a[0:3], 0
    v_mfma_f32_16x16x32_bf16 v[72:75], v[52:55], a[4:7], 0
    v_mfma_f32_16x16x32_bf16 v[76:79], v[52:55], a[8:11], 0
    v_mfma_f32_16x16x32_bf16 v[80:83], v[52:55], a[12:15], 0
    ds_read_b128 v[52:55], v5 offset:24576
    s_waitcnt lgkmcnt(3)
    v_mfma_f32_16x16x32_bf16 v[68:71], v[56:59], a[16:19], v[68:71]
    v_mfma_f32_16x16x32_bf16 v[72:75], v[56:59], a[20:23], v[72:75]
    v_mfma_f32_16x16x32_bf16 v[76:79], v[56:59], a[24:27], v[76:79]
    v_mfma_f32_16x16x32_bf16 v[80:83], v[56:59], a[28:31], v[80:83]
    ds_read_b128 v[56:59], v5 offset:25600
    s_waitcnt lgkmcnt(3)
    v_mfma_f32_16x16x32_bf16 v[68:71], v[60:63], a[32:35], v[68:71]
    v_mfma_f32_16x16x32_bf16 v[72:75], v[60:63], a[36:39], v[72:75]
    v_mfma_f32_16x16x32_bf16 v[76:79], v[60:63], a[40:43], v[76:79]
    v_mfma_f32_16x16x32_bf16 v[80:83], v[60:63], a[44:47], v[80:83]
    ds_read_b128 v[60:63], v5 offset:26624
    s_waitcnt lgkmcnt(3)
    v_mfma_f32_16x16x32_bf16 v[68:71], v[64:67], a[48:51], v[68:71]
    v_mfma_f32_16x16x32_bf16 v[72:75], v[64:67], a[52:55], v[72:75]
    v_mfma_f32_16x16x32_bf16 v[76:79], v[64:67], a[56:59], v[76:79]
    v_mfma_f32_16x16x32_bf16 v[80:83], v[64:67], a[60:63], v[80:83]
    ds_read_b128 v[64:67], v5 offset:27648
    s_waitcnt lgkmcnt(3)
    v_mfma_f32_16x16x32_bf16 v[68:71], v[52:55], a[64:67], v[68:71]
    v_mfma_f32_16x16x32_bf16 v[72:75], v[52:55], a[68:71], v[72:75]
    v_mfma_f32_16x16x32_bf16 v[76:79], v[52:55], a[72:75], v[76:79]
    v_mfma_f32_16x16x32_bf16 v[80:83], v[52:55], a[76:79], v[80:83]
    ds_read_b128 v[52:55], v5 offset:28672
    s_waitcnt lgkmcnt(3)
    v_mfma_f32_16x16x32_bf16 v[68:71], v[56:59], a[80:83], v[68:71]
    v_mfma_f32_16x16x32_bf16 v[72:75], v[56:59], a[84:87], v[72:75]
    v_mfma_f32_16x16x32_bf16 v[76:79], v[56:59], a[88:91], v[76:79]
    v_mfma_f32_16x16x32_bf16 v[80:83], v[56:59], a[92:95], v[80:83]
    ds_read_b128 v[56:59], v5 offset:29696
    s_waitcnt lgkmcnt(3)
    v_mfma_f32_16x16x32_bf16 v[68:71], v[60:63], a[96:99], v[68:71]
    v_mfma_f32_16x16x32_bf16 v[72:75], v[60:63], a[100:103], v[72:75]
    v_mfma_f32_16x16x32_bf16 v[76:79], v[60:63], a[104:107], v[76:79]
    v_mfma_f32_16x16x32_bf16 v[80:83], v[60:63], a[108:111], v[80:83]
    ds_read_b128 v[60:63], v5 offset:30720
    s_waitcnt lgkmcnt(3)
    v_mfma_f32_16x16x32_bf16 v[68:71], v[64:67], a[112:115], v[68:71]
    v_mfma_f32_16x16x32_bf16 v[72:75], v[64:67], a[116:119], v[72:75]
    v_mfma_f32_16x16x32_bf16 v[76:79], v[64:67], a[120:123], v[76:79]
    v_mfma_f32_16x16x32_bf16 v[80:83], v[64:67], a[124:127], v[80:83]
    ds_read_b128 v[64:67], v5 offset:31744
    s_waitcnt lgkmcnt(3)
    v_mfma_f32_16x16x32_bf16 v[68:71], v[52:55], a[128:131], v[68:71]
    v_mfma_f32_16x16x32_bf16 v[72:75], v[52:55], a[132:135], v[72:75]
    v_mfma_f32_16x16x32_bf16 v[76:79], v[52:55], a[136:139], v[76:79]
    v_mfma_f32_16x16x32_bf16 v[80:83], v[52:55], a[140:143], v[80:83]
    ds_read_b128 v[52:55], v5 offset:32768
    s_waitcnt lgkmcnt(3)
    v_mfma_f32_16x16x32_bf16 v[68:71], v[56:59], a[144:147], v[68:71]
    v_mfma_f32_16x16x32_bf16 v[72:75], v[56:59], a[148:151], v[72:75]
    v_mfma_f32_16x16x32_bf16 v[76:79], v[56:59], a[152:155], v[76:79]
    v_mfma_f32_16x16x32_bf16 v[80:83], v[56:59], a[156:159], v[80:83]
    ds_read_b128 v[56:59], v5 offset:33792
    s_waitcnt lgkmcnt(3)
    v_mfma_f32_16x16x32_bf16 v[68:71], v[60:63], a[160:163], v[68:71]
    v_mfma_f32_16x16x32_bf16 v[72:75], v[60:63], a[164:167], v[72:75]
    v_mfma_f32_16x16x32_bf16 v[76:79], v[60:63], a[168:171], v[76:79]
    v_mfma_f32_16x16x32_bf16 v[80:83], v[60:63], a[172:175], v[80:83]
    ds_read_b128 v[60:63], v5 offset:34816
    s_waitcnt lgkmcnt(3)
    v_mfma_f32_16x16x32_bf16 v[68:71], v[64:67], a[176:179], v[68:71]
    v_mfma_f32_16x16x32_bf16 v[72:75], v[64:67], a[180:183], v[72:75]
    v_mfma_f32_16x16x32_bf16 v[76:79], v[64:67], a[184:187], v[76:79]
    v_mfma_f32_16x16x32_bf16 v[80:83], v[64:67], a[188:191], v[80:83]
    ds_read_b128 v[64:67], v5 offset:35840
    s_waitcnt lgkmcnt(3)
    v_mfma_f32_16x16x32_bf16 v[68:71], v[52:55], a[192:195], v[68:71]
    v_mfma_f32_16x16x32_bf16 v[72:75], v[52:55], a[196:199], v[72:75]
    v_mfma_f32_16x16x32_bf16 v[76:79], v[52:55], a[200:203], v[76:79]
    v_mfma_f32_16x16x32_bf16 v[80:83], v[52:55], a[204:207], v[80:83]
    ds_read_b128 v[52:55], v5 offset:36864
    s_waitcnt lgkmcnt(3)
    v_mfma_f32_16x16x32_bf16 v[68:71], v[56:59], a[208:211], v[68:71]
    v_mfma_f32_16x16x32_bf16 v[72:75], v[56:59], a[212:215], v[72:75]
    v_mfma_f32_16x16x32_bf16 v[76:79], v[56:59], a[216:219], v[76:79]
    v_mfma_f32_16x16x32_bf16 v[80:83], v[56:59], a[220:223], v[80:83]
    ds_read_b128 v[56:59], v5 offset:37888
    s_waitcnt lgkmcnt(3)
    v_mfma_f32_16x16x32_bf16 v[68:71], v[60:63], a[224:227], v[68:71]
    v_mfma_f32_16x16x32_bf16 v[72:75], v[60:63], a[228:231], v[72:75]
    v_mfma_f32_16x16x32_bf16 v[76:79], v[60:63], a[232:235], v[76:79]
    v_mfma_f32_16x16x32_bf16 v[80:83], v[60:63], a[236:239], v[80:83]
    ds_read_b128 v[60:63], v5 offset:38912
    s_waitcnt lgkmcnt(3)
    v_mfma_f32_16x16x32_bf16 v[68:71], v[64:67], a[240:243], v[68:71]
    v_mfma_f32_16x16x32_bf16 v[72:75], v[64:67], a[244:247], v[72:75]
    v_mfma_f32_16x16x32_bf16 v[76:79], v[64:67], a[248:251], v[76:79]
    v_mfma_f32_16x16x32_bf16 v[80:83], v[64:67], a[252:255], v[80:83]
    ds_read_b128 v[64:67], v5 offset:39936
    s_waitcnt lgkmcnt(3)
    v_mfma_f32_16x16x32_bf16 v[68:71], v[52:55], v[192:195], v[68:71]
    v_mfma_f32_16x16x32_bf16 v[72:75], v[52:55], v[196:199], v[72:75]
    v_mfma_f32_16x16x32_bf16 v[76:79], v[52:55], v[200:203], v[76:79]
    v_mfma_f32_16x16x32_bf16 v[80:83], v[52:55], v[204:207], v[80:83]
    s_waitcnt lgkmcnt(2)
    v_mfma_f32_16x16x32_bf16 v[68:71], v[56:59], v[208:211], v[68:71]
    v_mfma_f32_16x16x32_bf16 v[72:75], v[56:59], v[212:215], v[72:75]
    v_mfma_f32_16x16x32_bf16 v[76:79], v[56:59], v[216:219], v[76:79]
    v_mfma_f32_16x16x32_bf16 v[80:83], v[56:59], v[220:223], v[80:83]
    s_waitcnt lgkmcnt(1)
    v_mfma_f32_16x16x32_bf16 v[68:71], v[60:63], v[224:227], v[68:71]
    v_mfma_f32_16x16x32_bf16 v[72:75], v[60:63], v[228:231], v[72:75]
    v_mfma_f32_16x16x32_bf16 v[76:79], v[60:63], v[232:235], v[76:79]
    v_mfma_f32_16x16x32_bf16 v[80:83], v[60:63], v[236:239], v[80:83]
    s_waitcnt lgkmcnt(0)
    v_mfma_f32_16x16x32_bf16 v[68:71], v[64:67], v[240:243], v[68:71]
    v_mfma_f32_16x16x32_bf16 v[72:75], v[64:67], v[244:247], v[72:75]
    v_mfma_f32_16x16x32_bf16 v[76:79], v[64:67], v[248:251], v[76:79]
    v_mfma_f32_16x16x32_bf16 v[80:83], v[64:67], v[252:255], v[80:83]
    s_waitcnt vmcnt(0)
    ds_write_b128 v4, v[32:35] offset:0
    ds_write_b128 v4, v[36:39] offset:1024
    ds_write_b128 v4, v[40:43] offset:2048
    ds_write_b128 v4, v[44:47] offset:3072
    ds_write_b128 v4, v[48:51] offset:4096
    s_lshr_b32 s43, s42, 1
    s_lshl_b32 s43, s43, 18
    s_add_u32 s43, s43, s44
    s_and_b32 s45, s42, 1
    s_lshl_b32 s45, s45, 3
    s_add_u32 s43, s43, s45
    v_cvt_pk_bf16_f32 v84, v68, v69
    v_cvt_pk_bf16_f32 v85, v70, v71
    v_cvt_pk_bf16_f32 v86, v72, v73
    v_cvt_pk_bf16_f32 v87, v74, v75
    v_cvt_pk_bf16_f32 v88, v76, v77
    v_cvt_pk_bf16_f32 v89, v78, v79
    v_cvt_pk_bf16_f32 v90, v80, v81
    v_cvt_pk_bf16_f32 v91, v82, v83
    buffer_store_dwordx2 v[84:85], v6, s[32:35], s43 offen offset:0 sc1
    buffer_store_dwordx2 v[86:87], v6, s[32:35], s43 offen offset:1024 sc1
    buffer_store_dwordx2 v[88:89], v6, s[32:35], s43 offen offset:2048 sc1
    buffer_store_dwordx2 v[90:91], v6, s[32:35], s43 offen offset:3072 sc1
    s_waitcnt lgkmcnt(0)
    s_barrier
    s_cmp_le_u32 s42, s49
    s_cbranch_scc1 g1_nf_4
    s_cmp_lg_u32 s3, 0
    s_cbranch_scc1 g1_nf_4
    s_lshl_b32 s43, s42, 2
    s_add_u32 s43, s43, s52
    buffer_store_dword v11, v12, s[32:35], s43 offen sc1
g1_nf_4:
    s_add_u32 s40, s40, 20480
    s_add_u32 s42, s42, 1
    s_cmp_lt_u32 s42, s46
    s_cbranch_scc1 g1_loop_v
    s_branch g1_fin
g1_fin:
    s_waitcnt vmcnt(0)
    s_barrier
    s_cmp_lg_u32 s3, 0
    s_cbranch_scc1 g1_post
    s_lshl_b32 s43, s42, 2
    s_add_u32 s43, s43, s52
    buffer_store_dword v11, v12, s[32:35], s43 offen sc1
g1_post:
    v_and_b32 v1, 63, v0
    v_lshrrev_b32 v2, 4, v1
    v_and_b32 v3, 15, v1
    v_lshlrev_b32 v4, 4, v1
    v_lshlrev_b32 v5, 3, v1
    v_lshlrev_b32 v12, 2, v1
    s_mov_b32 s56, 0x3db504f3
    s_mov_b32 s57, 0x3fb8aa3b
    v_cmp_gt_u32 s[52:53], 32, v1
    v_lshlrev_b32 v6, 2, v2
    v_add_u32 v7, 0, v6
    v_cmp_le_u32 s[60:61], v7, v3
    v_add_u32 v7, 1, v6
    v_cmp_le_u32 s[62:63], v7, v3
    v_add_u32 v7, 2, v6
    v_cmp_le_u32 s[64:65], v7, v3
    v_add_u32 v7, 3, v6
    v_cmp_le_u32 s[66:67], v7, v3
    s_mul_i32 s47, s3, 20480
    v_add_u32 v6, s47, v4
    s_mul_i32 s47, s3, 5120
    v_add_u32 v7, s47, v4
    v_add_u32 v11, 40960, v7
    s_mov_b32 s70, s2
    s_nop 3
p2_task:
    s_cmp_ge_u32 s70, 480
    s_cbranch_scc1 p2_fine
    s_lshr_b32 s36, s70, 3
    s_and_b32 s37, s70, 7
    s_lshl_b32 s44, s37, 2
    s_add_u32 s44, s44, s3
    s_lshr_b32 s45, s44, 1
    v_lshrrev_b32 v8, 1, v1
    v_lshlrev_b32 v8, 4, v8
    v_add_u32 v8, s45, v8
    v_lshlrev_b32 v8, 7, v8
    v_and_b32 v9, 1, v1
    v_add_u32 v8, v8, v9
    s_lshl_b32 s45, s36, 1
    v_add_u32 v8, s45, v8
    v_lshlrev_b32 v8, 2, v8
    v_add_u32 v8, 3342336, v8
    s_lshl_b32 s45, s44, 2
    s_add_u32 s45, s45, 3375104
    v_mov_b32 v9, s45
    v_cmp_gt_u32 vcc, 6, v1
    s_nop 1
    v_cndmask_b32 v8, v9, v8, vcc
    v_mov_b32 v9, s36
    v_mov_b32 v10, 0
    v_cndmask_b32 v9, v9, v10, vcc
    s_mov_b32 s46, 400000
    s_nop 3
p2_waitc:
    buffer_load_dword v10, v8, s[32:35], 0 offen sc1
    s_waitcnt vmcnt(0)
    v_cmp_le_u32 vcc, v10, v9
    s_nop 4
    s_cbranch_vccz p2_goc
    s_sleep 32
    s_sub_u32 s46, s46, 1
    s_cmp_lg_u32 s46, 0
    s_cbranch_scc1 p2_waitc
p2_goc:
    s_lshl_b32 s45, s36, 18
    s_lshl_b32 s47, s44, 13
    s_add_u32 s45, s45, s47
    s_lshl_b32 s46, s36, 17
    s_lshl_b32 s47, s44, 12
    s_add_u32 s46, s46, s47
    s_add_u32 s48, s47, 16777216
    s_add_u32 s47, s45, 33554432
    buffer_load_dwordx4 v[168:171], v4, s[32:35], s47 offen offset:0 sc1
    buffer_load_dwordx4 v[172:175], v4, s[32:35], s47 offen offset:1024 sc1
    buffer_load_dwordx4 v[176:179], v4, s[32:35], s47 offen offset:2048 sc1
    buffer_load_dwordx4 v[180:183], v4, s[32:35], s47 offen offset:3072 sc1
    s_add_u32 s47, s47, 4096
    buffer_load_dwordx4 v[184:187], v4, s[32:35], s47 offen offset:0 sc1
    buffer_load_dwordx4 v[188:191], v4, s[32:35], s47 offen offset:1024 sc1
    buffer_load_dwordx4 v[192:195], v4, s[32:35], s47 offen offset:2048 sc1
    buffer_load_dwordx4 v[196:199], v4, s[32:35], s47 offen offset:3072 sc1
    s_add_u32 s47, s45, 50331648
    buffer_load_dwordx4 v[200:203], v4, s[32:35], s47 offen offset:0 sc1
    buffer_load_dwordx4 v[204:207], v4, s[32:35], s47 offen offset:1024 sc1
    buffer_load_dwordx4 v[208:211], v4, s[32:35], s47 offen offset:2048 sc1
    buffer_load_dwordx4 v[212:215], v4, s[32:35], s47 offen offset:3072 sc1
    s_add_u32 s47, s47, 4096
    buffer_load_dwordx4 v[216:219], v4, s[32:35], s47 offen offset:0 sc1
    buffer_load_dwordx4 v[220:223], v4, s[32:35], s47 offen offset:1024 sc1
    buffer_load_dwordx4 v[224:227], v4, s[32:35], s47 offen offset:2048 sc1
    buffer_load_dwordx4 v[228:231], v4, s[32:35], s47 offen offset:3072 sc1
    s_add_u32 s47, s45, 67108864
    buffer_load_dwordx4 a[208:211], v4, s[32:35], s47 offen offset:0 sc1
    buffer_load_dwordx4 a[212:215], v4, s[32:35], s47 offen offset:1024 sc1
    buffer_load_dwordx4 a[216:219], v4, s[32:35], s47 offen offset:2048 sc1
    buffer_load_dwordx4 a[220:223], v4, s[32:35], s47 offen offset:3072 sc1
    s_add_u32 s47, s47, 4096
    buffer_load_dwordx4 a[224:227], v4, s[32:35], s47 offen offset:0 sc1
    buffer_load_dwordx4 a[228:231], v4, s[32:35], s47 offen offset:1024 sc1
    buffer_load_dwordx4 a[232:235], v4, s[32:35], s47 offen offset:2048 sc1
    buffer_load_dwordx4 a[236:239], v4, s[32:35], s47 offen offset:3072 sc1
    s_add_u32 s47, s46, 83886080
    buffer_load_dwordx4 v[232:235], v4, s[32:35], s47 offen offset:0 sc1
    buffer_load_dwordx4 v[236:239], v4, s[32:35], s47 offen offset:1024 sc1
    buffer_load_dwordx4 v[240:243], v4, s[32:35], s47 offen offset:2048 sc1
    buffer_load_dwordx4 v[244:247], v4, s[32:35], s47 offen offset:3072 sc1
    s_add_u32 s47, s46, 100663296
    buffer_load_dwordx2 a[240:241], v5, s[32:35], s47 offen offset:0 sc1
    buffer_load_dwordx2 a[242:243], v5, s[32:35], s47 offen offset:512 sc1
    buffer_load_dwordx2 a[244:245], v5, s[32:35], s47 offen offset:1024 sc1
    buffer_load_dwordx2 a[246:247], v5, s[32:35], s47 offen offset:1536 sc1
    buffer_load_dwordx2 a[248:249], v5, s[32:35], s47 offen offset:2048 sc1
    buffer_load_dwordx2 a[250:251], v5, s[32:35], s47 offen offset:2560 sc1
    buffer_load_dwordx2 a[252:253], v5, s[32:35], s47 offen offset:3072 sc1
    buffer_load_dwordx2 a[254:255], v5, s[32:35], s47 offen offset:3584 sc1
    s_add_u32 s45, s45, 8192
    s_add_u32 s46, s46, 4096
    s_add_u32 s47, s48, 0
    buffer_load_dwordx4 v[88:91], v4, s[32:35], s47 offen
    s_add_u32 s47, s48, 131072
    buffer_load_dwordx4 v[92:95], v4, s[32:35], s47 offen
    s_add_u32 s47, s48, 262144
    buffer_load_dwordx4 v[96:99], v4, s[32:35], s47 offen
    s_add_u32 s47, s48, 393216
    buffer_load_dwordx4 v[100:103], v4, s[32:35], s47 offen
    s_add_u32 s47, s48, 524288
    buffer_load_dwordx4 v[104:107], v4, s[32:35], s47 offen
    s_add_u32 s47, s48, 655360
    buffer_load_dwordx4 v[108:111], v4, s[32:35], s47 offen
    s_add_u32 s47, s48, 786432
    buffer_load_dwordx4 v[112:115], v4, s[32:35], s47 offen
    s_add_u32 s47, s48, 917504
    buffer_load_dwordx4 v[116:119], v4, s[32:35], s47 offen
    s_add_u32 s47, s48, 1048576
    buffer_load_dwordx4 v[120:123], v4, s[32:35], s47 offen
    s_add_u32 s47, s48, 1179648
    buffer_load_dwordx4 v[124:127], v4, s[32:35], s47 offen
    s_add_u32 s47, s48, 1024
    buffer_load_dwordx4 v[128:131], v4, s[32:35], s47 offen
    s_add_u32 s47, s48, 132096
    buffer_load_dwordx4 v[132:135], v4, s[32:35], s47 offen
    s_add_u32 s47, s48, 263168
    buffer_load_dwordx4 v[136:139], v4, s[32:35], s47 offen
    s_add_u32 s47, s48, 394240
    buffer_load_dwordx4 v[140:143], v4, s[32:35], s47 offen
    s_add_u32 s47, s48, 525312
    buffer_load_dwordx4 v[144:147], v4, s[32:35], s47 offen
    s_add_u32 s47, s48, 656384
    buffer_load_dwordx4 v[148:151], v4, s[32:35], s47 offen
    s_add_u32 s47, s48, 787456
    buffer_load_dwordx4 v[152:155], v4, s[32:35], s47 offen
    s_add_u32 s47, s48, 918528
    buffer_load_dwordx4 v[156:159], v4, s[32:35], s47 offen
    s_add_u32 s47, s48, 1049600
    buffer_load_dwordx4 v[160:163], v4, s[32:35], s47 offen
    s_add_u32 s47, s48, 1180672
    buffer_load_dwordx4 v[164:167], v4, s[32:35], s47 offen
    s_waitcnt vmcnt(20)
    v_mfma_f32_16x16x32_bf16 v[16:19], v[232:235], v[168:171], 0
    v_mfma_f32_16x16x32_bf16 v[20:23], v[200:203], v[168:171], 0
    v_mfma_f32_16x16x32_bf16 v[24:27], v[232:235], v[172:175], 0
    v_mfma_f32_16x16x32_bf16 v[28:31], v[200:203], v[172:175], 0
    v_mfma_f32_16x16x32_bf16 v[32:35], v[204:207], v[172:175], 0
    v_mfma_f32_16x16x32_bf16 v[16:19], v[236:239], v[176:179], v[16:19]
    v_mfma_f32_16x16x32_bf16 v[20:23], v[208:211], v[176:179], v[20:23]
    v_mfma_f32_16x16x32_bf16 v[24:27], v[236:239], v[180:183], v[24:27]
    v_mfma_f32_16x16x32_bf16 v[28:31], v[208:211], v[180:183], v[28:31]
    v_mfma_f32_16x16x32_bf16 v[32:35], v[212:215], v[180:183], v[32:35]
    v_mfma_f32_16x16x32_bf16 v[16:19], v[240:243], v[184:187], v[16:19]
    v_mfma_f32_16x16x32_bf16 v[20:23], v[216:219], v[184:187], v[20:23]
    v_mfma_f32_16x16x32_bf16 v[24:27], v[240:243], v[188:191], v[24:27]
    v_mfma_f32_16x16x32_bf16 v[28:31], v[216:219], v[188:191], v[28:31]
    v_mfma_f32_16x16x32_bf16 v[32:35], v[220:223], v[188:191], v[32:35]
    v_mfma_f32_16x16x32_bf16 v[16:19], v[244:247], v[192:195], v[16:19]
    v_mfma_f32_16x16x32_bf16 v[20:23], v[224:227], v[192:195], v[20:23]
    v_mfma_f32_16x16x32_bf16 v[24:27], v[244:247], v[196:199], v[24:27]
    v_mfma_f32_16x16x32_bf16 v[28:31], v[224:227], v[196:199], v[28:31]
    v_mfma_f32_16x16x32_bf16 v[32:35], v[228:231], v[196:199], v[32:35]
    s_nop 3
    v_cvt_pk_bf16_f32 v80, v16, v17
    v_lshlrev_b32 v16, 16, v80
    v_and_b32 v17, 0xffff0000, v80
    v_mul_f32 v16, s56, v16
    v_mul_f32 v17, s56, v17
    v_cvt_pk_bf16_f32 v80, v16, v17
    v_lshlrev_b32 v16, 16, v80
    v_and_b32 v17, 0xffff0000, v80
    v_cvt_pk_bf16_f32 v80, v18, v19
    v_lshlrev_b32 v18, 16, v80
    v_and_b32 v19, 0xffff0000, v80
    v_mul_f32 v18, s56, v18
    v_mul_f32 v19, s56, v19
    v_cvt_pk_bf16_f32 v80, v18, v19
    v_lshlrev_b32 v18, 16, v80
    v_and_b32 v19, 0xffff0000, v80
    v_cvt_pk_bf16_f32 v80, v20, v21
    v_lshlrev_b32 v20, 16, v80
    v_and_b32 v21, 0xffff0000, v80
    v_mul_f32 v20, s56, v20
    v_mul_f32 v21, s56, v21
    v_cvt_pk_bf16_f32 v80, v20, v21
    v_lshlrev_b32 v20, 16, v80
    v_and_b32 v21, 0xffff0000, v80
    v_cvt_pk_bf16_f32 v80, v22, v23
    v_lshlrev_b32 v22, 16, v80
    v_and_b32 v23, 0xffff0000, v80
    v_mul_f32 v22, s56, v22
    v_mul_f32 v23, s56, v23
    v_cvt_pk_bf16_f32 v80, v22, v23
    v_lshlrev_b32 v22, 16, v80
    v_and_b32 v23, 0xffff0000, v80
    v_mov_b32 v80, 0xff800000
    v_cndmask_b32 v16, v80, v16, s[52:53]
    v_cndmask_b32 v20, v80, v20, s[60:61]
    v_cndmask_b32 v17, v80, v17, s[52:53]
    v_cndmask_b32 v21, v80, v21, s[62:63]
    v_cndmask_b32 v18, v80, v18, s[52:53]
    v_cndmask_b32 v22, v80, v22, s[64:65]
    v_cndmask_b32 v19, v80, v19, s[52:53]
    v_cndmask_b32 v23, v80, v23, s[66:67]
    v_max_f32 v80, v16, v17
    v_max3_f32 v80, v80, v18, v19
    v_max3_f32 v80, v80, v20, v21
    v_max3_f32 v80, v80, v22, v23
    v_mov_b32 v81, v80
    v_mov_b32 v82, v80
    s_nop 1
    v_permlane16_swap_b32 v81, v82
    v_max_f32 v80, v81, v82
    v_mov_b32 v81, v80
    v_mov_b32 v82, v80
    s_nop 1
    v_permlane32_swap_b32 v81, v82
    v_max_f32 v80, v81, v82
    v_sub_f32 v16, v16, v80
    v_mul_f32 v16, s57, v16
    v_exp_f32 v16, v16
    v_sub_f32 v17, v17, v80
    v_mul_f32 v17, s57, v17
    v_exp_f32 v17, v17
    v_sub_f32 v18, v18, v80
    v_mul_f32 v18, s57, v18
    v_exp_f32 v18, v18
    v_sub_f32 v19, v19, v80
    v_mul_f32 v19, s57, v19
    v_exp_f32 v19, v19
    v_sub_f32 v20, v20, v80
    v_mul_f32 v20, s57, v20
    v_exp_f32 v20, v20
    v_sub_f32 v21, v21, v80
    v_mul_f32 v21, s57, v21
    v_exp_f32 v21, v21
    v_sub_f32 v22, v22, v80
    v_mul_f32 v22, s57, v22
    v_exp_f32 v22, v22
    v_sub_f32 v23, v23, v80
    v_mul_f32 v23, s57, v23
    v_exp_f32 v23, v23
    v_add_f32 v80, v16, v17
    v_add_f32 v80, v80, v18
    v_add_f32 v80, v80, v19
    v_add_f32 v80, v80, v20
    v_add_f32 v80, v80, v21
    v_add_f32 v80, v80, v22
    v_add_f32 v80, v80, v23
    v_mov_b32 v81, v80
    v_mov_b32 v82, v80
    s_nop 1
    v_permlane16_swap_b32 v81, v82
    v_add_f32 v80, v81, v82
    v_mov_b32 v81, v80
    v_mov_b32 v82, v80
    s_nop 1
    v_permlane32_swap_b32 v81, v82
    v_add_f32 v80, v81, v82
    v_rcp_f32 v81, v80
    s_nop 0
    v_fma_f32 v82, -v80, v81, 1.0
    v_fma_f32 v81, v82, v81, v81
    v_mul_f32 v16, v16, v81
    v_mul_f32 v17, v17, v81
    v_mul_f32 v18, v18, v81
    v_mul_f32 v19, v19, v81
    v_mul_f32 v20, v20, v81
    v_mul_f32 v21, v21, v81
    v_mul_f32 v22, v22, v81
    v_mul_f32 v23, v23, v81
    v_cvt_pk_bf16_f32 v40, v16, v17
    v_cvt_pk_bf16_f32 v41, v18, v19
    v_cvt_pk_bf16_f32 v36, v20, v21
    v_cvt_pk_bf16_f32 v37, v22, v23
    v_mov_b32 v38, 0
    v_mov_b32 v39, 0
    v_cvt_pk_bf16_f32 v80, v24, v25
    v_lshlrev_b32 v24, 16, v80
    v_and_b32 v25, 0xffff0000, v80
    v_mul_f32 v24, s56, v24
    v_mul_f32 v25, s56, v25
    v_cvt_pk_bf16_f32 v80, v24, v25
    v_lshlrev_b32 v24, 16, v80
    v_and_b32 v25, 0xffff0000, v80
    v_cvt_pk_bf16_f32 v80, v26, v27
    v_lshlrev_b32 v26, 16, v80
    v_and_b32 v27, 0xffff0000, v80
    v_mul_f32 v26, s56, v26
    v_mul_f32 v27, s56, v27
    v_cvt_pk_bf16_f32 v80, v26, v27
    v_lshlrev_b32 v26, 16, v80
    v_and_b32 v27, 0xffff0000, v80
    v_cvt_pk_bf16_f32 v80, v28, v29
    v_lshlrev_b32 v28, 16, v80
    v_and_b32 v29, 0xffff0000, v80
    v_mul_f32 v28, s56, v28
    v_mul_f32 v29, s56, v29
    v_cvt_pk_bf16_f32 v80, v28, v29
    v_lshlrev_b32 v28, 16, v80
    v_and_b32 v29, 0xffff0000, v80
    v_cvt_pk_bf16_f32 v80, v30, v31
    v_lshlrev_b32 v30, 16, v80
    v_and_b32 v31, 0xffff0000, v80
    v_mul_f32 v30, s56, v30
    v_mul_f32 v31, s56, v31
    v_cvt_pk_bf16_f32 v80, v30, v31
    v_lshlrev_b32 v30, 16, v80
    v_and_b32 v31, 0xffff0000, v80
    v_cvt_pk_bf16_f32 v80, v32, v33
    v_lshlrev_b32 v32, 16, v80
    v_and_b32 v33, 0xffff0000, v80
    v_mul_f32 v32, s56, v32
    v_mul_f32 v33, s56, v33
    v_cvt_pk_bf16_f32 v80, v32, v33
    v_lshlrev_b32 v32, 16, v80
    v_and_b32 v33, 0xffff0000, v80
    v_cvt_pk_bf16_f32 v80, v34, v35
    v_lshlrev_b32 v34, 16, v80
    v_and_b32 v35, 0xffff0000, v80
    v_mul_f32 v34, s56, v34
    v_mul_f32 v35, s56, v35
    v_cvt_pk_bf16_f32 v80, v34, v35
    v_lshlrev_b32 v34, 16, v80
    v_and_b32 v35, 0xffff0000, v80
    v_mov_b32 v80, 0xff800000
    v_cndmask_b32 v24, v80, v24, s[52:53]
    v_cndmask_b32 v32, v80, v32, s[60:61]
    v_cndmask_b32 v25, v80, v25, s[52:53]
    v_cndmask_b32 v33, v80, v33, s[62:63]
    v_cndmask_b32 v26, v80, v26, s[52:53]
    v_cndmask_b32 v34, v80, v34, s[64:65]
    v_cndmask_b32 v27, v80, v27, s[52:53]
    v_cndmask_b32 v35, v80, v35, s[66:67]
    v_max_f32 v80, v24, v25
    v_max3_f32 v80, v80, v26, v27
    v_max3_f32 v80, v80, v28, v29
    v_max3_f32 v80, v80, v30, v31
    v_max3_f32 v80, v80, v32, v33
    v_max3_f32 v80, v80, v34, v35
    v_mov_b32 v81, v80
    v_mov_b32 v82, v80
    s_nop 1
    v_permlane16_swap_b32 v81, v82
    v_max_f32 v80, v81, v82
    v_mov_b32 v81, v80
    v_mov_b32 v82, v80
    s_nop 1
    v_permlane32_swap_b32 v81, v82
    v_max_f32 v80, v81, v82
    v_sub_f32 v24, v24, v80
    v_mul_f32 v24, s57, v24
    v_exp_f32 v24, v24
    v_sub_f32 v25, v25, v80
    v_mul_f32 v25, s57, v25
    v_exp_f32 v25, v25
    v_sub_f32 v26, v26, v80
    v_mul_f32 v26, s57, v26
    v_exp_f32 v26, v26
    v_sub_f32 v27, v27, v80
    v_mul_f32 v27, s57, v27
    v_exp_f32 v27, v27
    v_sub_f32 v28, v28, v80
    v_mul_f32 v28, s57, v28
    v_exp_f32 v28, v28
    v_sub_f32 v29, v29, v80
    v_mul_f32 v29, s57, v29
    v_exp_f32 v29, v29
    v_sub_f32 v30, v30, v80
    v_mul_f32 v30, s57, v30
    v_exp_f32 v30, v30
    v_sub_f32 v31, v31, v80
    v_mul_f32 v31, s57, v31
    v_exp_f32 v31, v31
    v_sub_f32 v32, v32, v80
    v_mul_f32 v32, s57, v32
    v_exp_f32 v32, v32
    v_sub_f32 v33, v33, v80
    v_mul_f32 v33, s57, v33
    v_exp_f32 v33, v33
    v_sub_f32 v34, v34, v80
    v_mul_f32 v34, s57, v34
    v_exp_f32 v34, v34
    v_sub_f32 v35, v35, v80
    v_mul_f32 v35, s57, v35
    v_exp_f32 v35, v35
    v_add_f32 v80, v24, v25
    v_add_f32 v80, v80, v26
    v_add_f32 v80, v80, v27
    v_add_f32 v80, v80, v28
    v_add_f32 v80, v80, v29
    v_add_f32 v80, v80, v30
    v_add_f32 v80, v80, v31
    v_add_f32 v80, v80, v32
    v_add_f32 v80, v80, v33
    v_add_f32 v80, v80, v34
    v_add_f32 v80, v80, v35
    v_mov_b32 v81, v80
    v_mov_b32 v82, v80
    s_nop 1
    v_permlane16_swap_b32 v81, v82
    v_add_f32 v80, v81, v82
    v_mov_b32 v81, v80
    v_mov_b32 v82, v80
    s_nop 1
    v_permlane32_swap_b32 v81, v82
    v_add_f32 v80, v81, v82
    v_rcp_f32 v81, v80
    s_nop 0
    v_fma_f32 v82, -v80, v81, 1.0
    v_fma_f32 v81, v82, v81, v81
    v_mul_f32 v24, v24, v81
    v_mul_f32 v25, v25, v81
    v_mul_f32 v26, v26, v81
    v_mul_f32 v27, v27, v81
    v_mul_f32 v28, v28, v81
    v_mul_f32 v29, v29, v81
    v_mul_f32 v30, v30, v81
    v_mul_f32 v31, v31, v81
    v_mul_f32 v32, v32, v81
    v_mul_f32 v33, v33, v81
    v_mul_f32 v34, v34, v81
    v_mul_f32 v35, v35, v81
    v_cvt_pk_bf16_f32 v46, v24, v25
    v_cvt_pk_bf16_f32 v47, v26, v27
    v_cvt_pk_bf16_f32 v42, v28, v29
    v_cvt_pk_bf16_f32 v43, v30, v31
    v_cvt_pk_bf16_f32 v44, v32, v33
    v_cvt_pk_bf16_f32 v45, v34, v35
    v_mfma_f32_16x16x32_bf16 v[16:19], a[208:211], v[36:39], 0
    s_nop 0
    v_mfma_f32_16x16x32_bf16 v[20:23], a[208:211], v[42:45], 0
    v_mfma_f32_16x16x32_bf16 v[24:27], a[212:215], v[36:39], 0
    v_mfma_f32_16x16x32_bf16 v[28:31], a[212:215], v[42:45], 0
    s_nop 3
    v_mfma_f32_16x16x16_bf16 v[16:19], a[240:241], v[40:41], v[16:19]
    s_nop 0
    v_mfma_f32_16x16x16_bf16 v[20:23], a[240:241], v[46:47], v[20:23]
    v_mfma_f32_16x16x16_bf16 v[24:27], a[242:243], v[40:41], v[24:27]
    v_mfma_f32_16x16x16_bf16 v[28:31], a[242:243], v[46:47], v[28:31]
    s_nop 3
    v_cvt_pk_bf16_f32 v48, v16, v17
    v_cvt_pk_bf16_f32 v49, v18, v19
    v_cvt_pk_bf16_f32 v52, v20, v21
    v_cvt_pk_bf16_f32 v53, v22, v23
    v_cvt_pk_bf16_f32 v50, v24, v25
    v_cvt_pk_bf16_f32 v51, v26, v27
    v_cvt_pk_bf16_f32 v54, v28, v29
    v_cvt_pk_bf16_f32 v55, v30, v31
    v_mfma_f32_16x16x32_bf16 v[16:19], a[216:219], v[36:39], 0
    v_mfma_f32_16x16x32_bf16 v[20:23], a[216:219], v[42:45], 0
    v_mfma_f32_16x16x32_bf16 v[24:27], a[220:223], v[36:39], 0
    v_mfma_f32_16x16x32_bf16 v[28:31], a[220:223], v[42:45], 0
    s_nop 4
    v_mfma_f32_16x16x16_bf16 v[16:19], a[244:245], v[40:41], v[16:19]
    v_mfma_f32_16x16x16_bf16 v[20:23], a[244:245], v[46:47], v[20:23]
    v_mfma_f32_16x16x16_bf16 v[24:27], a[246:247], v[40:41], v[24:27]
    v_mfma_f32_16x16x16_bf16 v[28:31], a[246:247], v[46:47], v[28:31]
    s_nop 4
    v_cvt_pk_bf16_f32 v56, v16, v17
    v_cvt_pk_bf16_f32 v57, v18, v19
    v_cvt_pk_bf16_f32 v60, v20, v21
    v_cvt_pk_bf16_f32 v61, v22, v23
    v_cvt_pk_bf16_f32 v58, v24, v25
    v_cvt_pk_bf16_f32 v59, v26, v27
    v_cvt_pk_bf16_f32 v62, v28, v29
    v_cvt_pk_bf16_f32 v63, v30, v31
    v_mfma_f32_16x16x32_bf16 v[16:19], a[224:227], v[36:39], 0
    v_mfma_f32_16x16x32_bf16 v[20:23], a[224:227], v[42:45], 0
    v_mfma_f32_16x16x32_bf16 v[24:27], a[228:231], v[36:39], 0
    v_mfma_f32_16x16x32_bf16 v[28:31], a[228:231], v[42:45], 0
    s_nop 4
    v_mfma_f32_16x16x16_bf16 v[16:19], a[248:249], v[40:41], v[16:19]
    v_mfma_f32_16x16x16_bf16 v[20:23], a[248:249], v[46:47], v[20:23]
    v_mfma_f32_16x16x16_bf16 v[24:27], a[250:251], v[40:41], v[24:27]
    v_mfma_f32_16x16x16_bf16 v[28:31], a[250:251], v[46:47], v[28:31]
    s_nop 4
    v_cvt_pk_bf16_f32 v64, v16, v17
    v_cvt_pk_bf16_f32 v65, v18, v19
    v_cvt_pk_bf16_f32 v68, v20, v21
    v_cvt_pk_bf16_f32 v69, v22, v23
    v_cvt_pk_bf16_f32 v66, v24, v25
    v_cvt_pk_bf16_f32 v67, v26, v27
    v_cvt_pk_bf16_f32 v70, v28, v29
    v_cvt_pk_bf16_f32 v71, v30, v31
    v_mfma_f32_16x16x32_bf16 v[16:19], a[232:235], v[36:39], 0
    v_mfma_f32_16x16x32_bf16 v[20:23], a[232:235], v[42:45], 0
    v_mfma_f32_16x16x32_bf16 v[24:27], a[236:239], v[36:39], 0
    v_mfma_f32_16x16x32_bf16 v[28:31], a[236:239], v[42:45], 0
    s_nop 4
    v_mfma_f32_16x16x16_bf16 v[16:19], a[252:253], v[40:41], v[16:19]
    v_mfma_f32_16x16x16_bf16 v[20:23], a[252:253], v[46:47], v[20:23]
    v_mfma_f32_16x16x16_bf16 v[24:27], a[254:255], v[40:41], v[24:27]
    v_mfma_f32_16x16x16_bf16 v[28:31], a[254:255], v[46:47], v[28:31]
    s_nop 4
    v_cvt_pk_bf16_f32 v72, v16, v17
    v_cvt_pk_bf16_f32 v73, v18, v19
    v_cvt_pk_bf16_f32 v76, v20, v21
    v_cvt_pk_bf16_f32 v77, v22, v23
    v_cvt_pk_bf16_f32 v74, v24, v25
    v_cvt_pk_bf16_f32 v75, v26, v27
    v_cvt_pk_bf16_f32 v78, v28, v29
    v_cvt_pk_bf16_f32 v79, v30, v31
    s_mul_i32 s49, s36, 81920
    s_add_u32 s49, s49, 10485760
    s_waitcnt vmcnt(19)
    v_mfma_f32_16x16x32_bf16 a[0:3], v[88:91], v[48:51], 0
    v_mfma_f32_16x16x32_bf16 a[4:7], v[88:91], v[52:55], 0
    s_add_u32 s47, s48, 2048
    buffer_load_dwordx4 v[88:91], v4, s[32:35], s47 offen
    s_waitcnt vmcnt(19)
    v_mfma_f32_16x16x32_bf16 a[8:11], v[92:95], v[48:51], 0
    v_mfma_f32_16x16x32_bf16 a[12:15], v[92:95], v[52:55], 0
    s_add_u32 s47, s48, 133120
    buffer_load_dwordx4 v[92:95], v4, s[32:35], s47 offen
    s_waitcnt vmcnt(19)
    v_mfma_f32_16x16x32_bf16 a[16:19], v[96:99], v[48:51], 0
    v_mfma_f32_16x16x32_bf16 a[20:23], v[96:99], v[52:55], 0
    s_add_u32 s47, s48, 264192
    buffer_load_dwordx4 v[96:99], v4, s[32:35], s47 offen
    s_waitcnt vmcnt(19)
    v_mfma_f32_16x16x32_bf16 a[24:27], v[100:103], v[48:51], 0
    v_mfma_f32_16x16x32_bf16 a[28:31], v[100:103], v[52:55], 0
    s_add_u32 s47, s48, 395264
    buffer_load_dwordx4 v[100:103], v4, s[32:35], s47 offen
    s_waitcnt vmcnt(19)
    v_mfma_f32_16x16x32_bf16 a[32:35], v[104:107], v[48:51], 0
    v_mfma_f32_16x16x32_bf16 a[36:39], v[104:107], v[52:55], 0
    s_add_u32 s47, s48, 526336
    buffer_load_dwordx4 v[104:107], v4, s[32:35], s47 offen
    s_waitcnt vmcnt(19)
    v_mfma_f32_16x16x32_bf16 a[40:43], v[108:111], v[48:51], 0
    v_mfma_f32_16x16x32_bf16 a[44:47], v[108:111], v[52:55], 0
    s_add_u32 s47, s48, 657408
    buffer_load_dwordx4 v[108:111], v4, s[32:35], s47 offen
    s_waitcnt vmcnt(19)
    v_mfma_f32_16x16x32_bf16 a[48:51], v[112:115], v[48:51], 0
    v_mfma_f32_16x16x32_bf16 a[52:55], v[112:115], v[52:55], 0
    s_add_u32 s47, s48, 788480
    buffer_load_dwordx4 v[112:115], v4, s[32:35], s47 offen
    s_waitcnt vmcnt(19)
    v_mfma_f32_16x16x32_bf16 a[56:59], v[116:119], v[48:51], 0
    v_mfma_f32_16x16x32_bf16 a[60:63], v[116:119], v[52:55], 0
    s_add_u32 s47, s48, 919552
    buffer_load_dwordx4 v[116:119], v4, s[32:35], s47 offen
    s_waitcnt vmcnt(19)
    v_mfma_f32_16x16x32_bf16 a[64:67], v[120:123], v[48:51], 0
    v_mfma_f32_16x16x32_bf16 a[68:71], v[120:123], v[52:55], 0
    s_add_u32 s47, s48, 1050624
    buffer_load_dwordx4 v[120:123], v4, s[32:35], s47 offen
    s_waitcnt vmcnt(19)
    v_mfma_f32_16x16x32_bf16 a[72:75], v[124:127], v[48:51], 0
    v_mfma_f32_16x16x32_bf16 a[76:79], v[124:127], v[52:55], 0
    s_add_u32 s47, s48, 1181696
    buffer_load_dwordx4 v[124:127], v4, s[32:35], s47 offen
    s_waitcnt vmcnt(19)
    v_mfma_f32_16x16x32_bf16 a[0:3], v[128:131], v[56:59], a[0:3]
    v_mfma_f32_16x16x32_bf16 a[4:7], v[128:131], v[60:63], a[4:7]
    s_add_u32 s47, s48, 3072
    buffer_load_dwordx4 v[128:131], v4, s[32:35], s47 offen
    s_waitcnt vmcnt(19)
    v_mfma_f32_16x16x32_bf16 a[8:11], v[132:135], v[56:59], a[8:11]
    v_mfma_f32_16x16x32_bf16 a[12:15], v[132:135], v[60:63], a[12:15]
    s_add_u32 s47, s48, 134144
    buffer_load_dwordx4 v[132:135], v4, s[32:35], s47 offen
    s_waitcnt vmcnt(19)
    v_mfma_f32_16x16x32_bf16 a[16:19], v[136:139], v[56:59], a[16:19]
    v_mfma_f32_16x16x32_bf16 a[20:23], v[136:139], v[60:63], a[20:23]
    s_add_u32 s47, s48, 265216
    buffer_load_dwordx4 v[136:139], v4, s[32:35], s47 offen
    s_waitcnt vmcnt(19)
    v_mfma_f32_16x16x32_bf16 a[24:27], v[140:143], v[56:59], a[24:27]
    v_mfma_f32_16x16x32_bf16 a[28:31], v[140:143], v[60:63], a[28:31]
    s_add_u32 s47, s48, 396288
    buffer_load_dwordx4 v[140:143], v4, s[32:35], s47 offen
    s_waitcnt vmcnt(19)
    v_mfma_f32_16x16x32_bf16 a[32:35], v[144:147], v[56:59], a[32:35]
    v_mfma_f32_16x16x32_bf16 a[36:39], v[144:147], v[60:63], a[36:39]
    s_add_u32 s47, s48, 527360
    buffer_load_dwordx4 v[144:147], v4, s[32:35], s47 offen
    s_waitcnt vmcnt(19)
    v_mfma_f32_16x16x32_bf16 a[40:43], v[148:151], v[56:59], a[40:43]
    v_mfma_f32_16x16x32_bf16 a[44:47], v[148:151], v[60:63], a[44:47]
    s_add_u32 s47, s48, 658432
    buffer_load_dwordx4 v[148:151], v4, s[32:35], s47 offen
    s_waitcnt vmcnt(19)
    v_mfma_f32_16x16x32_bf16 a[48:51], v[152:155], v[56:59], a[48:51]
    v_mfma_f32_16x16x32_bf16 a[52:55], v[152:155], v[60:63], a[52:55]
    s_add_u32 s47, s48, 789504
    buffer_load_dwordx4 v[152:155], v4, s[32:35], s47 offen
    s_waitcnt vmcnt(19)
    v_mfma_f32_16x16x32_bf16 a[56:59], v[156:159], v[56:59], a[56:59]
    v_mfma_f32_16x16x32_bf16 a[60:63], v[156:159], v[60:63], a[60:63]
    s_add_u32 s47, s48, 920576
    buffer_load_dwordx4 v[156:159], v4, s[32:35], s47 offen
    s_waitcnt vmcnt(19)
    v_mfma_f32_16x16x32_bf16 a[64:67], v[160:163], v[56:59], a[64:67]
    v_mfma_f32_16x16x32_bf16 a[68:71], v[160:163], v[60:63], a[68:71]
    s_add_u32 s47, s48, 1051648
    buffer_load_dwordx4 v[160:163], v4, s[32:35], s47 offen
    s_waitcnt vmcnt(19)
    v_mfma_f32_16x16x32_bf16 a[72:75], v[164:167], v[56:59], a[72:75]
    v_mfma_f32_16x16x32_bf16 a[76:79], v[164:167], v[60:63], a[76:79]
    s_add_u32 s47, s48, 1182720
    buffer_load_dwordx4 v[164:167], v4, s[32:35], s47 offen
    s_waitcnt vmcnt(19)
    v_mfma_f32_16x16x32_bf16 a[0:3], v[88:91], v[64:67], a[0:3]
    v_mfma_f32_16x16x32_bf16 a[4:7], v[88:91], v[68:71], a[4:7]
    s_add_u32 s47, s48, 1310720
    buffer_load_dwordx4 v[88:91], v4, s[32:35], s47 offen
    s_waitcnt vmcnt(19)
    v_mfma_f32_16x16x32_bf16 a[8:11], v[92:95], v[64:67], a[8:11]
    v_mfma_f32_16x16x32_bf16 a[12:15], v[92:95], v[68:71], a[12:15]
    s_add_u32 s47, s48, 1441792
    buffer_load_dwordx4 v[92:95], v4, s[32:35], s47 offen
    s_waitcnt vmcnt(19)
    v_mfma_f32_16x16x32_bf16 a[16:19], v[96:99], v[64:67], a[16:19]
    v_mfma_f32_16x16x32_bf16 a[20:23], v[96:99], v[68:71], a[20:23]
    s_add_u32 s47, s48, 1572864
    buffer_load_dwordx4 v[96:99], v4, s[32:35], s47 offen
    s_waitcnt vmcnt(19)
    v_mfma_f32_16x16x32_bf16 a[24:27], v[100:103], v[64:67], a[24:27]
    v_mfma_f32_16x16x32_bf16 a[28:31], v[100:103], v[68:71], a[28:31]
    s_add_u32 s47, s48, 1703936
    buffer_load_dwordx4 v[100:103], v4, s[32:35], s47 offen
    s_waitcnt vmcnt(19)
    v_mfma_f32_16x16x32_bf16 a[32:35], v[104:107], v[64:67], a[32:35]
    v_mfma_f32_16x16x32_bf16 a[36:39], v[104:107], v[68:71], a[36:39]
    s_add_u32 s47, s48, 1835008
    buffer_load_dwordx4 v[104:107], v4, s[32:35], s47 offen
    s_waitcnt vmcnt(19)
    v_mfma_f32_16x16x32_bf16 a[40:43], v[108:111], v[64:67], a[40:43]
    v_mfma_f32_16x16x32_bf16 a[44:47], v[108:111], v[68:71], a[44:47]
    s_add_u32 s47, s48, 1966080
    buffer_load_dwordx4 v[108:111], v4, s[32:35], s47 offen
    s_waitcnt vmcnt(19)
    v_mfma_f32_16x16x32_bf16 a[48:51], v[112:115], v[64:67], a[48:51]
    v_mfma_f32_16x16x32_bf16 a[52:55], v[112:115], v[68:71], a[52:55]
    s_add_u32 s47, s48, 2097152
    buffer_load_dwordx4 v[112:115], v4, s[32:35], s47 offen
    s_waitcnt vmcnt(19)
    v_mfma_f32_16x16x32_bf16 a[56:59], v[116:119], v[64:67], a[56:59]
    v_mfma_f32_16x16x32_bf16 a[60:63], v[116:119], v[68:71], a[60:63]
    s_add_u32 s47, s48, 2228224
    buffer_load_dwordx4 v[116:119], v4, s[32:35], s47 offen
    s_waitcnt vmcnt(19)
    v_mfma_f32_16x16x32_bf16 a[64:67], v[120:123], v[64:67], a[64:67]
    v_mfma_f32_16x16x32_bf16 a[68:71], v[120:123], v[68:71], a[68:71]
    s_add_u32 s47, s48, 2359296
    buffer_load_dwordx4 v[120:123], v4, s[32:35], s47 offen
    s_waitcnt vmcnt(19)
    v_mfma_f32_16x16x32_bf16 a[72:75], v[124:127], v[64:67], a[72:75]
    v_mfma_f32_16x16x32_bf16 a[76:79], v[124:127], v[68:71], a[76:79]
    s_add_u32 s47, s48, 2490368
    buffer_load_dwordx4 v[124:127], v4, s[32:35], s47 offen
    s_waitcnt vmcnt(19)
    v_mfma_f32_16x16x32_bf16 a[0:3], v[128:131], v[72:75], a[0:3]
    v_mfma_f32_16x16x32_bf16 a[4:7], v[128:131], v[76:79], a[4:7]
    s_add_u32 s47, s48, 1311744
    buffer_load_dwordx4 v[128:131], v4, s[32:35], s47 offen
    s_waitcnt vmcnt(19)
    v_mfma_f32_16x16x32_bf16 a[8:11], v[132:135], v[72:75], a[8:11]
    v_mfma_f32_16x16x32_bf16 a[12:15], v[132:135], v[76:79], a[12:15]
    s_add_u32 s47, s48, 1442816
    buffer_load_dwordx4 v[132:135], v4, s[32:35], s47 offen
    s_waitcnt vmcnt(19)
    v_mfma_f32_16x16x32_bf16 a[16:19], v[136:139], v[72:75], a[16:19]
    v_mfma_f32_16x16x32_bf16 a[20:23], v[136:139], v[76:79], a[20:23]
    s_add_u32 s47, s48, 1573888
    buffer_load_dwordx4 v[136:139], v4, s[32:35], s47 offen
    s_waitcnt vmcnt(19)
    v_mfma_f32_16x16x32_bf16 a[24:27], v[140:143], v[72:75], a[24:27]
    v_mfma_f32_16x16x32_bf16 a[28:31], v[140:143], v[76:79], a[28:31]
    s_add_u32 s47, s48, 1704960
    buffer_load_dwordx4 v[140:143], v4, s[32:35], s47 offen
    s_waitcnt vmcnt(19)
    v_mfma_f32_16x16x32_bf16 a[32:35], v[144:147], v[72:75], a[32:35]
    v_mfma_f32_16x16x32_bf16 a[36:39], v[144:147], v[76:79], a[36:39]
    s_add_u32 s47, s48, 1836032
    buffer_load_dwordx4 v[144:147], v4, s[32:35], s47 offen
    s_waitcnt vmcnt(19)
    v_mfma_f32_16x16x32_bf16 a[40:43], v[148:151], v[72:75], a[40:43]
    v_mfma_f32_16x16x32_bf16 a[44:47], v[148:151], v[76:79], a[44:47]
    s_add_u32 s47, s48, 1967104
    buffer_load_dwordx4 v[148:151], v4, s[32:35], s47 offen
    s_waitcnt vmcnt(19)
    v_mfma_f32_16x16x32_bf16 a[48:51], v[152:155], v[72:75], a[48:51]
    v_mfma_f32_16x16x32_bf16 a[52:55], v[152:155], v[76:79], a[52:55]
    s_add_u32 s47, s48, 2098176
    buffer_load_dwordx4 v[152:155], v4, s[32:35], s47 offen
    s_waitcnt vmcnt(19)
    v_mfma_f32_16x16x32_bf16 a[56:59], v[156:159], v[72:75], a[56:59]
    v_mfma_f32_16x16x32_bf16 a[60:63], v[156:159], v[76:79], a[60:63]
    s_add_u32 s47, s48, 2229248
    buffer_load_dwordx4 v[156:159], v4, s[32:35], s47 offen
    s_waitcnt vmcnt(19)
    v_mfma_f32_16x16x32_bf16 a[64:67], v[160:163], v[72:75], a[64:67]
    v_mfma_f32_16x16x32_bf16 a[68:71], v[160:163], v[76:79], a[68:71]
    s_add_u32 s47, s48, 2360320
    buffer_load_dwordx4 v[160:163], v4, s[32:35], s47 offen
    s_waitcnt vmcnt(19)
    v_mfma_f32_16x16x32_bf16 a[72:75], v[164:167], v[72:75], a[72:75]
    v_mfma_f32_16x16x32_bf16 a[76:79], v[164:167], v[76:79], a[76:79]
    s_add_u32 s47, s48, 2491392
    buffer_load_dwordx4 v[164:167], v4, s[32:35], s47 offen
    s_add_u32 s48, s48, 1310720
    ds_write_b128 v6, a[0:3] offset:0
    ds_write_b128 v6, a[4:7] offset:1024
    ds_write_b128 v6, a[8:11] offset:2048
    ds_write_b128 v6, a[12:15] offset:3072
    ds_write_b128 v6, a[16:19] offset:4096
    ds_write_b128 v6, a[20:23] offset:5120
    ds_write_b128 v6, a[24:27] offset:6144
    ds_write_b128 v6, a[28:31] offset:7168
    ds_write_b128 v6, a[32:35] offset:8192
    ds_write_b128 v6, a[36:39] offset:9216
    ds_write_b128 v6, a[40:43] offset:10240
    ds_write_b128 v6, a[44:47] offset:11264
    ds_write_b128 v6, a[48:51] offset:12288
    ds_write_b128 v6, a[52:55] offset:13312
    ds_write_b128 v6, a[56:59] offset:14336
    ds_write_b128 v6, a[60:63] offset:15360
    ds_write_b128 v6, a[64:67] offset:16384
    ds_write_b128 v6, a[68:71] offset:17408
    ds_write_b128 v6, a[72:75] offset:18432
    ds_write_b128 v6, a[76:79] offset:19456
    s_waitcnt lgkmcnt(0)
    s_barrier
    ds_read_b128 v[16:19], v7 offset:0
    ds_read_b128 v[20:23], v7 offset:20480
    ds_read_b128 v[24:27], v11 offset:0
    ds_read_b128 v[28:31], v11 offset:20480
    s_mul_i32 s40, s3, 5
    s_add_u32 s40, s40, 0
    s_lshr_b32 s41, s40, 1
    s_and_b32 s42, s40, 1
    s_mul_i32 s42, s42, 40
    s_add_u32 s42, s42, s41
    s_add_u32 s42, s42, 0
    s_lshl_b32 s42, s42, 10
    s_add_u32 s42, s42, s49
    s_waitcnt lgkmcnt(0)
    v_add_f32 v16, v16, v20
    v_add_f32 v24, v24, v28
    v_add_f32 v80, v16, v24
    v_add_f32 v17, v17, v21
    v_add_f32 v25, v25, v29
    v_add_f32 v81, v17, v25
    v_add_f32 v18, v18, v22
    v_add_f32 v26, v26, v30
    v_add_f32 v82, v18, v26
    v_add_f32 v19, v19, v23
    v_add_f32 v27, v27, v31
    v_add_f32 v83, v19, v27
    buffer_atomic_add_f32 v80, v12, s[32:35], s42 offen offset:0
    buffer_atomic_add_f32 v81, v12, s[32:35], s42 offen offset:256
    buffer_atomic_add_f32 v82, v12, s[32:35], s42 offen offset:512
    buffer_atomic_add_f32 v83, v12, s[32:35], s42 offen offset:768
    ds_read_b128 v[16:19], v7 offset:1024
    ds_read_b128 v[20:23], v7 offset:21504
    ds_read_b128 v[24:27], v11 offset:1024
    ds_read_b128 v[28:31], v11 offset:21504
    s_mul_i32 s40, s3, 5
    s_add_u32 s40, s40, 1
    s_lshr_b32 s41, s40, 1
    s_and_b32 s42, s40, 1
    s_mul_i32 s42, s42, 40
    s_add_u32 s42, s42, s41
    s_add_u32 s42, s42, 0
    s_lshl_b32 s42, s42, 10
    s_add_u32 s42, s42, s49
    s_waitcnt lgkmcnt(0)
    v_add_f32 v16, v16, v20
    v_add_f32 v24, v24, v28
    v_add_f32 v80, v16, v24
    v_add_f32 v17, v17, v21
    v_add_f32 v25, v25, v29
    v_add_f32 v81, v17, v25
    v_add_f32 v18, v18, v22
    v_add_f32 v26, v26, v30
    v_add_f32 v82, v18, v26
    v_add_f32 v19, v19, v23
    v_add_f32 v27, v27, v31
    v_add_f32 v83, v19, v27
    buffer_atomic_add_f32 v80, v12, s[32:35], s42 offen offset:0
    buffer_atomic_add_f32 v81, v12, s[32:35], s42 offen offset:256
    buffer_atomic_add_f32 v82, v12, s[32:35], s42 offen offset:512
    buffer_atomic_add_f32 v83, v12, s[32:35], s42 offen offset:768
    ds_read_b128 v[16:19], v7 offset:2048
    ds_read_b128 v[20:23], v7 offset:22528
    ds_read_b128 v[24:27], v11 offset:2048
    ds_read_b128 v[28:31], v11 offset:22528
    s_mul_i32 s40, s3, 5
    s_add_u32 s40, s40, 2
    s_lshr_b32 s41, s40, 1
    s_and_b32 s42, s40, 1
    s_mul_i32 s42, s42, 40
    s_add_u32 s42, s42, s41
    s_add_u32 s42, s42, 0
    s_lshl_b32 s42, s42, 10
    s_add_u32 s42, s42, s49
    s_waitcnt lgkmcnt(0)
    v_add_f32 v16, v16, v20
    v_add_f32 v24, v24, v28
    v_add_f32 v80, v16, v24
    v_add_f32 v17, v17, v21
    v_add_f32 v25, v25, v29
    v_add_f32 v81, v17, v25
    v_add_f32 v18, v18, v22
    v_add_f32 v26, v26, v30
    v_add_f32 v82, v18, v26
    v_add_f32 v19, v19, v23
    v_add_f32 v27, v27, v31
    v_add_f32 v83, v19, v27
    buffer_atomic_add_f32 v80, v12, s[32:35], s42 offen offset:0
    buffer_atomic_add_f32 v81, v12, s[32:35], s42 offen offset:256
    buffer_atomic_add_f32 v82, v12, s[32:35], s42 offen offset:512
    buffer_atomic_add_f32 v83, v12, s[32:35], s42 offen offset:768
    ds_read_b128 v[16:19], v7 offset:3072
    ds_read_b128 v[20:23], v7 offset:23552
    ds_read_b128 v[24:27], v11 offset:3072
    ds_read_b128 v[28:31], v11 offset:23552
    s_mul_i32 s40, s3, 5
    s_add_u32 s40, s40, 3
    s_lshr_b32 s41, s40, 1
    s_and_b32 s42, s40, 1
    s_mul_i32 s42, s42, 40
    s_add_u32 s42, s42, s41
    s_add_u32 s42, s42, 0
    s_lshl_b32 s42, s42, 10
    s_add_u32 s42, s42, s49
    s_waitcnt lgkmcnt(0)
    v_add_f32 v16, v16, v20
    v_add_f32 v24, v24, v28
    v_add_f32 v80, v16, v24
    v_add_f32 v17, v17, v21
    v_add_f32 v25, v25, v29
    v_add_f32 v81, v17, v25
    v_add_f32 v18, v18, v22
    v_add_f32 v26, v26, v30
    v_add_f32 v82, v18, v26
    v_add_f32 v19, v19, v23
    v_add_f32 v27, v27, v31
    v_add_f32 v83, v19, v27
    buffer_atomic_add_f32 v80, v12, s[32:35], s42 offen offset:0
    buffer_atomic_add_f32 v81, v12, s[32:35], s42 offen offset:256
    buffer_atomic_add_f32 v82, v12, s[32:35], s42 offen offset:512
    buffer_atomic_add_f32 v83, v12, s[32:35], s42 offen offset:768
    ds_read_b128 v[16:19], v7 offset:4096
    ds_read_b128 v[20:23], v7 offset:24576
    ds_read_b128 v[24:27], v11 offset:4096
    ds_read_b128 v[28:31], v11 offset:24576
    s_mul_i32 s40, s3, 5
    s_add_u32 s40, s40, 4
    s_lshr_b32 s41, s40, 1
    s_and_b32 s42, s40, 1
    s_mul_i32 s42, s42, 40
    s_add_u32 s42, s42, s41
    s_add_u32 s42, s42, 0
    s_lshl_b32 s42, s42, 10
    s_add_u32 s42, s42, s49
    s_waitcnt lgkmcnt(0)
    v_add_f32 v16, v16, v20
    v_add_f32 v24, v24, v28
    v_add_f32 v80, v16, v24
    v_add_f32 v17, v17, v21
    v_add_f32 v25, v25, v29
    v_add_f32 v81, v17, v25
    v_add_f32 v18, v18, v22
    v_add_f32 v26, v26, v30
    v_add_f32 v82, v18, v26
    v_add_f32 v19, v19, v23
    v_add_f32 v27, v27, v31
    v_add_f32 v83, v19, v27
    buffer_atomic_add_f32 v80, v12, s[32:35], s42 offen offset:0
    buffer_atomic_add_f32 v81, v12, s[32:35], s42 offen offset:256
    buffer_atomic_add_f32 v82, v12, s[32:35], s42 offen offset:512
    buffer_atomic_add_f32 v83, v12, s[32:35], s42 offen offset:768
    s_barrier
    s_waitcnt vmcnt(19)
    v_mfma_f32_16x16x32_bf16 a[0:3], v[88:91], v[48:51], 0
    v_mfma_f32_16x16x32_bf16 a[4:7], v[88:91], v[52:55], 0
    s_add_u32 s47, s48, 2048
    buffer_load_dwordx4 v[88:91], v4, s[32:35], s47 offen
    s_waitcnt vmcnt(19)
    v_mfma_f32_16x16x32_bf16 a[8:11], v[92:95], v[48:51], 0
    v_mfma_f32_16x16x32_bf16 a[12:15], v[92:95], v[52:55], 0
    s_add_u32 s47, s48, 133120
    buffer_load_dwordx4 v[92:95], v4, s[32:35], s47 offen
    s_waitcnt vmcnt(19)
    v_mfma_f32_16x16x32_bf16 a[16:19], v[96:99], v[48:51], 0
    v_mfma_f32_16x16x32_bf16 a[20:23], v[96:99], v[52:55], 0
    s_add_u32 s47, s48, 264192
    buffer_load_dwordx4 v[96:99], v4, s[32:35], s47 offen
    s_waitcnt vmcnt(19)
    v_mfma_f32_16x16x32_bf16 a[24:27], v[100:103], v[48:51], 0
    v_mfma_f32_16x16x32_bf16 a[28:31], v[100:103], v[52:55], 0
    s_add_u32 s47, s48, 395264
    buffer_load_dwordx4 v[100:103], v4, s[32:35], s47 offen
    s_waitcnt vmcnt(19)
    v_mfma_f32_16x16x32_bf16 a[32:35], v[104:107], v[48:51], 0
    v_mfma_f32_16x16x32_bf16 a[36:39], v[104:107], v[52:55], 0
    s_add_u32 s47, s48, 526336
    buffer_load_dwordx4 v[104:107], v4, s[32:35], s47 offen
    s_waitcnt vmcnt(19)
    v_mfma_f32_16x16x32_bf16 a[40:43], v[108:111], v[48:51], 0
    v_mfma_f32_16x16x32_bf16 a[44:47], v[108:111], v[52:55], 0
    s_add_u32 s47, s48, 657408
    buffer_load_dwordx4 v[108:111], v4, s[32:35], s47 offen
    s_waitcnt vmcnt(19)
    v_mfma_f32_16x16x32_bf16 a[48:51], v[112:115], v[48:51], 0
    v_mfma_f32_16x16x32_bf16 a[52:55], v[112:115], v[52:55], 0
    s_add_u32 s47, s48, 788480
    buffer_load_dwordx4 v[112:115], v4, s[32:35], s47 offen
    s_waitcnt vmcnt(19)
    v_mfma_f32_16x16x32_bf16 a[56:59], v[116:119], v[48:51], 0
    v_mfma_f32_16x16x32_bf16 a[60:63], v[116:119], v[52:55], 0
    s_add_u32 s47, s48, 919552
    buffer_load_dwordx4 v[116:119], v4, s[32:35], s47 offen
    s_waitcnt vmcnt(19)
    v_mfma_f32_16x16x32_bf16 a[64:67], v[120:123], v[48:51], 0
    v_mfma_f32_16x16x32_bf16 a[68:71], v[120:123], v[52:55], 0
    s_add_u32 s47, s48, 1050624
    buffer_load_dwordx4 v[120:123], v4, s[32:35], s47 offen
    s_waitcnt vmcnt(19)
    v_mfma_f32_16x16x32_bf16 a[72:75], v[124:127], v[48:51], 0
    v_mfma_f32_16x16x32_bf16 a[76:79], v[124:127], v[52:55], 0
    s_add_u32 s47, s48, 1181696
    buffer_load_dwordx4 v[124:127], v4, s[32:35], s47 offen
    s_waitcnt vmcnt(19)
    v_mfma_f32_16x16x32_bf16 a[0:3], v[128:131], v[56:59], a[0:3]
    v_mfma_f32_16x16x32_bf16 a[4:7], v[128:131], v[60:63], a[4:7]
    s_add_u32 s47, s48, 3072
    buffer_load_dwordx4 v[128:131], v4, s[32:35], s47 offen
    s_waitcnt vmcnt(19)
    v_mfma_f32_16x16x32_bf16 a[8:11], v[132:135], v[56:59], a[8:11]
    v_mfma_f32_16x16x32_bf16 a[12:15], v[132:135], v[60:63], a[12:15]
    s_add_u32 s47, s48, 134144
    buffer_load_dwordx4 v[132:135], v4, s[32:35], s47 offen
    s_waitcnt vmcnt(19)
    v_mfma_f32_16x16x32_bf16 a[16:19], v[136:139], v[56:59], a[16:19]
    v_mfma_f32_16x16x32_bf16 a[20:23], v[136:139], v[60:63], a[20:23]
    s_add_u32 s47, s48, 265216
    buffer_load_dwordx4 v[136:139], v4, s[32:35], s47 offen
    s_waitcnt vmcnt(19)
    v_mfma_f32_16x16x32_bf16 a[24:27], v[140:143], v[56:59], a[24:27]
    v_mfma_f32_16x16x32_bf16 a[28:31], v[140:143], v[60:63], a[28:31]
    s_add_u32 s47, s48, 396288
    buffer_load_dwordx4 v[140:143], v4, s[32:35], s47 offen
    s_waitcnt vmcnt(19)
    v_mfma_f32_16x16x32_bf16 a[32:35], v[144:147], v[56:59], a[32:35]
    v_mfma_f32_16x16x32_bf16 a[36:39], v[144:147], v[60:63], a[36:39]
    s_add_u32 s47, s48, 527360
    buffer_load_dwordx4 v[144:147], v4, s[32:35], s47 offen
    s_waitcnt vmcnt(19)
    v_mfma_f32_16x16x32_bf16 a[40:43], v[148:151], v[56:59], a[40:43]
    v_mfma_f32_16x16x32_bf16 a[44:47], v[148:151], v[60:63], a[44:47]
    s_add_u32 s47, s48, 658432
    buffer_load_dwordx4 v[148:151], v4, s[32:35], s47 offen
    s_waitcnt vmcnt(19)
    v_mfma_f32_16x16x32_bf16 a[48:51], v[152:155], v[56:59], a[48:51]
    v_mfma_f32_16x16x32_bf16 a[52:55], v[152:155], v[60:63], a[52:55]
    s_add_u32 s47, s48, 789504
    buffer_load_dwordx4 v[152:155], v4, s[32:35], s47 offen
    s_waitcnt vmcnt(19)
    v_mfma_f32_16x16x32_bf16 a[56:59], v[156:159], v[56:59], a[56:59]
    v_mfma_f32_16x16x32_bf16 a[60:63], v[156:159], v[60:63], a[60:63]
    s_add_u32 s47, s48, 920576
    buffer_load_dwordx4 v[156:159], v4, s[32:35], s47 offen
    s_waitcnt vmcnt(19)
    v_mfma_f32_16x16x32_bf16 a[64:67], v[160:163], v[56:59], a[64:67]
    v_mfma_f32_16x16x32_bf16 a[68:71], v[160:163], v[60:63], a[68:71]
    s_add_u32 s47, s48, 1051648
    buffer_load_dwordx4 v[160:163], v4, s[32:35], s47 offen
    s_waitcnt vmcnt(19)
    v_mfma_f32_16x16x32_bf16 a[72:75], v[164:167], v[56:59], a[72:75]
    v_mfma_f32_16x16x32_bf16 a[76:79], v[164:167], v[60:63], a[76:79]
    s_add_u32 s47, s48, 1182720
    buffer_load_dwordx4 v[164:167], v4, s[32:35], s47 offen
    s_waitcnt vmcnt(19)
    v_mfma_f32_16x16x32_bf16 a[0:3], v[88:91], v[64:67], a[0:3]
    v_mfma_f32_16x16x32_bf16 a[4:7], v[88:91], v[68:71], a[4:7]
    s_add_u32 s47, s48, 1310720
    buffer_load_dwordx4 v[88:91], v4, s[32:35], s47 offen
    s_waitcnt vmcnt(19)
    v_mfma_f32_16x16x32_bf16 a[8:11], v[92:95], v[64:67], a[8:11]
    v_mfma_f32_16x16x32_bf16 a[12:15], v[92:95], v[68:71], a[12:15]
    s_add_u32 s47, s48, 1441792
    buffer_load_dwordx4 v[92:95], v4, s[32:35], s47 offen
    s_waitcnt vmcnt(19)
    v_mfma_f32_16x16x32_bf16 a[16:19], v[96:99], v[64:67], a[16:19]
    v_mfma_f32_16x16x32_bf16 a[20:23], v[96:99], v[68:71], a[20:23]
    s_add_u32 s47, s48, 1572864
    buffer_load_dwordx4 v[96:99], v4, s[32:35], s47 offen
    s_waitcnt vmcnt(19)
    v_mfma_f32_16x16x32_bf16 a[24:27], v[100:103], v[64:67], a[24:27]
    v_mfma_f32_16x16x32_bf16 a[28:31], v[100:103], v[68:71], a[28:31]
    s_add_u32 s47, s48, 1703936
    buffer_load_dwordx4 v[100:103], v4, s[32:35], s47 offen
    s_waitcnt vmcnt(19)
    v_mfma_f32_16x16x32_bf16 a[32:35], v[104:107], v[64:67], a[32:35]
    v_mfma_f32_16x16x32_bf16 a[36:39], v[104:107], v[68:71], a[36:39]
    s_add_u32 s47, s48, 1835008
    buffer_load_dwordx4 v[104:107], v4, s[32:35], s47 offen
    s_waitcnt vmcnt(19)
    v_mfma_f32_16x16x32_bf16 a[40:43], v[108:111], v[64:67], a[40:43]
    v_mfma_f32_16x16x32_bf16 a[44:47], v[108:111], v[68:71], a[44:47]
    s_add_u32 s47, s48, 1966080
    buffer_load_dwordx4 v[108:111], v4, s[32:35], s47 offen
    s_waitcnt vmcnt(19)
    v_mfma_f32_16x16x32_bf16 a[48:51], v[112:115], v[64:67], a[48:51]
    v_mfma_f32_16x16x32_bf16 a[52:55], v[112:115], v[68:71], a[52:55]
    s_add_u32 s47, s48, 2097152
    buffer_load_dwordx4 v[112:115], v4, s[32:35], s47 offen
    s_waitcnt vmcnt(19)
    v_mfma_f32_16x16x32_bf16 a[56:59], v[116:119], v[64:67], a[56:59]
    v_mfma_f32_16x16x32_bf16 a[60:63], v[116:119], v[68:71], a[60:63]
    s_add_u32 s47, s48, 2228224
    buffer_load_dwordx4 v[116:119], v4, s[32:35], s47 offen
    s_waitcnt vmcnt(19)
    v_mfma_f32_16x16x32_bf16 a[64:67], v[120:123], v[64:67], a[64:67]
    v_mfma_f32_16x16x32_bf16 a[68:71], v[120:123], v[68:71], a[68:71]
    s_add_u32 s47, s48, 2359296
    buffer_load_dwordx4 v[120:123], v4, s[32:35], s47 offen
    s_waitcnt vmcnt(19)
    v_mfma_f32_16x16x32_bf16 a[72:75], v[124:127], v[64:67], a[72:75]
    v_mfma_f32_16x16x32_bf16 a[76:79], v[124:127], v[68:71], a[76:79]
    s_add_u32 s47, s48, 2490368
    buffer_load_dwordx4 v[124:127], v4, s[32:35], s47 offen
    s_waitcnt vmcnt(19)
    v_mfma_f32_16x16x32_bf16 a[0:3], v[128:131], v[72:75], a[0:3]
    v_mfma_f32_16x16x32_bf16 a[4:7], v[128:131], v[76:79], a[4:7]
    s_add_u32 s47, s48, 1311744
    buffer_load_dwordx4 v[128:131], v4, s[32:35], s47 offen
    s_waitcnt vmcnt(19)
    v_mfma_f32_16x16x32_bf16 a[8:11], v[132:135], v[72:75], a[8:11]
    v_mfma_f32_16x16x32_bf16 a[12:15], v[132:135], v[76:79], a[12:15]
    s_add_u32 s47, s48, 1442816
    buffer_load_dwordx4 v[132:135], v4, s[32:35], s47 offen
    s_waitcnt vmcnt(19)
    v_mfma_f32_16x16x32_bf16 a[16:19], v[136:139], v[72:75], a[16:19]
    v_mfma_f32_16x16x32_bf16 a[20:23], v[136:139], v[76:79], a[20:23]
    s_add_u32 s47, s48, 1573888
    buffer_load_dwordx4 v[136:139], v4, s[32:35], s47 offen
    s_waitcnt vmcnt(19)
    v_mfma_f32_16x16x32_bf16 a[24:27], v[140:143], v[72:75], a[24:27]
    v_mfma_f32_16x16x32_bf16 a[28:31], v[140:143], v[76:79], a[28:31]
    s_add_u32 s47, s48, 1704960
    buffer_load_dwordx4 v[140:143], v4, s[32:35], s47 offen
    s_waitcnt vmcnt(19)
    v_mfma_f32_16x16x32_bf16 a[32:35], v[144:147], v[72:75], a[32:35]
    v_mfma_f32_16x16x32_bf16 a[36:39], v[144:147], v[76:79], a[36:39]
    s_add_u32 s47, s48, 1836032
    buffer_load_dwordx4 v[144:147], v4, s[32:35], s47 offen
    s_waitcnt vmcnt(19)
    v_mfma_f32_16x16x32_bf16 a[40:43], v[148:151], v[72:75], a[40:43]
    v_mfma_f32_16x16x32_bf16 a[44:47], v[148:151], v[76:79], a[44:47]
    s_add_u32 s47, s48, 1967104
    buffer_load_dwordx4 v[148:151], v4, s[32:35], s47 offen
    s_waitcnt vmcnt(19)
    v_mfma_f32_16x16x32_bf16 a[48:51], v[152:155], v[72:75], a[48:51]
    v_mfma_f32_16x16x32_bf16 a[52:55], v[152:155], v[76:79], a[52:55]
    s_add_u32 s47, s48, 2098176
    buffer_load_dwordx4 v[152:155], v4, s[32:35], s47 offen
    s_waitcnt vmcnt(19)
    v_mfma_f32_16x16x32_bf16 a[56:59], v[156:159], v[72:75], a[56:59]
    v_mfma_f32_16x16x32_bf16 a[60:63], v[156:159], v[76:79], a[60:63]
    s_add_u32 s47, s48, 2229248
    buffer_load_dwordx4 v[156:159], v4, s[32:35], s47 offen
    s_waitcnt vmcnt(19)
    v_mfma_f32_16x16x32_bf16 a[64:67], v[160:163], v[72:75], a[64:67]
    v_mfma_f32_16x16x32_bf16 a[68:71], v[160:163], v[76:79], a[68:71]
    s_add_u32 s47, s48, 2360320
    buffer_load_dwordx4 v[160:163], v4, s[32:35], s47 offen
    s_waitcnt vmcnt(19)
    v_mfma_f32_16x16x32_bf16 a[72:75], v[164:167], v[72:75], a[72:75]
    v_mfma_f32_16x16x32_bf16 a[76:79], v[164:167], v[76:79], a[76:79]
    s_add_u32 s47, s48, 2491392
    buffer_load_dwordx4 v[164:167], v4, s[32:35], s47 offen
    s_add_u32 s48, s48, 1310720
    ds_write_b128 v6, a[0:3] offset:0
    ds_write_b128 v6, a[4:7] offset:1024
    ds_write_b128 v6, a[8:11] offset:2048
    ds_write_b128 v6, a[12:15] offset:3072
    ds_write_b128 v6, a[16:19] offset:4096
    ds_write_b128 v6, a[20:23] offset:5120
    ds_write_b128 v6, a[24:27] offset:6144
    ds_write_b128 v6, a[28:31] offset:7168
    ds_write_b128 v6, a[32:35] offset:8192
    ds_write_b128 v6, a[36:39] offset:9216
    ds_write_b128 v6, a[40:43] offset:10240
    ds_write_b128 v6, a[44:47] offset:11264
    ds_write_b128 v6, a[48:51] offset:12288
    ds_write_b128 v6, a[52:55] offset:13312
    ds_write_b128 v6, a[56:59] offset:14336
    ds_write_b128 v6, a[60:63] offset:15360
    ds_write_b128 v6, a[64:67] offset:16384
    ds_write_b128 v6, a[68:71] offset:17408
    ds_write_b128 v6, a[72:75] offset:18432
    ds_write_b128 v6, a[76:79] offset:19456
    s_waitcnt lgkmcnt(0)
    s_barrier
    ds_read_b128 v[16:19], v7 offset:0
    ds_read_b128 v[20:23], v7 offset:20480
    ds_read_b128 v[24:27], v11 offset:0
    ds_read_b128 v[28:31], v11 offset:20480
    s_mul_i32 s40, s3, 5
    s_add_u32 s40, s40, 0
    s_lshr_b32 s41, s40, 1
    s_and_b32 s42, s40, 1
    s_mul_i32 s42, s42, 40
    s_add_u32 s42, s42, s41
    s_add_u32 s42, s42, 10
    s_lshl_b32 s42, s42, 10
    s_add_u32 s42, s42, s49
    s_waitcnt lgkmcnt(0)
    v_add_f32 v16, v16, v20
    v_add_f32 v24, v24, v28
    v_add_f32 v80, v16, v24
    v_add_f32 v17, v17, v21
    v_add_f32 v25, v25, v29
    v_add_f32 v81, v17, v25
    v_add_f32 v18, v18, v22
    v_add_f32 v26, v26, v30
    v_add_f32 v82, v18, v26
    v_add_f32 v19, v19, v23
    v_add_f32 v27, v27, v31
    v_add_f32 v83, v19, v27
    buffer_atomic_add_f32 v80, v12, s[32:35], s42 offen offset:0
    buffer_atomic_add_f32 v81, v12, s[32:35], s42 offen offset:256
    buffer_atomic_add_f32 v82, v12, s[32:35], s42 offen offset:512
    buffer_atomic_add_f32 v83, v12, s[32:35], s42 offen offset:768
    ds_read_b128 v[16:19], v7 offset:1024
    ds_read_b128 v[20:23], v7 offset:21504
    ds_read_b128 v[24:27], v11 offset:1024
    ds_read_b128 v[28:31], v11 offset:21504
    s_mul_i32 s40, s3, 5
    s_add_u32 s40, s40, 1
    s_lshr_b32 s41, s40, 1
    s_and_b32 s42, s40, 1
    s_mul_i32 s42, s42, 40
    s_add_u32 s42, s42, s41
    s_add_u32 s42, s42, 10
    s_lshl_b32 s42, s42, 10
    s_add_u32 s42, s42, s49
    s_waitcnt lgkmcnt(0)
    v_add_f32 v16, v16, v20
    v_add_f32 v24, v24, v28
    v_add_f32 v80, v16, v24
    v_add_f32 v17, v17, v21
    v_add_f32 v25, v25, v29
    v_add_f32 v81, v17, v25
    v_add_f32 v18, v18, v22
    v_add_f32 v26, v26, v30
    v_add_f32 v82, v18, v26
    v_add_f32 v19, v19, v23
    v_add_f32 v27, v27, v31
    v_add_f32 v83, v19, v27
    buffer_atomic_add_f32 v80, v12, s[32:35], s42 offen offset:0
    buffer_atomic_add_f32 v81, v12, s[32:35], s42 offen offset:256
    buffer_atomic_add_f32 v82, v12, s[32:35], s42 offen offset:512
    buffer_atomic_add_f32 v83, v12, s[32:35], s42 offen offset:768
    ds_read_b128 v[16:19], v7 offset:2048
    ds_read_b128 v[20:23], v7 offset:22528
    ds_read_b128 v[24:27], v11 offset:2048
    ds_read_b128 v[28:31], v11 offset:22528
    s_mul_i32 s40, s3, 5
    s_add_u32 s40, s40, 2
    s_lshr_b32 s41, s40, 1
    s_and_b32 s42, s40, 1
    s_mul_i32 s42, s42, 40
    s_add_u32 s42, s42, s41
    s_add_u32 s42, s42, 10
    s_lshl_b32 s42, s42, 10
    s_add_u32 s42, s42, s49
    s_waitcnt lgkmcnt(0)
    v_add_f32 v16, v16, v20
    v_add_f32 v24, v24, v28
    v_add_f32 v80, v16, v24
    v_add_f32 v17, v17, v21
    v_add_f32 v25, v25, v29
    v_add_f32 v81, v17, v25
    v_add_f32 v18, v18, v22
    v_add_f32 v26, v26, v30
    v_add_f32 v82, v18, v26
    v_add_f32 v19, v19, v23
    v_add_f32 v27, v27, v31
    v_add_f32 v83, v19, v27
    buffer_atomic_add_f32 v80, v12, s[32:35], s42 offen offset:0
    buffer_atomic_add_f32 v81, v12, s[32:35], s42 offen offset:256
    buffer_atomic_add_f32 v82, v12, s[32:35], s42 offen offset:512
    buffer_atomic_add_f32 v83, v12, s[32:35], s42 offen offset:768
    ds_read_b128 v[16:19], v7 offset:3072
    ds_read_b128 v[20:23], v7 offset:23552
    ds_read_b128 v[24:27], v11 offset:3072
    ds_read_b128 v[28:31], v11 offset:23552
    s_mul_i32 s40, s3, 5
    s_add_u32 s40, s40, 3
    s_lshr_b32 s41, s40, 1
    s_and_b32 s42, s40, 1
    s_mul_i32 s42, s42, 40
    s_add_u32 s42, s42, s41
    s_add_u32 s42, s42, 10
    s_lshl_b32 s42, s42, 10
    s_add_u32 s42, s42, s49
    s_waitcnt lgkmcnt(0)
    v_add_f32 v16, v16, v20
    v_add_f32 v24, v24, v28
    v_add_f32 v80, v16, v24
    v_add_f32 v17, v17, v21
    v_add_f32 v25, v25, v29
    v_add_f32 v81, v17, v25
    v_add_f32 v18, v18, v22
    v_add_f32 v26, v26, v30
    v_add_f32 v82, v18, v26
    v_add_f32 v19, v19, v23
    v_add_f32 v27, v27, v31
    v_add_f32 v83, v19, v27
    buffer_atomic_add_f32 v80, v12, s[32:35], s42 offen offset:0
    buffer_atomic_add_f32 v81, v12, s[32:35], s42 offen offset:256
    buffer_atomic_add_f32 v82, v12, s[32:35], s42 offen offset:512
    buffer_atomic_add_f32 v83, v12, s[32:35], s42 offen offset:768
    ds_read_b128 v[16:19], v7 offset:4096
    ds_read_b128 v[20:23], v7 offset:24576
    ds_read_b128 v[24:27], v11 offset:4096
    ds_read_b128 v[28:31], v11 offset:24576
    s_mul_i32 s40, s3, 5
    s_add_u32 s40, s40, 4
    s_lshr_b32 s41, s40, 1
    s_and_b32 s42, s40, 1
    s_mul_i32 s42, s42, 40
    s_add_u32 s42, s42, s41
    s_add_u32 s42, s42, 10
    s_lshl_b32 s42, s42, 10
    s_add_u32 s42, s42, s49
    s_waitcnt lgkmcnt(0)
    v_add_f32 v16, v16, v20
    v_add_f32 v24, v24, v28
    v_add_f32 v80, v16, v24
    v_add_f32 v17, v17, v21
    v_add_f32 v25, v25, v29
    v_add_f32 v81, v17, v25
    v_add_f32 v18, v18, v22
    v_add_f32 v26, v26, v30
    v_add_f32 v82, v18, v26
    v_add_f32 v19, v19, v23
    v_add_f32 v27, v27, v31
    v_add_f32 v83, v19, v27
    buffer_atomic_add_f32 v80, v12, s[32:35], s42 offen offset:0
    buffer_atomic_add_f32 v81, v12, s[32:35], s42 offen offset:256
    buffer_atomic_add_f32 v82, v12, s[32:35], s42 offen offset:512
    buffer_atomic_add_f32 v83, v12, s[32:35], s42 offen offset:768
    s_barrier
    s_waitcnt vmcnt(19)
    v_mfma_f32_16x16x32_bf16 a[0:3], v[88:91], v[48:51], 0
    v_mfma_f32_16x16x32_bf16 a[4:7], v[88:91], v[52:55], 0
    s_add_u32 s47, s48, 2048
    buffer_load_dwordx4 v[88:91], v4, s[32:35], s47 offen
    s_waitcnt vmcnt(19)
    v_mfma_f32_16x16x32_bf16 a[8:11], v[92:95], v[48:51], 0
    v_mfma_f32_16x16x32_bf16 a[12:15], v[92:95], v[52:55], 0
    s_add_u32 s47, s48, 133120
    buffer_load_dwordx4 v[92:95], v4, s[32:35], s47 offen
    s_waitcnt vmcnt(19)
    v_mfma_f32_16x16x32_bf16 a[16:19], v[96:99], v[48:51], 0
    v_mfma_f32_16x16x32_bf16 a[20:23], v[96:99], v[52:55], 0
    s_add_u32 s47, s48, 264192
    buffer_load_dwordx4 v[96:99], v4, s[32:35], s47 offen
    s_waitcnt vmcnt(19)
    v_mfma_f32_16x16x32_bf16 a[24:27], v[100:103], v[48:51], 0
    v_mfma_f32_16x16x32_bf16 a[28:31], v[100:103], v[52:55], 0
    s_add_u32 s47, s48, 395264
    buffer_load_dwordx4 v[100:103], v4, s[32:35], s47 offen
    s_waitcnt vmcnt(19)
    v_mfma_f32_16x16x32_bf16 a[32:35], v[104:107], v[48:51], 0
    v_mfma_f32_16x16x32_bf16 a[36:39], v[104:107], v[52:55], 0
    s_add_u32 s47, s48, 526336
    buffer_load_dwordx4 v[104:107], v4, s[32:35], s47 offen
    s_waitcnt vmcnt(19)
    v_mfma_f32_16x16x32_bf16 a[40:43], v[108:111], v[48:51], 0
    v_mfma_f32_16x16x32_bf16 a[44:47], v[108:111], v[52:55], 0
    s_add_u32 s47, s48, 657408
    buffer_load_dwordx4 v[108:111], v4, s[32:35], s47 offen
    s_waitcnt vmcnt(19)
    v_mfma_f32_16x16x32_bf16 a[48:51], v[112:115], v[48:51], 0
    v_mfma_f32_16x16x32_bf16 a[52:55], v[112:115], v[52:55], 0
    s_add_u32 s47, s48, 788480
    buffer_load_dwordx4 v[112:115], v4, s[32:35], s47 offen
    s_waitcnt vmcnt(19)
    v_mfma_f32_16x16x32_bf16 a[56:59], v[116:119], v[48:51], 0
    v_mfma_f32_16x16x32_bf16 a[60:63], v[116:119], v[52:55], 0
    s_add_u32 s47, s48, 919552
    buffer_load_dwordx4 v[116:119], v4, s[32:35], s47 offen
    s_waitcnt vmcnt(19)
    v_mfma_f32_16x16x32_bf16 a[64:67], v[120:123], v[48:51], 0
    v_mfma_f32_16x16x32_bf16 a[68:71], v[120:123], v[52:55], 0
    s_add_u32 s47, s48, 1050624
    buffer_load_dwordx4 v[120:123], v4, s[32:35], s47 offen
    s_waitcnt vmcnt(19)
    v_mfma_f32_16x16x32_bf16 a[72:75], v[124:127], v[48:51], 0
    v_mfma_f32_16x16x32_bf16 a[76:79], v[124:127], v[52:55], 0
    s_add_u32 s47, s48, 1181696
    buffer_load_dwordx4 v[124:127], v4, s[32:35], s47 offen
    s_waitcnt vmcnt(19)
    v_mfma_f32_16x16x32_bf16 a[0:3], v[128:131], v[56:59], a[0:3]
    v_mfma_f32_16x16x32_bf16 a[4:7], v[128:131], v[60:63], a[4:7]
    s_add_u32 s47, s48, 3072
    buffer_load_dwordx4 v[128:131], v4, s[32:35], s47 offen
    s_waitcnt vmcnt(19)
    v_mfma_f32_16x16x32_bf16 a[8:11], v[132:135], v[56:59], a[8:11]
    v_mfma_f32_16x16x32_bf16 a[12:15], v[132:135], v[60:63], a[12:15]
    s_add_u32 s47, s48, 134144
    buffer_load_dwordx4 v[132:135], v4, s[32:35], s47 offen
    s_waitcnt vmcnt(19)
    v_mfma_f32_16x16x32_bf16 a[16:19], v[136:139], v[56:59], a[16:19]
    v_mfma_f32_16x16x32_bf16 a[20:23], v[136:139], v[60:63], a[20:23]
    s_add_u32 s47, s48, 265216
    buffer_load_dwordx4 v[136:139], v4, s[32:35], s47 offen
    s_waitcnt vmcnt(19)
    v_mfma_f32_16x16x32_bf16 a[24:27], v[140:143], v[56:59], a[24:27]
    v_mfma_f32_16x16x32_bf16 a[28:31], v[140:143], v[60:63], a[28:31]
    s_add_u32 s47, s48, 396288
    buffer_load_dwordx4 v[140:143], v4, s[32:35], s47 offen
    s_waitcnt vmcnt(19)
    v_mfma_f32_16x16x32_bf16 a[32:35], v[144:147], v[56:59], a[32:35]
    v_mfma_f32_16x16x32_bf16 a[36:39], v[144:147], v[60:63], a[36:39]
    s_add_u32 s47, s48, 527360
    buffer_load_dwordx4 v[144:147], v4, s[32:35], s47 offen
    s_waitcnt vmcnt(19)
    v_mfma_f32_16x16x32_bf16 a[40:43], v[148:151], v[56:59], a[40:43]
    v_mfma_f32_16x16x32_bf16 a[44:47], v[148:151], v[60:63], a[44:47]
    s_add_u32 s47, s48, 658432
    buffer_load_dwordx4 v[148:151], v4, s[32:35], s47 offen
    s_waitcnt vmcnt(19)
    v_mfma_f32_16x16x32_bf16 a[48:51], v[152:155], v[56:59], a[48:51]
    v_mfma_f32_16x16x32_bf16 a[52:55], v[152:155], v[60:63], a[52:55]
    s_add_u32 s47, s48, 789504
    buffer_load_dwordx4 v[152:155], v4, s[32:35], s47 offen
    s_waitcnt vmcnt(19)
    v_mfma_f32_16x16x32_bf16 a[56:59], v[156:159], v[56:59], a[56:59]
    v_mfma_f32_16x16x32_bf16 a[60:63], v[156:159], v[60:63], a[60:63]
    s_add_u32 s47, s48, 920576
    buffer_load_dwordx4 v[156:159], v4, s[32:35], s47 offen
    s_waitcnt vmcnt(19)
    v_mfma_f32_16x16x32_bf16 a[64:67], v[160:163], v[56:59], a[64:67]
    v_mfma_f32_16x16x32_bf16 a[68:71], v[160:163], v[60:63], a[68:71]
    s_add_u32 s47, s48, 1051648
    buffer_load_dwordx4 v[160:163], v4, s[32:35], s47 offen
    s_waitcnt vmcnt(19)
    v_mfma_f32_16x16x32_bf16 a[72:75], v[164:167], v[56:59], a[72:75]
    v_mfma_f32_16x16x32_bf16 a[76:79], v[164:167], v[60:63], a[76:79]
    s_add_u32 s47, s48, 1182720
    buffer_load_dwordx4 v[164:167], v4, s[32:35], s47 offen
    s_waitcnt vmcnt(19)
    v_mfma_f32_16x16x32_bf16 a[0:3], v[88:91], v[64:67], a[0:3]
    v_mfma_f32_16x16x32_bf16 a[4:7], v[88:91], v[68:71], a[4:7]
    s_add_u32 s47, s48, 1310720
    buffer_load_dwordx4 v[88:91], v4, s[32:35], s47 offen
    s_waitcnt vmcnt(19)
    v_mfma_f32_16x16x32_bf16 a[8:11], v[92:95], v[64:67], a[8:11]
    v_mfma_f32_16x16x32_bf16 a[12:15], v[92:95], v[68:71], a[12:15]
    s_add_u32 s47, s48, 1441792
    buffer_load_dwordx4 v[92:95], v4, s[32:35], s47 offen
    s_waitcnt vmcnt(19)
    v_mfma_f32_16x16x32_bf16 a[16:19], v[96:99], v[64:67], a[16:19]
    v_mfma_f32_16x16x32_bf16 a[20:23], v[96:99], v[68:71], a[20:23]
    s_add_u32 s47, s48, 1572864
    buffer_load_dwordx4 v[96:99], v4, s[32:35], s47 offen
    s_waitcnt vmcnt(19)
    v_mfma_f32_16x16x32_bf16 a[24:27], v[100:103], v[64:67], a[24:27]
    v_mfma_f32_16x16x32_bf16 a[28:31], v[100:103], v[68:71], a[28:31]
    s_add_u32 s47, s48, 1703936
    buffer_load_dwordx4 v[100:103], v4, s[32:35], s47 offen
    s_waitcnt vmcnt(19)
    v_mfma_f32_16x16x32_bf16 a[32:35], v[104:107], v[64:67], a[32:35]
    v_mfma_f32_16x16x32_bf16 a[36:39], v[104:107], v[68:71], a[36:39]
    s_add_u32 s47, s48, 1835008
    buffer_load_dwordx4 v[104:107], v4, s[32:35], s47 offen
    s_waitcnt vmcnt(19)
    v_mfma_f32_16x16x32_bf16 a[40:43], v[108:111], v[64:67], a[40:43]
    v_mfma_f32_16x16x32_bf16 a[44:47], v[108:111], v[68:71], a[44:47]
    s_add_u32 s47, s48, 1966080
    buffer_load_dwordx4 v[108:111], v4, s[32:35], s47 offen
    s_waitcnt vmcnt(19)
    v_mfma_f32_16x16x32_bf16 a[48:51], v[112:115], v[64:67], a[48:51]
    v_mfma_f32_16x16x32_bf16 a[52:55], v[112:115], v[68:71], a[52:55]
    s_add_u32 s47, s48, 2097152
    buffer_load_dwordx4 v[112:115], v4, s[32:35], s47 offen
    s_waitcnt vmcnt(19)
    v_mfma_f32_16x16x32_bf16 a[56:59], v[116:119], v[64:67], a[56:59]
    v_mfma_f32_16x16x32_bf16 a[60:63], v[116:119], v[68:71], a[60:63]
    s_add_u32 s47, s48, 2228224
    buffer_load_dwordx4 v[116:119], v4, s[32:35], s47 offen
    s_waitcnt vmcnt(19)
    v_mfma_f32_16x16x32_bf16 a[64:67], v[120:123], v[64:67], a[64:67]
    v_mfma_f32_16x16x32_bf16 a[68:71], v[120:123], v[68:71], a[68:71]
    s_add_u32 s47, s48, 2359296
    buffer_load_dwordx4 v[120:123], v4, s[32:35], s47 offen
    s_waitcnt vmcnt(19)
    v_mfma_f32_16x16x32_bf16 a[72:75], v[124:127], v[64:67], a[72:75]
    v_mfma_f32_16x16x32_bf16 a[76:79], v[124:127], v[68:71], a[76:79]
    s_add_u32 s47, s48, 2490368
    buffer_load_dwordx4 v[124:127], v4, s[32:35], s47 offen
    s_waitcnt vmcnt(19)
    v_mfma_f32_16x16x32_bf16 a[0:3], v[128:131], v[72:75], a[0:3]
    v_mfma_f32_16x16x32_bf16 a[4:7], v[128:131], v[76:79], a[4:7]
    s_add_u32 s47, s48, 1311744
    buffer_load_dwordx4 v[128:131], v4, s[32:35], s47 offen
    s_waitcnt vmcnt(19)
    v_mfma_f32_16x16x32_bf16 a[8:11], v[132:135], v[72:75], a[8:11]
    v_mfma_f32_16x16x32_bf16 a[12:15], v[132:135], v[76:79], a[12:15]
    s_add_u32 s47, s48, 1442816
    buffer_load_dwordx4 v[132:135], v4, s[32:35], s47 offen
    s_waitcnt vmcnt(19)
    v_mfma_f32_16x16x32_bf16 a[16:19], v[136:139], v[72:75], a[16:19]
    v_mfma_f32_16x16x32_bf16 a[20:23], v[136:139], v[76:79], a[20:23]
    s_add_u32 s47, s48, 1573888
    buffer_load_dwordx4 v[136:139], v4, s[32:35], s47 offen
    s_waitcnt vmcnt(19)
    v_mfma_f32_16x16x32_bf16 a[24:27], v[140:143], v[72:75], a[24:27]
    v_mfma_f32_16x16x32_bf16 a[28:31], v[140:143], v[76:79], a[28:31]
    s_add_u32 s47, s48, 1704960
    buffer_load_dwordx4 v[140:143], v4, s[32:35], s47 offen
    s_waitcnt vmcnt(19)
    v_mfma_f32_16x16x32_bf16 a[32:35], v[144:147], v[72:75], a[32:35]
    v_mfma_f32_16x16x32_bf16 a[36:39], v[144:147], v[76:79], a[36:39]
    s_add_u32 s47, s48, 1836032
    buffer_load_dwordx4 v[144:147], v4, s[32:35], s47 offen
    s_waitcnt vmcnt(19)
    v_mfma_f32_16x16x32_bf16 a[40:43], v[148:151], v[72:75], a[40:43]
    v_mfma_f32_16x16x32_bf16 a[44:47], v[148:151], v[76:79], a[44:47]
    s_add_u32 s47, s48, 1967104
    buffer_load_dwordx4 v[148:151], v4, s[32:35], s47 offen
    s_waitcnt vmcnt(19)
    v_mfma_f32_16x16x32_bf16 a[48:51], v[152:155], v[72:75], a[48:51]
    v_mfma_f32_16x16x32_bf16 a[52:55], v[152:155], v[76:79], a[52:55]
    s_add_u32 s47, s48, 2098176
    buffer_load_dwordx4 v[152:155], v4, s[32:35], s47 offen
    s_waitcnt vmcnt(19)
    v_mfma_f32_16x16x32_bf16 a[56:59], v[156:159], v[72:75], a[56:59]
    v_mfma_f32_16x16x32_bf16 a[60:63], v[156:159], v[76:79], a[60:63]
    s_add_u32 s47, s48, 2229248
    buffer_load_dwordx4 v[156:159], v4, s[32:35], s47 offen
    s_waitcnt vmcnt(19)
    v_mfma_f32_16x16x32_bf16 a[64:67], v[160:163], v[72:75], a[64:67]
    v_mfma_f32_16x16x32_bf16 a[68:71], v[160:163], v[76:79], a[68:71]
    s_add_u32 s47, s48, 2360320
    buffer_load_dwordx4 v[160:163], v4, s[32:35], s47 offen
    s_waitcnt vmcnt(19)
    v_mfma_f32_16x16x32_bf16 a[72:75], v[164:167], v[72:75], a[72:75]
    v_mfma_f32_16x16x32_bf16 a[76:79], v[164:167], v[76:79], a[76:79]
    s_add_u32 s47, s48, 2491392
    buffer_load_dwordx4 v[164:167], v4, s[32:35], s47 offen
    s_add_u32 s48, s48, 1310720
    ds_write_b128 v6, a[0:3] offset:0
    ds_write_b128 v6, a[4:7] offset:1024
    ds_write_b128 v6, a[8:11] offset:2048
    ds_write_b128 v6, a[12:15] offset:3072
    ds_write_b128 v6, a[16:19] offset:4096
    ds_write_b128 v6, a[20:23] offset:5120
    ds_write_b128 v6, a[24:27] offset:6144
    ds_write_b128 v6, a[28:31] offset:7168
    ds_write_b128 v6, a[32:35] offset:8192
    ds_write_b128 v6, a[36:39] offset:9216
    ds_write_b128 v6, a[40:43] offset:10240
    ds_write_b128 v6, a[44:47] offset:11264
    ds_write_b128 v6, a[48:51] offset:12288
    ds_write_b128 v6, a[52:55] offset:13312
    ds_write_b128 v6, a[56:59] offset:14336
    ds_write_b128 v6, a[60:63] offset:15360
    ds_write_b128 v6, a[64:67] offset:16384
    ds_write_b128 v6, a[68:71] offset:17408
    ds_write_b128 v6, a[72:75] offset:18432
    ds_write_b128 v6, a[76:79] offset:19456
    s_waitcnt lgkmcnt(0)
    s_barrier
    ds_read_b128 v[16:19], v7 offset:0
    ds_read_b128 v[20:23], v7 offset:20480
    ds_read_b128 v[24:27], v11 offset:0
    ds_read_b128 v[28:31], v11 offset:20480
    s_mul_i32 s40, s3, 5
    s_add_u32 s40, s40, 0
    s_lshr_b32 s41, s40, 1
    s_and_b32 s42, s40, 1
    s_mul_i32 s42, s42, 40
    s_add_u32 s42, s42, s41
    s_add_u32 s42, s42, 20
    s_lshl_b32 s42, s42, 10
    s_add_u32 s42, s42, s49
    s_waitcnt lgkmcnt(0)
    v_add_f32 v16, v16, v20
    v_add_f32 v24, v24, v28
    v_add_f32 v80, v16, v24
    v_add_f32 v17, v17, v21
    v_add_f32 v25, v25, v29
    v_add_f32 v81, v17, v25
    v_add_f32 v18, v18, v22
    v_add_f32 v26, v26, v30
    v_add_f32 v82, v18, v26
    v_add_f32 v19, v19, v23
    v_add_f32 v27, v27, v31
    v_add_f32 v83, v19, v27
    buffer_atomic_add_f32 v80, v12, s[32:35], s42 offen offset:0
    buffer_atomic_add_f32 v81, v12, s[32:35], s42 offen offset:256
    buffer_atomic_add_f32 v82, v12, s[32:35], s42 offen offset:512
    buffer_atomic_add_f32 v83, v12, s[32:35], s42 offen offset:768
    ds_read_b128 v[16:19], v7 offset:1024
    ds_read_b128 v[20:23], v7 offset:21504
    ds_read_b128 v[24:27], v11 offset:1024
    ds_read_b128 v[28:31], v11 offset:21504
    s_mul_i32 s40, s3, 5
    s_add_u32 s40, s40, 1
    s_lshr_b32 s41, s40, 1
    s_and_b32 s42, s40, 1
    s_mul_i32 s42, s42, 40
    s_add_u32 s42, s42, s41
    s_add_u32 s42, s42, 20
    s_lshl_b32 s42, s42, 10
    s_add_u32 s42, s42, s49
    s_waitcnt lgkmcnt(0)
    v_add_f32 v16, v16, v20
    v_add_f32 v24, v24, v28
    v_add_f32 v80, v16, v24
    v_add_f32 v17, v17, v21
    v_add_f32 v25, v25, v29
    v_add_f32 v81, v17, v25
    v_add_f32 v18, v18, v22
    v_add_f32 v26, v26, v30
    v_add_f32 v82, v18, v26
    v_add_f32 v19, v19, v23
    v_add_f32 v27, v27, v31
    v_add_f32 v83, v19, v27
    buffer_atomic_add_f32 v80, v12, s[32:35], s42 offen offset:0
    buffer_atomic_add_f32 v81, v12, s[32:35], s42 offen offset:256
    buffer_atomic_add_f32 v82, v12, s[32:35], s42 offen offset:512
    buffer_atomic_add_f32 v83, v12, s[32:35], s42 offen offset:768
    ds_read_b128 v[16:19], v7 offset:2048
    ds_read_b128 v[20:23], v7 offset:22528
    ds_read_b128 v[24:27], v11 offset:2048
    ds_read_b128 v[28:31], v11 offset:22528
    s_mul_i32 s40, s3, 5
    s_add_u32 s40, s40, 2
    s_lshr_b32 s41, s40, 1
    s_and_b32 s42, s40, 1
    s_mul_i32 s42, s42, 40
    s_add_u32 s42, s42, s41
    s_add_u32 s42, s42, 20
    s_lshl_b32 s42, s42, 10
    s_add_u32 s42, s42, s49
    s_waitcnt lgkmcnt(0)
    v_add_f32 v16, v16, v20
    v_add_f32 v24, v24, v28
    v_add_f32 v80, v16, v24
    v_add_f32 v17, v17, v21
    v_add_f32 v25, v25, v29
    v_add_f32 v81, v17, v25
    v_add_f32 v18, v18, v22
    v_add_f32 v26, v26, v30
    v_add_f32 v82, v18, v26
    v_add_f32 v19, v19, v23
    v_add_f32 v27, v27, v31
    v_add_f32 v83, v19, v27
    buffer_atomic_add_f32 v80, v12, s[32:35], s42 offen offset:0
    buffer_atomic_add_f32 v81, v12, s[32:35], s42 offen offset:256
    buffer_atomic_add_f32 v82, v12, s[32:35], s42 offen offset:512
    buffer_atomic_add_f32 v83, v12, s[32:35], s42 offen offset:768
    ds_read_b128 v[16:19], v7 offset:3072
    ds_read_b128 v[20:23], v7 offset:23552
    ds_read_b128 v[24:27], v11 offset:3072
    ds_read_b128 v[28:31], v11 offset:23552
    s_mul_i32 s40, s3, 5
    s_add_u32 s40, s40, 3
    s_lshr_b32 s41, s40, 1
    s_and_b32 s42, s40, 1
    s_mul_i32 s42, s42, 40
    s_add_u32 s42, s42, s41
    s_add_u32 s42, s42, 20
    s_lshl_b32 s42, s42, 10
    s_add_u32 s42, s42, s49
    s_waitcnt lgkmcnt(0)
    v_add_f32 v16, v16, v20
    v_add_f32 v24, v24, v28
    v_add_f32 v80, v16, v24
    v_add_f32 v17, v17, v21
    v_add_f32 v25, v25, v29
    v_add_f32 v81, v17, v25
    v_add_f32 v18, v18, v22
    v_add_f32 v26, v26, v30
    v_add_f32 v82, v18, v26
    v_add_f32 v19, v19, v23
    v_add_f32 v27, v27, v31
    v_add_f32 v83, v19, v27
    buffer_atomic_add_f32 v80, v12, s[32:35], s42 offen offset:0
    buffer_atomic_add_f32 v81, v12, s[32:35], s42 offen offset:256
    buffer_atomic_add_f32 v82, v12, s[32:35], s42 offen offset:512
    buffer_atomic_add_f32 v83, v12, s[32:35], s42 offen offset:768
    ds_read_b128 v[16:19], v7 offset:4096
    ds_read_b128 v[20:23], v7 offset:24576
    ds_read_b128 v[24:27], v11 offset:4096
    ds_read_b128 v[28:31], v11 offset:24576
    s_mul_i32 s40, s3, 5
    s_add_u32 s40, s40, 4
    s_lshr_b32 s41, s40, 1
    s_and_b32 s42, s40, 1
    s_mul_i32 s42, s42, 40
    s_add_u32 s42, s42, s41
    s_add_u32 s42, s42, 20
    s_lshl_b32 s42, s42, 10
    s_add_u32 s42, s42, s49
    s_waitcnt lgkmcnt(0)
    v_add_f32 v16, v16, v20
    v_add_f32 v24, v24, v28
    v_add_f32 v80, v16, v24
    v_add_f32 v17, v17, v21
    v_add_f32 v25, v25, v29
    v_add_f32 v81, v17, v25
    v_add_f32 v18, v18, v22
    v_add_f32 v26, v26, v30
    v_add_f32 v82, v18, v26
    v_add_f32 v19, v19, v23
    v_add_f32 v27, v27, v31
    v_add_f32 v83, v19, v27
    buffer_atomic_add_f32 v80, v12, s[32:35], s42 offen offset:0
    buffer_atomic_add_f32 v81, v12, s[32:35], s42 offen offset:256
    buffer_atomic_add_f32 v82, v12, s[32:35], s42 offen offset:512
    buffer_atomic_add_f32 v83, v12, s[32:35], s42 offen offset:768
    s_barrier
    s_waitcnt vmcnt(19)
    v_mfma_f32_16x16x32_bf16 a[0:3], v[88:91], v[48:51], 0
    v_mfma_f32_16x16x32_bf16 a[4:7], v[88:91], v[52:55], 0
    s_add_u32 s47, s48, 2048
    buffer_load_dwordx4 v[88:91], v4, s[32:35], s47 offen
    s_waitcnt vmcnt(19)
    v_mfma_f32_16x16x32_bf16 a[8:11], v[92:95], v[48:51], 0
    v_mfma_f32_16x16x32_bf16 a[12:15], v[92:95], v[52:55], 0
    s_add_u32 s47, s48, 133120
    buffer_load_dwordx4 v[92:95], v4, s[32:35], s47 offen
    s_waitcnt vmcnt(19)
    v_mfma_f32_16x16x32_bf16 a[16:19], v[96:99], v[48:51], 0
    v_mfma_f32_16x16x32_bf16 a[20:23], v[96:99], v[52:55], 0
    s_add_u32 s47, s48, 264192
    buffer_load_dwordx4 v[96:99], v4, s[32:35], s47 offen
    s_waitcnt vmcnt(19)
    v_mfma_f32_16x16x32_bf16 a[24:27], v[100:103], v[48:51], 0
    v_mfma_f32_16x16x32_bf16 a[28:31], v[100:103], v[52:55], 0
    s_add_u32 s47, s48, 395264
    buffer_load_dwordx4 v[100:103], v4, s[32:35], s47 offen
    s_waitcnt vmcnt(19)
    v_mfma_f32_16x16x32_bf16 a[32:35], v[104:107], v[48:51], 0
    v_mfma_f32_16x16x32_bf16 a[36:39], v[104:107], v[52:55], 0
    s_add_u32 s47, s48, 526336
    buffer_load_dwordx4 v[104:107], v4, s[32:35], s47 offen
    s_waitcnt vmcnt(19)
    v_mfma_f32_16x16x32_bf16 a[40:43], v[108:111], v[48:51], 0
    v_mfma_f32_16x16x32_bf16 a[44:47], v[108:111], v[52:55], 0
    s_add_u32 s47, s48, 657408
    buffer_load_dwordx4 v[108:111], v4, s[32:35], s47 offen
    s_waitcnt vmcnt(19)
    v_mfma_f32_16x16x32_bf16 a[48:51], v[112:115], v[48:51], 0
    v_mfma_f32_16x16x32_bf16 a[52:55], v[112:115], v[52:55], 0
    s_add_u32 s47, s48, 788480
    buffer_load_dwordx4 v[112:115], v4, s[32:35], s47 offen
    s_waitcnt vmcnt(19)
    v_mfma_f32_16x16x32_bf16 a[56:59], v[116:119], v[48:51], 0
    v_mfma_f32_16x16x32_bf16 a[60:63], v[116:119], v[52:55], 0
    s_add_u32 s47, s48, 919552
    buffer_load_dwordx4 v[116:119], v4, s[32:35], s47 offen
    s_waitcnt vmcnt(19)
    v_mfma_f32_16x16x32_bf16 a[64:67], v[120:123], v[48:51], 0
    v_mfma_f32_16x16x32_bf16 a[68:71], v[120:123], v[52:55], 0
    s_add_u32 s47, s48, 1050624
    buffer_load_dwordx4 v[120:123], v4, s[32:35], s47 offen
    s_waitcnt vmcnt(19)
    v_mfma_f32_16x16x32_bf16 a[72:75], v[124:127], v[48:51], 0
    v_mfma_f32_16x16x32_bf16 a[76:79], v[124:127], v[52:55], 0
    s_add_u32 s47, s48, 1181696
    buffer_load_dwordx4 v[124:127], v4, s[32:35], s47 offen
    s_waitcnt vmcnt(19)
    v_mfma_f32_16x16x32_bf16 a[0:3], v[128:131], v[56:59], a[0:3]
    v_mfma_f32_16x16x32_bf16 a[4:7], v[128:131], v[60:63], a[4:7]
    s_add_u32 s47, s48, 3072
    buffer_load_dwordx4 v[128:131], v4, s[32:35], s47 offen
    s_waitcnt vmcnt(19)
    v_mfma_f32_16x16x32_bf16 a[8:11], v[132:135], v[56:59], a[8:11]
    v_mfma_f32_16x16x32_bf16 a[12:15], v[132:135], v[60:63], a[12:15]
    s_add_u32 s47, s48, 134144
    buffer_load_dwordx4 v[132:135], v4, s[32:35], s47 offen
    s_waitcnt vmcnt(19)
    v_mfma_f32_16x16x32_bf16 a[16:19], v[136:139], v[56:59], a[16:19]
    v_mfma_f32_16x16x32_bf16 a[20:23], v[136:139], v[60:63], a[20:23]
    s_add_u32 s47, s48, 265216
    buffer_load_dwordx4 v[136:139], v4, s[32:35], s47 offen
    s_waitcnt vmcnt(19)
    v_mfma_f32_16x16x32_bf16 a[24:27], v[140:143], v[56:59], a[24:27]
    v_mfma_f32_16x16x32_bf16 a[28:31], v[140:143], v[60:63], a[28:31]
    s_add_u32 s47, s48, 396288
    buffer_load_dwordx4 v[140:143], v4, s[32:35], s47 offen
    s_waitcnt vmcnt(19)
    v_mfma_f32_16x16x32_bf16 a[32:35], v[144:147], v[56:59], a[32:35]
    v_mfma_f32_16x16x32_bf16 a[36:39], v[144:147], v[60:63], a[36:39]
    s_add_u32 s47, s48, 527360
    buffer_load_dwordx4 v[144:147], v4, s[32:35], s47 offen
    s_waitcnt vmcnt(19)
    v_mfma_f32_16x16x32_bf16 a[40:43], v[148:151], v[56:59], a[40:43]
    v_mfma_f32_16x16x32_bf16 a[44:47], v[148:151], v[60:63], a[44:47]
    s_add_u32 s47, s48, 658432
    buffer_load_dwordx4 v[148:151], v4, s[32:35], s47 offen
    s_waitcnt vmcnt(19)
    v_mfma_f32_16x16x32_bf16 a[48:51], v[152:155], v[56:59], a[48:51]
    v_mfma_f32_16x16x32_bf16 a[52:55], v[152:155], v[60:63], a[52:55]
    s_add_u32 s47, s48, 789504
    buffer_load_dwordx4 v[152:155], v4, s[32:35], s47 offen
    s_waitcnt vmcnt(19)
    v_mfma_f32_16x16x32_bf16 a[56:59], v[156:159], v[56:59], a[56:59]
    v_mfma_f32_16x16x32_bf16 a[60:63], v[156:159], v[60:63], a[60:63]
    s_add_u32 s47, s48, 920576
    buffer_load_dwordx4 v[156:159], v4, s[32:35], s47 offen
    s_waitcnt vmcnt(19)
    v_mfma_f32_16x16x32_bf16 a[64:67], v[160:163], v[56:59], a[64:67]
    v_mfma_f32_16x16x32_bf16 a[68:71], v[160:163], v[60:63], a[68:71]
    s_add_u32 s47, s48, 1051648
    buffer_load_dwordx4 v[160:163], v4, s[32:35], s47 offen
    s_waitcnt vmcnt(19)
    v_mfma_f32_16x16x32_bf16 a[72:75], v[164:167], v[56:59], a[72:75]
    v_mfma_f32_16x16x32_bf16 a[76:79], v[164:167], v[60:63], a[76:79]
    s_add_u32 s47, s48, 1182720
    buffer_load_dwordx4 v[164:167], v4, s[32:35], s47 offen
    s_waitcnt vmcnt(19)
    v_mfma_f32_16x16x32_bf16 a[0:3], v[88:91], v[64:67], a[0:3]
    v_mfma_f32_16x16x32_bf16 a[4:7], v[88:91], v[68:71], a[4:7]
    s_waitcnt vmcnt(18)
    v_mfma_f32_16x16x32_bf16 a[8:11], v[92:95], v[64:67], a[8:11]
    v_mfma_f32_16x16x32_bf16 a[12:15], v[92:95], v[68:71], a[12:15]
    s_waitcnt vmcnt(17)
    v_mfma_f32_16x16x32_bf16 a[16:19], v[96:99], v[64:67], a[16:19]
    v_mfma_f32_16x16x32_bf16 a[20:23], v[96:99], v[68:71], a[20:23]
    s_waitcnt vmcnt(16)
    v_mfma_f32_16x16x32_bf16 a[24:27], v[100:103], v[64:67], a[24:27]
    v_mfma_f32_16x16x32_bf16 a[28:31], v[100:103], v[68:71], a[28:31]
    s_waitcnt vmcnt(15)
    v_mfma_f32_16x16x32_bf16 a[32:35], v[104:107], v[64:67], a[32:35]
    v_mfma_f32_16x16x32_bf16 a[36:39], v[104:107], v[68:71], a[36:39]
    s_waitcnt vmcnt(14)
    v_mfma_f32_16x16x32_bf16 a[40:43], v[108:111], v[64:67], a[40:43]
    v_mfma_f32_16x16x32_bf16 a[44:47], v[108:111], v[68:71], a[44:47]
    s_waitcnt vmcnt(13)
    v_mfma_f32_16x16x32_bf16 a[48:51], v[112:115], v[64:67], a[48:51]
    v_mfma_f32_16x16x32_bf16 a[52:55], v[112:115], v[68:71], a[52:55]
    s_waitcnt vmcnt(12)
    v_mfma_f32_16x16x32_bf16 a[56:59], v[116:119], v[64:67], a[56:59]
    v_mfma_f32_16x16x32_bf16 a[60:63], v[116:119], v[68:71], a[60:63]
    s_waitcnt vmcnt(11)
    v_mfma_f32_16x16x32_bf16 a[64:67], v[120:123], v[64:67], a[64:67]
    v_mfma_f32_16x16x32_bf16 a[68:71], v[120:123], v[68:71], a[68:71]
    s_waitcnt vmcnt(10)
    v_mfma_f32_16x16x32_bf16 a[72:75], v[124:127], v[64:67], a[72:75]
    v_mfma_f32_16x16x32_bf16 a[76:79], v[124:127], v[68:71], a[76:79]
    s_waitcnt vmcnt(9)
    v_mfma_f32_16x16x32_bf16 a[0:3], v[128:131], v[72:75], a[0:3]
    v_mfma_f32_16x16x32_bf16 a[4:7], v[128:131], v[76:79], a[4:7]
    s_waitcnt vmcnt(8)
    v_mfma_f32_16x16x32_bf16 a[8:11], v[132:135], v[72:75], a[8:11]
    v_mfma_f32_16x16x32_bf16 a[12:15], v[132:135], v[76:79], a[12:15]
    s_waitcnt vmcnt(7)
    v_mfma_f32_16x16x32_bf16 a[16:19], v[136:139], v[72:75], a[16:19]
    v_mfma_f32_16x16x32_bf16 a[20:23], v[136:139], v[76:79], a[20:23]
    s_waitcnt vmcnt(6)
    v_mfma_f32_16x16x32_bf16 a[24:27], v[140:143], v[72:75], a[24:27]
    v_mfma_f32_16x16x32_bf16 a[28:31], v[140:143], v[76:79], a[28:31]
    s_waitcnt vmcnt(5)
    v_mfma_f32_16x16x32_bf16 a[32:35], v[144:147], v[72:75], a[32:35]
    v_mfma_f32_16x16x32_bf16 a[36:39], v[144:147], v[76:79], a[36:39]
    s_waitcnt vmcnt(4)
    v_mfma_f32_16x16x32_bf16 a[40:43], v[148:151], v[72:75], a[40:43]
    v_mfma_f32_16x16x32_bf16 a[44:47], v[148:151], v[76:79], a[44:47]
    s_waitcnt vmcnt(3)
    v_mfma_f32_16x16x32_bf16 a[48:51], v[152:155], v[72:75], a[48:51]
    v_mfma_f32_16x16x32_bf16 a[52:55], v[152:155], v[76:79], a[52:55]
    s_waitcnt vmcnt(2)
    v_mfma_f32_16x16x32_bf16 a[56:59], v[156:159], v[72:75], a[56:59]
    v_mfma_f32_16x16x32_bf16 a[60:63], v[156:159], v[76:79], a[60:63]
    s_waitcnt vmcnt(1)
    v_mfma_f32_16x16x32_bf16 a[64:67], v[160:163], v[72:75], a[64:67]
    v_mfma_f32_16x16x32_bf16 a[68:71], v[160:163], v[76:79], a[68:71]
    s_waitcnt vmcnt(0)
    v_mfma_f32_16x16x32_bf16 a[72:75], v[164:167], v[72:75], a[72:75]
    v_mfma_f32_16x16x32_bf16 a[76:79], v[164:167], v[76:79], a[76:79]
    s_add_u32 s48, s48, 1310720
    ds_write_b128 v6, a[0:3] offset:0
    ds_write_b128 v6, a[4:7] offset:1024
    ds_write_b128 v6, a[8:11] offset:2048
    ds_write_b128 v6, a[12:15] offset:3072
    ds_write_b128 v6, a[16:19] offset:4096
    ds_write_b128 v6, a[20:23] offset:5120
    ds_write_b128 v6, a[24:27] offset:6144
    ds_write_b128 v6, a[28:31] offset:7168
    ds_write_b128 v6, a[32:35] offset:8192
    ds_write_b128 v6, a[36:39] offset:9216
    ds_write_b128 v6, a[40:43] offset:10240
    ds_write_b128 v6, a[44:47] offset:11264
    ds_write_b128 v6, a[48:51] offset:12288
    ds_write_b128 v6, a[52:55] offset:13312
    ds_write_b128 v6, a[56:59] offset:14336
    ds_write_b128 v6, a[60:63] offset:15360
    ds_write_b128 v6, a[64:67] offset:16384
    ds_write_b128 v6, a[68:71] offset:17408
    ds_write_b128 v6, a[72:75] offset:18432
    ds_write_b128 v6, a[76:79] offset:19456
    s_waitcnt lgkmcnt(0)
    s_barrier
    ds_read_b128 v[16:19], v7 offset:0
    ds_read_b128 v[20:23], v7 offset:20480
    ds_read_b128 v[24:27], v11 offset:0
    ds_read_b128 v[28:31], v11 offset:20480
    s_mul_i32 s40, s3, 5
    s_add_u32 s40, s40, 0
    s_lshr_b32 s41, s40, 1
    s_and_b32 s42, s40, 1
    s_mul_i32 s42, s42, 40
    s_add_u32 s42, s42, s41
    s_add_u32 s42, s42, 30
    s_lshl_b32 s42, s42, 10
    s_add_u32 s42, s42, s49
    s_waitcnt lgkmcnt(0)
    v_add_f32 v16, v16, v20
    v_add_f32 v24, v24, v28
    v_add_f32 v80, v16, v24
    v_add_f32 v17, v17, v21
    v_add_f32 v25, v25, v29
    v_add_f32 v81, v17, v25
    v_add_f32 v18, v18, v22
    v_add_f32 v26, v26, v30
    v_add_f32 v82, v18, v26
    v_add_f32 v19, v19, v23
    v_add_f32 v27, v27, v31
    v_add_f32 v83, v19, v27
    buffer_atomic_add_f32 v80, v12, s[32:35], s42 offen offset:0
    buffer_atomic_add_f32 v81, v12, s[32:35], s42 offen offset:256
    buffer_atomic_add_f32 v82, v12, s[32:35], s42 offen offset:512
    buffer_atomic_add_f32 v83, v12, s[32:35], s42 offen offset:768
    ds_read_b128 v[16:19], v7 offset:1024
    ds_read_b128 v[20:23], v7 offset:21504
    ds_read_b128 v[24:27], v11 offset:1024
    ds_read_b128 v[28:31], v11 offset:21504
    s_mul_i32 s40, s3, 5
    s_add_u32 s40, s40, 1
    s_lshr_b32 s41, s40, 1
    s_and_b32 s42, s40, 1
    s_mul_i32 s42, s42, 40
    s_add_u32 s42, s42, s41
    s_add_u32 s42, s42, 30
    s_lshl_b32 s42, s42, 10
    s_add_u32 s42, s42, s49
    s_waitcnt lgkmcnt(0)
    v_add_f32 v16, v16, v20
    v_add_f32 v24, v24, v28
    v_add_f32 v80, v16, v24
    v_add_f32 v17, v17, v21
    v_add_f32 v25, v25, v29
    v_add_f32 v81, v17, v25
    v_add_f32 v18, v18, v22
    v_add_f32 v26, v26, v30
    v_add_f32 v82, v18, v26
    v_add_f32 v19, v19, v23
    v_add_f32 v27, v27, v31
    v_add_f32 v83, v19, v27
    buffer_atomic_add_f32 v80, v12, s[32:35], s42 offen offset:0
    buffer_atomic_add_f32 v81, v12, s[32:35], s42 offen offset:256
    buffer_atomic_add_f32 v82, v12, s[32:35], s42 offen offset:512
    buffer_atomic_add_f32 v83, v12, s[32:35], s42 offen offset:768
    ds_read_b128 v[16:19], v7 offset:2048
    ds_read_b128 v[20:23], v7 offset:22528
    ds_read_b128 v[24:27], v11 offset:2048
    ds_read_b128 v[28:31], v11 offset:22528
    s_mul_i32 s40, s3, 5
    s_add_u32 s40, s40, 2
    s_lshr_b32 s41, s40, 1
    s_and_b32 s42, s40, 1
    s_mul_i32 s42, s42, 40
    s_add_u32 s42, s42, s41
    s_add_u32 s42, s42, 30
    s_lshl_b32 s42, s42, 10
    s_add_u32 s42, s42, s49
    s_waitcnt lgkmcnt(0)
    v_add_f32 v16, v16, v20
    v_add_f32 v24, v24, v28
    v_add_f32 v80, v16, v24
    v_add_f32 v17, v17, v21
    v_add_f32 v25, v25, v29
    v_add_f32 v81, v17, v25
    v_add_f32 v18, v18, v22
    v_add_f32 v26, v26, v30
    v_add_f32 v82, v18, v26
    v_add_f32 v19, v19, v23
    v_add_f32 v27, v27, v31
    v_add_f32 v83, v19, v27
    buffer_atomic_add_f32 v80, v12, s[32:35], s42 offen offset:0
    buffer_atomic_add_f32 v81, v12, s[32:35], s42 offen offset:256
    buffer_atomic_add_f32 v82, v12, s[32:35], s42 offen offset:512
    buffer_atomic_add_f32 v83, v12, s[32:35], s42 offen offset:768
    ds_read_b128 v[16:19], v7 offset:3072
    ds_read_b128 v[20:23], v7 offset:23552
    ds_read_b128 v[24:27], v11 offset:3072
    ds_read_b128 v[28:31], v11 offset:23552
    s_mul_i32 s40, s3, 5
    s_add_u32 s40, s40, 3
    s_lshr_b32 s41, s40, 1
    s_and_b32 s42, s40, 1
    s_mul_i32 s42, s42, 40
    s_add_u32 s42, s42, s41
    s_add_u32 s42, s42, 30
    s_lshl_b32 s42, s42, 10
    s_add_u32 s42, s42, s49
    s_waitcnt lgkmcnt(0)
    v_add_f32 v16, v16, v20
    v_add_f32 v24, v24, v28
    v_add_f32 v80, v16, v24
    v_add_f32 v17, v17, v21
    v_add_f32 v25, v25, v29
    v_add_f32 v81, v17, v25
    v_add_f32 v18, v18, v22
    v_add_f32 v26, v26, v30
    v_add_f32 v82, v18, v26
    v_add_f32 v19, v19, v23
    v_add_f32 v27, v27, v31
    v_add_f32 v83, v19, v27
    buffer_atomic_add_f32 v80, v12, s[32:35], s42 offen offset:0
    buffer_atomic_add_f32 v81, v12, s[32:35], s42 offen offset:256
    buffer_atomic_add_f32 v82, v12, s[32:35], s42 offen offset:512
    buffer_atomic_add_f32 v83, v12, s[32:35], s42 offen offset:768
    ds_read_b128 v[16:19], v7 offset:4096
    ds_read_b128 v[20:23], v7 offset:24576
    ds_read_b128 v[24:27], v11 offset:4096
    ds_read_b128 v[28:31], v11 offset:24576
    s_mul_i32 s40, s3, 5
    s_add_u32 s40, s40, 4
    s_lshr_b32 s41, s40, 1
    s_and_b32 s42, s40, 1
    s_mul_i32 s42, s42, 40
    s_add_u32 s42, s42, s41
    s_add_u32 s42, s42, 30
    s_lshl_b32 s42, s42, 10
    s_add_u32 s42, s42, s49
    s_waitcnt lgkmcnt(0)
    v_add_f32 v16, v16, v20
    v_add_f32 v24, v24, v28
    v_add_f32 v80, v16, v24
    v_add_f32 v17, v17, v21
    v_add_f32 v25, v25, v29
    v_add_f32 v81, v17, v25
    v_add_f32 v18, v18, v22
    v_add_f32 v26, v26, v30
    v_add_f32 v82, v18, v26
    v_add_f32 v19, v19, v23
    v_add_f32 v27, v27, v31
    v_add_f32 v83, v19, v27
    buffer_atomic_add_f32 v80, v12, s[32:35], s42 offen offset:0
    buffer_atomic_add_f32 v81, v12, s[32:35], s42 offen offset:256
    buffer_atomic_add_f32 v82, v12, s[32:35], s42 offen offset:512
    buffer_atomic_add_f32 v83, v12, s[32:35], s42 offen offset:768
    s_barrier
    s_branch p2_next
p2_fine:
    s_sub_u32 s71, s70, 480
    s_lshr_b32 s36, s71, 5
    s_add_u32 s36, s36, 60
    s_lshr_b32 s37, s71, 2
    s_and_b32 s37, s37, 7
    s_and_b32 s71, s71, 3
    s_lshl_b32 s44, s37, 2
    s_add_u32 s44, s44, s3
    s_lshr_b32 s45, s44, 1
    v_lshrrev_b32 v8, 1, v1
    v_lshlrev_b32 v8, 4, v8
    v_add_u32 v8, s45, v8
    v_lshlrev_b32 v8, 7, v8
    v_and_b32 v9, 1, v1
    v_add_u32 v8, v8, v9
    s_lshl_b32 s45, s36, 1
    v_add_u32 v8, s45, v8
    v_lshlrev_b32 v8, 2, v8
    v_add_u32 v8, 3342336, v8
    s_lshl_b32 s45, s44, 2
    s_add_u32 s45, s45, 3375104
    v_mov_b32 v9, s45
    v_cmp_gt_u32 vcc, 6, v1
    s_nop 1
    v_cndmask_b32 v8, v9, v8, vcc
    v_mov_b32 v9, s36
    v_mov_b32 v10, 0
    v_cndmask_b32 v9, v9, v10, vcc
    s_mov_b32 s46, 400000
    s_nop 3
p2_waitf:
    buffer_load_dword v10, v8, s[32:35], 0 offen sc1
    s_waitcnt vmcnt(0)
    v_cmp_le_u32 vcc, v10, v9
    s_nop 4
    s_cbranch_vccz p2_gof
    s_sleep 32
    s_sub_u32 s46, s46, 1
    s_cmp_lg_u32 s46, 0
    s_cbranch_scc1 p2_waitf
p2_gof:
    s_lshl_b32 s45, s36, 18
    s_lshl_b32 s47, s44, 13
    s_add_u32 s45, s45, s47
    s_lshl_b32 s46, s36, 17
    s_lshl_b32 s47, s44, 12
    s_add_u32 s46, s46, s47
    s_add_u32 s48, s47, 16777216
    s_mul_i32 s47, s71, 1310720
    s_add_u32 s48, s48, s47
    s_add_u32 s47, s45, 33554432
    buffer_load_dwordx4 v[168:171], v4, s[32:35], s47 offen offset:0 sc1
    buffer_load_dwordx4 v[172:175], v4, s[32:35], s47 offen offset:1024 sc1
    buffer_load_dwordx4 v[176:179], v4, s[32:35], s47 offen offset:2048 sc1
    buffer_load_dwordx4 v[180:183], v4, s[32:35], s47 offen offset:3072 sc1
    s_add_u32 s47, s47, 4096
    buffer_load_dwordx4 v[184:187], v4, s[32:35], s47 offen offset:0 sc1
    buffer_load_dwordx4 v[188:191], v4, s[32:35], s47 offen offset:1024 sc1
    buffer_load_dwordx4 v[192:195], v4, s[32:35], s47 offen offset:2048 sc1
    buffer_load_dwordx4 v[196:199], v4, s[32:35], s47 offen offset:3072 sc1
    s_add_u32 s47, s45, 50331648
    buffer_load_dwordx4 v[200:203], v4, s[32:35], s47 offen offset:0 sc1
    buffer_load_dwordx4 v[204:207], v4, s[32:35], s47 offen offset:1024 sc1
    buffer_load_dwordx4 v[208:211], v4, s[32:35], s47 offen offset:2048 sc1
    buffer_load_dwordx4 v[212:215], v4, s[32:35], s47 offen offset:3072 sc1
    s_add_u32 s47, s47, 4096
    buffer_load_dwordx4 v[216:219], v4, s[32:35], s47 offen offset:0 sc1
    buffer_load_dwordx4 v[220:223], v4, s[32:35], s47 offen offset:1024 sc1
    buffer_load_dwordx4 v[224:227], v4, s[32:35], s47 offen offset:2048 sc1
    buffer_load_dwordx4 v[228:231], v4, s[32:35], s47 offen offset:3072 sc1
    s_add_u32 s47, s45, 67108864
    buffer_load_dwordx4 a[208:211], v4, s[32:35], s47 offen offset:0 sc1
    buffer_load_dwordx4 a[212:215], v4, s[32:35], s47 offen offset:1024 sc1
    buffer_load_dwordx4 a[216:219], v4, s[32:35], s47 offen offset:2048 sc1
    buffer_load_dwordx4 a[220:223], v4, s[32:35], s47 offen offset:3072 sc1
    s_add_u32 s47, s47, 4096
    buffer_load_dwordx4 a[224:227], v4, s[32:35], s47 offen offset:0 sc1
    buffer_load_dwordx4 a[228:231], v4, s[32:35], s47 offen offset:1024 sc1
    buffer_load_dwordx4 a[232:235], v4, s[32:35], s47 offen offset:2048 sc1
    buffer_load_dwordx4 a[236:239], v4, s[32:35], s47 offen offset:3072 sc1
    s_add_u32 s47, s46, 83886080
    buffer_load_dwordx4 v[232:235], v4, s[32:35], s47 offen offset:0 sc1
    buffer_load_dwordx4 v[236:239], v4, s[32:35], s47 offen offset:1024 sc1
    buffer_load_dwordx4 v[240:243], v4, s[32:35], s47 offen offset:2048 sc1
    buffer_load_dwordx4 v[244:247], v4, s[32:35], s47 offen offset:3072 sc1
    s_add_u32 s47, s46, 100663296
    buffer_load_dwordx2 a[240:241], v5, s[32:35], s47 offen offset:0 sc1
    buffer_load_dwordx2 a[242:243], v5, s[32:35], s47 offen offset:512 sc1
    buffer_load_dwordx2 a[244:245], v5, s[32:35], s47 offen offset:1024 sc1
    buffer_load_dwordx2 a[246:247], v5, s[32:35], s47 offen offset:1536 sc1
    buffer_load_dwordx2 a[248:249], v5, s[32:35], s47 offen offset:2048 sc1
    buffer_load_dwordx2 a[250:251], v5, s[32:35], s47 offen offset:2560 sc1
    buffer_load_dwordx2 a[252:253], v5, s[32:35], s47 offen offset:3072 sc1
    buffer_load_dwordx2 a[254:255], v5, s[32:35], s47 offen offset:3584 sc1
    s_add_u32 s45, s45, 8192
    s_add_u32 s46, s46, 4096
    s_add_u32 s47, s48, 0
    buffer_load_dwordx4 v[88:91], v4, s[32:35], s47 offen
    s_add_u32 s47, s48, 131072
    buffer_load_dwordx4 v[92:95], v4, s[32:35], s47 offen
    s_add_u32 s47, s48, 262144
    buffer_load_dwordx4 v[96:99], v4, s[32:35], s47 offen
    s_add_u32 s47, s48, 393216
    buffer_load_dwordx4 v[100:103], v4, s[32:35], s47 offen
    s_add_u32 s47, s48, 524288
    buffer_load_dwordx4 v[104:107], v4, s[32:35], s47 offen
    s_add_u32 s47, s48, 655360
    buffer_load_dwordx4 v[108:111], v4, s[32:35], s47 offen
    s_add_u32 s47, s48, 786432
    buffer_load_dwordx4 v[112:115], v4, s[32:35], s47 offen
    s_add_u32 s47, s48, 917504
    buffer_load_dwordx4 v[116:119], v4, s[32:35], s47 offen
    s_add_u32 s47, s48, 1048576
    buffer_load_dwordx4 v[120:123], v4, s[32:35], s47 offen
    s_add_u32 s47, s48, 1179648
    buffer_load_dwordx4 v[124:127], v4, s[32:35], s47 offen
    s_add_u32 s47, s48, 1024
    buffer_load_dwordx4 v[128:131], v4, s[32:35], s47 offen
    s_add_u32 s47, s48, 132096
    buffer_load_dwordx4 v[132:135], v4, s[32:35], s47 offen
    s_add_u32 s47, s48, 263168
    buffer_load_dwordx4 v[136:139], v4, s[32:35], s47 offen
    s_add_u32 s47, s48, 394240
    buffer_load_dwordx4 v[140:143], v4, s[32:35], s47 offen
    s_add_u32 s47, s48, 525312
    buffer_load_dwordx4 v[144:147], v4, s[32:35], s47 offen
    s_add_u32 s47, s48, 656384
    buffer_load_dwordx4 v[148:151], v4, s[32:35], s47 offen
    s_add_u32 s47, s48, 787456
    buffer_load_dwordx4 v[152:155], v4, s[32:35], s47 offen
    s_add_u32 s47, s48, 918528
    buffer_load_dwordx4 v[156:159], v4, s[32:35], s47 offen
    s_add_u32 s47, s48, 1049600
    buffer_load_dwordx4 v[160:163], v4, s[32:35], s47 offen
    s_add_u32 s47, s48, 1180672
    buffer_load_dwordx4 v[164:167], v4, s[32:35], s47 offen
    s_waitcnt vmcnt(20)
    v_mfma_f32_16x16x32_bf16 v[16:19], v[232:235], v[168:171], 0
    v_mfma_f32_16x16x32_bf16 v[20:23], v[200:203], v[168:171], 0
    v_mfma_f32_16x16x32_bf16 v[24:27], v[232:235], v[172:175], 0
    v_mfma_f32_16x16x32_bf16 v[28:31], v[200:203], v[172:175], 0
    v_mfma_f32_16x16x32_bf16 v[32:35], v[204:207], v[172:175], 0
    v_mfma_f32_16x16x32_bf16 v[16:19], v[236:239], v[176:179], v[16:19]
    v_mfma_f32_16x16x32_bf16 v[20:23], v[208:211], v[176:179], v[20:23]
    v_mfma_f32_16x16x32_bf16 v[24:27], v[236:239], v[180:183], v[24:27]
    v_mfma_f32_16x16x32_bf16 v[28:31], v[208:211], v[180:183], v[28:31]
    v_mfma_f32_16x16x32_bf16 v[32:35], v[212:215], v[180:183], v[32:35]
    v_mfma_f32_16x16x32_bf16 v[16:19], v[240:243], v[184:187], v[16:19]
    v_mfma_f32_16x16x32_bf16 v[20:23], v[216:219], v[184:187], v[20:23]
    v_mfma_f32_16x16x32_bf16 v[24:27], v[240:243], v[188:191], v[24:27]
    v_mfma_f32_16x16x32_bf16 v[28:31], v[216:219], v[188:191], v[28:31]
    v_mfma_f32_16x16x32_bf16 v[32:35], v[220:223], v[188:191], v[32:35]
    v_mfma_f32_16x16x32_bf16 v[16:19], v[244:247], v[192:195], v[16:19]
    v_mfma_f32_16x16x32_bf16 v[20:23], v[224:227], v[192:195], v[20:23]
    v_mfma_f32_16x16x32_bf16 v[24:27], v[244:247], v[196:199], v[24:27]
    v_mfma_f32_16x16x32_bf16 v[28:31], v[224:227], v[196:199], v[28:31]
    v_mfma_f32_16x16x32_bf16 v[32:35], v[228:231], v[196:199], v[32:35]
    s_nop 3
    v_cvt_pk_bf16_f32 v80, v16, v17
    v_lshlrev_b32 v16, 16, v80
    v_and_b32 v17, 0xffff0000, v80
    v_mul_f32 v16, s56, v16
    v_mul_f32 v17, s56, v17
    v_cvt_pk_bf16_f32 v80, v16, v17
    v_lshlrev_b32 v16, 16, v80
    v_and_b32 v17, 0xffff0000, v80
    v_cvt_pk_bf16_f32 v80, v18, v19
    v_lshlrev_b32 v18, 16, v80
    v_and_b32 v19, 0xffff0000, v80
    v_mul_f32 v18, s56, v18
    v_mul_f32 v19, s56, v19
    v_cvt_pk_bf16_f32 v80, v18, v19
    v_lshlrev_b32 v18, 16, v80
    v_and_b32 v19, 0xffff0000, v80
    v_cvt_pk_bf16_f32 v80, v20, v21
    v_lshlrev_b32 v20, 16, v80
    v_and_b32 v21, 0xffff0000, v80
    v_mul_f32 v20, s56, v20
    v_mul_f32 v21, s56, v21
    v_cvt_pk_bf16_f32 v80, v20, v21
    v_lshlrev_b32 v20, 16, v80
    v_and_b32 v21, 0xffff0000, v80
    v_cvt_pk_bf16_f32 v80, v22, v23
    v_lshlrev_b32 v22, 16, v80
    v_and_b32 v23, 0xffff0000, v80
    v_mul_f32 v22, s56, v22
    v_mul_f32 v23, s56, v23
    v_cvt_pk_bf16_f32 v80, v22, v23
    v_lshlrev_b32 v22, 16, v80
    v_and_b32 v23, 0xffff0000, v80
    v_mov_b32 v80, 0xff800000
    v_cndmask_b32 v16, v80, v16, s[52:53]
    v_cndmask_b32 v20, v80, v20, s[60:61]
    v_cndmask_b32 v17, v80, v17, s[52:53]
    v_cndmask_b32 v21, v80, v21, s[62:63]
    v_cndmask_b32 v18, v80, v18, s[52:53]
    v_cndmask_b32 v22, v80, v22, s[64:65]
    v_cndmask_b32 v19, v80, v19, s[52:53]
    v_cndmask_b32 v23, v80, v23, s[66:67]
    v_max_f32 v80, v16, v17
    v_max3_f32 v80, v80, v18, v19
    v_max3_f32 v80, v80, v20, v21
    v_max3_f32 v80, v80, v22, v23
    v_mov_b32 v81, v80
    v_mov_b32 v82, v80
    s_nop 1
    v_permlane16_swap_b32 v81, v82
    v_max_f32 v80, v81, v82
    v_mov_b32 v81, v80
    v_mov_b32 v82, v80
    s_nop 1
    v_permlane32_swap_b32 v81, v82
    v_max_f32 v80, v81, v82
    v_sub_f32 v16, v16, v80
    v_mul_f32 v16, s57, v16
    v_exp_f32 v16, v16
    v_sub_f32 v17, v17, v80
    v_mul_f32 v17, s57, v17
    v_exp_f32 v17, v17
    v_sub_f32 v18, v18, v80
    v_mul_f32 v18, s57, v18
    v_exp_f32 v18, v18
    v_sub_f32 v19, v19, v80
    v_mul_f32 v19, s57, v19
    v_exp_f32 v19, v19
    v_sub_f32 v20, v20, v80
    v_mul_f32 v20, s57, v20
    v_exp_f32 v20, v20
    v_sub_f32 v21, v21, v80
    v_mul_f32 v21, s57, v21
    v_exp_f32 v21, v21
    v_sub_f32 v22, v22, v80
    v_mul_f32 v22, s57, v22
    v_exp_f32 v22, v22
    v_sub_f32 v23, v23, v80
    v_mul_f32 v23, s57, v23
    v_exp_f32 v23, v23
    v_add_f32 v80, v16, v17
    v_add_f32 v80, v80, v18
    v_add_f32 v80, v80, v19
    v_add_f32 v80, v80, v20
    v_add_f32 v80, v80, v21
    v_add_f32 v80, v80, v22
    v_add_f32 v80, v80, v23
    v_mov_b32 v81, v80
    v_mov_b32 v82, v80
    s_nop 1
    v_permlane16_swap_b32 v81, v82
    v_add_f32 v80, v81, v82
    v_mov_b32 v81, v80
    v_mov_b32 v82, v80
    s_nop 1
    v_permlane32_swap_b32 v81, v82
    v_add_f32 v80, v81, v82
    v_rcp_f32 v81, v80
    s_nop 0
    v_fma_f32 v82, -v80, v81, 1.0
    v_fma_f32 v81, v82, v81, v81
    v_mul_f32 v16, v16, v81
    v_mul_f32 v17, v17, v81
    v_mul_f32 v18, v18, v81
    v_mul_f32 v19, v19, v81
    v_mul_f32 v20, v20, v81
    v_mul_f32 v21, v21, v81
    v_mul_f32 v22, v22, v81
    v_mul_f32 v23, v23, v81
    v_cvt_pk_bf16_f32 v40, v16, v17
    v_cvt_pk_bf16_f32 v41, v18, v19
    v_cvt_pk_bf16_f32 v36, v20, v21
    v_cvt_pk_bf16_f32 v37, v22, v23
    v_mov_b32 v38, 0
    v_mov_b32 v39, 0
    v_cvt_pk_bf16_f32 v80, v24, v25
    v_lshlrev_b32 v24, 16, v80
    v_and_b32 v25, 0xffff0000, v80
    v_mul_f32 v24, s56, v24
    v_mul_f32 v25, s56, v25
    v_cvt_pk_bf16_f32 v80, v24, v25
    v_lshlrev_b32 v24, 16, v80
    v_and_b32 v25, 0xffff0000, v80
    v_cvt_pk_bf16_f32 v80, v26, v27
    v_lshlrev_b32 v26, 16, v80
    v_and_b32 v27, 0xffff0000, v80
    v_mul_f32 v26, s56, v26
    v_mul_f32 v27, s56, v27
    v_cvt_pk_bf16_f32 v80, v26, v27
    v_lshlrev_b32 v26, 16, v80
    v_and_b32 v27, 0xffff0000, v80
    v_cvt_pk_bf16_f32 v80, v28, v29
    v_lshlrev_b32 v28, 16, v80
    v_and_b32 v29, 0xffff0000, v80
    v_mul_f32 v28, s56, v28
    v_mul_f32 v29, s56, v29
    v_cvt_pk_bf16_f32 v80, v28, v29
    v_lshlrev_b32 v28, 16, v80
    v_and_b32 v29, 0xffff0000, v80
    v_cvt_pk_bf16_f32 v80, v30, v31
    v_lshlrev_b32 v30, 16, v80
    v_and_b32 v31, 0xffff0000, v80
    v_mul_f32 v30, s56, v30
    v_mul_f32 v31, s56, v31
    v_cvt_pk_bf16_f32 v80, v30, v31
    v_lshlrev_b32 v30, 16, v80
    v_and_b32 v31, 0xffff0000, v80
    v_cvt_pk_bf16_f32 v80, v32, v33
    v_lshlrev_b32 v32, 16, v80
    v_and_b32 v33, 0xffff0000, v80
    v_mul_f32 v32, s56, v32
    v_mul_f32 v33, s56, v33
    v_cvt_pk_bf16_f32 v80, v32, v33
    v_lshlrev_b32 v32, 16, v80
    v_and_b32 v33, 0xffff0000, v80
    v_cvt_pk_bf16_f32 v80, v34, v35
    v_lshlrev_b32 v34, 16, v80
    v_and_b32 v35, 0xffff0000, v80
    v_mul_f32 v34, s56, v34
    v_mul_f32 v35, s56, v35
    v_cvt_pk_bf16_f32 v80, v34, v35
    v_lshlrev_b32 v34, 16, v80
    v_and_b32 v35, 0xffff0000, v80
    v_mov_b32 v80, 0xff800000
    v_cndmask_b32 v24, v80, v24, s[52:53]
    v_cndmask_b32 v32, v80, v32, s[60:61]
    v_cndmask_b32 v25, v80, v25, s[52:53]
    v_cndmask_b32 v33, v80, v33, s[62:63]
    v_cndmask_b32 v26, v80, v26, s[52:53]
    v_cndmask_b32 v34, v80, v34, s[64:65]
    v_cndmask_b32 v27, v80, v27, s[52:53]
    v_cndmask_b32 v35, v80, v35, s[66:67]
    v_max_f32 v80, v24, v25
    v_max3_f32 v80, v80, v26, v27
    v_max3_f32 v80, v80, v28, v29
    v_max3_f32 v80, v80, v30, v31
    v_max3_f32 v80, v80, v32, v33
    v_max3_f32 v80, v80, v34, v35
    v_mov_b32 v81, v80
    v_mov_b32 v82, v80
    s_nop 1
    v_permlane16_swap_b32 v81, v82
    v_max_f32 v80, v81, v82
    v_mov_b32 v81, v80
    v_mov_b32 v82, v80
    s_nop 1
    v_permlane32_swap_b32 v81, v82
    v_max_f32 v80, v81, v82
    v_sub_f32 v24, v24, v80
    v_mul_f32 v24, s57, v24
    v_exp_f32 v24, v24
    v_sub_f32 v25, v25, v80
    v_mul_f32 v25, s57, v25
    v_exp_f32 v25, v25
    v_sub_f32 v26, v26, v80
    v_mul_f32 v26, s57, v26
    v_exp_f32 v26, v26
    v_sub_f32 v27, v27, v80
    v_mul_f32 v27, s57, v27
    v_exp_f32 v27, v27
    v_sub_f32 v28, v28, v80
    v_mul_f32 v28, s57, v28
    v_exp_f32 v28, v28
    v_sub_f32 v29, v29, v80
    v_mul_f32 v29, s57, v29
    v_exp_f32 v29, v29
    v_sub_f32 v30, v30, v80
    v_mul_f32 v30, s57, v30
    v_exp_f32 v30, v30
    v_sub_f32 v31, v31, v80
    v_mul_f32 v31, s57, v31
    v_exp_f32 v31, v31
    v_sub_f32 v32, v32, v80
    v_mul_f32 v32, s57, v32
    v_exp_f32 v32, v32
    v_sub_f32 v33, v33, v80
    v_mul_f32 v33, s57, v33
    v_exp_f32 v33, v33
    v_sub_f32 v34, v34, v80
    v_mul_f32 v34, s57, v34
    v_exp_f32 v34, v34
    v_sub_f32 v35, v35, v80
    v_mul_f32 v35, s57, v35
    v_exp_f32 v35, v35
    v_add_f32 v80, v24, v25
    v_add_f32 v80, v80, v26
    v_add_f32 v80, v80, v27
    v_add_f32 v80, v80, v28
    v_add_f32 v80, v80, v29
    v_add_f32 v80, v80, v30
    v_add_f32 v80, v80, v31
    v_add_f32 v80, v80, v32
    v_add_f32 v80, v80, v33
    v_add_f32 v80, v80, v34
    v_add_f32 v80, v80, v35
    v_mov_b32 v81, v80
    v_mov_b32 v82, v80
    s_nop 1
    v_permlane16_swap_b32 v81, v82
    v_add_f32 v80, v81, v82
    v_mov_b32 v81, v80
    v_mov_b32 v82, v80
    s_nop 1
    v_permlane32_swap_b32 v81, v82
    v_add_f32 v80, v81, v82
    v_rcp_f32 v81, v80
    s_nop 0
    v_fma_f32 v82, -v80, v81, 1.0
    v_fma_f32 v81, v82, v81, v81
    v_mul_f32 v24, v24, v81
    v_mul_f32 v25, v25, v81
    v_mul_f32 v26, v26, v81
    v_mul_f32 v27, v27, v81
    v_mul_f32 v28, v28, v81
    v_mul_f32 v29, v29, v81
    v_mul_f32 v30, v30, v81
    v_mul_f32 v31, v31, v81
    v_mul_f32 v32, v32, v81
    v_mul_f32 v33, v33, v81
    v_mul_f32 v34, v34, v81
    v_mul_f32 v35, v35, v81
    v_cvt_pk_bf16_f32 v46, v24, v25
    v_cvt_pk_bf16_f32 v47, v26, v27
    v_cvt_pk_bf16_f32 v42, v28, v29
    v_cvt_pk_bf16_f32 v43, v30, v31
    v_cvt_pk_bf16_f32 v44, v32, v33
    v_cvt_pk_bf16_f32 v45, v34, v35
    v_mfma_f32_16x16x32_bf16 v[16:19], a[208:211], v[36:39], 0
    s_nop 0
    v_mfma_f32_16x16x32_bf16 v[20:23], a[208:211], v[42:45], 0
    v_mfma_f32_16x16x32_bf16 v[24:27], a[212:215], v[36:39], 0
    v_mfma_f32_16x16x32_bf16 v[28:31], a[212:215], v[42:45], 0
    s_nop 3
    v_mfma_f32_16x16x16_bf16 v[16:19], a[240:241], v[40:41], v[16:19]
    s_nop 0
    v_mfma_f32_16x16x16_bf16 v[20:23], a[240:241], v[46:47], v[20:23]
    v_mfma_f32_16x16x16_bf16 v[24:27], a[242:243], v[40:41], v[24:27]
    v_mfma_f32_16x16x16_bf16 v[28:31], a[242:243], v[46:47], v[28:31]
    s_nop 3
    v_cvt_pk_bf16_f32 v48, v16, v17
    v_cvt_pk_bf16_f32 v49, v18, v19
    v_cvt_pk_bf16_f32 v52, v20, v21
    v_cvt_pk_bf16_f32 v53, v22, v23
    v_cvt_pk_bf16_f32 v50, v24, v25
    v_cvt_pk_bf16_f32 v51, v26, v27
    v_cvt_pk_bf16_f32 v54, v28, v29
    v_cvt_pk_bf16_f32 v55, v30, v31
    v_mfma_f32_16x16x32_bf16 v[16:19], a[216:219], v[36:39], 0
    v_mfma_f32_16x16x32_bf16 v[20:23], a[216:219], v[42:45], 0
    v_mfma_f32_16x16x32_bf16 v[24:27], a[220:223], v[36:39], 0
    v_mfma_f32_16x16x32_bf16 v[28:31], a[220:223], v[42:45], 0
    s_nop 4
    v_mfma_f32_16x16x16_bf16 v[16:19], a[244:245], v[40:41], v[16:19]
    v_mfma_f32_16x16x16_bf16 v[20:23], a[244:245], v[46:47], v[20:23]
    v_mfma_f32_16x16x16_bf16 v[24:27], a[246:247], v[40:41], v[24:27]
    v_mfma_f32_16x16x16_bf16 v[28:31], a[246:247], v[46:47], v[28:31]
    s_nop 4
    v_cvt_pk_bf16_f32 v56, v16, v17
    v_cvt_pk_bf16_f32 v57, v18, v19
    v_cvt_pk_bf16_f32 v60, v20, v21
    v_cvt_pk_bf16_f32 v61, v22, v23
    v_cvt_pk_bf16_f32 v58, v24, v25
    v_cvt_pk_bf16_f32 v59, v26, v27
    v_cvt_pk_bf16_f32 v62, v28, v29
    v_cvt_pk_bf16_f32 v63, v30, v31
    v_mfma_f32_16x16x32_bf16 v[16:19], a[224:227], v[36:39], 0
    v_mfma_f32_16x16x32_bf16 v[20:23], a[224:227], v[42:45], 0
    v_mfma_f32_16x16x32_bf16 v[24:27], a[228:231], v[36:39], 0
    v_mfma_f32_16x16x32_bf16 v[28:31], a[228:231], v[42:45], 0
    s_nop 4
    v_mfma_f32_16x16x16_bf16 v[16:19], a[248:249], v[40:41], v[16:19]
    v_mfma_f32_16x16x16_bf16 v[20:23], a[248:249], v[46:47], v[20:23]
    v_mfma_f32_16x16x16_bf16 v[24:27], a[250:251], v[40:41], v[24:27]
    v_mfma_f32_16x16x16_bf16 v[28:31], a[250:251], v[46:47], v[28:31]
    s_nop 4
    v_cvt_pk_bf16_f32 v64, v16, v17
    v_cvt_pk_bf16_f32 v65, v18, v19
    v_cvt_pk_bf16_f32 v68, v20, v21
    v_cvt_pk_bf16_f32 v69, v22, v23
    v_cvt_pk_bf16_f32 v66, v24, v25
    v_cvt_pk_bf16_f32 v67, v26, v27
    v_cvt_pk_bf16_f32 v70, v28, v29
    v_cvt_pk_bf16_f32 v71, v30, v31
    v_mfma_f32_16x16x32_bf16 v[16:19], a[232:235], v[36:39], 0
    v_mfma_f32_16x16x32_bf16 v[20:23], a[232:235], v[42:45], 0
    v_mfma_f32_16x16x32_bf16 v[24:27], a[236:239], v[36:39], 0
    v_mfma_f32_16x16x32_bf16 v[28:31], a[236:239], v[42:45], 0
    s_nop 4
    v_mfma_f32_16x16x16_bf16 v[16:19], a[252:253], v[40:41], v[16:19]
    v_mfma_f32_16x16x16_bf16 v[20:23], a[252:253], v[46:47], v[20:23]
    v_mfma_f32_16x16x16_bf16 v[24:27], a[254:255], v[40:41], v[24:27]
    v_mfma_f32_16x16x16_bf16 v[28:31], a[254:255], v[46:47], v[28:31]
    s_nop 4
    v_cvt_pk_bf16_f32 v72, v16, v17
    v_cvt_pk_bf16_f32 v73, v18, v19
    v_cvt_pk_bf16_f32 v76, v20, v21
    v_cvt_pk_bf16_f32 v77, v22, v23
    v_cvt_pk_bf16_f32 v74, v24, v25
    v_cvt_pk_bf16_f32 v75, v26, v27
    v_cvt_pk_bf16_f32 v78, v28, v29
    v_cvt_pk_bf16_f32 v79, v30, v31
    s_mul_i32 s49, s36, 81920
    s_add_u32 s49, s49, 10485760
    s_mul_i32 s47, s71, 10240
    s_add_u32 s49, s49, s47
    s_waitcnt vmcnt(19)
    v_mfma_f32_16x16x32_bf16 a[0:3], v[88:91], v[48:51], 0
    v_mfma_f32_16x16x32_bf16 a[4:7], v[88:91], v[52:55], 0
    s_add_u32 s47, s48, 2048
    buffer_load_dwordx4 v[88:91], v4, s[32:35], s47 offen
    s_waitcnt vmcnt(19)
    v_mfma_f32_16x16x32_bf16 a[8:11], v[92:95], v[48:51], 0
    v_mfma_f32_16x16x32_bf16 a[12:15], v[92:95], v[52:55], 0
    s_add_u32 s47, s48, 133120
    buffer_load_dwordx4 v[92:95], v4, s[32:35], s47 offen
    s_waitcnt vmcnt(19)
    v_mfma_f32_16x16x32_bf16 a[16:19], v[96:99], v[48:51], 0
    v_mfma_f32_16x16x32_bf16 a[20:23], v[96:99], v[52:55], 0
    s_add_u32 s47, s48, 264192
    buffer_load_dwordx4 v[96:99], v4, s[32:35], s47 offen
    s_waitcnt vmcnt(19)
    v_mfma_f32_16x16x32_bf16 a[24:27], v[100:103], v[48:51], 0
    v_mfma_f32_16x16x32_bf16 a[28:31], v[100:103], v[52:55], 0
    s_add_u32 s47, s48, 395264
    buffer_load_dwordx4 v[100:103], v4, s[32:35], s47 offen
    s_waitcnt vmcnt(19)
    v_mfma_f32_16x16x32_bf16 a[32:35], v[104:107], v[48:51], 0
    v_mfma_f32_16x16x32_bf16 a[36:39], v[104:107], v[52:55], 0
    s_add_u32 s47, s48, 526336
    buffer_load_dwordx4 v[104:107], v4, s[32:35], s47 offen
    s_waitcnt vmcnt(19)
    v_mfma_f32_16x16x32_bf16 a[40:43], v[108:111], v[48:51], 0
    v_mfma_f32_16x16x32_bf16 a[44:47], v[108:111], v[52:55], 0
    s_add_u32 s47, s48, 657408
    buffer_load_dwordx4 v[108:111], v4, s[32:35], s47 offen
    s_waitcnt vmcnt(19)
    v_mfma_f32_16x16x32_bf16 a[48:51], v[112:115], v[48:51], 0
    v_mfma_f32_16x16x32_bf16 a[52:55], v[112:115], v[52:55], 0
    s_add_u32 s47, s48, 788480
    buffer_load_dwordx4 v[112:115], v4, s[32:35], s47 offen
    s_waitcnt vmcnt(19)
    v_mfma_f32_16x16x32_bf16 a[56:59], v[116:119], v[48:51], 0
    v_mfma_f32_16x16x32_bf16 a[60:63], v[116:119], v[52:55], 0
    s_add_u32 s47, s48, 919552
    buffer_load_dwordx4 v[116:119], v4, s[32:35], s47 offen
    s_waitcnt vmcnt(19)
    v_mfma_f32_16x16x32_bf16 a[64:67], v[120:123], v[48:51], 0
    v_mfma_f32_16x16x32_bf16 a[68:71], v[120:123], v[52:55], 0
    s_add_u32 s47, s48, 1050624
    buffer_load_dwordx4 v[120:123], v4, s[32:35], s47 offen
    s_waitcnt vmcnt(19)
    v_mfma_f32_16x16x32_bf16 a[72:75], v[124:127], v[48:51], 0
    v_mfma_f32_16x16x32_bf16 a[76:79], v[124:127], v[52:55], 0
    s_add_u32 s47, s48, 1181696
    buffer_load_dwordx4 v[124:127], v4, s[32:35], s47 offen
    s_waitcnt vmcnt(19)
    v_mfma_f32_16x16x32_bf16 a[0:3], v[128:131], v[56:59], a[0:3]
    v_mfma_f32_16x16x32_bf16 a[4:7], v[128:131], v[60:63], a[4:7]
    s_add_u32 s47, s48, 3072
    buffer_load_dwordx4 v[128:131], v4, s[32:35], s47 offen
    s_waitcnt vmcnt(19)
    v_mfma_f32_16x16x32_bf16 a[8:11], v[132:135], v[56:59], a[8:11]
    v_mfma_f32_16x16x32_bf16 a[12:15], v[132:135], v[60:63], a[12:15]
    s_add_u32 s47, s48, 134144
    buffer_load_dwordx4 v[132:135], v4, s[32:35], s47 offen
    s_waitcnt vmcnt(19)
    v_mfma_f32_16x16x32_bf16 a[16:19], v[136:139], v[56:59], a[16:19]
    v_mfma_f32_16x16x32_bf16 a[20:23], v[136:139], v[60:63], a[20:23]
    s_add_u32 s47, s48, 265216
    buffer_load_dwordx4 v[136:139], v4, s[32:35], s47 offen
    s_waitcnt vmcnt(19)
    v_mfma_f32_16x16x32_bf16 a[24:27], v[140:143], v[56:59], a[24:27]
    v_mfma_f32_16x16x32_bf16 a[28:31], v[140:143], v[60:63], a[28:31]
    s_add_u32 s47, s48, 396288
    buffer_load_dwordx4 v[140:143], v4, s[32:35], s47 offen
    s_waitcnt vmcnt(19)
    v_mfma_f32_16x16x32_bf16 a[32:35], v[144:147], v[56:59], a[32:35]
    v_mfma_f32_16x16x32_bf16 a[36:39], v[144:147], v[60:63], a[36:39]
    s_add_u32 s47, s48, 527360
    buffer_load_dwordx4 v[144:147], v4, s[32:35], s47 offen
    s_waitcnt vmcnt(19)
    v_mfma_f32_16x16x32_bf16 a[40:43], v[148:151], v[56:59], a[40:43]
    v_mfma_f32_16x16x32_bf16 a[44:47], v[148:151], v[60:63], a[44:47]
    s_add_u32 s47, s48, 658432
    buffer_load_dwordx4 v[148:151], v4, s[32:35], s47 offen
    s_waitcnt vmcnt(19)
    v_mfma_f32_16x16x32_bf16 a[48:51], v[152:155], v[56:59], a[48:51]
    v_mfma_f32_16x16x32_bf16 a[52:55], v[152:155], v[60:63], a[52:55]
    s_add_u32 s47, s48, 789504
    buffer_load_dwordx4 v[152:155], v4, s[32:35], s47 offen
    s_waitcnt vmcnt(19)
    v_mfma_f32_16x16x32_bf16 a[56:59], v[156:159], v[56:59], a[56:59]
    v_mfma_f32_16x16x32_bf16 a[60:63], v[156:159], v[60:63], a[60:63]
    s_add_u32 s47, s48, 920576
    buffer_load_dwordx4 v[156:159], v4, s[32:35], s47 offen
    s_waitcnt vmcnt(19)
    v_mfma_f32_16x16x32_bf16 a[64:67], v[160:163], v[56:59], a[64:67]
    v_mfma_f32_16x16x32_bf16 a[68:71], v[160:163], v[60:63], a[68:71]
    s_add_u32 s47, s48, 1051648
    buffer_load_dwordx4 v[160:163], v4, s[32:35], s47 offen
    s_waitcnt vmcnt(19)
    v_mfma_f32_16x16x32_bf16 a[72:75], v[164:167], v[56:59], a[72:75]
    v_mfma_f32_16x16x32_bf16 a[76:79], v[164:167], v[60:63], a[76:79]
    s_add_u32 s47, s48, 1182720
    buffer_load_dwordx4 v[164:167], v4, s[32:35], s47 offen
    s_waitcnt vmcnt(19)
    v_mfma_f32_16x16x32_bf16 a[0:3], v[88:91], v[64:67], a[0:3]
    v_mfma_f32_16x16x32_bf16 a[4:7], v[88:91], v[68:71], a[4:7]
    s_waitcnt vmcnt(18)
    v_mfma_f32_16x16x32_bf16 a[8:11], v[92:95], v[64:67], a[8:11]
    v_mfma_f32_16x16x32_bf16 a[12:15], v[92:95], v[68:71], a[12:15]
    s_waitcnt vmcnt(17)
    v_mfma_f32_16x16x32_bf16 a[16:19], v[96:99], v[64:67], a[16:19]
    v_mfma_f32_16x16x32_bf16 a[20:23], v[96:99], v[68:71], a[20:23]
    s_waitcnt vmcnt(16)
    v_mfma_f32_16x16x32_bf16 a[24:27], v[100:103], v[64:67], a[24:27]
    v_mfma_f32_16x16x32_bf16 a[28:31], v[100:103], v[68:71], a[28:31]
    s_waitcnt vmcnt(15)
    v_mfma_f32_16x16x32_bf16 a[32:35], v[104:107], v[64:67], a[32:35]
    v_mfma_f32_16x16x32_bf16 a[36:39], v[104:107], v[68:71], a[36:39]
    s_waitcnt vmcnt(14)
    v_mfma_f32_16x16x32_bf16 a[40:43], v[108:111], v[64:67], a[40:43]
    v_mfma_f32_16x16x32_bf16 a[44:47], v[108:111], v[68:71], a[44:47]
    s_waitcnt vmcnt(13)
    v_mfma_f32_16x16x32_bf16 a[48:51], v[112:115], v[64:67], a[48:51]
    v_mfma_f32_16x16x32_bf16 a[52:55], v[112:115], v[68:71], a[52:55]
    s_waitcnt vmcnt(12)
    v_mfma_f32_16x16x32_bf16 a[56:59], v[116:119], v[64:67], a[56:59]
    v_mfma_f32_16x16x32_bf16 a[60:63], v[116:119], v[68:71], a[60:63]
    s_waitcnt vmcnt(11)
    v_mfma_f32_16x16x32_bf16 a[64:67], v[120:123], v[64:67], a[64:67]
    v_mfma_f32_16x16x32_bf16 a[68:71], v[120:123], v[68:71], a[68:71]
    s_waitcnt vmcnt(10)
    v_mfma_f32_16x16x32_bf16 a[72:75], v[124:127], v[64:67], a[72:75]
    v_mfma_f32_16x16x32_bf16 a[76:79], v[124:127], v[68:71], a[76:79]
    s_waitcnt vmcnt(9)
    v_mfma_f32_16x16x32_bf16 a[0:3], v[128:131], v[72:75], a[0:3]
    v_mfma_f32_16x16x32_bf16 a[4:7], v[128:131], v[76:79], a[4:7]
    s_waitcnt vmcnt(8)
    v_mfma_f32_16x16x32_bf16 a[8:11], v[132:135], v[72:75], a[8:11]
    v_mfma_f32_16x16x32_bf16 a[12:15], v[132:135], v[76:79], a[12:15]
    s_waitcnt vmcnt(7)
    v_mfma_f32_16x16x32_bf16 a[16:19], v[136:139], v[72:75], a[16:19]
    v_mfma_f32_16x16x32_bf16 a[20:23], v[136:139], v[76:79], a[20:23]
    s_waitcnt vmcnt(6)
    v_mfma_f32_16x16x32_bf16 a[24:27], v[140:143], v[72:75], a[24:27]
    v_mfma_f32_16x16x32_bf16 a[28:31], v[140:143], v[76:79], a[28:31]
    s_waitcnt vmcnt(5)
    v_mfma_f32_16x16x32_bf16 a[32:35], v[144:147], v[72:75], a[32:35]
    v_mfma_f32_16x16x32_bf16 a[36:39], v[144:147], v[76:79], a[36:39]
    s_waitcnt vmcnt(4)
    v_mfma_f32_16x16x32_bf16 a[40:43], v[148:151], v[72:75], a[40:43]
    v_mfma_f32_16x16x32_bf16 a[44:47], v[148:151], v[76:79], a[44:47]
    s_waitcnt vmcnt(3)
    v_mfma_f32_16x16x32_bf16 a[48:51], v[152:155], v[72:75], a[48:51]
    v_mfma_f32_16x16x32_bf16 a[52:55], v[152:155], v[76:79], a[52:55]
    s_waitcnt vmcnt(2)
    v_mfma_f32_16x16x32_bf16 a[56:59], v[156:159], v[72:75], a[56:59]
    v_mfma_f32_16x16x32_bf16 a[60:63], v[156:159], v[76:79], a[60:63]
    s_waitcnt vmcnt(1)
    v_mfma_f32_16x16x32_bf16 a[64:67], v[160:163], v[72:75], a[64:67]
    v_mfma_f32_16x16x32_bf16 a[68:71], v[160:163], v[76:79], a[68:71]
    s_waitcnt vmcnt(0)
    v_mfma_f32_16x16x32_bf16 a[72:75], v[164:167], v[72:75], a[72:75]
    v_mfma_f32_16x16x32_bf16 a[76:79], v[164:167], v[76:79], a[76:79]
    s_add_u32 s48, s48, 1310720
    ds_write_b128 v6, a[0:3] offset:0
    ds_write_b128 v6, a[4:7] offset:1024
    ds_write_b128 v6, a[8:11] offset:2048
    ds_write_b128 v6, a[12:15] offset:3072
    ds_write_b128 v6, a[16:19] offset:4096
    ds_write_b128 v6, a[20:23] offset:5120
    ds_write_b128 v6, a[24:27] offset:6144
    ds_write_b128 v6, a[28:31] offset:7168
    ds_write_b128 v6, a[32:35] offset:8192
    ds_write_b128 v6, a[36:39] offset:9216
    ds_write_b128 v6, a[40:43] offset:10240
    ds_write_b128 v6, a[44:47] offset:11264
    ds_write_b128 v6, a[48:51] offset:12288
    ds_write_b128 v6, a[52:55] offset:13312
    ds_write_b128 v6, a[56:59] offset:14336
    ds_write_b128 v6, a[60:63] offset:15360
    ds_write_b128 v6, a[64:67] offset:16384
    ds_write_b128 v6, a[68:71] offset:17408
    ds_write_b128 v6, a[72:75] offset:18432
    ds_write_b128 v6, a[76:79] offset:19456
    s_waitcnt lgkmcnt(0)
    s_barrier
    ds_read_b128 v[16:19], v7 offset:0
    ds_read_b128 v[20:23], v7 offset:20480
    ds_read_b128 v[24:27], v11 offset:0
    ds_read_b128 v[28:31], v11 offset:20480
    s_mul_i32 s40, s3, 5
    s_add_u32 s40, s40, 0
    s_lshr_b32 s41, s40, 1
    s_and_b32 s42, s40, 1
    s_mul_i32 s42, s42, 40
    s_add_u32 s42, s42, s41
    s_add_u32 s42, s42, 0
    s_lshl_b32 s42, s42, 10
    s_add_u32 s42, s42, s49
    s_waitcnt lgkmcnt(0)
    v_add_f32 v16, v16, v20
    v_add_f32 v24, v24, v28
    v_add_f32 v80, v16, v24
    v_add_f32 v17, v17, v21
    v_add_f32 v25, v25, v29
    v_add_f32 v81, v17, v25
    v_add_f32 v18, v18, v22
    v_add_f32 v26, v26, v30
    v_add_f32 v82, v18, v26
    v_add_f32 v19, v19, v23
    v_add_f32 v27, v27, v31
    v_add_f32 v83, v19, v27
    buffer_atomic_add_f32 v80, v12, s[32:35], s42 offen offset:0
    buffer_atomic_add_f32 v81, v12, s[32:35], s42 offen offset:256
    buffer_atomic_add_f32 v82, v12, s[32:35], s42 offen offset:512
    buffer_atomic_add_f32 v83, v12, s[32:35], s42 offen offset:768
    ds_read_b128 v[16:19], v7 offset:1024
    ds_read_b128 v[20:23], v7 offset:21504
    ds_read_b128 v[24:27], v11 offset:1024
    ds_read_b128 v[28:31], v11 offset:21504
    s_mul_i32 s40, s3, 5
    s_add_u32 s40, s40, 1
    s_lshr_b32 s41, s40, 1
    s_and_b32 s42, s40, 1
    s_mul_i32 s42, s42, 40
    s_add_u32 s42, s42, s41
    s_add_u32 s42, s42, 0
    s_lshl_b32 s42, s42, 10
    s_add_u32 s42, s42, s49
    s_waitcnt lgkmcnt(0)
    v_add_f32 v16, v16, v20
    v_add_f32 v24, v24, v28
    v_add_f32 v80, v16, v24
    v_add_f32 v17, v17, v21
    v_add_f32 v25, v25, v29
    v_add_f32 v81, v17, v25
    v_add_f32 v18, v18, v22
    v_add_f32 v26, v26, v30
    v_add_f32 v82, v18, v26
    v_add_f32 v19, v19, v23
    v_add_f32 v27, v27, v31
    v_add_f32 v83, v19, v27
    buffer_atomic_add_f32 v80, v12, s[32:35], s42 offen offset:0
    buffer_atomic_add_f32 v81, v12, s[32:35], s42 offen offset:256
    buffer_atomic_add_f32 v82, v12, s[32:35], s42 offen offset:512
    buffer_atomic_add_f32 v83, v12, s[32:35], s42 offen offset:768
    ds_read_b128 v[16:19], v7 offset:2048
    ds_read_b128 v[20:23], v7 offset:22528
    ds_read_b128 v[24:27], v11 offset:2048
    ds_read_b128 v[28:31], v11 offset:22528
    s_mul_i32 s40, s3, 5
    s_add_u32 s40, s40, 2
    s_lshr_b32 s41, s40, 1
    s_and_b32 s42, s40, 1
    s_mul_i32 s42, s42, 40
    s_add_u32 s42, s42, s41
    s_add_u32 s42, s42, 0
    s_lshl_b32 s42, s42, 10
    s_add_u32 s42, s42, s49
    s_waitcnt lgkmcnt(0)
    v_add_f32 v16, v16, v20
    v_add_f32 v24, v24, v28
    v_add_f32 v80, v16, v24
    v_add_f32 v17, v17, v21
    v_add_f32 v25, v25, v29
    v_add_f32 v81, v17, v25
    v_add_f32 v18, v18, v22
    v_add_f32 v26, v26, v30
    v_add_f32 v82, v18, v26
    v_add_f32 v19, v19, v23
    v_add_f32 v27, v27, v31
    v_add_f32 v83, v19, v27
    buffer_atomic_add_f32 v80, v12, s[32:35], s42 offen offset:0
    buffer_atomic_add_f32 v81, v12, s[32:35], s42 offen offset:256
    buffer_atomic_add_f32 v82, v12, s[32:35], s42 offen offset:512
    buffer_atomic_add_f32 v83, v12, s[32:35], s42 offen offset:768
    ds_read_b128 v[16:19], v7 offset:3072
    ds_read_b128 v[20:23], v7 offset:23552
    ds_read_b128 v[24:27], v11 offset:3072
    ds_read_b128 v[28:31], v11 offset:23552
    s_mul_i32 s40, s3, 5
    s_add_u32 s40, s40, 3
    s_lshr_b32 s41, s40, 1
    s_and_b32 s42, s40, 1
    s_mul_i32 s42, s42, 40
    s_add_u32 s42, s42, s41
    s_add_u32 s42, s42, 0
    s_lshl_b32 s42, s42, 10
    s_add_u32 s42, s42, s49
    s_waitcnt lgkmcnt(0)
    v_add_f32 v16, v16, v20
    v_add_f32 v24, v24, v28
    v_add_f32 v80, v16, v24
    v_add_f32 v17, v17, v21
    v_add_f32 v25, v25, v29
    v_add_f32 v81, v17, v25
    v_add_f32 v18, v18, v22
    v_add_f32 v26, v26, v30
    v_add_f32 v82, v18, v26
    v_add_f32 v19, v19, v23
    v_add_f32 v27, v27, v31
    v_add_f32 v83, v19, v27
    buffer_atomic_add_f32 v80, v12, s[32:35], s42 offen offset:0
    buffer_atomic_add_f32 v81, v12, s[32:35], s42 offen offset:256
    buffer_atomic_add_f32 v82, v12, s[32:35], s42 offen offset:512
    buffer_atomic_add_f32 v83, v12, s[32:35], s42 offen offset:768
    ds_read_b128 v[16:19], v7 offset:4096
    ds_read_b128 v[20:23], v7 offset:24576
    ds_read_b128 v[24:27], v11 offset:4096
    ds_read_b128 v[28:31], v11 offset:24576
    s_mul_i32 s40, s3, 5
    s_add_u32 s40, s40, 4
    s_lshr_b32 s41, s40, 1
    s_and_b32 s42, s40, 1
    s_mul_i32 s42, s42, 40
    s_add_u32 s42, s42, s41
    s_add_u32 s42, s42, 0
    s_lshl_b32 s42, s42, 10
    s_add_u32 s42, s42, s49
    s_waitcnt lgkmcnt(0)
    v_add_f32 v16, v16, v20
    v_add_f32 v24, v24, v28
    v_add_f32 v80, v16, v24
    v_add_f32 v17, v17, v21
    v_add_f32 v25, v25, v29
    v_add_f32 v81, v17, v25
    v_add_f32 v18, v18, v22
    v_add_f32 v26, v26, v30
    v_add_f32 v82, v18, v26
    v_add_f32 v19, v19, v23
    v_add_f32 v27, v27, v31
    v_add_f32 v83, v19, v27
    buffer_atomic_add_f32 v80, v12, s[32:35], s42 offen offset:0
    buffer_atomic_add_f32 v81, v12, s[32:35], s42 offen offset:256
    buffer_atomic_add_f32 v82, v12, s[32:35], s42 offen offset:512
    buffer_atomic_add_f32 v83, v12, s[32:35], s42 offen offset:768
    s_barrier
p2_next:
    s_add_u32 s70, s70, 144
    s_cmp_lt_u32 s70, 608
    s_cbranch_scc1 p2_task
    s_mov_b32 s40, 0
    s_endpgm
moe1_start:
    s_sub_u32 s36, s2, 144
    s_mov_b32 s24, s10
    s_and_b32 s25, s11, 0xffff
    s_mov_b32 s26, 2211840
    s_mov_b32 s27, 0x00020000
    s_mov_b32 s28, s14
    s_and_b32 s29, s15, 0xffff
    s_mov_b32 s30, 2211840
    s_mov_b32 s31, 0x00020000
    v_lshlrev_b32 v3, 2, v0
    s_mov_b32 s37, 3145728
    buffer_load_dword v10, v3, s[32:35], s37 offen
    s_add_u32 s37, s37, 1024
    buffer_load_dword v11, v3, s[32:35], s37 offen
    s_add_u32 s37, s37, 1024
    buffer_load_dword v12, v3, s[32:35], s37 offen
    s_add_u32 s37, s37, 1024
    buffer_load_dword v13, v3, s[32:35], s37 offen
    s_add_u32 s37, s37, 1024
    buffer_load_dword v14, v3, s[32:35], s37 offen
    s_add_u32 s37, s37, 1024
    buffer_load_dword v15, v3, s[32:35], s37 offen
    s_add_u32 s37, s37, 1024
    buffer_load_dword v16, v3, s[32:35], s37 offen
    s_add_u32 s37, s37, 1024
    buffer_load_dword v17, v3, s[32:35], s37 offen
    s_add_u32 s37, s37, 1024
    s_waitcnt vmcnt(0)
    v_mov_b32 v4, 0x80000000
    v_ashrrev_i32 v5, 31, v10
    v_or_b32 v5, v4, v5
    v_xor_b32 v10, v10, v5
    v_and_b32 v10, 0xffff0000, v10
    v_sub_u32 v5, 65535, v0
    v_or_b32 v10, v10, v5
    v_ashrrev_i32 v5, 31, v11
    v_or_b32 v5, v4, v5
    v_xor_b32 v11, v11, v5
    v_and_b32 v11, 0xffff0000, v11
    v_sub_u32 v5, 65279, v0
    v_or_b32 v11, v11, v5
    v_ashrrev_i32 v5, 31, v12
    v_or_b32 v5, v4, v5
    v_xor_b32 v12, v12, v5
    v_and_b32 v12, 0xffff0000, v12
    v_sub_u32 v5, 65023, v0
    v_or_b32 v12, v12, v5
    v_ashrrev_i32 v5, 31, v13
    v_or_b32 v5, v4, v5
    v_xor_b32 v13, v13, v5
    v_and_b32 v13, 0xffff0000, v13
    v_sub_u32 v5, 64767, v0
    v_or_b32 v13, v13, v5
    v_ashrrev_i32 v5, 31, v14
    v_or_b32 v5, v4, v5
    v_xor_b32 v14, v14, v5
    v_and_b32 v14, 0xffff0000, v14
    v_sub_u32 v5, 64511, v0
    v_or_b32 v14, v14, v5
    v_ashrrev_i32 v5, 31, v15
    v_or_b32 v5, v4, v5
    v_xor_b32 v15, v15, v5
    v_and_b32 v15, 0xffff0000, v15
    v_sub_u32 v5, 64255, v0
    v_or_b32 v15, v15, v5
    v_ashrrev_i32 v5, 31, v16
    v_or_b32 v5, v4, v5
    v_xor_b32 v16, v16, v5
    v_and_b32 v16, 0xffff0000, v16
    v_sub_u32 v5, 63999, v0
    v_or_b32 v16, v16, v5
    v_ashrrev_i32 v5, 31, v17
    v_or_b32 v5, v4, v5
    v_xor_b32 v17, v17, v5
    v_and_b32 v17, 0xffff0000, v17
    v_sub_u32 v5, 63743, v0
    v_or_b32 v17, v17, v5
    v_lshlrev_b32 v6, 2, v2
    v_mov_b32 v7, 0
    v_max_u32 v5, v10, v11
    v_max3_u32 v5, v5, v12, v13
    v_max3_u32 v5, v5, v14, v15
    v_max3_u32 v5, v5, v16, v17
    s_nop 1
    v_max_u32_dpp v5, v5, v5 row_shr:1 row_mask:0xf bank_mask:0xf bound_ctrl:0
    s_nop 1
    v_max_u32_dpp v5, v5, v5 row_shr:2 row_mask:0xf bank_mask:0xf bound_ctrl:0
    s_nop 1
    v_max_u32_dpp v5, v5, v5 row_shr:4 row_mask:0xf bank_mask:0xf bound_ctrl:0
    s_nop 1
    v_max_u32_dpp v5, v5, v5 row_shr:8 row_mask:0xf bank_mask:0xf bound_ctrl:0
    s_nop 1
    v_max_u32_dpp v5, v5, v5 row_bcast:15 row_mask:0xa bank_mask:0xf
    s_nop 1
    v_max_u32_dpp v5, v5, v5 row_bcast:31 row_mask:0xc bank_mask:0xf
    s_nop 0
    v_readlane_b32 s38, v5, 63
    s_nop 1
    v_mov_b32 v5, s38
    ds_write_b32 v6, v5 offset:0
    s_waitcnt lgkmcnt(0)
    s_barrier
    ds_read_b128 v[20:23], v7 offset:0
    s_waitcnt lgkmcnt(0)
    v_max_u32 v5, v20, v21
    v_max3_u32 v5, v5, v22, v23
    v_cmp_eq_u32 vcc, v5, v10
    s_nop 1
    v_cndmask_b32 v10, v10, v7, vcc
    v_cmp_eq_u32 vcc, v5, v11
    s_nop 1
    v_cndmask_b32 v11, v11, v7, vcc
    v_cmp_eq_u32 vcc, v5, v12
    s_nop 1
    v_cndmask_b32 v12, v12, v7, vcc
    v_cmp_eq_u32 vcc, v5, v13
    s_nop 1
    v_cndmask_b32 v13, v13, v7, vcc
    v_cmp_eq_u32 vcc, v5, v14
    s_nop 1
    v_cndmask_b32 v14, v14, v7, vcc
    v_cmp_eq_u32 vcc, v5, v15
    s_nop 1
    v_cndmask_b32 v15, v15, v7, vcc
    v_cmp_eq_u32 vcc, v5, v16
    s_nop 1
    v_cndmask_b32 v16, v16, v7, vcc
    v_cmp_eq_u32 vcc, v5, v17
    s_nop 1
    v_cndmask_b32 v17, v17, v7, vcc
    v_and_b32 v5, 0xffff, v5
    v_sub_u32 v5, 0xffff, v5
    ds_write_b32 v7, v5 offset:256
    v_max_u32 v5, v10, v11
    v_max3_u32 v5, v5, v12, v13
    v_max3_u32 v5, v5, v14, v15
    v_max3_u32 v5, v5, v16, v17
    s_nop 1
    v_max_u32_dpp v5, v5, v5 row_shr:1 row_mask:0xf bank_mask:0xf bound_ctrl:0
    s_nop 1
    v_max_u32_dpp v5, v5, v5 row_shr:2 row_mask:0xf bank_mask:0xf bound_ctrl:0
    s_nop 1
    v_max_u32_dpp v5, v5, v5 row_shr:4 row_mask:0xf bank_mask:0xf bound_ctrl:0
    s_nop 1
    v_max_u32_dpp v5, v5, v5 row_shr:8 row_mask:0xf bank_mask:0xf bound_ctrl:0
    s_nop 1
    v_max_u32_dpp v5, v5, v5 row_bcast:15 row_mask:0xa bank_mask:0xf
    s_nop 1
    v_max_u32_dpp v5, v5, v5 row_bcast:31 row_mask:0xc bank_mask:0xf
    s_nop 0
    v_readlane_b32 s38, v5, 63
    s_nop 1
    v_mov_b32 v5, s38
    ds_write_b32 v6, v5 offset:16
    s_waitcnt lgkmcnt(0)
    s_barrier
    ds_read_b128 v[20:23], v7 offset:16
    s_waitcnt lgkmcnt(0)
    v_max_u32 v5, v20, v21
    v_max3_u32 v5, v5, v22, v23
    v_cmp_eq_u32 vcc, v5, v10
    s_nop 1
    v_cndmask_b32 v10, v10, v7, vcc
    v_cmp_eq_u32 vcc, v5, v11
    s_nop 1
    v_cndmask_b32 v11, v11, v7, vcc
    v_cmp_eq_u32 vcc, v5, v12
    s_nop 1
    v_cndmask_b32 v12, v12, v7, vcc
    v_cmp_eq_u32 vcc, v5, v13
    s_nop 1
    v_cndmask_b32 v13, v13, v7, vcc
    v_cmp_eq_u32 vcc, v5, v14
    s_nop 1
    v_cndmask_b32 v14, v14, v7, vcc
    v_cmp_eq_u32 vcc, v5, v15
    s_nop 1
    v_cndmask_b32 v15, v15, v7, vcc
    v_cmp_eq_u32 vcc, v5, v16
    s_nop 1
    v_cndmask_b32 v16, v16, v7, vcc
    v_cmp_eq_u32 vcc, v5, v17
    s_nop 1
    v_cndmask_b32 v17, v17, v7, vcc
    v_and_b32 v5, 0xffff, v5
    v_sub_u32 v5, 0xffff, v5
    ds_write_b32 v7, v5 offset:260
    v_max_u32 v5, v10, v11
    v_max3_u32 v5, v5, v12, v13
    v_max3_u32 v5, v5, v14, v15
    v_max3_u32 v5, v5, v16, v17
    s_nop 1
    v_max_u32_dpp v5, v5, v5 row_shr:1 row_mask:0xf bank_mask:0xf bound_ctrl:0
    s_nop 1
    v_max_u32_dpp v5, v5, v5 row_shr:2 row_mask:0xf bank_mask:0xf bound_ctrl:0
    s_nop 1
    v_max_u32_dpp v5, v5, v5 row_shr:4 row_mask:0xf bank_mask:0xf bound_ctrl:0
    s_nop 1
    v_max_u32_dpp v5, v5, v5 row_shr:8 row_mask:0xf bank_mask:0xf bound_ctrl:0
    s_nop 1
    v_max_u32_dpp v5, v5, v5 row_bcast:15 row_mask:0xa bank_mask:0xf
    s_nop 1
    v_max_u32_dpp v5, v5, v5 row_bcast:31 row_mask:0xc bank_mask:0xf
    s_nop 0
    v_readlane_b32 s38, v5, 63
    s_nop 1
    v_mov_b32 v5, s38
    ds_write_b32 v6, v5 offset:32
    s_waitcnt lgkmcnt(0)
    s_barrier
    ds_read_b128 v[20:23], v7 offset:32
    s_waitcnt lgkmcnt(0)
    v_max_u32 v5, v20, v21
    v_max3_u32 v5, v5, v22, v23
    v_cmp_eq_u32 vcc, v5, v10
    s_nop 1
    v_cndmask_b32 v10, v10, v7, vcc
    v_cmp_eq_u32 vcc, v5, v11
    s_nop 1
    v_cndmask_b32 v11, v11, v7, vcc
    v_cmp_eq_u32 vcc, v5, v12
    s_nop 1
    v_cndmask_b32 v12, v12, v7, vcc
    v_cmp_eq_u32 vcc, v5, v13
    s_nop 1
    v_cndmask_b32 v13, v13, v7, vcc
    v_cmp_eq_u32 vcc, v5, v14
    s_nop 1
    v_cndmask_b32 v14, v14, v7, vcc
    v_cmp_eq_u32 vcc, v5, v15
    s_nop 1
    v_cndmask_b32 v15, v15, v7, vcc
    v_cmp_eq_u32 vcc, v5, v16
    s_nop 1
    v_cndmask_b32 v16, v16, v7, vcc
    v_cmp_eq_u32 vcc, v5, v17
    s_nop 1
    v_cndmask_b32 v17, v17, v7, vcc
    v_and_b32 v5, 0xffff, v5
    v_sub_u32 v5, 0xffff, v5
    ds_write_b32 v7, v5 offset:264
    v_max_u32 v5, v10, v11
    v_max3_u32 v5, v5, v12, v13
    v_max3_u32 v5, v5, v14, v15
    v_max3_u32 v5, v5, v16, v17
    s_nop 1
    v_max_u32_dpp v5, v5, v5 row_shr:1 row_mask:0xf bank_mask:0xf bound_ctrl:0
    s_nop 1
    v_max_u32_dpp v5, v5, v5 row_shr:2 row_mask:0xf bank_mask:0xf bound_ctrl:0
    s_nop 1
    v_max_u32_dpp v5, v5, v5 row_shr:4 row_mask:0xf bank_mask:0xf bound_ctrl:0
    s_nop 1
    v_max_u32_dpp v5, v5, v5 row_shr:8 row_mask:0xf bank_mask:0xf bound_ctrl:0
    s_nop 1
    v_max_u32_dpp v5, v5, v5 row_bcast:15 row_mask:0xa bank_mask:0xf
    s_nop 1
    v_max_u32_dpp v5, v5, v5 row_bcast:31 row_mask:0xc bank_mask:0xf
    s_nop 0
    v_readlane_b32 s38, v5, 63
    s_nop 1
    v_mov_b32 v5, s38
    ds_write_b32 v6, v5 offset:48
    s_waitcnt lgkmcnt(0)
    s_barrier
    ds_read_b128 v[20:23], v7 offset:48
    s_waitcnt lgkmcnt(0)
    v_max_u32 v5, v20, v21
    v_max3_u32 v5, v5, v22, v23
    v_cmp_eq_u32 vcc, v5, v10
    s_nop 1
    v_cndmask_b32 v10, v10, v7, vcc
    v_cmp_eq_u32 vcc, v5, v11
    s_nop 1
    v_cndmask_b32 v11, v11, v7, vcc
    v_cmp_eq_u32 vcc, v5, v12
    s_nop 1
    v_cndmask_b32 v12, v12, v7, vcc
    v_cmp_eq_u32 vcc, v5, v13
    s_nop 1
    v_cndmask_b32 v13, v13, v7, vcc
    v_cmp_eq_u32 vcc, v5, v14
    s_nop 1
    v_cndmask_b32 v14, v14, v7, vcc
    v_cmp_eq_u32 vcc, v5, v15
    s_nop 1
    v_cndmask_b32 v15, v15, v7, vcc
    v_cmp_eq_u32 vcc, v5, v16
    s_nop 1
    v_cndmask_b32 v16, v16, v7, vcc
    v_cmp_eq_u32 vcc, v5, v17
    s_nop 1
    v_cndmask_b32 v17, v17, v7, vcc
    v_and_b32 v5, 0xffff, v5
    v_sub_u32 v5, 0xffff, v5
    ds_write_b32 v7, v5 offset:268
    v_max_u32 v5, v10, v11
    v_max3_u32 v5, v5, v12, v13
    v_max3_u32 v5, v5, v14, v15
    v_max3_u32 v5, v5, v16, v17
    s_nop 1
    v_max_u32_dpp v5, v5, v5 row_shr:1 row_mask:0xf bank_mask:0xf bound_ctrl:0
    s_nop 1
    v_max_u32_dpp v5, v5, v5 row_shr:2 row_mask:0xf bank_mask:0xf bound_ctrl:0
    s_nop 1
    v_max_u32_dpp v5, v5, v5 row_shr:4 row_mask:0xf bank_mask:0xf bound_ctrl:0
    s_nop 1
    v_max_u32_dpp v5, v5, v5 row_shr:8 row_mask:0xf bank_mask:0xf bound_ctrl:0
    s_nop 1
    v_max_u32_dpp v5, v5, v5 row_bcast:15 row_mask:0xa bank_mask:0xf
    s_nop 1
    v_max_u32_dpp v5, v5, v5 row_bcast:31 row_mask:0xc bank_mask:0xf
    s_nop 0
    v_readlane_b32 s38, v5, 63
    s_nop 1
    v_mov_b32 v5, s38
    ds_write_b32 v6, v5 offset:64
    s_waitcnt lgkmcnt(0)
    s_barrier
    ds_read_b128 v[20:23], v7 offset:64
    s_waitcnt lgkmcnt(0)
    v_max_u32 v5, v20, v21
    v_max3_u32 v5, v5, v22, v23
    v_cmp_eq_u32 vcc, v5, v10
    s_nop 1
    v_cndmask_b32 v10, v10, v7, vcc
    v_cmp_eq_u32 vcc, v5, v11
    s_nop 1
    v_cndmask_b32 v11, v11, v7, vcc
    v_cmp_eq_u32 vcc, v5, v12
    s_nop 1
    v_cndmask_b32 v12, v12, v7, vcc
    v_cmp_eq_u32 vcc, v5, v13
    s_nop 1
    v_cndmask_b32 v13, v13, v7, vcc
    v_cmp_eq_u32 vcc, v5, v14
    s_nop 1
    v_cndmask_b32 v14, v14, v7, vcc
    v_cmp_eq_u32 vcc, v5, v15
    s_nop 1
    v_cndmask_b32 v15, v15, v7, vcc
    v_cmp_eq_u32 vcc, v5, v16
    s_nop 1
    v_cndmask_b32 v16, v16, v7, vcc
    v_cmp_eq_u32 vcc, v5, v17
    s_nop 1
    v_cndmask_b32 v17, v17, v7, vcc
    v_and_b32 v5, 0xffff, v5
    v_sub_u32 v5, 0xffff, v5
    ds_write_b32 v7, v5 offset:272
    v_max_u32 v5, v10, v11
    v_max3_u32 v5, v5, v12, v13
    v_max3_u32 v5, v5, v14, v15
    v_max3_u32 v5, v5, v16, v17
    s_nop 1
    v_max_u32_dpp v5, v5, v5 row_shr:1 row_mask:0xf bank_mask:0xf bound_ctrl:0
    s_nop 1
    v_max_u32_dpp v5, v5, v5 row_shr:2 row_mask:0xf bank_mask:0xf bound_ctrl:0
    s_nop 1
    v_max_u32_dpp v5, v5, v5 row_shr:4 row_mask:0xf bank_mask:0xf bound_ctrl:0
    s_nop 1
    v_max_u32_dpp v5, v5, v5 row_shr:8 row_mask:0xf bank_mask:0xf bound_ctrl:0
    s_nop 1
    v_max_u32_dpp v5, v5, v5 row_bcast:15 row_mask:0xa bank_mask:0xf
    s_nop 1
    v_max_u32_dpp v5, v5, v5 row_bcast:31 row_mask:0xc bank_mask:0xf
    s_nop 0
    v_readlane_b32 s38, v5, 63
    s_nop 1
    v_mov_b32 v5, s38
    ds_write_b32 v6, v5 offset:80
    s_waitcnt lgkmcnt(0)
    s_barrier
    ds_read_b128 v[20:23], v7 offset:80
    s_waitcnt lgkmcnt(0)
    v_max_u32 v5, v20, v21
    v_max3_u32 v5, v5, v22, v23
    v_cmp_eq_u32 vcc, v5, v10
    s_nop 1
    v_cndmask_b32 v10, v10, v7, vcc
    v_cmp_eq_u32 vcc, v5, v11
    s_nop 1
    v_cndmask_b32 v11, v11, v7, vcc
    v_cmp_eq_u32 vcc, v5, v12
    s_nop 1
    v_cndmask_b32 v12, v12, v7, vcc
    v_cmp_eq_u32 vcc, v5, v13
    s_nop 1
    v_cndmask_b32 v13, v13, v7, vcc
    v_cmp_eq_u32 vcc, v5, v14
    s_nop 1
    v_cndmask_b32 v14, v14, v7, vcc
    v_cmp_eq_u32 vcc, v5, v15
    s_nop 1
    v_cndmask_b32 v15, v15, v7, vcc
    v_cmp_eq_u32 vcc, v5, v16
    s_nop 1
    v_cndmask_b32 v16, v16, v7, vcc
    v_cmp_eq_u32 vcc, v5, v17
    s_nop 1
    v_cndmask_b32 v17, v17, v7, vcc
    v_and_b32 v5, 0xffff, v5
    v_sub_u32 v5, 0xffff, v5
    ds_write_b32 v7, v5 offset:276
    v_max_u32 v5, v10, v11
    v_max3_u32 v5, v5, v12, v13
    v_max3_u32 v5, v5, v14, v15
    v_max3_u32 v5, v5, v16, v17
    s_nop 1
    v_max_u32_dpp v5, v5, v5 row_shr:1 row_mask:0xf bank_mask:0xf bound_ctrl:0
    s_nop 1
    v_max_u32_dpp v5, v5, v5 row_shr:2 row_mask:0xf bank_mask:0xf bound_ctrl:0
    s_nop 1
    v_max_u32_dpp v5, v5, v5 row_shr:4 row_mask:0xf bank_mask:0xf bound_ctrl:0
    s_nop 1
    v_max_u32_dpp v5, v5, v5 row_shr:8 row_mask:0xf bank_mask:0xf bound_ctrl:0
    s_nop 1
    v_max_u32_dpp v5, v5, v5 row_bcast:15 row_mask:0xa bank_mask:0xf
    s_nop 1
    v_max_u32_dpp v5, v5, v5 row_bcast:31 row_mask:0xc bank_mask:0xf
    s_nop 0
    v_readlane_b32 s38, v5, 63
    s_nop 1
    v_mov_b32 v5, s38
    ds_write_b32 v6, v5 offset:96
    s_waitcnt lgkmcnt(0)
    s_barrier
    ds_read_b128 v[20:23], v7 offset:96
    s_waitcnt lgkmcnt(0)
    v_max_u32 v5, v20, v21
    v_max3_u32 v5, v5, v22, v23
    v_cmp_eq_u32 vcc, v5, v10
    s_nop 1
    v_cndmask_b32 v10, v10, v7, vcc
    v_cmp_eq_u32 vcc, v5, v11
    s_nop 1
    v_cndmask_b32 v11, v11, v7, vcc
    v_cmp_eq_u32 vcc, v5, v12
    s_nop 1
    v_cndmask_b32 v12, v12, v7, vcc
    v_cmp_eq_u32 vcc, v5, v13
    s_nop 1
    v_cndmask_b32 v13, v13, v7, vcc
    v_cmp_eq_u32 vcc, v5, v14
    s_nop 1
    v_cndmask_b32 v14, v14, v7, vcc
    v_cmp_eq_u32 vcc, v5, v15
    s_nop 1
    v_cndmask_b32 v15, v15, v7, vcc
    v_cmp_eq_u32 vcc, v5, v16
    s_nop 1
    v_cndmask_b32 v16, v16, v7, vcc
    v_cmp_eq_u32 vcc, v5, v17
    s_nop 1
    v_cndmask_b32 v17, v17, v7, vcc
    v_and_b32 v5, 0xffff, v5
    v_sub_u32 v5, 0xffff, v5
    ds_write_b32 v7, v5 offset:280
    v_max_u32 v5, v10, v11
    v_max3_u32 v5, v5, v12, v13
    v_max3_u32 v5, v5, v14, v15
    v_max3_u32 v5, v5, v16, v17
    s_nop 1
    v_max_u32_dpp v5, v5, v5 row_shr:1 row_mask:0xf bank_mask:0xf bound_ctrl:0
    s_nop 1
    v_max_u32_dpp v5, v5, v5 row_shr:2 row_mask:0xf bank_mask:0xf bound_ctrl:0
    s_nop 1
    v_max_u32_dpp v5, v5, v5 row_shr:4 row_mask:0xf bank_mask:0xf bound_ctrl:0
    s_nop 1
    v_max_u32_dpp v5, v5, v5 row_shr:8 row_mask:0xf bank_mask:0xf bound_ctrl:0
    s_nop 1
    v_max_u32_dpp v5, v5, v5 row_bcast:15 row_mask:0xa bank_mask:0xf
    s_nop 1
    v_max_u32_dpp v5, v5, v5 row_bcast:31 row_mask:0xc bank_mask:0xf
    s_nop 0
    v_readlane_b32 s38, v5, 63
    s_nop 1
    v_mov_b32 v5, s38
    ds_write_b32 v6, v5 offset:112
    s_waitcnt lgkmcnt(0)
    s_barrier
    ds_read_b128 v[20:23], v7 offset:112
    s_waitcnt lgkmcnt(0)
    v_max_u32 v5, v20, v21
    v_max3_u32 v5, v5, v22, v23
    v_cmp_eq_u32 vcc, v5, v10
    s_nop 1
    v_cndmask_b32 v10, v10, v7, vcc
    v_cmp_eq_u32 vcc, v5, v11
    s_nop 1
    v_cndmask_b32 v11, v11, v7, vcc
    v_cmp_eq_u32 vcc, v5, v12
    s_nop 1
    v_cndmask_b32 v12, v12, v7, vcc
    v_cmp_eq_u32 vcc, v5, v13
    s_nop 1
    v_cndmask_b32 v13, v13, v7, vcc
    v_cmp_eq_u32 vcc, v5, v14
    s_nop 1
    v_cndmask_b32 v14, v14, v7, vcc
    v_cmp_eq_u32 vcc, v5, v15
    s_nop 1
    v_cndmask_b32 v15, v15, v7, vcc
    v_cmp_eq_u32 vcc, v5, v16
    s_nop 1
    v_cndmask_b32 v16, v16, v7, vcc
    v_cmp_eq_u32 vcc, v5, v17
    s_nop 1
    v_cndmask_b32 v17, v17, v7, vcc
    v_and_b32 v5, 0xffff, v5
    v_sub_u32 v5, 0xffff, v5
    ds_write_b32 v7, v5 offset:284
    s_waitcnt lgkmcnt(0)
    s_barrier
    v_and_b32 v5, 7, v9
    v_lshlrev_b32 v5, 2, v5
    ds_read_b32 v4, v5 offset:256
    s_waitcnt lgkmcnt(0)
    s_or_b32 s38, s36, s3
    s_cmp_lg_u32 s38, 0
    s_nop 0
    s_cbranch_scc1 moe1_noidx
    v_lshlrev_b32 v5, 2, v4
    s_mov_b32 s37, 3145728
    buffer_load_dword v6, v5, s[32:35], s37 offen
    v_lshlrev_b32 v5, 2, v1
    v_cmp_gt_u32 vcc, 8, v1
    s_nop 0
    s_and_saveexec_b64 s[42:43], vcc
    s_mov_b32 s37, 3178496
    buffer_store_dword v4, v5, s[32:35], s37 offen sc1
    s_waitcnt vmcnt(1)
    buffer_store_dword v6, v5, s[32:35], s37 offen offset:32 sc1
    s_mov_b64 exec, s[42:43]
moe1_noidx:
    v_mul_u32_u24 v5, 1280, v4
    v_lshl_add_u32 v5, v8, 4, v5
    buffer_load_dwordx4 v[100:103], v5, s[32:35], 0 offen offset:0
    buffer_load_dwordx4 v[104:107], v5, s[32:35], 0 offen offset:64
    buffer_load_dwordx4 v[108:111], v5, s[32:35], 0 offen offset:128
    buffer_load_dwordx4 v[112:115], v5, s[32:35], 0 offen offset:192
    buffer_load_dwordx4 v[116:119], v5, s[32:35], 0 offen offset:256
    buffer_load_dwordx4 v[120:123], v5, s[32:35], 0 offen offset:320
    buffer_load_dwordx4 v[124:127], v5, s[32:35], 0 offen offset:384
    buffer_load_dwordx4 v[128:131], v5, s[32:35], 0 offen offset:448
    buffer_load_dwordx4 v[132:135], v5, s[32:35], 0 offen offset:512
    buffer_load_dwordx4 v[136:139], v5, s[32:35], 0 offen offset:576
    buffer_load_dwordx4 v[140:143], v5, s[32:35], 0 offen offset:640
    buffer_load_dwordx4 v[144:147], v5, s[32:35], 0 offen offset:704
    buffer_load_dwordx4 v[148:151], v5, s[32:35], 0 offen offset:768
    buffer_load_dwordx4 v[152:155], v5, s[32:35], 0 offen offset:832
    buffer_load_dwordx4 v[156:159], v5, s[32:35], 0 offen offset:896
    buffer_load_dwordx4 v[160:163], v5, s[32:35], 0 offen offset:960
    buffer_load_dwordx4 v[164:167], v5, s[32:35], 0 offen offset:1024
    buffer_load_dwordx4 v[168:171], v5, s[32:35], 0 offen offset:1088
    buffer_load_dwordx4 v[172:175], v5, s[32:35], 0 offen offset:1152
    buffer_load_dwordx4 v[176:179], v5, s[32:35], 0 offen offset:1216
    s_lshl_b32 s38, s36, 6
    s_lshl_b32 s39, s3, 4
    s_add_u32 s38, s38, s39
    v_add_u32 v6, s38, v9
    v_lshlrev_b32 v6, 1, v6
    v_mul_u32_u24 v7, 27648, v8
    v_add_u32 v6, v6, v7
    s_mov_b32 s47, 0
    buffer_load_ushort v30, v6, s[24:27], s47 offen
    buffer_load_ushort v38, v6, s[28:31], s47 offen
    s_mov_b32 s47, 3456
    buffer_load_ushort v31, v6, s[24:27], s47 offen
    buffer_load_ushort v39, v6, s[28:31], s47 offen
    s_mov_b32 s47, 6912
    buffer_load_ushort v32, v6, s[24:27], s47 offen
    buffer_load_ushort v40, v6, s[28:31], s47 offen
    s_mov_b32 s47, 10368
    buffer_load_ushort v33, v6, s[24:27], s47 offen
    buffer_load_ushort v41, v6, s[28:31], s47 offen
    s_mov_b32 s47, 13824
    buffer_load_ushort v34, v6, s[24:27], s47 offen
    buffer_load_ushort v42, v6, s[28:31], s47 offen
    s_mov_b32 s47, 17280
    buffer_load_ushort v35, v6, s[24:27], s47 offen
    buffer_load_ushort v43, v6, s[28:31], s47 offen
    s_mov_b32 s47, 20736
    buffer_load_ushort v36, v6, s[24:27], s47 offen
    buffer_load_ushort v44, v6, s[28:31], s47 offen
    s_mov_b32 s47, 24192
    buffer_load_ushort v37, v6, s[24:27], s47 offen
    buffer_load_ushort v45, v6, s[28:31], s47 offen
    s_mov_b32 s47, 110592
    buffer_load_ushort v46, v6, s[24:27], s47 offen
    buffer_load_ushort v54, v6, s[28:31], s47 offen
    s_mov_b32 s47, 114048
    buffer_load_ushort v47, v6, s[24:27], s47 offen
    buffer_load_ushort v55, v6, s[28:31], s47 offen
    s_mov_b32 s47, 117504
    buffer_load_ushort v48, v6, s[24:27], s47 offen
    buffer_load_ushort v56, v6, s[28:31], s47 offen
    s_mov_b32 s47, 120960
    buffer_load_ushort v49, v6, s[24:27], s47 offen
    buffer_load_ushort v57, v6, s[28:31], s47 offen
    s_mov_b32 s47, 124416
    buffer_load_ushort v50, v6, s[24:27], s47 offen
    buffer_load_ushort v58, v6, s[28:31], s47 offen
    s_mov_b32 s47, 127872
    buffer_load_ushort v51, v6, s[24:27], s47 offen
    buffer_load_ushort v59, v6, s[28:31], s47 offen
    s_mov_b32 s47, 131328
    buffer_load_ushort v52, v6, s[24:27], s47 offen
    buffer_load_ushort v60, v6, s[28:31], s47 offen
    s_mov_b32 s47, 134784
    buffer_load_ushort v53, v6, s[24:27], s47 offen
    buffer_load_ushort v61, v6, s[28:31], s47 offen
    s_mov_b32 s47, 221184
    buffer_load_ushort v62, v6, s[24:27], s47 offen
    buffer_load_ushort v70, v6, s[28:31], s47 offen
    s_mov_b32 s47, 224640
    buffer_load_ushort v63, v6, s[24:27], s47 offen
    buffer_load_ushort v71, v6, s[28:31], s47 offen
    s_mov_b32 s47, 228096
    buffer_load_ushort v64, v6, s[24:27], s47 offen
    buffer_load_ushort v72, v6, s[28:31], s47 offen
    s_mov_b32 s47, 231552
    buffer_load_ushort v65, v6, s[24:27], s47 offen
    buffer_load_ushort v73, v6, s[28:31], s47 offen
    s_mov_b32 s47, 235008
    buffer_load_ushort v66, v6, s[24:27], s47 offen
    buffer_load_ushort v74, v6, s[28:31], s47 offen
    s_mov_b32 s47, 238464
    buffer_load_ushort v67, v6, s[24:27], s47 offen
    buffer_load_ushort v75, v6, s[28:31], s47 offen
    s_mov_b32 s47, 241920
    buffer_load_ushort v68, v6, s[24:27], s47 offen
    buffer_load_ushort v76, v6, s[28:31], s47 offen
    s_mov_b32 s47, 245376
    buffer_load_ushort v69, v6, s[24:27], s47 offen
    buffer_load_ushort v77, v6, s[28:31], s47 offen
    s_mov_b32 s47, 331776
    buffer_load_ushort v78, v6, s[24:27], s47 offen
    buffer_load_ushort v86, v6, s[28:31], s47 offen
    s_mov_b32 s47, 335232
    buffer_load_ushort v79, v6, s[24:27], s47 offen
    buffer_load_ushort v87, v6, s[28:31], s47 offen
    s_mov_b32 s47, 338688
    buffer_load_ushort v80, v6, s[24:27], s47 offen
    buffer_load_ushort v88, v6, s[28:31], s47 offen
    s_mov_b32 s47, 342144
    buffer_load_ushort v81, v6, s[24:27], s47 offen
    buffer_load_ushort v89, v6, s[28:31], s47 offen
    s_mov_b32 s47, 345600
    buffer_load_ushort v82, v6, s[24:27], s47 offen
    buffer_load_ushort v90, v6, s[28:31], s47 offen
    s_mov_b32 s47, 349056
    buffer_load_ushort v83, v6, s[24:27], s47 offen
    buffer_load_ushort v91, v6, s[28:31], s47 offen
    s_mov_b32 s47, 352512
    buffer_load_ushort v84, v6, s[24:27], s47 offen
    buffer_load_ushort v92, v6, s[28:31], s47 offen
    s_mov_b32 s47, 355968
    buffer_load_ushort v85, v6, s[24:27], s47 offen
    buffer_load_ushort v93, v6, s[28:31], s47 offen
    s_waitcnt vmcnt(48)
    v_lshl_or_b32 v20, v31, 16, v30
    v_lshl_or_b32 v24, v39, 16, v38
    v_lshl_or_b32 v21, v33, 16, v32
    v_lshl_or_b32 v25, v41, 16, v40
    v_lshl_or_b32 v22, v35, 16, v34
    v_lshl_or_b32 v26, v43, 16, v42
    v_lshl_or_b32 v23, v37, 16, v36
    v_lshl_or_b32 v27, v45, 16, v44
    s_nop 0
    v_mfma_f32_16x16x32_bf16 v[12:15], v[20:23], v[100:103], 0
    v_mfma_f32_16x16x32_bf16 v[16:19], v[24:27], v[100:103], 0
    s_mov_b32 s47, 442368
    buffer_load_ushort v30, v6, s[24:27], s47 offen
    buffer_load_ushort v38, v6, s[28:31], s47 offen
    s_mov_b32 s47, 445824
    buffer_load_ushort v31, v6, s[24:27], s47 offen
    buffer_load_ushort v39, v6, s[28:31], s47 offen
    s_mov_b32 s47, 449280
    buffer_load_ushort v32, v6, s[24:27], s47 offen
    buffer_load_ushort v40, v6, s[28:31], s47 offen
    s_mov_b32 s47, 452736
    buffer_load_ushort v33, v6, s[24:27], s47 offen
    buffer_load_ushort v41, v6, s[28:31], s47 offen
    s_mov_b32 s47, 456192
    buffer_load_ushort v34, v6, s[24:27], s47 offen
    buffer_load_ushort v42, v6, s[28:31], s47 offen
    s_mov_b32 s47, 459648
    buffer_load_ushort v35, v6, s[24:27], s47 offen
    buffer_load_ushort v43, v6, s[28:31], s47 offen
    s_mov_b32 s47, 463104
    buffer_load_ushort v36, v6, s[24:27], s47 offen
    buffer_load_ushort v44, v6, s[28:31], s47 offen
    s_mov_b32 s47, 466560
    buffer_load_ushort v37, v6, s[24:27], s47 offen
    buffer_load_ushort v45, v6, s[28:31], s47 offen
    s_waitcnt vmcnt(48)
    v_lshl_or_b32 v20, v47, 16, v46
    v_lshl_or_b32 v24, v55, 16, v54
    v_lshl_or_b32 v21, v49, 16, v48
    v_lshl_or_b32 v25, v57, 16, v56
    v_lshl_or_b32 v22, v51, 16, v50
    v_lshl_or_b32 v26, v59, 16, v58
    v_lshl_or_b32 v23, v53, 16, v52
    v_lshl_or_b32 v27, v61, 16, v60
    s_nop 0
    v_mfma_f32_16x16x32_bf16 v[12:15], v[20:23], v[104:107], v[12:15]
    v_mfma_f32_16x16x32_bf16 v[16:19], v[24:27], v[104:107], v[16:19]
    s_mov_b32 s47, 552960
    buffer_load_ushort v46, v6, s[24:27], s47 offen
    buffer_load_ushort v54, v6, s[28:31], s47 offen
    s_mov_b32 s47, 556416
    buffer_load_ushort v47, v6, s[24:27], s47 offen
    buffer_load_ushort v55, v6, s[28:31], s47 offen
    s_mov_b32 s47, 559872
    buffer_load_ushort v48, v6, s[24:27], s47 offen
    buffer_load_ushort v56, v6, s[28:31], s47 offen
    s_mov_b32 s47, 563328
    buffer_load_ushort v49, v6, s[24:27], s47 offen
    buffer_load_ushort v57, v6, s[28:31], s47 offen
    s_mov_b32 s47, 566784
    buffer_load_ushort v50, v6, s[24:27], s47 offen
    buffer_load_ushort v58, v6, s[28:31], s47 offen
    s_mov_b32 s47, 570240
    buffer_load_ushort v51, v6, s[24:27], s47 offen
    buffer_load_ushort v59, v6, s[28:31], s47 offen
    s_mov_b32 s47, 573696
    buffer_load_ushort v52, v6, s[24:27], s47 offen
    buffer_load_ushort v60, v6, s[28:31], s47 offen
    s_mov_b32 s47, 577152
    buffer_load_ushort v53, v6, s[24:27], s47 offen
    buffer_load_ushort v61, v6, s[28:31], s47 offen
    s_waitcnt vmcnt(48)
    v_lshl_or_b32 v20, v63, 16, v62
    v_lshl_or_b32 v24, v71, 16, v70
    v_lshl_or_b32 v21, v65, 16, v64
    v_lshl_or_b32 v25, v73, 16, v72
    v_lshl_or_b32 v22, v67, 16, v66
    v_lshl_or_b32 v26, v75, 16, v74
    v_lshl_or_b32 v23, v69, 16, v68
    v_lshl_or_b32 v27, v77, 16, v76
    s_nop 0
    v_mfma_f32_16x16x32_bf16 v[12:15], v[20:23], v[108:111], v[12:15]
    v_mfma_f32_16x16x32_bf16 v[16:19], v[24:27], v[108:111], v[16:19]
    s_mov_b32 s47, 663552
    buffer_load_ushort v62, v6, s[24:27], s47 offen
    buffer_load_ushort v70, v6, s[28:31], s47 offen
    s_mov_b32 s47, 667008
    buffer_load_ushort v63, v6, s[24:27], s47 offen
    buffer_load_ushort v71, v6, s[28:31], s47 offen
    s_mov_b32 s47, 670464
    buffer_load_ushort v64, v6, s[24:27], s47 offen
    buffer_load_ushort v72, v6, s[28:31], s47 offen
    s_mov_b32 s47, 673920
    buffer_load_ushort v65, v6, s[24:27], s47 offen
    buffer_load_ushort v73, v6, s[28:31], s47 offen
    s_mov_b32 s47, 677376
    buffer_load_ushort v66, v6, s[24:27], s47 offen
    buffer_load_ushort v74, v6, s[28:31], s47 offen
    s_mov_b32 s47, 680832
    buffer_load_ushort v67, v6, s[24:27], s47 offen
    buffer_load_ushort v75, v6, s[28:31], s47 offen
    s_mov_b32 s47, 684288
    buffer_load_ushort v68, v6, s[24:27], s47 offen
    buffer_load_ushort v76, v6, s[28:31], s47 offen
    s_mov_b32 s47, 687744
    buffer_load_ushort v69, v6, s[24:27], s47 offen
    buffer_load_ushort v77, v6, s[28:31], s47 offen
    s_waitcnt vmcnt(48)
    v_lshl_or_b32 v20, v79, 16, v78
    v_lshl_or_b32 v24, v87, 16, v86
    v_lshl_or_b32 v21, v81, 16, v80
    v_lshl_or_b32 v25, v89, 16, v88
    v_lshl_or_b32 v22, v83, 16, v82
    v_lshl_or_b32 v26, v91, 16, v90
    v_lshl_or_b32 v23, v85, 16, v84
    v_lshl_or_b32 v27, v93, 16, v92
    s_nop 0
    v_mfma_f32_16x16x32_bf16 v[12:15], v[20:23], v[112:115], v[12:15]
    v_mfma_f32_16x16x32_bf16 v[16:19], v[24:27], v[112:115], v[16:19]
    s_mov_b32 s47, 774144
    buffer_load_ushort v78, v6, s[24:27], s47 offen
    buffer_load_ushort v86, v6, s[28:31], s47 offen
    s_mov_b32 s47, 777600
    buffer_load_ushort v79, v6, s[24:27], s47 offen
    buffer_load_ushort v87, v6, s[28:31], s47 offen
    s_mov_b32 s47, 781056
    buffer_load_ushort v80, v6, s[24:27], s47 offen
    buffer_load_ushort v88, v6, s[28:31], s47 offen
    s_mov_b32 s47, 784512
    buffer_load_ushort v81, v6, s[24:27], s47 offen
    buffer_load_ushort v89, v6, s[28:31], s47 offen
    s_mov_b32 s47, 787968
    buffer_load_ushort v82, v6, s[24:27], s47 offen
    buffer_load_ushort v90, v6, s[28:31], s47 offen
    s_mov_b32 s47, 791424
    buffer_load_ushort v83, v6, s[24:27], s47 offen
    buffer_load_ushort v91, v6, s[28:31], s47 offen
    s_mov_b32 s47, 794880
    buffer_load_ushort v84, v6, s[24:27], s47 offen
    buffer_load_ushort v92, v6, s[28:31], s47 offen
    s_mov_b32 s47, 798336
    buffer_load_ushort v85, v6, s[24:27], s47 offen
    buffer_load_ushort v93, v6, s[28:31], s47 offen
    s_waitcnt vmcnt(48)
    v_lshl_or_b32 v20, v31, 16, v30
    v_lshl_or_b32 v24, v39, 16, v38
    v_lshl_or_b32 v21, v33, 16, v32
    v_lshl_or_b32 v25, v41, 16, v40
    v_lshl_or_b32 v22, v35, 16, v34
    v_lshl_or_b32 v26, v43, 16, v42
    v_lshl_or_b32 v23, v37, 16, v36
    v_lshl_or_b32 v27, v45, 16, v44
    s_nop 0
    v_mfma_f32_16x16x32_bf16 v[12:15], v[20:23], v[116:119], v[12:15]
    v_mfma_f32_16x16x32_bf16 v[16:19], v[24:27], v[116:119], v[16:19]
    s_mov_b32 s47, 884736
    buffer_load_ushort v30, v6, s[24:27], s47 offen
    buffer_load_ushort v38, v6, s[28:31], s47 offen
    s_mov_b32 s47, 888192
    buffer_load_ushort v31, v6, s[24:27], s47 offen
    buffer_load_ushort v39, v6, s[28:31], s47 offen
    s_mov_b32 s47, 891648
    buffer_load_ushort v32, v6, s[24:27], s47 offen
    buffer_load_ushort v40, v6, s[28:31], s47 offen
    s_mov_b32 s47, 895104
    buffer_load_ushort v33, v6, s[24:27], s47 offen
    buffer_load_ushort v41, v6, s[28:31], s47 offen
    s_mov_b32 s47, 898560
    buffer_load_ushort v34, v6, s[24:27], s47 offen
    buffer_load_ushort v42, v6, s[28:31], s47 offen
    s_mov_b32 s47, 902016
    buffer_load_ushort v35, v6, s[24:27], s47 offen
    buffer_load_ushort v43, v6, s[28:31], s47 offen
    s_mov_b32 s47, 905472
    buffer_load_ushort v36, v6, s[24:27], s47 offen
    buffer_load_ushort v44, v6, s[28:31], s47 offen
    s_mov_b32 s47, 908928
    buffer_load_ushort v37, v6, s[24:27], s47 offen
    buffer_load_ushort v45, v6, s[28:31], s47 offen
    s_waitcnt vmcnt(48)
    v_lshl_or_b32 v20, v47, 16, v46
    v_lshl_or_b32 v24, v55, 16, v54
    v_lshl_or_b32 v21, v49, 16, v48
    v_lshl_or_b32 v25, v57, 16, v56
    v_lshl_or_b32 v22, v51, 16, v50
    v_lshl_or_b32 v26, v59, 16, v58
    v_lshl_or_b32 v23, v53, 16, v52
    v_lshl_or_b32 v27, v61, 16, v60
    s_nop 0
    v_mfma_f32_16x16x32_bf16 v[12:15], v[20:23], v[120:123], v[12:15]
    v_mfma_f32_16x16x32_bf16 v[16:19], v[24:27], v[120:123], v[16:19]
    s_mov_b32 s47, 995328
    buffer_load_ushort v46, v6, s[24:27], s47 offen
    buffer_load_ushort v54, v6, s[28:31], s47 offen
    s_mov_b32 s47, 998784
    buffer_load_ushort v47, v6, s[24:27], s47 offen
    buffer_load_ushort v55, v6, s[28:31], s47 offen
    s_mov_b32 s47, 1002240
    buffer_load_ushort v48, v6, s[24:27], s47 offen
    buffer_load_ushort v56, v6, s[28:31], s47 offen
    s_mov_b32 s47, 1005696
    buffer_load_ushort v49, v6, s[24:27], s47 offen
    buffer_load_ushort v57, v6, s[28:31], s47 offen
    s_mov_b32 s47, 1009152
    buffer_load_ushort v50, v6, s[24:27], s47 offen
    buffer_load_ushort v58, v6, s[28:31], s47 offen
    s_mov_b32 s47, 1012608
    buffer_load_ushort v51, v6, s[24:27], s47 offen
    buffer_load_ushort v59, v6, s[28:31], s47 offen
    s_mov_b32 s47, 1016064
    buffer_load_ushort v52, v6, s[24:27], s47 offen
    buffer_load_ushort v60, v6, s[28:31], s47 offen
    s_mov_b32 s47, 1019520
    buffer_load_ushort v53, v6, s[24:27], s47 offen
    buffer_load_ushort v61, v6, s[28:31], s47 offen
    s_waitcnt vmcnt(48)
    v_lshl_or_b32 v20, v63, 16, v62
    v_lshl_or_b32 v24, v71, 16, v70
    v_lshl_or_b32 v21, v65, 16, v64
    v_lshl_or_b32 v25, v73, 16, v72
    v_lshl_or_b32 v22, v67, 16, v66
    v_lshl_or_b32 v26, v75, 16, v74
    v_lshl_or_b32 v23, v69, 16, v68
    v_lshl_or_b32 v27, v77, 16, v76
    s_nop 0
    v_mfma_f32_16x16x32_bf16 v[12:15], v[20:23], v[124:127], v[12:15]
    v_mfma_f32_16x16x32_bf16 v[16:19], v[24:27], v[124:127], v[16:19]
    s_mov_b32 s47, 1105920
    buffer_load_ushort v62, v6, s[24:27], s47 offen
    buffer_load_ushort v70, v6, s[28:31], s47 offen
    s_mov_b32 s47, 1109376
    buffer_load_ushort v63, v6, s[24:27], s47 offen
    buffer_load_ushort v71, v6, s[28:31], s47 offen
    s_mov_b32 s47, 1112832
    buffer_load_ushort v64, v6, s[24:27], s47 offen
    buffer_load_ushort v72, v6, s[28:31], s47 offen
    s_mov_b32 s47, 1116288
    buffer_load_ushort v65, v6, s[24:27], s47 offen
    buffer_load_ushort v73, v6, s[28:31], s47 offen
    s_mov_b32 s47, 1119744
    buffer_load_ushort v66, v6, s[24:27], s47 offen
    buffer_load_ushort v74, v6, s[28:31], s47 offen
    s_mov_b32 s47, 1123200
    buffer_load_ushort v67, v6, s[24:27], s47 offen
    buffer_load_ushort v75, v6, s[28:31], s47 offen
    s_mov_b32 s47, 1126656
    buffer_load_ushort v68, v6, s[24:27], s47 offen
    buffer_load_ushort v76, v6, s[28:31], s47 offen
    s_mov_b32 s47, 1130112
    buffer_load_ushort v69, v6, s[24:27], s47 offen
    buffer_load_ushort v77, v6, s[28:31], s47 offen
    s_waitcnt vmcnt(48)
    v_lshl_or_b32 v20, v79, 16, v78
    v_lshl_or_b32 v24, v87, 16, v86
    v_lshl_or_b32 v21, v81, 16, v80
    v_lshl_or_b32 v25, v89, 16, v88
    v_lshl_or_b32 v22, v83, 16, v82
    v_lshl_or_b32 v26, v91, 16, v90
    v_lshl_or_b32 v23, v85, 16, v84
    v_lshl_or_b32 v27, v93, 16, v92
    s_nop 0
    v_mfma_f32_16x16x32_bf16 v[12:15], v[20:23], v[128:131], v[12:15]
    v_mfma_f32_16x16x32_bf16 v[16:19], v[24:27], v[128:131], v[16:19]
    s_mov_b32 s47, 1216512
    buffer_load_ushort v78, v6, s[24:27], s47 offen
    buffer_load_ushort v86, v6, s[28:31], s47 offen
    s_mov_b32 s47, 1219968
    buffer_load_ushort v79, v6, s[24:27], s47 offen
    buffer_load_ushort v87, v6, s[28:31], s47 offen
    s_mov_b32 s47, 1223424
    buffer_load_ushort v80, v6, s[24:27], s47 offen
    buffer_load_ushort v88, v6, s[28:31], s47 offen
    s_mov_b32 s47, 1226880
    buffer_load_ushort v81, v6, s[24:27], s47 offen
    buffer_load_ushort v89, v6, s[28:31], s47 offen
    s_mov_b32 s47, 1230336
    buffer_load_ushort v82, v6, s[24:27], s47 offen
    buffer_load_ushort v90, v6, s[28:31], s47 offen
    s_mov_b32 s47, 1233792
    buffer_load_ushort v83, v6, s[24:27], s47 offen
    buffer_load_ushort v91, v6, s[28:31], s47 offen
    s_mov_b32 s47, 1237248
    buffer_load_ushort v84, v6, s[24:27], s47 offen
    buffer_load_ushort v92, v6, s[28:31], s47 offen
    s_mov_b32 s47, 1240704
    buffer_load_ushort v85, v6, s[24:27], s47 offen
    buffer_load_ushort v93, v6, s[28:31], s47 offen
    s_waitcnt vmcnt(48)
    v_lshl_or_b32 v20, v31, 16, v30
    v_lshl_or_b32 v24, v39, 16, v38
    v_lshl_or_b32 v21, v33, 16, v32
    v_lshl_or_b32 v25, v41, 16, v40
    v_lshl_or_b32 v22, v35, 16, v34
    v_lshl_or_b32 v26, v43, 16, v42
    v_lshl_or_b32 v23, v37, 16, v36
    v_lshl_or_b32 v27, v45, 16, v44
    s_nop 0
    v_mfma_f32_16x16x32_bf16 v[12:15], v[20:23], v[132:135], v[12:15]
    v_mfma_f32_16x16x32_bf16 v[16:19], v[24:27], v[132:135], v[16:19]
    s_mov_b32 s47, 1327104
    buffer_load_ushort v30, v6, s[24:27], s47 offen
    buffer_load_ushort v38, v6, s[28:31], s47 offen
    s_mov_b32 s47, 1330560
    buffer_load_ushort v31, v6, s[24:27], s47 offen
    buffer_load_ushort v39, v6, s[28:31], s47 offen
    s_mov_b32 s47, 1334016
    buffer_load_ushort v32, v6, s[24:27], s47 offen
    buffer_load_ushort v40, v6, s[28:31], s47 offen
    s_mov_b32 s47, 1337472
    buffer_load_ushort v33, v6, s[24:27], s47 offen
    buffer_load_ushort v41, v6, s[28:31], s47 offen
    s_mov_b32 s47, 1340928
    buffer_load_ushort v34, v6, s[24:27], s47 offen
    buffer_load_ushort v42, v6, s[28:31], s47 offen
    s_mov_b32 s47, 1344384
    buffer_load_ushort v35, v6, s[24:27], s47 offen
    buffer_load_ushort v43, v6, s[28:31], s47 offen
    s_mov_b32 s47, 1347840
    buffer_load_ushort v36, v6, s[24:27], s47 offen
    buffer_load_ushort v44, v6, s[28:31], s47 offen
    s_mov_b32 s47, 1351296
    buffer_load_ushort v37, v6, s[24:27], s47 offen
    buffer_load_ushort v45, v6, s[28:31], s47 offen
    s_waitcnt vmcnt(48)
    v_lshl_or_b32 v20, v47, 16, v46
    v_lshl_or_b32 v24, v55, 16, v54
    v_lshl_or_b32 v21, v49, 16, v48
    v_lshl_or_b32 v25, v57, 16, v56
    v_lshl_or_b32 v22, v51, 16, v50
    v_lshl_or_b32 v26, v59, 16, v58
    v_lshl_or_b32 v23, v53, 16, v52
    v_lshl_or_b32 v27, v61, 16, v60
    s_nop 0
    v_mfma_f32_16x16x32_bf16 v[12:15], v[20:23], v[136:139], v[12:15]
    v_mfma_f32_16x16x32_bf16 v[16:19], v[24:27], v[136:139], v[16:19]
    s_mov_b32 s47, 1437696
    buffer_load_ushort v46, v6, s[24:27], s47 offen
    buffer_load_ushort v54, v6, s[28:31], s47 offen
    s_mov_b32 s47, 1441152
    buffer_load_ushort v47, v6, s[24:27], s47 offen
    buffer_load_ushort v55, v6, s[28:31], s47 offen
    s_mov_b32 s47, 1444608
    buffer_load_ushort v48, v6, s[24:27], s47 offen
    buffer_load_ushort v56, v6, s[28:31], s47 offen
    s_mov_b32 s47, 1448064
    buffer_load_ushort v49, v6, s[24:27], s47 offen
    buffer_load_ushort v57, v6, s[28:31], s47 offen
    s_mov_b32 s47, 1451520
    buffer_load_ushort v50, v6, s[24:27], s47 offen
    buffer_load_ushort v58, v6, s[28:31], s47 offen
    s_mov_b32 s47, 1454976
    buffer_load_ushort v51, v6, s[24:27], s47 offen
    buffer_load_ushort v59, v6, s[28:31], s47 offen
    s_mov_b32 s47, 1458432
    buffer_load_ushort v52, v6, s[24:27], s47 offen
    buffer_load_ushort v60, v6, s[28:31], s47 offen
    s_mov_b32 s47, 1461888
    buffer_load_ushort v53, v6, s[24:27], s47 offen
    buffer_load_ushort v61, v6, s[28:31], s47 offen
    s_waitcnt vmcnt(48)
    v_lshl_or_b32 v20, v63, 16, v62
    v_lshl_or_b32 v24, v71, 16, v70
    v_lshl_or_b32 v21, v65, 16, v64
    v_lshl_or_b32 v25, v73, 16, v72
    v_lshl_or_b32 v22, v67, 16, v66
    v_lshl_or_b32 v26, v75, 16, v74
    v_lshl_or_b32 v23, v69, 16, v68
    v_lshl_or_b32 v27, v77, 16, v76
    s_nop 0
    v_mfma_f32_16x16x32_bf16 v[12:15], v[20:23], v[140:143], v[12:15]
    v_mfma_f32_16x16x32_bf16 v[16:19], v[24:27], v[140:143], v[16:19]
    s_mov_b32 s47, 1548288
    buffer_load_ushort v62, v6, s[24:27], s47 offen
    buffer_load_ushort v70, v6, s[28:31], s47 offen
    s_mov_b32 s47, 1551744
    buffer_load_ushort v63, v6, s[24:27], s47 offen
    buffer_load_ushort v71, v6, s[28:31], s47 offen
    s_mov_b32 s47, 1555200
    buffer_load_ushort v64, v6, s[24:27], s47 offen
    buffer_load_ushort v72, v6, s[28:31], s47 offen
    s_mov_b32 s47, 1558656
    buffer_load_ushort v65, v6, s[24:27], s47 offen
    buffer_load_ushort v73, v6, s[28:31], s47 offen
    s_mov_b32 s47, 1562112
    buffer_load_ushort v66, v6, s[24:27], s47 offen
    buffer_load_ushort v74, v6, s[28:31], s47 offen
    s_mov_b32 s47, 1565568
    buffer_load_ushort v67, v6, s[24:27], s47 offen
    buffer_load_ushort v75, v6, s[28:31], s47 offen
    s_mov_b32 s47, 1569024
    buffer_load_ushort v68, v6, s[24:27], s47 offen
    buffer_load_ushort v76, v6, s[28:31], s47 offen
    s_mov_b32 s47, 1572480
    buffer_load_ushort v69, v6, s[24:27], s47 offen
    buffer_load_ushort v77, v6, s[28:31], s47 offen
    s_waitcnt vmcnt(48)
    v_lshl_or_b32 v20, v79, 16, v78
    v_lshl_or_b32 v24, v87, 16, v86
    v_lshl_or_b32 v21, v81, 16, v80
    v_lshl_or_b32 v25, v89, 16, v88
    v_lshl_or_b32 v22, v83, 16, v82
    v_lshl_or_b32 v26, v91, 16, v90
    v_lshl_or_b32 v23, v85, 16, v84
    v_lshl_or_b32 v27, v93, 16, v92
    s_nop 0
    v_mfma_f32_16x16x32_bf16 v[12:15], v[20:23], v[144:147], v[12:15]
    v_mfma_f32_16x16x32_bf16 v[16:19], v[24:27], v[144:147], v[16:19]
    s_mov_b32 s47, 1658880
    buffer_load_ushort v78, v6, s[24:27], s47 offen
    buffer_load_ushort v86, v6, s[28:31], s47 offen
    s_mov_b32 s47, 1662336
    buffer_load_ushort v79, v6, s[24:27], s47 offen
    buffer_load_ushort v87, v6, s[28:31], s47 offen
    s_mov_b32 s47, 1665792
    buffer_load_ushort v80, v6, s[24:27], s47 offen
    buffer_load_ushort v88, v6, s[28:31], s47 offen
    s_mov_b32 s47, 1669248
    buffer_load_ushort v81, v6, s[24:27], s47 offen
    buffer_load_ushort v89, v6, s[28:31], s47 offen
    s_mov_b32 s47, 1672704
    buffer_load_ushort v82, v6, s[24:27], s47 offen
    buffer_load_ushort v90, v6, s[28:31], s47 offen
    s_mov_b32 s47, 1676160
    buffer_load_ushort v83, v6, s[24:27], s47 offen
    buffer_load_ushort v91, v6, s[28:31], s47 offen
    s_mov_b32 s47, 1679616
    buffer_load_ushort v84, v6, s[24:27], s47 offen
    buffer_load_ushort v92, v6, s[28:31], s47 offen
    s_mov_b32 s47, 1683072
    buffer_load_ushort v85, v6, s[24:27], s47 offen
    buffer_load_ushort v93, v6, s[28:31], s47 offen
    s_waitcnt vmcnt(48)
    v_lshl_or_b32 v20, v31, 16, v30
    v_lshl_or_b32 v24, v39, 16, v38
    v_lshl_or_b32 v21, v33, 16, v32
    v_lshl_or_b32 v25, v41, 16, v40
    v_lshl_or_b32 v22, v35, 16, v34
    v_lshl_or_b32 v26, v43, 16, v42
    v_lshl_or_b32 v23, v37, 16, v36
    v_lshl_or_b32 v27, v45, 16, v44
    s_nop 0
    v_mfma_f32_16x16x32_bf16 v[12:15], v[20:23], v[148:151], v[12:15]
    v_mfma_f32_16x16x32_bf16 v[16:19], v[24:27], v[148:151], v[16:19]
    s_mov_b32 s47, 1769472
    buffer_load_ushort v30, v6, s[24:27], s47 offen
    buffer_load_ushort v38, v6, s[28:31], s47 offen
    s_mov_b32 s47, 1772928
    buffer_load_ushort v31, v6, s[24:27], s47 offen
    buffer_load_ushort v39, v6, s[28:31], s47 offen
    s_mov_b32 s47, 1776384
    buffer_load_ushort v32, v6, s[24:27], s47 offen
    buffer_load_ushort v40, v6, s[28:31], s47 offen
    s_mov_b32 s47, 1779840
    buffer_load_ushort v33, v6, s[24:27], s47 offen
    buffer_load_ushort v41, v6, s[28:31], s47 offen
    s_mov_b32 s47, 1783296
    buffer_load_ushort v34, v6, s[24:27], s47 offen
    buffer_load_ushort v42, v6, s[28:31], s47 offen
    s_mov_b32 s47, 1786752
    buffer_load_ushort v35, v6, s[24:27], s47 offen
    buffer_load_ushort v43, v6, s[28:31], s47 offen
    s_mov_b32 s47, 1790208
    buffer_load_ushort v36, v6, s[24:27], s47 offen
    buffer_load_ushort v44, v6, s[28:31], s47 offen
    s_mov_b32 s47, 1793664
    buffer_load_ushort v37, v6, s[24:27], s47 offen
    buffer_load_ushort v45, v6, s[28:31], s47 offen
    s_waitcnt vmcnt(48)
    v_lshl_or_b32 v20, v47, 16, v46
    v_lshl_or_b32 v24, v55, 16, v54
    v_lshl_or_b32 v21, v49, 16, v48
    v_lshl_or_b32 v25, v57, 16, v56
    v_lshl_or_b32 v22, v51, 16, v50
    v_lshl_or_b32 v26, v59, 16, v58
    v_lshl_or_b32 v23, v53, 16, v52
    v_lshl_or_b32 v27, v61, 16, v60
    s_nop 0
    v_mfma_f32_16x16x32_bf16 v[12:15], v[20:23], v[152:155], v[12:15]
    v_mfma_f32_16x16x32_bf16 v[16:19], v[24:27], v[152:155], v[16:19]
    s_mov_b32 s47, 1880064
    buffer_load_ushort v46, v6, s[24:27], s47 offen
    buffer_load_ushort v54, v6, s[28:31], s47 offen
    s_mov_b32 s47, 1883520
    buffer_load_ushort v47, v6, s[24:27], s47 offen
    buffer_load_ushort v55, v6, s[28:31], s47 offen
    s_mov_b32 s47, 1886976
    buffer_load_ushort v48, v6, s[24:27], s47 offen
    buffer_load_ushort v56, v6, s[28:31], s47 offen
    s_mov_b32 s47, 1890432
    buffer_load_ushort v49, v6, s[24:27], s47 offen
    buffer_load_ushort v57, v6, s[28:31], s47 offen
    s_mov_b32 s47, 1893888
    buffer_load_ushort v50, v6, s[24:27], s47 offen
    buffer_load_ushort v58, v6, s[28:31], s47 offen
    s_mov_b32 s47, 1897344
    buffer_load_ushort v51, v6, s[24:27], s47 offen
    buffer_load_ushort v59, v6, s[28:31], s47 offen
    s_mov_b32 s47, 1900800
    buffer_load_ushort v52, v6, s[24:27], s47 offen
    buffer_load_ushort v60, v6, s[28:31], s47 offen
    s_mov_b32 s47, 1904256
    buffer_load_ushort v53, v6, s[24:27], s47 offen
    buffer_load_ushort v61, v6, s[28:31], s47 offen
    s_waitcnt vmcnt(48)
    v_lshl_or_b32 v20, v63, 16, v62
    v_lshl_or_b32 v24, v71, 16, v70
    v_lshl_or_b32 v21, v65, 16, v64
    v_lshl_or_b32 v25, v73, 16, v72
    v_lshl_or_b32 v22, v67, 16, v66
    v_lshl_or_b32 v26, v75, 16, v74
    v_lshl_or_b32 v23, v69, 16, v68
    v_lshl_or_b32 v27, v77, 16, v76
    s_nop 0
    v_mfma_f32_16x16x32_bf16 v[12:15], v[20:23], v[156:159], v[12:15]
    v_mfma_f32_16x16x32_bf16 v[16:19], v[24:27], v[156:159], v[16:19]
    s_mov_b32 s47, 1990656
    buffer_load_ushort v62, v6, s[24:27], s47 offen
    buffer_load_ushort v70, v6, s[28:31], s47 offen
    s_mov_b32 s47, 1994112
    buffer_load_ushort v63, v6, s[24:27], s47 offen
    buffer_load_ushort v71, v6, s[28:31], s47 offen
    s_mov_b32 s47, 1997568
    buffer_load_ushort v64, v6, s[24:27], s47 offen
    buffer_load_ushort v72, v6, s[28:31], s47 offen
    s_mov_b32 s47, 2001024
    buffer_load_ushort v65, v6, s[24:27], s47 offen
    buffer_load_ushort v73, v6, s[28:31], s47 offen
    s_mov_b32 s47, 2004480
    buffer_load_ushort v66, v6, s[24:27], s47 offen
    buffer_load_ushort v74, v6, s[28:31], s47 offen
    s_mov_b32 s47, 2007936
    buffer_load_ushort v67, v6, s[24:27], s47 offen
    buffer_load_ushort v75, v6, s[28:31], s47 offen
    s_mov_b32 s47, 2011392
    buffer_load_ushort v68, v6, s[24:27], s47 offen
    buffer_load_ushort v76, v6, s[28:31], s47 offen
    s_mov_b32 s47, 2014848
    buffer_load_ushort v69, v6, s[24:27], s47 offen
    buffer_load_ushort v77, v6, s[28:31], s47 offen
    s_waitcnt vmcnt(48)
    v_lshl_or_b32 v20, v79, 16, v78
    v_lshl_or_b32 v24, v87, 16, v86
    v_lshl_or_b32 v21, v81, 16, v80
    v_lshl_or_b32 v25, v89, 16, v88
    v_lshl_or_b32 v22, v83, 16, v82
    v_lshl_or_b32 v26, v91, 16, v90
    v_lshl_or_b32 v23, v85, 16, v84
    v_lshl_or_b32 v27, v93, 16, v92
    s_nop 0
    v_mfma_f32_16x16x32_bf16 v[12:15], v[20:23], v[160:163], v[12:15]
    v_mfma_f32_16x16x32_bf16 v[16:19], v[24:27], v[160:163], v[16:19]
    s_mov_b32 s47, 2101248
    buffer_load_ushort v78, v6, s[24:27], s47 offen
    buffer_load_ushort v86, v6, s[28:31], s47 offen
    s_mov_b32 s47, 2104704
    buffer_load_ushort v79, v6, s[24:27], s47 offen
    buffer_load_ushort v87, v6, s[28:31], s47 offen
    s_mov_b32 s47, 2108160
    buffer_load_ushort v80, v6, s[24:27], s47 offen
    buffer_load_ushort v88, v6, s[28:31], s47 offen
    s_mov_b32 s47, 2111616
    buffer_load_ushort v81, v6, s[24:27], s47 offen
    buffer_load_ushort v89, v6, s[28:31], s47 offen
    s_mov_b32 s47, 2115072
    buffer_load_ushort v82, v6, s[24:27], s47 offen
    buffer_load_ushort v90, v6, s[28:31], s47 offen
    s_mov_b32 s47, 2118528
    buffer_load_ushort v83, v6, s[24:27], s47 offen
    buffer_load_ushort v91, v6, s[28:31], s47 offen
    s_mov_b32 s47, 2121984
    buffer_load_ushort v84, v6, s[24:27], s47 offen
    buffer_load_ushort v92, v6, s[28:31], s47 offen
    s_mov_b32 s47, 2125440
    buffer_load_ushort v85, v6, s[24:27], s47 offen
    buffer_load_ushort v93, v6, s[28:31], s47 offen
    s_waitcnt vmcnt(48)
    v_lshl_or_b32 v20, v31, 16, v30
    v_lshl_or_b32 v24, v39, 16, v38
    v_lshl_or_b32 v21, v33, 16, v32
    v_lshl_or_b32 v25, v41, 16, v40
    v_lshl_or_b32 v22, v35, 16, v34
    v_lshl_or_b32 v26, v43, 16, v42
    v_lshl_or_b32 v23, v37, 16, v36
    v_lshl_or_b32 v27, v45, 16, v44
    s_nop 0
    v_mfma_f32_16x16x32_bf16 v[12:15], v[20:23], v[164:167], v[12:15]
    v_mfma_f32_16x16x32_bf16 v[16:19], v[24:27], v[164:167], v[16:19]
    s_waitcnt vmcnt(32)
    v_lshl_or_b32 v20, v47, 16, v46
    v_lshl_or_b32 v24, v55, 16, v54
    v_lshl_or_b32 v21, v49, 16, v48
    v_lshl_or_b32 v25, v57, 16, v56
    v_lshl_or_b32 v22, v51, 16, v50
    v_lshl_or_b32 v26, v59, 16, v58
    v_lshl_or_b32 v23, v53, 16, v52
    v_lshl_or_b32 v27, v61, 16, v60
    s_nop 0
    v_mfma_f32_16x16x32_bf16 v[12:15], v[20:23], v[168:171], v[12:15]
    v_mfma_f32_16x16x32_bf16 v[16:19], v[24:27], v[168:171], v[16:19]
    s_waitcnt vmcnt(16)
    v_lshl_or_b32 v20, v63, 16, v62
    v_lshl_or_b32 v24, v71, 16, v70
    v_lshl_or_b32 v21, v65, 16, v64
    v_lshl_or_b32 v25, v73, 16, v72
    v_lshl_or_b32 v22, v67, 16, v66
    v_lshl_or_b32 v26, v75, 16, v74
    v_lshl_or_b32 v23, v69, 16, v68
    v_lshl_or_b32 v27, v77, 16, v76
    s_nop 0
    v_mfma_f32_16x16x32_bf16 v[12:15], v[20:23], v[172:175], v[12:15]
    v_mfma_f32_16x16x32_bf16 v[16:19], v[24:27], v[172:175], v[16:19]
    s_waitcnt vmcnt(0)
    v_lshl_or_b32 v20, v79, 16, v78
    v_lshl_or_b32 v24, v87, 16, v86
    v_lshl_or_b32 v21, v81, 16, v80
    v_lshl_or_b32 v25, v89, 16, v88
    v_lshl_or_b32 v22, v83, 16, v82
    v_lshl_or_b32 v26, v91, 16, v90
    v_lshl_or_b32 v23, v85, 16, v84
    v_lshl_or_b32 v27, v93, 16, v92
    s_nop 0
    v_mfma_f32_16x16x32_bf16 v[12:15], v[20:23], v[176:179], v[12:15]
    v_mfma_f32_16x16x32_bf16 v[16:19], v[24:27], v[176:179], v[16:19]
    s_mov_b32 s38, 0xbfb8aa3b
    s_nop 6
    v_cvt_pk_bf16_f32 v20, v12, v16
    v_lshlrev_b32 v21, 16, v20
    v_and_b32 v22, 0xffff0000, v20
    v_mul_f32 v23, s38, v21
    v_exp_f32 v23, v23
    s_nop 0
    v_add_f32 v23, 1.0, v23
    v_rcp_f32 v24, v23
    s_nop 0
    v_mul_f32 v25, v21, v24
    v_fma_f32 v26, -v25, v23, v21
    v_fma_f32 v25, v26, v24, v25
    v_cvt_pk_bf16_f32 v25, v25, v25
    v_lshlrev_b32 v25, 16, v25
    v_mul_f32 v12, v25, v22
    v_cvt_pk_bf16_f32 v20, v13, v17
    v_lshlrev_b32 v21, 16, v20
    v_and_b32 v22, 0xffff0000, v20
    v_mul_f32 v23, s38, v21
    v_exp_f32 v23, v23
    s_nop 0
    v_add_f32 v23, 1.0, v23
    v_rcp_f32 v24, v23
    s_nop 0
    v_mul_f32 v25, v21, v24
    v_fma_f32 v26, -v25, v23, v21
    v_fma_f32 v25, v26, v24, v25
    v_cvt_pk_bf16_f32 v25, v25, v25
    v_lshlrev_b32 v25, 16, v25
    v_mul_f32 v13, v25, v22
    v_cvt_pk_bf16_f32 v20, v14, v18
    v_lshlrev_b32 v21, 16, v20
    v_and_b32 v22, 0xffff0000, v20
    v_mul_f32 v23, s38, v21
    v_exp_f32 v23, v23
    s_nop 0
    v_add_f32 v23, 1.0, v23
    v_rcp_f32 v24, v23
    s_nop 0
    v_mul_f32 v25, v21, v24
    v_fma_f32 v26, -v25, v23, v21
    v_fma_f32 v25, v26, v24, v25
    v_cvt_pk_bf16_f32 v25, v25, v25
    v_lshlrev_b32 v25, 16, v25
    v_mul_f32 v14, v25, v22
    v_cvt_pk_bf16_f32 v20, v15, v19
    v_lshlrev_b32 v21, 16, v20
    v_and_b32 v22, 0xffff0000, v20
    v_mul_f32 v23, s38, v21
    v_exp_f32 v23, v23
    s_nop 0
    v_add_f32 v23, 1.0, v23
    v_rcp_f32 v24, v23
    s_nop 0
    v_mul_f32 v25, v21, v24
    v_fma_f32 v26, -v25, v23, v21
    v_fma_f32 v25, v26, v24, v25
    v_cvt_pk_bf16_f32 v25, v25, v25
    v_lshlrev_b32 v25, 16, v25
    v_mul_f32 v15, v25, v22
    v_cvt_pk_bf16_f32 v20, v12, v13
    v_cvt_pk_bf16_f32 v21, v14, v15
    v_mul_u32_u24 v5, 3456, v9
    v_lshl_add_u32 v5, v8, 3, v5
    s_lshl_b32 s39, s36, 7
    s_lshl_b32 s40, s3, 5
    s_add_u32 s39, s39, s40
    s_add_u32 s39, s39, 3211264
    v_cmp_gt_u32 vcc, 8, v9
    s_nop 0
    s_and_saveexec_b64 s[42:43], vcc
    buffer_store_dwordx2 v[20:21], v5, s[32:35], s39 offen sc1
    s_mov_b64 exec, s[42:43]
    s_waitcnt vmcnt(0)
    s_barrier
    s_cmp_lg_u32 s3, 0
    s_cbranch_scc1 moe1_nofl
    s_lshl_b32 s39, s36, 2
    s_add_u32 s39, s39, 3379200
    v_mov_b32 v5, 1
    v_mov_b32 v6, 0
    buffer_store_dword v5, v6, s[32:35], s39 offen sc1
    s_nop 3
moe1_nofl:
    s_cmp_ge_u32 s36, 10
    s_cbranch_scc1 g1_done
    v_min_u32 v5, 26, v1
    v_lshlrev_b32 v5, 2, v5
    s_mov_b32 s39, 3379200
    s_mov_b32 s46, 400000
    s_nop 2
moe1_wait:
    buffer_load_dword v6, v5, s[32:35], s39 offen sc1
    s_waitcnt vmcnt(0)
    v_cmp_eq_u32 vcc, 0, v6
    s_nop 4
    s_cbranch_vccz moe1_go
    s_sleep 16
    s_sub_u32 s46, s46, 1
    s_cmp_lg_u32 s46, 0
    s_cbranch_scc1 moe1_wait
moe1_go:
    v_mov_b32 v2, v8
    v_mov_b32 v3, v9
    s_add_u32 s2, s36, 72
    s_sub_u32 s36, s2, 72
    s_load_dwordx2 s[4:5], s[0:1], 88
    s_waitcnt lgkmcnt(0)
    s_mov_b32 s20, s4
    s_and_b32 s21, s5, 0xffff
    s_mov_b32 s22, 2211840
    s_mov_b32 s23, 0x00020000
    v_and_b32 v5, 7, v3
    v_lshlrev_b32 v6, 2, v5
    s_mov_b32 s37, 3178496
    buffer_load_dword v8, v6, s[32:35], s37 offen offset:32 sc1
    v_mul_u32_u24 v5, 3456, v5
    v_lshl_add_u32 v5, v2, 4, v5
    s_mov_b32 s37, 3211264
    buffer_load_dwordx4 v[32:35], v5, s[32:35], s37 offen offset:0 sc1
    buffer_load_dwordx4 v[36:39], v5, s[32:35], s37 offen offset:64 sc1
    buffer_load_dwordx4 v[40:43], v5, s[32:35], s37 offen offset:128 sc1
    buffer_load_dwordx4 v[44:47], v5, s[32:35], s37 offen offset:192 sc1
    buffer_load_dwordx4 v[48:51], v5, s[32:35], s37 offen offset:256 sc1
    buffer_load_dwordx4 v[52:55], v5, s[32:35], s37 offen offset:320 sc1
    buffer_load_dwordx4 v[56:59], v5, s[32:35], s37 offen offset:384 sc1
    buffer_load_dwordx4 v[60:63], v5, s[32:35], s37 offen offset:448 sc1
    buffer_load_dwordx4 v[64:67], v5, s[32:35], s37 offen offset:512 sc1
    buffer_load_dwordx4 v[68:71], v5, s[32:35], s37 offen offset:576 sc1
    buffer_load_dwordx4 v[72:75], v5, s[32:35], s37 offen offset:640 sc1
    buffer_load_dwordx4 v[76:79], v5, s[32:35], s37 offen offset:704 sc1
    buffer_load_dwordx4 v[80:83], v5, s[32:35], s37 offen offset:768 sc1
    buffer_load_dwordx4 v[84:87], v5, s[32:35], s37 offen offset:832 sc1
    buffer_load_dwordx4 v[88:91], v5, s[32:35], s37 offen offset:896 sc1
    buffer_load_dwordx4 v[92:95], v5, s[32:35], s37 offen offset:960 sc1
    buffer_load_dwordx4 v[96:99], v5, s[32:35], s37 offen offset:1024 sc1
    buffer_load_dwordx4 v[100:103], v5, s[32:35], s37 offen offset:1088 sc1
    buffer_load_dwordx4 v[104:107], v5, s[32:35], s37 offen offset:1152 sc1
    buffer_load_dwordx4 v[108:111], v5, s[32:35], s37 offen offset:1216 sc1
    buffer_load_dwordx4 v[112:115], v5, s[32:35], s37 offen offset:1280 sc1
    buffer_load_dwordx4 v[116:119], v5, s[32:35], s37 offen offset:1344 sc1
    buffer_load_dwordx4 v[120:123], v5, s[32:35], s37 offen offset:1408 sc1
    buffer_load_dwordx4 v[124:127], v5, s[32:35], s37 offen offset:1472 sc1
    buffer_load_dwordx4 v[128:131], v5, s[32:35], s37 offen offset:1536 sc1
    buffer_load_dwordx4 v[132:135], v5, s[32:35], s37 offen offset:1600 sc1
    buffer_load_dwordx4 v[136:139], v5, s[32:35], s37 offen offset:1664 sc1
    buffer_load_dwordx4 v[140:143], v5, s[32:35], s37 offen offset:1728 sc1
    buffer_load_dwordx4 v[144:147], v5, s[32:35], s37 offen offset:1792 sc1
    buffer_load_dwordx4 v[148:151], v5, s[32:35], s37 offen offset:1856 sc1
    buffer_load_dwordx4 v[152:155], v5, s[32:35], s37 offen offset:1920 sc1
    buffer_load_dwordx4 v[156:159], v5, s[32:35], s37 offen offset:1984 sc1
    buffer_load_dwordx4 v[160:163], v5, s[32:35], s37 offen offset:2048 sc1
    buffer_load_dwordx4 v[164:167], v5, s[32:35], s37 offen offset:2112 sc1
    buffer_load_dwordx4 v[168:171], v5, s[32:35], s37 offen offset:2176 sc1
    buffer_load_dwordx4 v[172:175], v5, s[32:35], s37 offen offset:2240 sc1
    buffer_load_dwordx4 v[176:179], v5, s[32:35], s37 offen offset:2304 sc1
    buffer_load_dwordx4 v[180:183], v5, s[32:35], s37 offen offset:2368 sc1
    buffer_load_dwordx4 v[184:187], v5, s[32:35], s37 offen offset:2432 sc1
    buffer_load_dwordx4 v[188:191], v5, s[32:35], s37 offen offset:2496 sc1
    buffer_load_dwordx4 v[192:195], v5, s[32:35], s37 offen offset:2560 sc1
    buffer_load_dwordx4 v[196:199], v5, s[32:35], s37 offen offset:2624 sc1
    buffer_load_dwordx4 v[200:203], v5, s[32:35], s37 offen offset:2688 sc1
    buffer_load_dwordx4 v[204:207], v5, s[32:35], s37 offen offset:2752 sc1
    buffer_load_dwordx4 v[208:211], v5, s[32:35], s37 offen offset:2816 sc1
    buffer_load_dwordx4 v[212:215], v5, s[32:35], s37 offen offset:2880 sc1
    buffer_load_dwordx4 v[216:219], v5, s[32:35], s37 offen offset:2944 sc1
    buffer_load_dwordx4 v[220:223], v5, s[32:35], s37 offen offset:3008 sc1
    buffer_load_dwordx4 v[224:227], v5, s[32:35], s37 offen offset:3072 sc1
    buffer_load_dwordx4 v[228:231], v5, s[32:35], s37 offen offset:3136 sc1
    buffer_load_dwordx4 v[232:235], v5, s[32:35], s37 offen offset:3200 sc1
    buffer_load_dwordx4 v[236:239], v5, s[32:35], s37 offen offset:3264 sc1
    buffer_load_dwordx4 v[240:243], v5, s[32:35], s37 offen offset:3328 sc1
    buffer_load_dwordx4 v[244:247], v5, s[32:35], s37 offen offset:3392 sc1
    s_lshl_b32 s38, s36, 6
    s_lshl_b32 s39, s3, 4
    s_add_u32 s38, s38, s39
    v_add_u32 v6, s38, v3
    v_lshlrev_b32 v6, 1, v6
    v_mul_u32_u24 v7, 10240, v2
    v_add_u32 v6, v6, v7
    s_mov_b32 s47, 0
    buffer_load_ushort a0, v6, s[20:23], s47 offen
    s_mov_b32 s47, 1280
    buffer_load_ushort a1, v6, s[20:23], s47 offen
    s_mov_b32 s47, 2560
    buffer_load_ushort a2, v6, s[20:23], s47 offen
    s_mov_b32 s47, 3840
    buffer_load_ushort a3, v6, s[20:23], s47 offen
    s_mov_b32 s47, 5120
    buffer_load_ushort a4, v6, s[20:23], s47 offen
    s_mov_b32 s47, 6400
    buffer_load_ushort a5, v6, s[20:23], s47 offen
    s_mov_b32 s47, 7680
    buffer_load_ushort a6, v6, s[20:23], s47 offen
    s_mov_b32 s47, 8960
    buffer_load_ushort a7, v6, s[20:23], s47 offen
    s_mov_b32 s47, 40960
    buffer_load_ushort a8, v6, s[20:23], s47 offen
    s_mov_b32 s47, 42240
    buffer_load_ushort a9, v6, s[20:23], s47 offen
    s_mov_b32 s47, 43520
    buffer_load_ushort a10, v6, s[20:23], s47 offen
    s_mov_b32 s47, 44800
    buffer_load_ushort a11, v6, s[20:23], s47 offen
    s_mov_b32 s47, 46080
    buffer_load_ushort a12, v6, s[20:23], s47 offen
    s_mov_b32 s47, 47360
    buffer_load_ushort a13, v6, s[20:23], s47 offen
    s_mov_b32 s47, 48640
    buffer_load_ushort a14, v6, s[20:23], s47 offen
    s_mov_b32 s47, 49920
    buffer_load_ushort a15, v6, s[20:23], s47 offen
    s_mov_b32 s47, 81920
    buffer_load_ushort a16, v6, s[20:23], s47 offen
    s_mov_b32 s47, 83200
    buffer_load_ushort a17, v6, s[20:23], s47 offen
    s_mov_b32 s47, 84480
    buffer_load_ushort a18, v6, s[20:23], s47 offen
    s_mov_b32 s47, 85760
    buffer_load_ushort a19, v6, s[20:23], s47 offen
    s_mov_b32 s47, 87040
    buffer_load_ushort a20, v6, s[20:23], s47 offen
    s_mov_b32 s47, 88320
    buffer_load_ushort a21, v6, s[20:23], s47 offen
    s_mov_b32 s47, 89600
    buffer_load_ushort a22, v6, s[20:23], s47 offen
    s_mov_b32 s47, 90880
    buffer_load_ushort a23, v6, s[20:23], s47 offen
    s_mov_b32 s47, 122880
    buffer_load_ushort a24, v6, s[20:23], s47 offen
    s_mov_b32 s47, 124160
    buffer_load_ushort a25, v6, s[20:23], s47 offen
    s_mov_b32 s47, 125440
    buffer_load_ushort a26, v6, s[20:23], s47 offen
    s_mov_b32 s47, 126720
    buffer_load_ushort a27, v6, s[20:23], s47 offen
    s_mov_b32 s47, 128000
    buffer_load_ushort a28, v6, s[20:23], s47 offen
    s_mov_b32 s47, 129280
    buffer_load_ushort a29, v6, s[20:23], s47 offen
    s_mov_b32 s47, 130560
    buffer_load_ushort a30, v6, s[20:23], s47 offen
    s_mov_b32 s47, 131840
    buffer_load_ushort a31, v6, s[20:23], s47 offen
    s_mov_b32 s47, 163840
    buffer_load_ushort a32, v6, s[20:23], s47 offen
    s_mov_b32 s47, 165120
    buffer_load_ushort a33, v6, s[20:23], s47 offen
    s_mov_b32 s47, 166400
    buffer_load_ushort a34, v6, s[20:23], s47 offen
    s_mov_b32 s47, 167680
    buffer_load_ushort a35, v6, s[20:23], s47 offen
    s_mov_b32 s47, 168960
    buffer_load_ushort a36, v6, s[20:23], s47 offen
    s_mov_b32 s47, 170240
    buffer_load_ushort a37, v6, s[20:23], s47 offen
    s_mov_b32 s47, 171520
    buffer_load_ushort a38, v6, s[20:23], s47 offen
    s_mov_b32 s47, 172800
    buffer_load_ushort a39, v6, s[20:23], s47 offen
    s_mov_b32 s47, 204800
    buffer_load_ushort a40, v6, s[20:23], s47 offen
    s_mov_b32 s47, 206080
    buffer_load_ushort a41, v6, s[20:23], s47 offen
    s_mov_b32 s47, 207360
    buffer_load_ushort a42, v6, s[20:23], s47 offen
    s_mov_b32 s47, 208640
    buffer_load_ushort a43, v6, s[20:23], s47 offen
    s_mov_b32 s47, 209920
    buffer_load_ushort a44, v6, s[20:23], s47 offen
    s_mov_b32 s47, 211200
    buffer_load_ushort a45, v6, s[20:23], s47 offen
    s_mov_b32 s47, 212480
    buffer_load_ushort a46, v6, s[20:23], s47 offen
    s_mov_b32 s47, 213760
    buffer_load_ushort a47, v6, s[20:23], s47 offen
    s_waitcnt vmcnt(40)
    v_accvgpr_read_b32 v16, a0
    v_accvgpr_read_b32 v17, a1
    v_lshl_or_b32 v20, v17, 16, v16
    v_accvgpr_read_b32 v16, a2
    v_accvgpr_read_b32 v17, a3
    v_lshl_or_b32 v21, v17, 16, v16
    v_accvgpr_read_b32 v16, a4
    v_accvgpr_read_b32 v17, a5
    v_lshl_or_b32 v22, v17, 16, v16
    v_accvgpr_read_b32 v16, a6
    v_accvgpr_read_b32 v17, a7
    v_lshl_or_b32 v23, v17, 16, v16
    s_nop 1
    v_mfma_f32_16x16x32_bf16 v[12:15], v[20:23], v[32:35], 0
    s_mov_b32 s47, 245760
    buffer_load_ushort a0, v6, s[20:23], s47 offen
    s_mov_b32 s47, 247040
    buffer_load_ushort a1, v6, s[20:23], s47 offen
    s_mov_b32 s47, 248320
    buffer_load_ushort a2, v6, s[20:23], s47 offen
    s_mov_b32 s47, 249600
    buffer_load_ushort a3, v6, s[20:23], s47 offen
    s_mov_b32 s47, 250880
    buffer_load_ushort a4, v6, s[20:23], s47 offen
    s_mov_b32 s47, 252160
    buffer_load_ushort a5, v6, s[20:23], s47 offen
    s_mov_b32 s47, 253440
    buffer_load_ushort a6, v6, s[20:23], s47 offen
    s_mov_b32 s47, 254720
    buffer_load_ushort a7, v6, s[20:23], s47 offen
    s_waitcnt vmcnt(40)
    v_accvgpr_read_b32 v16, a8
    v_accvgpr_read_b32 v17, a9
    v_lshl_or_b32 v20, v17, 16, v16
    v_accvgpr_read_b32 v16, a10
    v_accvgpr_read_b32 v17, a11
    v_lshl_or_b32 v21, v17, 16, v16
    v_accvgpr_read_b32 v16, a12
    v_accvgpr_read_b32 v17, a13
    v_lshl_or_b32 v22, v17, 16, v16
    v_accvgpr_read_b32 v16, a14
    v_accvgpr_read_b32 v17, a15
    v_lshl_or_b32 v23, v17, 16, v16
    s_nop 1
    v_mfma_f32_16x16x32_bf16 v[12:15], v[20:23], v[36:39], v[12:15]
    s_mov_b32 s47, 286720
    buffer_load_ushort a8, v6, s[20:23], s47 offen
    s_mov_b32 s47, 288000
    buffer_load_ushort a9, v6, s[20:23], s47 offen
    s_mov_b32 s47, 289280
    buffer_load_ushort a10, v6, s[20:23], s47 offen
    s_mov_b32 s47, 290560
    buffer_load_ushort a11, v6, s[20:23], s47 offen
    s_mov_b32 s47, 291840
    buffer_load_ushort a12, v6, s[20:23], s47 offen
    s_mov_b32 s47, 293120
    buffer_load_ushort a13, v6, s[20:23], s47 offen
    s_mov_b32 s47, 294400
    buffer_load_ushort a14, v6, s[20:23], s47 offen
    s_mov_b32 s47, 295680
    buffer_load_ushort a15, v6, s[20:23], s47 offen
    s_waitcnt vmcnt(40)
    v_accvgpr_read_b32 v16, a16
    v_accvgpr_read_b32 v17, a17
    v_lshl_or_b32 v20, v17, 16, v16
    v_accvgpr_read_b32 v16, a18
    v_accvgpr_read_b32 v17, a19
    v_lshl_or_b32 v21, v17, 16, v16
    v_accvgpr_read_b32 v16, a20
    v_accvgpr_read_b32 v17, a21
    v_lshl_or_b32 v22, v17, 16, v16
    v_accvgpr_read_b32 v16, a22
    v_accvgpr_read_b32 v17, a23
    v_lshl_or_b32 v23, v17, 16, v16
    s_nop 1
    v_mfma_f32_16x16x32_bf16 v[12:15], v[20:23], v[40:43], v[12:15]
    s_mov_b32 s47, 327680
    buffer_load_ushort a16, v6, s[20:23], s47 offen
    s_mov_b32 s47, 328960
    buffer_load_ushort a17, v6, s[20:23], s47 offen
    s_mov_b32 s47, 330240
    buffer_load_ushort a18, v6, s[20:23], s47 offen
    s_mov_b32 s47, 331520
    buffer_load_ushort a19, v6, s[20:23], s47 offen
    s_mov_b32 s47, 332800
    buffer_load_ushort a20, v6, s[20:23], s47 offen
    s_mov_b32 s47, 334080
    buffer_load_ushort a21, v6, s[20:23], s47 offen
    s_mov_b32 s47, 335360
    buffer_load_ushort a22, v6, s[20:23], s47 offen
    s_mov_b32 s47, 336640
    buffer_load_ushort a23, v6, s[20:23], s47 offen
    s_waitcnt vmcnt(40)
    v_accvgpr_read_b32 v16, a24
    v_accvgpr_read_b32 v17, a25
    v_lshl_or_b32 v20, v17, 16, v16
    v_accvgpr_read_b32 v16, a26
    v_accvgpr_read_b32 v17, a27
    v_lshl_or_b32 v21, v17, 16, v16
    v_accvgpr_read_b32 v16, a28
    v_accvgpr_read_b32 v17, a29
    v_lshl_or_b32 v22, v17, 16, v16
    v_accvgpr_read_b32 v16, a30
    v_accvgpr_read_b32 v17, a31
    v_lshl_or_b32 v23, v17, 16, v16
    s_nop 1
    v_mfma_f32_16x16x32_bf16 v[12:15], v[20:23], v[44:47], v[12:15]
    s_mov_b32 s47, 368640
    buffer_load_ushort a24, v6, s[20:23], s47 offen
    s_mov_b32 s47, 369920
    buffer_load_ushort a25, v6, s[20:23], s47 offen
    s_mov_b32 s47, 371200
    buffer_load_ushort a26, v6, s[20:23], s47 offen
    s_mov_b32 s47, 372480
    buffer_load_ushort a27, v6, s[20:23], s47 offen
    s_mov_b32 s47, 373760
    buffer_load_ushort a28, v6, s[20:23], s47 offen
    s_mov_b32 s47, 375040
    buffer_load_ushort a29, v6, s[20:23], s47 offen
    s_mov_b32 s47, 376320
    buffer_load_ushort a30, v6, s[20:23], s47 offen
    s_mov_b32 s47, 377600
    buffer_load_ushort a31, v6, s[20:23], s47 offen
    s_waitcnt vmcnt(40)
    v_accvgpr_read_b32 v16, a32
    v_accvgpr_read_b32 v17, a33
    v_lshl_or_b32 v20, v17, 16, v16
    v_accvgpr_read_b32 v16, a34
    v_accvgpr_read_b32 v17, a35
    v_lshl_or_b32 v21, v17, 16, v16
    v_accvgpr_read_b32 v16, a36
    v_accvgpr_read_b32 v17, a37
    v_lshl_or_b32 v22, v17, 16, v16
    v_accvgpr_read_b32 v16, a38
    v_accvgpr_read_b32 v17, a39
    v_lshl_or_b32 v23, v17, 16, v16
    s_nop 1
    v_mfma_f32_16x16x32_bf16 v[12:15], v[20:23], v[48:51], v[12:15]
    s_mov_b32 s47, 409600
    buffer_load_ushort a32, v6, s[20:23], s47 offen
    s_mov_b32 s47, 410880
    buffer_load_ushort a33, v6, s[20:23], s47 offen
    s_mov_b32 s47, 412160
    buffer_load_ushort a34, v6, s[20:23], s47 offen
    s_mov_b32 s47, 413440
    buffer_load_ushort a35, v6, s[20:23], s47 offen
    s_mov_b32 s47, 414720
    buffer_load_ushort a36, v6, s[20:23], s47 offen
    s_mov_b32 s47, 416000
    buffer_load_ushort a37, v6, s[20:23], s47 offen
    s_mov_b32 s47, 417280
    buffer_load_ushort a38, v6, s[20:23], s47 offen
    s_mov_b32 s47, 418560
    buffer_load_ushort a39, v6, s[20:23], s47 offen
    s_waitcnt vmcnt(40)
    v_accvgpr_read_b32 v16, a40
    v_accvgpr_read_b32 v17, a41
    v_lshl_or_b32 v20, v17, 16, v16
    v_accvgpr_read_b32 v16, a42
    v_accvgpr_read_b32 v17, a43
    v_lshl_or_b32 v21, v17, 16, v16
    v_accvgpr_read_b32 v16, a44
    v_accvgpr_read_b32 v17, a45
    v_lshl_or_b32 v22, v17, 16, v16
    v_accvgpr_read_b32 v16, a46
    v_accvgpr_read_b32 v17, a47
    v_lshl_or_b32 v23, v17, 16, v16
    s_nop 1
    v_mfma_f32_16x16x32_bf16 v[12:15], v[20:23], v[52:55], v[12:15]
    s_mov_b32 s47, 450560
    buffer_load_ushort a40, v6, s[20:23], s47 offen
    s_mov_b32 s47, 451840
    buffer_load_ushort a41, v6, s[20:23], s47 offen
    s_mov_b32 s47, 453120
    buffer_load_ushort a42, v6, s[20:23], s47 offen
    s_mov_b32 s47, 454400
    buffer_load_ushort a43, v6, s[20:23], s47 offen
    s_mov_b32 s47, 455680
    buffer_load_ushort a44, v6, s[20:23], s47 offen
    s_mov_b32 s47, 456960
    buffer_load_ushort a45, v6, s[20:23], s47 offen
    s_mov_b32 s47, 458240
    buffer_load_ushort a46, v6, s[20:23], s47 offen
    s_mov_b32 s47, 459520
    buffer_load_ushort a47, v6, s[20:23], s47 offen
    s_waitcnt vmcnt(40)
    v_accvgpr_read_b32 v16, a0
    v_accvgpr_read_b32 v17, a1
    v_lshl_or_b32 v20, v17, 16, v16
    v_accvgpr_read_b32 v16, a2
    v_accvgpr_read_b32 v17, a3
    v_lshl_or_b32 v21, v17, 16, v16
    v_accvgpr_read_b32 v16, a4
    v_accvgpr_read_b32 v17, a5
    v_lshl_or_b32 v22, v17, 16, v16
    v_accvgpr_read_b32 v16, a6
    v_accvgpr_read_b32 v17, a7
    v_lshl_or_b32 v23, v17, 16, v16
    s_nop 1
    v_mfma_f32_16x16x32_bf16 v[12:15], v[20:23], v[56:59], v[12:15]
    s_mov_b32 s47, 491520
    buffer_load_ushort a0, v6, s[20:23], s47 offen
    s_mov_b32 s47, 492800
    buffer_load_ushort a1, v6, s[20:23], s47 offen
    s_mov_b32 s47, 494080
    buffer_load_ushort a2, v6, s[20:23], s47 offen
    s_mov_b32 s47, 495360
    buffer_load_ushort a3, v6, s[20:23], s47 offen
    s_mov_b32 s47, 496640
    buffer_load_ushort a4, v6, s[20:23], s47 offen
    s_mov_b32 s47, 497920
    buffer_load_ushort a5, v6, s[20:23], s47 offen
    s_mov_b32 s47, 499200
    buffer_load_ushort a6, v6, s[20:23], s47 offen
    s_mov_b32 s47, 500480
    buffer_load_ushort a7, v6, s[20:23], s47 offen
    s_waitcnt vmcnt(40)
    v_accvgpr_read_b32 v16, a8
    v_accvgpr_read_b32 v17, a9
    v_lshl_or_b32 v20, v17, 16, v16
    v_accvgpr_read_b32 v16, a10
    v_accvgpr_read_b32 v17, a11
    v_lshl_or_b32 v21, v17, 16, v16
    v_accvgpr_read_b32 v16, a12
    v_accvgpr_read_b32 v17, a13
    v_lshl_or_b32 v22, v17, 16, v16
    v_accvgpr_read_b32 v16, a14
    v_accvgpr_read_b32 v17, a15
    v_lshl_or_b32 v23, v17, 16, v16
    s_nop 1
    v_mfma_f32_16x16x32_bf16 v[12:15], v[20:23], v[60:63], v[12:15]
    s_mov_b32 s47, 532480
    buffer_load_ushort a8, v6, s[20:23], s47 offen
    s_mov_b32 s47, 533760
    buffer_load_ushort a9, v6, s[20:23], s47 offen
    s_mov_b32 s47, 535040
    buffer_load_ushort a10, v6, s[20:23], s47 offen
    s_mov_b32 s47, 536320
    buffer_load_ushort a11, v6, s[20:23], s47 offen
    s_mov_b32 s47, 537600
    buffer_load_ushort a12, v6, s[20:23], s47 offen
    s_mov_b32 s47, 538880
    buffer_load_ushort a13, v6, s[20:23], s47 offen
    s_mov_b32 s47, 540160
    buffer_load_ushort a14, v6, s[20:23], s47 offen
    s_mov_b32 s47, 541440
    buffer_load_ushort a15, v6, s[20:23], s47 offen
    s_waitcnt vmcnt(40)
    v_accvgpr_read_b32 v16, a16
    v_accvgpr_read_b32 v17, a17
    v_lshl_or_b32 v20, v17, 16, v16
    v_accvgpr_read_b32 v16, a18
    v_accvgpr_read_b32 v17, a19
    v_lshl_or_b32 v21, v17, 16, v16
    v_accvgpr_read_b32 v16, a20
    v_accvgpr_read_b32 v17, a21
    v_lshl_or_b32 v22, v17, 16, v16
    v_accvgpr_read_b32 v16, a22
    v_accvgpr_read_b32 v17, a23
    v_lshl_or_b32 v23, v17, 16, v16
    s_nop 1
    v_mfma_f32_16x16x32_bf16 v[12:15], v[20:23], v[64:67], v[12:15]
    s_mov_b32 s47, 573440
    buffer_load_ushort a16, v6, s[20:23], s47 offen
    s_mov_b32 s47, 574720
    buffer_load_ushort a17, v6, s[20:23], s47 offen
    s_mov_b32 s47, 576000
    buffer_load_ushort a18, v6, s[20:23], s47 offen
    s_mov_b32 s47, 577280
    buffer_load_ushort a19, v6, s[20:23], s47 offen
    s_mov_b32 s47, 578560
    buffer_load_ushort a20, v6, s[20:23], s47 offen
    s_mov_b32 s47, 579840
    buffer_load_ushort a21, v6, s[20:23], s47 offen
    s_mov_b32 s47, 581120
    buffer_load_ushort a22, v6, s[20:23], s47 offen
    s_mov_b32 s47, 582400
    buffer_load_ushort a23, v6, s[20:23], s47 offen
    s_waitcnt vmcnt(40)
    v_accvgpr_read_b32 v16, a24
    v_accvgpr_read_b32 v17, a25
    v_lshl_or_b32 v20, v17, 16, v16
    v_accvgpr_read_b32 v16, a26
    v_accvgpr_read_b32 v17, a27
    v_lshl_or_b32 v21, v17, 16, v16
    v_accvgpr_read_b32 v16, a28
    v_accvgpr_read_b32 v17, a29
    v_lshl_or_b32 v22, v17, 16, v16
    v_accvgpr_read_b32 v16, a30
    v_accvgpr_read_b32 v17, a31
    v_lshl_or_b32 v23, v17, 16, v16
    s_nop 1
    v_mfma_f32_16x16x32_bf16 v[12:15], v[20:23], v[68:71], v[12:15]
    s_mov_b32 s47, 614400
    buffer_load_ushort a24, v6, s[20:23], s47 offen
    s_mov_b32 s47, 615680
    buffer_load_ushort a25, v6, s[20:23], s47 offen
    s_mov_b32 s47, 616960
    buffer_load_ushort a26, v6, s[20:23], s47 offen
    s_mov_b32 s47, 618240
    buffer_load_ushort a27, v6, s[20:23], s47 offen
    s_mov_b32 s47, 619520
    buffer_load_ushort a28, v6, s[20:23], s47 offen
    s_mov_b32 s47, 620800
    buffer_load_ushort a29, v6, s[20:23], s47 offen
    s_mov_b32 s47, 622080
    buffer_load_ushort a30, v6, s[20:23], s47 offen
    s_mov_b32 s47, 623360
    buffer_load_ushort a31, v6, s[20:23], s47 offen
    s_waitcnt vmcnt(40)
    v_accvgpr_read_b32 v16, a32
    v_accvgpr_read_b32 v17, a33
    v_lshl_or_b32 v20, v17, 16, v16
    v_accvgpr_read_b32 v16, a34
    v_accvgpr_read_b32 v17, a35
    v_lshl_or_b32 v21, v17, 16, v16
    v_accvgpr_read_b32 v16, a36
    v_accvgpr_read_b32 v17, a37
    v_lshl_or_b32 v22, v17, 16, v16
    v_accvgpr_read_b32 v16, a38
    v_accvgpr_read_b32 v17, a39
    v_lshl_or_b32 v23, v17, 16, v16
    s_nop 1
    v_mfma_f32_16x16x32_bf16 v[12:15], v[20:23], v[72:75], v[12:15]
    s_mov_b32 s47, 655360
    buffer_load_ushort a32, v6, s[20:23], s47 offen
    s_mov_b32 s47, 656640
    buffer_load_ushort a33, v6, s[20:23], s47 offen
    s_mov_b32 s47, 657920
    buffer_load_ushort a34, v6, s[20:23], s47 offen
    s_mov_b32 s47, 659200
    buffer_load_ushort a35, v6, s[20:23], s47 offen
    s_mov_b32 s47, 660480
    buffer_load_ushort a36, v6, s[20:23], s47 offen
    s_mov_b32 s47, 661760
    buffer_load_ushort a37, v6, s[20:23], s47 offen
    s_mov_b32 s47, 663040
    buffer_load_ushort a38, v6, s[20:23], s47 offen
    s_mov_b32 s47, 664320
    buffer_load_ushort a39, v6, s[20:23], s47 offen
    s_waitcnt vmcnt(40)
    v_accvgpr_read_b32 v16, a40
    v_accvgpr_read_b32 v17, a41
    v_lshl_or_b32 v20, v17, 16, v16
    v_accvgpr_read_b32 v16, a42
    v_accvgpr_read_b32 v17, a43
    v_lshl_or_b32 v21, v17, 16, v16
    v_accvgpr_read_b32 v16, a44
    v_accvgpr_read_b32 v17, a45
    v_lshl_or_b32 v22, v17, 16, v16
    v_accvgpr_read_b32 v16, a46
    v_accvgpr_read_b32 v17, a47
    v_lshl_or_b32 v23, v17, 16, v16
    s_nop 1
    v_mfma_f32_16x16x32_bf16 v[12:15], v[20:23], v[76:79], v[12:15]
    s_mov_b32 s47, 696320
    buffer_load_ushort a40, v6, s[20:23], s47 offen
    s_mov_b32 s47, 697600
    buffer_load_ushort a41, v6, s[20:23], s47 offen
    s_mov_b32 s47, 698880
    buffer_load_ushort a42, v6, s[20:23], s47 offen
    s_mov_b32 s47, 700160
    buffer_load_ushort a43, v6, s[20:23], s47 offen
    s_mov_b32 s47, 701440
    buffer_load_ushort a44, v6, s[20:23], s47 offen
    s_mov_b32 s47, 702720
    buffer_load_ushort a45, v6, s[20:23], s47 offen
    s_mov_b32 s47, 704000
    buffer_load_ushort a46, v6, s[20:23], s47 offen
    s_mov_b32 s47, 705280
    buffer_load_ushort a47, v6, s[20:23], s47 offen
    s_waitcnt vmcnt(40)
    v_accvgpr_read_b32 v16, a0
    v_accvgpr_read_b32 v17, a1
    v_lshl_or_b32 v20, v17, 16, v16
    v_accvgpr_read_b32 v16, a2
    v_accvgpr_read_b32 v17, a3
    v_lshl_or_b32 v21, v17, 16, v16
    v_accvgpr_read_b32 v16, a4
    v_accvgpr_read_b32 v17, a5
    v_lshl_or_b32 v22, v17, 16, v16
    v_accvgpr_read_b32 v16, a6
    v_accvgpr_read_b32 v17, a7
    v_lshl_or_b32 v23, v17, 16, v16
    s_nop 1
    v_mfma_f32_16x16x32_bf16 v[12:15], v[20:23], v[80:83], v[12:15]
    s_mov_b32 s47, 737280
    buffer_load_ushort a0, v6, s[20:23], s47 offen
    s_mov_b32 s47, 738560
    buffer_load_ushort a1, v6, s[20:23], s47 offen
    s_mov_b32 s47, 739840
    buffer_load_ushort a2, v6, s[20:23], s47 offen
    s_mov_b32 s47, 741120
    buffer_load_ushort a3, v6, s[20:23], s47 offen
    s_mov_b32 s47, 742400
    buffer_load_ushort a4, v6, s[20:23], s47 offen
    s_mov_b32 s47, 743680
    buffer_load_ushort a5, v6, s[20:23], s47 offen
    s_mov_b32 s47, 744960
    buffer_load_ushort a6, v6, s[20:23], s47 offen
    s_mov_b32 s47, 746240
    buffer_load_ushort a7, v6, s[20:23], s47 offen
    s_waitcnt vmcnt(40)
    v_accvgpr_read_b32 v16, a8
    v_accvgpr_read_b32 v17, a9
    v_lshl_or_b32 v20, v17, 16, v16
    v_accvgpr_read_b32 v16, a10
    v_accvgpr_read_b32 v17, a11
    v_lshl_or_b32 v21, v17, 16, v16
    v_accvgpr_read_b32 v16, a12
    v_accvgpr_read_b32 v17, a13
    v_lshl_or_b32 v22, v17, 16, v16
    v_accvgpr_read_b32 v16, a14
    v_accvgpr_read_b32 v17, a15
    v_lshl_or_b32 v23, v17, 16, v16
    s_nop 1
    v_mfma_f32_16x16x32_bf16 v[12:15], v[20:23], v[84:87], v[12:15]
    s_mov_b32 s47, 778240
    buffer_load_ushort a8, v6, s[20:23], s47 offen
    s_mov_b32 s47, 779520
    buffer_load_ushort a9, v6, s[20:23], s47 offen
    s_mov_b32 s47, 780800
    buffer_load_ushort a10, v6, s[20:23], s47 offen
    s_mov_b32 s47, 782080
    buffer_load_ushort a11, v6, s[20:23], s47 offen
    s_mov_b32 s47, 783360
    buffer_load_ushort a12, v6, s[20:23], s47 offen
    s_mov_b32 s47, 784640
    buffer_load_ushort a13, v6, s[20:23], s47 offen
    s_mov_b32 s47, 785920
    buffer_load_ushort a14, v6, s[20:23], s47 offen
    s_mov_b32 s47, 787200
    buffer_load_ushort a15, v6, s[20:23], s47 offen
    s_waitcnt vmcnt(40)
    v_accvgpr_read_b32 v16, a16
    v_accvgpr_read_b32 v17, a17
    v_lshl_or_b32 v20, v17, 16, v16
    v_accvgpr_read_b32 v16, a18
    v_accvgpr_read_b32 v17, a19
    v_lshl_or_b32 v21, v17, 16, v16
    v_accvgpr_read_b32 v16, a20
    v_accvgpr_read_b32 v17, a21
    v_lshl_or_b32 v22, v17, 16, v16
    v_accvgpr_read_b32 v16, a22
    v_accvgpr_read_b32 v17, a23
    v_lshl_or_b32 v23, v17, 16, v16
    s_nop 1
    v_mfma_f32_16x16x32_bf16 v[12:15], v[20:23], v[88:91], v[12:15]
    s_mov_b32 s47, 819200
    buffer_load_ushort a16, v6, s[20:23], s47 offen
    s_mov_b32 s47, 820480
    buffer_load_ushort a17, v6, s[20:23], s47 offen
    s_mov_b32 s47, 821760
    buffer_load_ushort a18, v6, s[20:23], s47 offen
    s_mov_b32 s47, 823040
    buffer_load_ushort a19, v6, s[20:23], s47 offen
    s_mov_b32 s47, 824320
    buffer_load_ushort a20, v6, s[20:23], s47 offen
    s_mov_b32 s47, 825600
    buffer_load_ushort a21, v6, s[20:23], s47 offen
    s_mov_b32 s47, 826880
    buffer_load_ushort a22, v6, s[20:23], s47 offen
    s_mov_b32 s47, 828160
    buffer_load_ushort a23, v6, s[20:23], s47 offen
    s_waitcnt vmcnt(40)
    v_accvgpr_read_b32 v16, a24
    v_accvgpr_read_b32 v17, a25
    v_lshl_or_b32 v20, v17, 16, v16
    v_accvgpr_read_b32 v16, a26
    v_accvgpr_read_b32 v17, a27
    v_lshl_or_b32 v21, v17, 16, v16
    v_accvgpr_read_b32 v16, a28
    v_accvgpr_read_b32 v17, a29
    v_lshl_or_b32 v22, v17, 16, v16
    v_accvgpr_read_b32 v16, a30
    v_accvgpr_read_b32 v17, a31
    v_lshl_or_b32 v23, v17, 16, v16
    s_nop 1
    v_mfma_f32_16x16x32_bf16 v[12:15], v[20:23], v[92:95], v[12:15]
    s_mov_b32 s47, 860160
    buffer_load_ushort a24, v6, s[20:23], s47 offen
    s_mov_b32 s47, 861440
    buffer_load_ushort a25, v6, s[20:23], s47 offen
    s_mov_b32 s47, 862720
    buffer_load_ushort a26, v6, s[20:23], s47 offen
    s_mov_b32 s47, 864000
    buffer_load_ushort a27, v6, s[20:23], s47 offen
    s_mov_b32 s47, 865280
    buffer_load_ushort a28, v6, s[20:23], s47 offen
    s_mov_b32 s47, 866560
    buffer_load_ushort a29, v6, s[20:23], s47 offen
    s_mov_b32 s47, 867840
    buffer_load_ushort a30, v6, s[20:23], s47 offen
    s_mov_b32 s47, 869120
    buffer_load_ushort a31, v6, s[20:23], s47 offen
    s_waitcnt vmcnt(40)
    v_accvgpr_read_b32 v16, a32
    v_accvgpr_read_b32 v17, a33
    v_lshl_or_b32 v20, v17, 16, v16
    v_accvgpr_read_b32 v16, a34
    v_accvgpr_read_b32 v17, a35
    v_lshl_or_b32 v21, v17, 16, v16
    v_accvgpr_read_b32 v16, a36
    v_accvgpr_read_b32 v17, a37
    v_lshl_or_b32 v22, v17, 16, v16
    v_accvgpr_read_b32 v16, a38
    v_accvgpr_read_b32 v17, a39
    v_lshl_or_b32 v23, v17, 16, v16
    s_nop 1
    v_mfma_f32_16x16x32_bf16 v[12:15], v[20:23], v[96:99], v[12:15]
    s_mov_b32 s47, 901120
    buffer_load_ushort a32, v6, s[20:23], s47 offen
    s_mov_b32 s47, 902400
    buffer_load_ushort a33, v6, s[20:23], s47 offen
    s_mov_b32 s47, 903680
    buffer_load_ushort a34, v6, s[20:23], s47 offen
    s_mov_b32 s47, 904960
    buffer_load_ushort a35, v6, s[20:23], s47 offen
    s_mov_b32 s47, 906240
    buffer_load_ushort a36, v6, s[20:23], s47 offen
    s_mov_b32 s47, 907520
    buffer_load_ushort a37, v6, s[20:23], s47 offen
    s_mov_b32 s47, 908800
    buffer_load_ushort a38, v6, s[20:23], s47 offen
    s_mov_b32 s47, 910080
    buffer_load_ushort a39, v6, s[20:23], s47 offen
    s_waitcnt vmcnt(40)
    v_accvgpr_read_b32 v16, a40
    v_accvgpr_read_b32 v17, a41
    v_lshl_or_b32 v20, v17, 16, v16
    v_accvgpr_read_b32 v16, a42
    v_accvgpr_read_b32 v17, a43
    v_lshl_or_b32 v21, v17, 16, v16
    v_accvgpr_read_b32 v16, a44
    v_accvgpr_read_b32 v17, a45
    v_lshl_or_b32 v22, v17, 16, v16
    v_accvgpr_read_b32 v16, a46
    v_accvgpr_read_b32 v17, a47
    v_lshl_or_b32 v23, v17, 16, v16
    s_nop 1
    v_mfma_f32_16x16x32_bf16 v[12:15], v[20:23], v[100:103], v[12:15]
    s_mov_b32 s47, 942080
    buffer_load_ushort a40, v6, s[20:23], s47 offen
    s_mov_b32 s47, 943360
    buffer_load_ushort a41, v6, s[20:23], s47 offen
    s_mov_b32 s47, 944640
    buffer_load_ushort a42, v6, s[20:23], s47 offen
    s_mov_b32 s47, 945920
    buffer_load_ushort a43, v6, s[20:23], s47 offen
    s_mov_b32 s47, 947200
    buffer_load_ushort a44, v6, s[20:23], s47 offen
    s_mov_b32 s47, 948480
    buffer_load_ushort a45, v6, s[20:23], s47 offen
    s_mov_b32 s47, 949760
    buffer_load_ushort a46, v6, s[20:23], s47 offen
    s_mov_b32 s47, 951040
    buffer_load_ushort a47, v6, s[20:23], s47 offen
    s_waitcnt vmcnt(40)
    v_accvgpr_read_b32 v16, a0
    v_accvgpr_read_b32 v17, a1
    v_lshl_or_b32 v20, v17, 16, v16
    v_accvgpr_read_b32 v16, a2
    v_accvgpr_read_b32 v17, a3
    v_lshl_or_b32 v21, v17, 16, v16
    v_accvgpr_read_b32 v16, a4
    v_accvgpr_read_b32 v17, a5
    v_lshl_or_b32 v22, v17, 16, v16
    v_accvgpr_read_b32 v16, a6
    v_accvgpr_read_b32 v17, a7
    v_lshl_or_b32 v23, v17, 16, v16
    s_nop 1
    v_mfma_f32_16x16x32_bf16 v[12:15], v[20:23], v[104:107], v[12:15]
    s_mov_b32 s47, 983040
    buffer_load_ushort a0, v6, s[20:23], s47 offen
    s_mov_b32 s47, 984320
    buffer_load_ushort a1, v6, s[20:23], s47 offen
    s_mov_b32 s47, 985600
    buffer_load_ushort a2, v6, s[20:23], s47 offen
    s_mov_b32 s47, 986880
    buffer_load_ushort a3, v6, s[20:23], s47 offen
    s_mov_b32 s47, 988160
    buffer_load_ushort a4, v6, s[20:23], s47 offen
    s_mov_b32 s47, 989440
    buffer_load_ushort a5, v6, s[20:23], s47 offen
    s_mov_b32 s47, 990720
    buffer_load_ushort a6, v6, s[20:23], s47 offen
    s_mov_b32 s47, 992000
    buffer_load_ushort a7, v6, s[20:23], s47 offen
    s_waitcnt vmcnt(40)
    v_accvgpr_read_b32 v16, a8
    v_accvgpr_read_b32 v17, a9
    v_lshl_or_b32 v20, v17, 16, v16
    v_accvgpr_read_b32 v16, a10
    v_accvgpr_read_b32 v17, a11
    v_lshl_or_b32 v21, v17, 16, v16
    v_accvgpr_read_b32 v16, a12
    v_accvgpr_read_b32 v17, a13
    v_lshl_or_b32 v22, v17, 16, v16
    v_accvgpr_read_b32 v16, a14
    v_accvgpr_read_b32 v17, a15
    v_lshl_or_b32 v23, v17, 16, v16
    s_nop 1
    v_mfma_f32_16x16x32_bf16 v[12:15], v[20:23], v[108:111], v[12:15]
    s_mov_b32 s47, 1024000
    buffer_load_ushort a8, v6, s[20:23], s47 offen
    s_mov_b32 s47, 1025280
    buffer_load_ushort a9, v6, s[20:23], s47 offen
    s_mov_b32 s47, 1026560
    buffer_load_ushort a10, v6, s[20:23], s47 offen
    s_mov_b32 s47, 1027840
    buffer_load_ushort a11, v6, s[20:23], s47 offen
    s_mov_b32 s47, 1029120
    buffer_load_ushort a12, v6, s[20:23], s47 offen
    s_mov_b32 s47, 1030400
    buffer_load_ushort a13, v6, s[20:23], s47 offen
    s_mov_b32 s47, 1031680
    buffer_load_ushort a14, v6, s[20:23], s47 offen
    s_mov_b32 s47, 1032960
    buffer_load_ushort a15, v6, s[20:23], s47 offen
    s_waitcnt vmcnt(40)
    v_accvgpr_read_b32 v16, a16
    v_accvgpr_read_b32 v17, a17
    v_lshl_or_b32 v20, v17, 16, v16
    v_accvgpr_read_b32 v16, a18
    v_accvgpr_read_b32 v17, a19
    v_lshl_or_b32 v21, v17, 16, v16
    v_accvgpr_read_b32 v16, a20
    v_accvgpr_read_b32 v17, a21
    v_lshl_or_b32 v22, v17, 16, v16
    v_accvgpr_read_b32 v16, a22
    v_accvgpr_read_b32 v17, a23
    v_lshl_or_b32 v23, v17, 16, v16
    s_nop 1
    v_mfma_f32_16x16x32_bf16 v[12:15], v[20:23], v[112:115], v[12:15]
    s_mov_b32 s47, 1064960
    buffer_load_ushort a16, v6, s[20:23], s47 offen
    s_mov_b32 s47, 1066240
    buffer_load_ushort a17, v6, s[20:23], s47 offen
    s_mov_b32 s47, 1067520
    buffer_load_ushort a18, v6, s[20:23], s47 offen
    s_mov_b32 s47, 1068800
    buffer_load_ushort a19, v6, s[20:23], s47 offen
    s_mov_b32 s47, 1070080
    buffer_load_ushort a20, v6, s[20:23], s47 offen
    s_mov_b32 s47, 1071360
    buffer_load_ushort a21, v6, s[20:23], s47 offen
    s_mov_b32 s47, 1072640
    buffer_load_ushort a22, v6, s[20:23], s47 offen
    s_mov_b32 s47, 1073920
    buffer_load_ushort a23, v6, s[20:23], s47 offen
    s_waitcnt vmcnt(40)
    v_accvgpr_read_b32 v16, a24
    v_accvgpr_read_b32 v17, a25
    v_lshl_or_b32 v20, v17, 16, v16
    v_accvgpr_read_b32 v16, a26
    v_accvgpr_read_b32 v17, a27
    v_lshl_or_b32 v21, v17, 16, v16
    v_accvgpr_read_b32 v16, a28
    v_accvgpr_read_b32 v17, a29
    v_lshl_or_b32 v22, v17, 16, v16
    v_accvgpr_read_b32 v16, a30
    v_accvgpr_read_b32 v17, a31
    v_lshl_or_b32 v23, v17, 16, v16
    s_nop 1
    v_mfma_f32_16x16x32_bf16 v[12:15], v[20:23], v[116:119], v[12:15]
    s_mov_b32 s47, 1105920
    buffer_load_ushort a24, v6, s[20:23], s47 offen
    s_mov_b32 s47, 1107200
    buffer_load_ushort a25, v6, s[20:23], s47 offen
    s_mov_b32 s47, 1108480
    buffer_load_ushort a26, v6, s[20:23], s47 offen
    s_mov_b32 s47, 1109760
    buffer_load_ushort a27, v6, s[20:23], s47 offen
    s_mov_b32 s47, 1111040
    buffer_load_ushort a28, v6, s[20:23], s47 offen
    s_mov_b32 s47, 1112320
    buffer_load_ushort a29, v6, s[20:23], s47 offen
    s_mov_b32 s47, 1113600
    buffer_load_ushort a30, v6, s[20:23], s47 offen
    s_mov_b32 s47, 1114880
    buffer_load_ushort a31, v6, s[20:23], s47 offen
    s_waitcnt vmcnt(40)
    v_accvgpr_read_b32 v16, a32
    v_accvgpr_read_b32 v17, a33
    v_lshl_or_b32 v20, v17, 16, v16
    v_accvgpr_read_b32 v16, a34
    v_accvgpr_read_b32 v17, a35
    v_lshl_or_b32 v21, v17, 16, v16
    v_accvgpr_read_b32 v16, a36
    v_accvgpr_read_b32 v17, a37
    v_lshl_or_b32 v22, v17, 16, v16
    v_accvgpr_read_b32 v16, a38
    v_accvgpr_read_b32 v17, a39
    v_lshl_or_b32 v23, v17, 16, v16
    s_nop 1
    v_mfma_f32_16x16x32_bf16 v[12:15], v[20:23], v[120:123], v[12:15]
    s_mov_b32 s47, 1146880
    buffer_load_ushort a32, v6, s[20:23], s47 offen
    s_mov_b32 s47, 1148160
    buffer_load_ushort a33, v6, s[20:23], s47 offen
    s_mov_b32 s47, 1149440
    buffer_load_ushort a34, v6, s[20:23], s47 offen
    s_mov_b32 s47, 1150720
    buffer_load_ushort a35, v6, s[20:23], s47 offen
    s_mov_b32 s47, 1152000
    buffer_load_ushort a36, v6, s[20:23], s47 offen
    s_mov_b32 s47, 1153280
    buffer_load_ushort a37, v6, s[20:23], s47 offen
    s_mov_b32 s47, 1154560
    buffer_load_ushort a38, v6, s[20:23], s47 offen
    s_mov_b32 s47, 1155840
    buffer_load_ushort a39, v6, s[20:23], s47 offen
    s_waitcnt vmcnt(40)
    v_accvgpr_read_b32 v16, a40
    v_accvgpr_read_b32 v17, a41
    v_lshl_or_b32 v20, v17, 16, v16
    v_accvgpr_read_b32 v16, a42
    v_accvgpr_read_b32 v17, a43
    v_lshl_or_b32 v21, v17, 16, v16
    v_accvgpr_read_b32 v16, a44
    v_accvgpr_read_b32 v17, a45
    v_lshl_or_b32 v22, v17, 16, v16
    v_accvgpr_read_b32 v16, a46
    v_accvgpr_read_b32 v17, a47
    v_lshl_or_b32 v23, v17, 16, v16
    s_nop 1
    v_mfma_f32_16x16x32_bf16 v[12:15], v[20:23], v[124:127], v[12:15]
    s_mov_b32 s47, 1187840
    buffer_load_ushort a40, v6, s[20:23], s47 offen
    s_mov_b32 s47, 1189120
    buffer_load_ushort a41, v6, s[20:23], s47 offen
    s_mov_b32 s47, 1190400
    buffer_load_ushort a42, v6, s[20:23], s47 offen
    s_mov_b32 s47, 1191680
    buffer_load_ushort a43, v6, s[20:23], s47 offen
    s_mov_b32 s47, 1192960
    buffer_load_ushort a44, v6, s[20:23], s47 offen
    s_mov_b32 s47, 1194240
    buffer_load_ushort a45, v6, s[20:23], s47 offen
    s_mov_b32 s47, 1195520
    buffer_load_ushort a46, v6, s[20:23], s47 offen
    s_mov_b32 s47, 1196800
    buffer_load_ushort a47, v6, s[20:23], s47 offen
    s_waitcnt vmcnt(40)
    v_accvgpr_read_b32 v16, a0
    v_accvgpr_read_b32 v17, a1
    v_lshl_or_b32 v20, v17, 16, v16
    v_accvgpr_read_b32 v16, a2
    v_accvgpr_read_b32 v17, a3
    v_lshl_or_b32 v21, v17, 16, v16
    v_accvgpr_read_b32 v16, a4
    v_accvgpr_read_b32 v17, a5
    v_lshl_or_b32 v22, v17, 16, v16
    v_accvgpr_read_b32 v16, a6
    v_accvgpr_read_b32 v17, a7
    v_lshl_or_b32 v23, v17, 16, v16
    s_nop 1
    v_mfma_f32_16x16x32_bf16 v[12:15], v[20:23], v[128:131], v[12:15]
    s_mov_b32 s47, 1228800
    buffer_load_ushort a0, v6, s[20:23], s47 offen
    s_mov_b32 s47, 1230080
    buffer_load_ushort a1, v6, s[20:23], s47 offen
    s_mov_b32 s47, 1231360
    buffer_load_ushort a2, v6, s[20:23], s47 offen
    s_mov_b32 s47, 1232640
    buffer_load_ushort a3, v6, s[20:23], s47 offen
    s_mov_b32 s47, 1233920
    buffer_load_ushort a4, v6, s[20:23], s47 offen
    s_mov_b32 s47, 1235200
    buffer_load_ushort a5, v6, s[20:23], s47 offen
    s_mov_b32 s47, 1236480
    buffer_load_ushort a6, v6, s[20:23], s47 offen
    s_mov_b32 s47, 1237760
    buffer_load_ushort a7, v6, s[20:23], s47 offen
    s_waitcnt vmcnt(40)
    v_accvgpr_read_b32 v16, a8
    v_accvgpr_read_b32 v17, a9
    v_lshl_or_b32 v20, v17, 16, v16
    v_accvgpr_read_b32 v16, a10
    v_accvgpr_read_b32 v17, a11
    v_lshl_or_b32 v21, v17, 16, v16
    v_accvgpr_read_b32 v16, a12
    v_accvgpr_read_b32 v17, a13
    v_lshl_or_b32 v22, v17, 16, v16
    v_accvgpr_read_b32 v16, a14
    v_accvgpr_read_b32 v17, a15
    v_lshl_or_b32 v23, v17, 16, v16
    s_nop 1
    v_mfma_f32_16x16x32_bf16 v[12:15], v[20:23], v[132:135], v[12:15]
    s_mov_b32 s47, 1269760
    buffer_load_ushort a8, v6, s[20:23], s47 offen
    s_mov_b32 s47, 1271040
    buffer_load_ushort a9, v6, s[20:23], s47 offen
    s_mov_b32 s47, 1272320
    buffer_load_ushort a10, v6, s[20:23], s47 offen
    s_mov_b32 s47, 1273600
    buffer_load_ushort a11, v6, s[20:23], s47 offen
    s_mov_b32 s47, 1274880
    buffer_load_ushort a12, v6, s[20:23], s47 offen
    s_mov_b32 s47, 1276160
    buffer_load_ushort a13, v6, s[20:23], s47 offen
    s_mov_b32 s47, 1277440
    buffer_load_ushort a14, v6, s[20:23], s47 offen
    s_mov_b32 s47, 1278720
    buffer_load_ushort a15, v6, s[20:23], s47 offen
    s_waitcnt vmcnt(40)
    v_accvgpr_read_b32 v16, a16
    v_accvgpr_read_b32 v17, a17
    v_lshl_or_b32 v20, v17, 16, v16
    v_accvgpr_read_b32 v16, a18
    v_accvgpr_read_b32 v17, a19
    v_lshl_or_b32 v21, v17, 16, v16
    v_accvgpr_read_b32 v16, a20
    v_accvgpr_read_b32 v17, a21
    v_lshl_or_b32 v22, v17, 16, v16
    v_accvgpr_read_b32 v16, a22
    v_accvgpr_read_b32 v17, a23
    v_lshl_or_b32 v23, v17, 16, v16
    s_nop 1
    v_mfma_f32_16x16x32_bf16 v[12:15], v[20:23], v[136:139], v[12:15]
    s_mov_b32 s47, 1310720
    buffer_load_ushort a16, v6, s[20:23], s47 offen
    s_mov_b32 s47, 1312000
    buffer_load_ushort a17, v6, s[20:23], s47 offen
    s_mov_b32 s47, 1313280
    buffer_load_ushort a18, v6, s[20:23], s47 offen
    s_mov_b32 s47, 1314560
    buffer_load_ushort a19, v6, s[20:23], s47 offen
    s_mov_b32 s47, 1315840
    buffer_load_ushort a20, v6, s[20:23], s47 offen
    s_mov_b32 s47, 1317120
    buffer_load_ushort a21, v6, s[20:23], s47 offen
    s_mov_b32 s47, 1318400
    buffer_load_ushort a22, v6, s[20:23], s47 offen
    s_mov_b32 s47, 1319680
    buffer_load_ushort a23, v6, s[20:23], s47 offen
    s_waitcnt vmcnt(40)
    v_accvgpr_read_b32 v16, a24
    v_accvgpr_read_b32 v17, a25
    v_lshl_or_b32 v20, v17, 16, v16
    v_accvgpr_read_b32 v16, a26
    v_accvgpr_read_b32 v17, a27
    v_lshl_or_b32 v21, v17, 16, v16
    v_accvgpr_read_b32 v16, a28
    v_accvgpr_read_b32 v17, a29
    v_lshl_or_b32 v22, v17, 16, v16
    v_accvgpr_read_b32 v16, a30
    v_accvgpr_read_b32 v17, a31
    v_lshl_or_b32 v23, v17, 16, v16
    s_nop 1
    v_mfma_f32_16x16x32_bf16 v[12:15], v[20:23], v[140:143], v[12:15]
    s_mov_b32 s47, 1351680
    buffer_load_ushort a24, v6, s[20:23], s47 offen
    s_mov_b32 s47, 1352960
    buffer_load_ushort a25, v6, s[20:23], s47 offen
    s_mov_b32 s47, 1354240
    buffer_load_ushort a26, v6, s[20:23], s47 offen
    s_mov_b32 s47, 1355520
    buffer_load_ushort a27, v6, s[20:23], s47 offen
    s_mov_b32 s47, 1356800
    buffer_load_ushort a28, v6, s[20:23], s47 offen
    s_mov_b32 s47, 1358080
    buffer_load_ushort a29, v6, s[20:23], s47 offen
    s_mov_b32 s47, 1359360
    buffer_load_ushort a30, v6, s[20:23], s47 offen
    s_mov_b32 s47, 1360640
    buffer_load_ushort a31, v6, s[20:23], s47 offen
    s_waitcnt vmcnt(40)
    v_accvgpr_read_b32 v16, a32
    v_accvgpr_read_b32 v17, a33
    v_lshl_or_b32 v20, v17, 16, v16
    v_accvgpr_read_b32 v16, a34
    v_accvgpr_read_b32 v17, a35
    v_lshl_or_b32 v21, v17, 16, v16
    v_accvgpr_read_b32 v16, a36
    v_accvgpr_read_b32 v17, a37
    v_lshl_or_b32 v22, v17, 16, v16
    v_accvgpr_read_b32 v16, a38
    v_accvgpr_read_b32 v17, a39
    v_lshl_or_b32 v23, v17, 16, v16
    s_nop 1
    v_mfma_f32_16x16x32_bf16 v[12:15], v[20:23], v[144:147], v[12:15]
    s_mov_b32 s47, 1392640
    buffer_load_ushort a32, v6, s[20:23], s47 offen
    s_mov_b32 s47, 1393920
    buffer_load_ushort a33, v6, s[20:23], s47 offen
    s_mov_b32 s47, 1395200
    buffer_load_ushort a34, v6, s[20:23], s47 offen
    s_mov_b32 s47, 1396480
    buffer_load_ushort a35, v6, s[20:23], s47 offen
    s_mov_b32 s47, 1397760
    buffer_load_ushort a36, v6, s[20:23], s47 offen
    s_mov_b32 s47, 1399040
    buffer_load_ushort a37, v6, s[20:23], s47 offen
    s_mov_b32 s47, 1400320
    buffer_load_ushort a38, v6, s[20:23], s47 offen
    s_mov_b32 s47, 1401600
    buffer_load_ushort a39, v6, s[20:23], s47 offen
    s_waitcnt vmcnt(40)
    v_accvgpr_read_b32 v16, a40
    v_accvgpr_read_b32 v17, a41
    v_lshl_or_b32 v20, v17, 16, v16
    v_accvgpr_read_b32 v16, a42
    v_accvgpr_read_b32 v17, a43
    v_lshl_or_b32 v21, v17, 16, v16
    v_accvgpr_read_b32 v16, a44
    v_accvgpr_read_b32 v17, a45
    v_lshl_or_b32 v22, v17, 16, v16
    v_accvgpr_read_b32 v16, a46
    v_accvgpr_read_b32 v17, a47
    v_lshl_or_b32 v23, v17, 16, v16
    s_nop 1
    v_mfma_f32_16x16x32_bf16 v[12:15], v[20:23], v[148:151], v[12:15]
    s_mov_b32 s47, 1433600
    buffer_load_ushort a40, v6, s[20:23], s47 offen
    s_mov_b32 s47, 1434880
    buffer_load_ushort a41, v6, s[20:23], s47 offen
    s_mov_b32 s47, 1436160
    buffer_load_ushort a42, v6, s[20:23], s47 offen
    s_mov_b32 s47, 1437440
    buffer_load_ushort a43, v6, s[20:23], s47 offen
    s_mov_b32 s47, 1438720
    buffer_load_ushort a44, v6, s[20:23], s47 offen
    s_mov_b32 s47, 1440000
    buffer_load_ushort a45, v6, s[20:23], s47 offen
    s_mov_b32 s47, 1441280
    buffer_load_ushort a46, v6, s[20:23], s47 offen
    s_mov_b32 s47, 1442560
    buffer_load_ushort a47, v6, s[20:23], s47 offen
    s_waitcnt vmcnt(40)
    v_accvgpr_read_b32 v16, a0
    v_accvgpr_read_b32 v17, a1
    v_lshl_or_b32 v20, v17, 16, v16
    v_accvgpr_read_b32 v16, a2
    v_accvgpr_read_b32 v17, a3
    v_lshl_or_b32 v21, v17, 16, v16
    v_accvgpr_read_b32 v16, a4
    v_accvgpr_read_b32 v17, a5
    v_lshl_or_b32 v22, v17, 16, v16
    v_accvgpr_read_b32 v16, a6
    v_accvgpr_read_b32 v17, a7
    v_lshl_or_b32 v23, v17, 16, v16
    s_nop 1
    v_mfma_f32_16x16x32_bf16 v[12:15], v[20:23], v[152:155], v[12:15]
    s_mov_b32 s47, 1474560
    buffer_load_ushort a0, v6, s[20:23], s47 offen
    s_mov_b32 s47, 1475840
    buffer_load_ushort a1, v6, s[20:23], s47 offen
    s_mov_b32 s47, 1477120
    buffer_load_ushort a2, v6, s[20:23], s47 offen
    s_mov_b32 s47, 1478400
    buffer_load_ushort a3, v6, s[20:23], s47 offen
    s_mov_b32 s47, 1479680
    buffer_load_ushort a4, v6, s[20:23], s47 offen
    s_mov_b32 s47, 1480960
    buffer_load_ushort a5, v6, s[20:23], s47 offen
    s_mov_b32 s47, 1482240
    buffer_load_ushort a6, v6, s[20:23], s47 offen
    s_mov_b32 s47, 1483520
    buffer_load_ushort a7, v6, s[20:23], s47 offen
    s_waitcnt vmcnt(40)
    v_accvgpr_read_b32 v16, a8
    v_accvgpr_read_b32 v17, a9
    v_lshl_or_b32 v20, v17, 16, v16
    v_accvgpr_read_b32 v16, a10
    v_accvgpr_read_b32 v17, a11
    v_lshl_or_b32 v21, v17, 16, v16
    v_accvgpr_read_b32 v16, a12
    v_accvgpr_read_b32 v17, a13
    v_lshl_or_b32 v22, v17, 16, v16
    v_accvgpr_read_b32 v16, a14
    v_accvgpr_read_b32 v17, a15
    v_lshl_or_b32 v23, v17, 16, v16
    s_nop 1
    v_mfma_f32_16x16x32_bf16 v[12:15], v[20:23], v[156:159], v[12:15]
    s_mov_b32 s47, 1515520
    buffer_load_ushort a8, v6, s[20:23], s47 offen
    s_mov_b32 s47, 1516800
    buffer_load_ushort a9, v6, s[20:23], s47 offen
    s_mov_b32 s47, 1518080
    buffer_load_ushort a10, v6, s[20:23], s47 offen
    s_mov_b32 s47, 1519360
    buffer_load_ushort a11, v6, s[20:23], s47 offen
    s_mov_b32 s47, 1520640
    buffer_load_ushort a12, v6, s[20:23], s47 offen
    s_mov_b32 s47, 1521920
    buffer_load_ushort a13, v6, s[20:23], s47 offen
    s_mov_b32 s47, 1523200
    buffer_load_ushort a14, v6, s[20:23], s47 offen
    s_mov_b32 s47, 1524480
    buffer_load_ushort a15, v6, s[20:23], s47 offen
    s_waitcnt vmcnt(40)
    v_accvgpr_read_b32 v16, a16
    v_accvgpr_read_b32 v17, a17
    v_lshl_or_b32 v20, v17, 16, v16
    v_accvgpr_read_b32 v16, a18
    v_accvgpr_read_b32 v17, a19
    v_lshl_or_b32 v21, v17, 16, v16
    v_accvgpr_read_b32 v16, a20
    v_accvgpr_read_b32 v17, a21
    v_lshl_or_b32 v22, v17, 16, v16
    v_accvgpr_read_b32 v16, a22
    v_accvgpr_read_b32 v17, a23
    v_lshl_or_b32 v23, v17, 16, v16
    s_nop 1
    v_mfma_f32_16x16x32_bf16 v[12:15], v[20:23], v[160:163], v[12:15]
    s_mov_b32 s47, 1556480
    buffer_load_ushort a16, v6, s[20:23], s47 offen
    s_mov_b32 s47, 1557760
    buffer_load_ushort a17, v6, s[20:23], s47 offen
    s_mov_b32 s47, 1559040
    buffer_load_ushort a18, v6, s[20:23], s47 offen
    s_mov_b32 s47, 1560320
    buffer_load_ushort a19, v6, s[20:23], s47 offen
    s_mov_b32 s47, 1561600
    buffer_load_ushort a20, v6, s[20:23], s47 offen
    s_mov_b32 s47, 1562880
    buffer_load_ushort a21, v6, s[20:23], s47 offen
    s_mov_b32 s47, 1564160
    buffer_load_ushort a22, v6, s[20:23], s47 offen
    s_mov_b32 s47, 1565440
    buffer_load_ushort a23, v6, s[20:23], s47 offen
    s_waitcnt vmcnt(40)
    v_accvgpr_read_b32 v16, a24
    v_accvgpr_read_b32 v17, a25
    v_lshl_or_b32 v20, v17, 16, v16
    v_accvgpr_read_b32 v16, a26
    v_accvgpr_read_b32 v17, a27
    v_lshl_or_b32 v21, v17, 16, v16
    v_accvgpr_read_b32 v16, a28
    v_accvgpr_read_b32 v17, a29
    v_lshl_or_b32 v22, v17, 16, v16
    v_accvgpr_read_b32 v16, a30
    v_accvgpr_read_b32 v17, a31
    v_lshl_or_b32 v23, v17, 16, v16
    s_nop 1
    v_mfma_f32_16x16x32_bf16 v[12:15], v[20:23], v[164:167], v[12:15]
    s_mov_b32 s47, 1597440
    buffer_load_ushort a24, v6, s[20:23], s47 offen
    s_mov_b32 s47, 1598720
    buffer_load_ushort a25, v6, s[20:23], s47 offen
    s_mov_b32 s47, 1600000
    buffer_load_ushort a26, v6, s[20:23], s47 offen
    s_mov_b32 s47, 1601280
    buffer_load_ushort a27, v6, s[20:23], s47 offen
    s_mov_b32 s47, 1602560
    buffer_load_ushort a28, v6, s[20:23], s47 offen
    s_mov_b32 s47, 1603840
    buffer_load_ushort a29, v6, s[20:23], s47 offen
    s_mov_b32 s47, 1605120
    buffer_load_ushort a30, v6, s[20:23], s47 offen
    s_mov_b32 s47, 1606400
    buffer_load_ushort a31, v6, s[20:23], s47 offen
    s_waitcnt vmcnt(40)
    v_accvgpr_read_b32 v16, a32
    v_accvgpr_read_b32 v17, a33
    v_lshl_or_b32 v20, v17, 16, v16
    v_accvgpr_read_b32 v16, a34
    v_accvgpr_read_b32 v17, a35
    v_lshl_or_b32 v21, v17, 16, v16
    v_accvgpr_read_b32 v16, a36
    v_accvgpr_read_b32 v17, a37
    v_lshl_or_b32 v22, v17, 16, v16
    v_accvgpr_read_b32 v16, a38
    v_accvgpr_read_b32 v17, a39
    v_lshl_or_b32 v23, v17, 16, v16
    s_nop 1
    v_mfma_f32_16x16x32_bf16 v[12:15], v[20:23], v[168:171], v[12:15]
    s_mov_b32 s47, 1638400
    buffer_load_ushort a32, v6, s[20:23], s47 offen
    s_mov_b32 s47, 1639680
    buffer_load_ushort a33, v6, s[20:23], s47 offen
    s_mov_b32 s47, 1640960
    buffer_load_ushort a34, v6, s[20:23], s47 offen
    s_mov_b32 s47, 1642240
    buffer_load_ushort a35, v6, s[20:23], s47 offen
    s_mov_b32 s47, 1643520
    buffer_load_ushort a36, v6, s[20:23], s47 offen
    s_mov_b32 s47, 1644800
    buffer_load_ushort a37, v6, s[20:23], s47 offen
    s_mov_b32 s47, 1646080
    buffer_load_ushort a38, v6, s[20:23], s47 offen
    s_mov_b32 s47, 1647360
    buffer_load_ushort a39, v6, s[20:23], s47 offen
    s_waitcnt vmcnt(40)
    v_accvgpr_read_b32 v16, a40
    v_accvgpr_read_b32 v17, a41
    v_lshl_or_b32 v20, v17, 16, v16
    v_accvgpr_read_b32 v16, a42
    v_accvgpr_read_b32 v17, a43
    v_lshl_or_b32 v21, v17, 16, v16
    v_accvgpr_read_b32 v16, a44
    v_accvgpr_read_b32 v17, a45
    v_lshl_or_b32 v22, v17, 16, v16
    v_accvgpr_read_b32 v16, a46
    v_accvgpr_read_b32 v17, a47
    v_lshl_or_b32 v23, v17, 16, v16
    s_nop 1
    v_mfma_f32_16x16x32_bf16 v[12:15], v[20:23], v[172:175], v[12:15]
    s_mov_b32 s47, 1679360
    buffer_load_ushort a40, v6, s[20:23], s47 offen
    s_mov_b32 s47, 1680640
    buffer_load_ushort a41, v6, s[20:23], s47 offen
    s_mov_b32 s47, 1681920
    buffer_load_ushort a42, v6, s[20:23], s47 offen
    s_mov_b32 s47, 1683200
    buffer_load_ushort a43, v6, s[20:23], s47 offen
    s_mov_b32 s47, 1684480
    buffer_load_ushort a44, v6, s[20:23], s47 offen
    s_mov_b32 s47, 1685760
    buffer_load_ushort a45, v6, s[20:23], s47 offen
    s_mov_b32 s47, 1687040
    buffer_load_ushort a46, v6, s[20:23], s47 offen
    s_mov_b32 s47, 1688320
    buffer_load_ushort a47, v6, s[20:23], s47 offen
    s_waitcnt vmcnt(40)
    v_accvgpr_read_b32 v16, a0
    v_accvgpr_read_b32 v17, a1
    v_lshl_or_b32 v20, v17, 16, v16
    v_accvgpr_read_b32 v16, a2
    v_accvgpr_read_b32 v17, a3
    v_lshl_or_b32 v21, v17, 16, v16
    v_accvgpr_read_b32 v16, a4
    v_accvgpr_read_b32 v17, a5
    v_lshl_or_b32 v22, v17, 16, v16
    v_accvgpr_read_b32 v16, a6
    v_accvgpr_read_b32 v17, a7
    v_lshl_or_b32 v23, v17, 16, v16
    s_nop 1
    v_mfma_f32_16x16x32_bf16 v[12:15], v[20:23], v[176:179], v[12:15]
    s_mov_b32 s47, 1720320
    buffer_load_ushort a0, v6, s[20:23], s47 offen
    s_mov_b32 s47, 1721600
    buffer_load_ushort a1, v6, s[20:23], s47 offen
    s_mov_b32 s47, 1722880
    buffer_load_ushort a2, v6, s[20:23], s47 offen
    s_mov_b32 s47, 1724160
    buffer_load_ushort a3, v6, s[20:23], s47 offen
    s_mov_b32 s47, 1725440
    buffer_load_ushort a4, v6, s[20:23], s47 offen
    s_mov_b32 s47, 1726720
    buffer_load_ushort a5, v6, s[20:23], s47 offen
    s_mov_b32 s47, 1728000
    buffer_load_ushort a6, v6, s[20:23], s47 offen
    s_mov_b32 s47, 1729280
    buffer_load_ushort a7, v6, s[20:23], s47 offen
    s_waitcnt vmcnt(40)
    v_accvgpr_read_b32 v16, a8
    v_accvgpr_read_b32 v17, a9
    v_lshl_or_b32 v20, v17, 16, v16
    v_accvgpr_read_b32 v16, a10
    v_accvgpr_read_b32 v17, a11
    v_lshl_or_b32 v21, v17, 16, v16
    v_accvgpr_read_b32 v16, a12
    v_accvgpr_read_b32 v17, a13
    v_lshl_or_b32 v22, v17, 16, v16
    v_accvgpr_read_b32 v16, a14
    v_accvgpr_read_b32 v17, a15
    v_lshl_or_b32 v23, v17, 16, v16
    s_nop 1
    v_mfma_f32_16x16x32_bf16 v[12:15], v[20:23], v[180:183], v[12:15]
    s_mov_b32 s47, 1761280
    buffer_load_ushort a8, v6, s[20:23], s47 offen
    s_mov_b32 s47, 1762560
    buffer_load_ushort a9, v6, s[20:23], s47 offen
    s_mov_b32 s47, 1763840
    buffer_load_ushort a10, v6, s[20:23], s47 offen
    s_mov_b32 s47, 1765120
    buffer_load_ushort a11, v6, s[20:23], s47 offen
    s_mov_b32 s47, 1766400
    buffer_load_ushort a12, v6, s[20:23], s47 offen
    s_mov_b32 s47, 1767680
    buffer_load_ushort a13, v6, s[20:23], s47 offen
    s_mov_b32 s47, 1768960
    buffer_load_ushort a14, v6, s[20:23], s47 offen
    s_mov_b32 s47, 1770240
    buffer_load_ushort a15, v6, s[20:23], s47 offen
    s_waitcnt vmcnt(40)
    v_accvgpr_read_b32 v16, a16
    v_accvgpr_read_b32 v17, a17
    v_lshl_or_b32 v20, v17, 16, v16
    v_accvgpr_read_b32 v16, a18
    v_accvgpr_read_b32 v17, a19
    v_lshl_or_b32 v21, v17, 16, v16
    v_accvgpr_read_b32 v16, a20
    v_accvgpr_read_b32 v17, a21
    v_lshl_or_b32 v22, v17, 16, v16
    v_accvgpr_read_b32 v16, a22
    v_accvgpr_read_b32 v17, a23
    v_lshl_or_b32 v23, v17, 16, v16
    s_nop 1
    v_mfma_f32_16x16x32_bf16 v[12:15], v[20:23], v[184:187], v[12:15]
    s_mov_b32 s47, 1802240
    buffer_load_ushort a16, v6, s[20:23], s47 offen
    s_mov_b32 s47, 1803520
    buffer_load_ushort a17, v6, s[20:23], s47 offen
    s_mov_b32 s47, 1804800
    buffer_load_ushort a18, v6, s[20:23], s47 offen
    s_mov_b32 s47, 1806080
    buffer_load_ushort a19, v6, s[20:23], s47 offen
    s_mov_b32 s47, 1807360
    buffer_load_ushort a20, v6, s[20:23], s47 offen
    s_mov_b32 s47, 1808640
    buffer_load_ushort a21, v6, s[20:23], s47 offen
    s_mov_b32 s47, 1809920
    buffer_load_ushort a22, v6, s[20:23], s47 offen
    s_mov_b32 s47, 1811200
    buffer_load_ushort a23, v6, s[20:23], s47 offen
    s_waitcnt vmcnt(40)
    v_accvgpr_read_b32 v16, a24
    v_accvgpr_read_b32 v17, a25
    v_lshl_or_b32 v20, v17, 16, v16
    v_accvgpr_read_b32 v16, a26
    v_accvgpr_read_b32 v17, a27
    v_lshl_or_b32 v21, v17, 16, v16
    v_accvgpr_read_b32 v16, a28
    v_accvgpr_read_b32 v17, a29
    v_lshl_or_b32 v22, v17, 16, v16
    v_accvgpr_read_b32 v16, a30
    v_accvgpr_read_b32 v17, a31
    v_lshl_or_b32 v23, v17, 16, v16
    s_nop 1
    v_mfma_f32_16x16x32_bf16 v[12:15], v[20:23], v[188:191], v[12:15]
    s_mov_b32 s47, 1843200
    buffer_load_ushort a24, v6, s[20:23], s47 offen
    s_mov_b32 s47, 1844480
    buffer_load_ushort a25, v6, s[20:23], s47 offen
    s_mov_b32 s47, 1845760
    buffer_load_ushort a26, v6, s[20:23], s47 offen
    s_mov_b32 s47, 1847040
    buffer_load_ushort a27, v6, s[20:23], s47 offen
    s_mov_b32 s47, 1848320
    buffer_load_ushort a28, v6, s[20:23], s47 offen
    s_mov_b32 s47, 1849600
    buffer_load_ushort a29, v6, s[20:23], s47 offen
    s_mov_b32 s47, 1850880
    buffer_load_ushort a30, v6, s[20:23], s47 offen
    s_mov_b32 s47, 1852160
    buffer_load_ushort a31, v6, s[20:23], s47 offen
    s_waitcnt vmcnt(40)
    v_accvgpr_read_b32 v16, a32
    v_accvgpr_read_b32 v17, a33
    v_lshl_or_b32 v20, v17, 16, v16
    v_accvgpr_read_b32 v16, a34
    v_accvgpr_read_b32 v17, a35
    v_lshl_or_b32 v21, v17, 16, v16
    v_accvgpr_read_b32 v16, a36
    v_accvgpr_read_b32 v17, a37
    v_lshl_or_b32 v22, v17, 16, v16
    v_accvgpr_read_b32 v16, a38
    v_accvgpr_read_b32 v17, a39
    v_lshl_or_b32 v23, v17, 16, v16
    s_nop 1
    v_mfma_f32_16x16x32_bf16 v[12:15], v[20:23], v[192:195], v[12:15]
    s_mov_b32 s47, 1884160
    buffer_load_ushort a32, v6, s[20:23], s47 offen
    s_mov_b32 s47, 1885440
    buffer_load_ushort a33, v6, s[20:23], s47 offen
    s_mov_b32 s47, 1886720
    buffer_load_ushort a34, v6, s[20:23], s47 offen
    s_mov_b32 s47, 1888000
    buffer_load_ushort a35, v6, s[20:23], s47 offen
    s_mov_b32 s47, 1889280
    buffer_load_ushort a36, v6, s[20:23], s47 offen
    s_mov_b32 s47, 1890560
    buffer_load_ushort a37, v6, s[20:23], s47 offen
    s_mov_b32 s47, 1891840
    buffer_load_ushort a38, v6, s[20:23], s47 offen
    s_mov_b32 s47, 1893120
    buffer_load_ushort a39, v6, s[20:23], s47 offen
    s_waitcnt vmcnt(40)
    v_accvgpr_read_b32 v16, a40
    v_accvgpr_read_b32 v17, a41
    v_lshl_or_b32 v20, v17, 16, v16
    v_accvgpr_read_b32 v16, a42
    v_accvgpr_read_b32 v17, a43
    v_lshl_or_b32 v21, v17, 16, v16
    v_accvgpr_read_b32 v16, a44
    v_accvgpr_read_b32 v17, a45
    v_lshl_or_b32 v22, v17, 16, v16
    v_accvgpr_read_b32 v16, a46
    v_accvgpr_read_b32 v17, a47
    v_lshl_or_b32 v23, v17, 16, v16
    s_nop 1
    v_mfma_f32_16x16x32_bf16 v[12:15], v[20:23], v[196:199], v[12:15]
    s_mov_b32 s47, 1925120
    buffer_load_ushort a40, v6, s[20:23], s47 offen
    s_mov_b32 s47, 1926400
    buffer_load_ushort a41, v6, s[20:23], s47 offen
    s_mov_b32 s47, 1927680
    buffer_load_ushort a42, v6, s[20:23], s47 offen
    s_mov_b32 s47, 1928960
    buffer_load_ushort a43, v6, s[20:23], s47 offen
    s_mov_b32 s47, 1930240
    buffer_load_ushort a44, v6, s[20:23], s47 offen
    s_mov_b32 s47, 1931520
    buffer_load_ushort a45, v6, s[20:23], s47 offen
    s_mov_b32 s47, 1932800
    buffer_load_ushort a46, v6, s[20:23], s47 offen
    s_mov_b32 s47, 1934080
    buffer_load_ushort a47, v6, s[20:23], s47 offen
    s_waitcnt vmcnt(40)
    v_accvgpr_read_b32 v16, a0
    v_accvgpr_read_b32 v17, a1
    v_lshl_or_b32 v20, v17, 16, v16
    v_accvgpr_read_b32 v16, a2
    v_accvgpr_read_b32 v17, a3
    v_lshl_or_b32 v21, v17, 16, v16
    v_accvgpr_read_b32 v16, a4
    v_accvgpr_read_b32 v17, a5
    v_lshl_or_b32 v22, v17, 16, v16
    v_accvgpr_read_b32 v16, a6
    v_accvgpr_read_b32 v17, a7
    v_lshl_or_b32 v23, v17, 16, v16
    s_nop 1
    v_mfma_f32_16x16x32_bf16 v[12:15], v[20:23], v[200:203], v[12:15]
    s_mov_b32 s47, 1966080
    buffer_load_ushort a0, v6, s[20:23], s47 offen
    s_mov_b32 s47, 1967360
    buffer_load_ushort a1, v6, s[20:23], s47 offen
    s_mov_b32 s47, 1968640
    buffer_load_ushort a2, v6, s[20:23], s47 offen
    s_mov_b32 s47, 1969920
    buffer_load_ushort a3, v6, s[20:23], s47 offen
    s_mov_b32 s47, 1971200
    buffer_load_ushort a4, v6, s[20:23], s47 offen
    s_mov_b32 s47, 1972480
    buffer_load_ushort a5, v6, s[20:23], s47 offen
    s_mov_b32 s47, 1973760
    buffer_load_ushort a6, v6, s[20:23], s47 offen
    s_mov_b32 s47, 1975040
    buffer_load_ushort a7, v6, s[20:23], s47 offen
    s_waitcnt vmcnt(40)
    v_accvgpr_read_b32 v16, a8
    v_accvgpr_read_b32 v17, a9
    v_lshl_or_b32 v20, v17, 16, v16
    v_accvgpr_read_b32 v16, a10
    v_accvgpr_read_b32 v17, a11
    v_lshl_or_b32 v21, v17, 16, v16
    v_accvgpr_read_b32 v16, a12
    v_accvgpr_read_b32 v17, a13
    v_lshl_or_b32 v22, v17, 16, v16
    v_accvgpr_read_b32 v16, a14
    v_accvgpr_read_b32 v17, a15
    v_lshl_or_b32 v23, v17, 16, v16
    s_nop 1
    v_mfma_f32_16x16x32_bf16 v[12:15], v[20:23], v[204:207], v[12:15]
    s_mov_b32 s47, 2007040
    buffer_load_ushort a8, v6, s[20:23], s47 offen
    s_mov_b32 s47, 2008320
    buffer_load_ushort a9, v6, s[20:23], s47 offen
    s_mov_b32 s47, 2009600
    buffer_load_ushort a10, v6, s[20:23], s47 offen
    s_mov_b32 s47, 2010880
    buffer_load_ushort a11, v6, s[20:23], s47 offen
    s_mov_b32 s47, 2012160
    buffer_load_ushort a12, v6, s[20:23], s47 offen
    s_mov_b32 s47, 2013440
    buffer_load_ushort a13, v6, s[20:23], s47 offen
    s_mov_b32 s47, 2014720
    buffer_load_ushort a14, v6, s[20:23], s47 offen
    s_mov_b32 s47, 2016000
    buffer_load_ushort a15, v6, s[20:23], s47 offen
    s_waitcnt vmcnt(40)
    v_accvgpr_read_b32 v16, a16
    v_accvgpr_read_b32 v17, a17
    v_lshl_or_b32 v20, v17, 16, v16
    v_accvgpr_read_b32 v16, a18
    v_accvgpr_read_b32 v17, a19
    v_lshl_or_b32 v21, v17, 16, v16
    v_accvgpr_read_b32 v16, a20
    v_accvgpr_read_b32 v17, a21
    v_lshl_or_b32 v22, v17, 16, v16
    v_accvgpr_read_b32 v16, a22
    v_accvgpr_read_b32 v17, a23
    v_lshl_or_b32 v23, v17, 16, v16
    s_nop 1
    v_mfma_f32_16x16x32_bf16 v[12:15], v[20:23], v[208:211], v[12:15]
    s_mov_b32 s47, 2048000
    buffer_load_ushort a16, v6, s[20:23], s47 offen
    s_mov_b32 s47, 2049280
    buffer_load_ushort a17, v6, s[20:23], s47 offen
    s_mov_b32 s47, 2050560
    buffer_load_ushort a18, v6, s[20:23], s47 offen
    s_mov_b32 s47, 2051840
    buffer_load_ushort a19, v6, s[20:23], s47 offen
    s_mov_b32 s47, 2053120
    buffer_load_ushort a20, v6, s[20:23], s47 offen
    s_mov_b32 s47, 2054400
    buffer_load_ushort a21, v6, s[20:23], s47 offen
    s_mov_b32 s47, 2055680
    buffer_load_ushort a22, v6, s[20:23], s47 offen
    s_mov_b32 s47, 2056960
    buffer_load_ushort a23, v6, s[20:23], s47 offen
    s_waitcnt vmcnt(40)
    v_accvgpr_read_b32 v16, a24
    v_accvgpr_read_b32 v17, a25
    v_lshl_or_b32 v20, v17, 16, v16
    v_accvgpr_read_b32 v16, a26
    v_accvgpr_read_b32 v17, a27
    v_lshl_or_b32 v21, v17, 16, v16
    v_accvgpr_read_b32 v16, a28
    v_accvgpr_read_b32 v17, a29
    v_lshl_or_b32 v22, v17, 16, v16
    v_accvgpr_read_b32 v16, a30
    v_accvgpr_read_b32 v17, a31
    v_lshl_or_b32 v23, v17, 16, v16
    s_nop 1
    v_mfma_f32_16x16x32_bf16 v[12:15], v[20:23], v[212:215], v[12:15]
    s_mov_b32 s47, 2088960
    buffer_load_ushort a24, v6, s[20:23], s47 offen
    s_mov_b32 s47, 2090240
    buffer_load_ushort a25, v6, s[20:23], s47 offen
    s_mov_b32 s47, 2091520
    buffer_load_ushort a26, v6, s[20:23], s47 offen
    s_mov_b32 s47, 2092800
    buffer_load_ushort a27, v6, s[20:23], s47 offen
    s_mov_b32 s47, 2094080
    buffer_load_ushort a28, v6, s[20:23], s47 offen
    s_mov_b32 s47, 2095360
    buffer_load_ushort a29, v6, s[20:23], s47 offen
    s_mov_b32 s47, 2096640
    buffer_load_ushort a30, v6, s[20:23], s47 offen
    s_mov_b32 s47, 2097920
    buffer_load_ushort a31, v6, s[20:23], s47 offen
    s_waitcnt vmcnt(40)
    v_accvgpr_read_b32 v16, a32
    v_accvgpr_read_b32 v17, a33
    v_lshl_or_b32 v20, v17, 16, v16
    v_accvgpr_read_b32 v16, a34
    v_accvgpr_read_b32 v17, a35
    v_lshl_or_b32 v21, v17, 16, v16
    v_accvgpr_read_b32 v16, a36
    v_accvgpr_read_b32 v17, a37
    v_lshl_or_b32 v22, v17, 16, v16
    v_accvgpr_read_b32 v16, a38
    v_accvgpr_read_b32 v17, a39
    v_lshl_or_b32 v23, v17, 16, v16
    s_nop 1
    v_mfma_f32_16x16x32_bf16 v[12:15], v[20:23], v[216:219], v[12:15]
    s_mov_b32 s47, 2129920
    buffer_load_ushort a32, v6, s[20:23], s47 offen
    s_mov_b32 s47, 2131200
    buffer_load_ushort a33, v6, s[20:23], s47 offen
    s_mov_b32 s47, 2132480
    buffer_load_ushort a34, v6, s[20:23], s47 offen
    s_mov_b32 s47, 2133760
    buffer_load_ushort a35, v6, s[20:23], s47 offen
    s_mov_b32 s47, 2135040
    buffer_load_ushort a36, v6, s[20:23], s47 offen
    s_mov_b32 s47, 2136320
    buffer_load_ushort a37, v6, s[20:23], s47 offen
    s_mov_b32 s47, 2137600
    buffer_load_ushort a38, v6, s[20:23], s47 offen
    s_mov_b32 s47, 2138880
    buffer_load_ushort a39, v6, s[20:23], s47 offen
    s_waitcnt vmcnt(40)
    v_accvgpr_read_b32 v16, a40
    v_accvgpr_read_b32 v17, a41
    v_lshl_or_b32 v20, v17, 16, v16
    v_accvgpr_read_b32 v16, a42
    v_accvgpr_read_b32 v17, a43
    v_lshl_or_b32 v21, v17, 16, v16
    v_accvgpr_read_b32 v16, a44
    v_accvgpr_read_b32 v17, a45
    v_lshl_or_b32 v22, v17, 16, v16
    v_accvgpr_read_b32 v16, a46
    v_accvgpr_read_b32 v17, a47
    v_lshl_or_b32 v23, v17, 16, v16
    s_nop 1
    v_mfma_f32_16x16x32_bf16 v[12:15], v[20:23], v[220:223], v[12:15]
    s_mov_b32 s47, 2170880
    buffer_load_ushort a40, v6, s[20:23], s47 offen
    s_mov_b32 s47, 2172160
    buffer_load_ushort a41, v6, s[20:23], s47 offen
    s_mov_b32 s47, 2173440
    buffer_load_ushort a42, v6, s[20:23], s47 offen
    s_mov_b32 s47, 2174720
    buffer_load_ushort a43, v6, s[20:23], s47 offen
    s_mov_b32 s47, 2176000
    buffer_load_ushort a44, v6, s[20:23], s47 offen
    s_mov_b32 s47, 2177280
    buffer_load_ushort a45, v6, s[20:23], s47 offen
    s_mov_b32 s47, 2178560
    buffer_load_ushort a46, v6, s[20:23], s47 offen
    s_mov_b32 s47, 2179840
    buffer_load_ushort a47, v6, s[20:23], s47 offen
    s_waitcnt vmcnt(40)
    v_accvgpr_read_b32 v16, a0
    v_accvgpr_read_b32 v17, a1
    v_lshl_or_b32 v20, v17, 16, v16
    v_accvgpr_read_b32 v16, a2
    v_accvgpr_read_b32 v17, a3
    v_lshl_or_b32 v21, v17, 16, v16
    v_accvgpr_read_b32 v16, a4
    v_accvgpr_read_b32 v17, a5
    v_lshl_or_b32 v22, v17, 16, v16
    v_accvgpr_read_b32 v16, a6
    v_accvgpr_read_b32 v17, a7
    v_lshl_or_b32 v23, v17, 16, v16
    s_nop 1
    v_mfma_f32_16x16x32_bf16 v[12:15], v[20:23], v[224:227], v[12:15]
    s_waitcnt vmcnt(32)
    v_accvgpr_read_b32 v16, a8
    v_accvgpr_read_b32 v17, a9
    v_lshl_or_b32 v20, v17, 16, v16
    v_accvgpr_read_b32 v16, a10
    v_accvgpr_read_b32 v17, a11
    v_lshl_or_b32 v21, v17, 16, v16
    v_accvgpr_read_b32 v16, a12
    v_accvgpr_read_b32 v17, a13
    v_lshl_or_b32 v22, v17, 16, v16
    v_accvgpr_read_b32 v16, a14
    v_accvgpr_read_b32 v17, a15
    v_lshl_or_b32 v23, v17, 16, v16
    s_nop 1
    v_mfma_f32_16x16x32_bf16 v[12:15], v[20:23], v[228:231], v[12:15]
    s_waitcnt vmcnt(24)
    v_accvgpr_read_b32 v16, a16
    v_accvgpr_read_b32 v17, a17
    v_lshl_or_b32 v20, v17, 16, v16
    v_accvgpr_read_b32 v16, a18
    v_accvgpr_read_b32 v17, a19
    v_lshl_or_b32 v21, v17, 16, v16
    v_accvgpr_read_b32 v16, a20
    v_accvgpr_read_b32 v17, a21
    v_lshl_or_b32 v22, v17, 16, v16
    v_accvgpr_read_b32 v16, a22
    v_accvgpr_read_b32 v17, a23
    v_lshl_or_b32 v23, v17, 16, v16
    s_nop 1
    v_mfma_f32_16x16x32_bf16 v[12:15], v[20:23], v[232:235], v[12:15]
    s_waitcnt vmcnt(16)
    v_accvgpr_read_b32 v16, a24
    v_accvgpr_read_b32 v17, a25
    v_lshl_or_b32 v20, v17, 16, v16
    v_accvgpr_read_b32 v16, a26
    v_accvgpr_read_b32 v17, a27
    v_lshl_or_b32 v21, v17, 16, v16
    v_accvgpr_read_b32 v16, a28
    v_accvgpr_read_b32 v17, a29
    v_lshl_or_b32 v22, v17, 16, v16
    v_accvgpr_read_b32 v16, a30
    v_accvgpr_read_b32 v17, a31
    v_lshl_or_b32 v23, v17, 16, v16
    s_nop 1
    v_mfma_f32_16x16x32_bf16 v[12:15], v[20:23], v[236:239], v[12:15]
    s_waitcnt vmcnt(8)
    v_accvgpr_read_b32 v16, a32
    v_accvgpr_read_b32 v17, a33
    v_lshl_or_b32 v20, v17, 16, v16
    v_accvgpr_read_b32 v16, a34
    v_accvgpr_read_b32 v17, a35
    v_lshl_or_b32 v21, v17, 16, v16
    v_accvgpr_read_b32 v16, a36
    v_accvgpr_read_b32 v17, a37
    v_lshl_or_b32 v22, v17, 16, v16
    v_accvgpr_read_b32 v16, a38
    v_accvgpr_read_b32 v17, a39
    v_lshl_or_b32 v23, v17, 16, v16
    s_nop 1
    v_mfma_f32_16x16x32_bf16 v[12:15], v[20:23], v[240:243], v[12:15]
    s_waitcnt vmcnt(0)
    v_accvgpr_read_b32 v16, a40
    v_accvgpr_read_b32 v17, a41
    v_lshl_or_b32 v20, v17, 16, v16
    v_accvgpr_read_b32 v16, a42
    v_accvgpr_read_b32 v17, a43
    v_lshl_or_b32 v21, v17, 16, v16
    v_accvgpr_read_b32 v16, a44
    v_accvgpr_read_b32 v17, a45
    v_lshl_or_b32 v22, v17, 16, v16
    v_accvgpr_read_b32 v16, a46
    v_accvgpr_read_b32 v17, a47
    v_lshl_or_b32 v23, v17, 16, v16
    s_nop 1
    v_mfma_f32_16x16x32_bf16 v[12:15], v[20:23], v[244:247], v[12:15]
    s_mov_b32 s38, 0xbfb8aa3b
    v_mul_f32 v9, s38, v8
    v_exp_f32 v9, v9
    s_nop 0
    v_add_f32 v9, 1.0, v9
    v_rcp_f32 v10, v9
    s_nop 0
    v_fma_f32 v11, -v9, v10, 1.0
    v_fma_f32 v10, v11, v10, v10
    v_cvt_pk_bf16_f32 v10, v10, v10
    v_lshlrev_b32 v10, 16, v10
    v_cvt_pk_bf16_f32 v16, v12, v13
    v_lshlrev_b32 v17, 16, v16
    v_and_b32 v18, 0xffff0000, v16
    v_mul_f32 v17, v17, v10
    v_mul_f32 v18, v18, v10
    v_cvt_pk_bf16_f32 v20, v17, v18
    v_cvt_pk_bf16_f32 v16, v14, v15
    v_lshlrev_b32 v17, 16, v16
    v_and_b32 v18, 0xffff0000, v16
    v_mul_f32 v17, v17, v10
    v_mul_f32 v18, v18, v10
    v_cvt_pk_bf16_f32 v21, v17, v18
    v_mul_u32_u24 v5, 1280, v3
    v_lshl_add_u32 v5, v2, 3, v5
    s_lshl_b32 s39, s36, 7
    s_lshl_b32 s40, s3, 5
    s_add_u32 s39, s39, s40
    s_add_u32 s39, s39, 3276800
    v_cmp_gt_u32 vcc, 8, v3
    s_nop 0
    s_and_saveexec_b64 s[42:43], vcc
    buffer_store_dwordx2 v[20:21], v5, s[32:35], s39 offen
    s_nop 1
    s_endpgm
g1_done:
    s_endpgm
.globl final_kernel
.p2align 8
.type final_kernel,@function
final_kernel:
    s_cmp_ge_u32 s2, 128
    s_cbranch_scc1 fi_done
    s_load_dwordx2 s[4:5], s[0:1], 0
    s_load_dwordx2 s[6:7], s[0:1], 96
    s_load_dwordx2 s[12:13], s[0:1], 112
    v_and_b32 v1, 63, v0
    v_lshrrev_b32 v2, 6, v0
    s_nop 0
    v_readfirstlane_b32 s3, v2
    v_lshrrev_b32 v2, 4, v1
    v_and_b32 v3, 15, v1
    s_waitcnt lgkmcnt(0)
    s_mov_b32 s20, s4
    s_and_b32 s21, s5, 0xffff
    s_mov_b32 s22, 2621440
    s_mov_b32 s23, 0x00020000
    s_mov_b32 s24, s6
    s_and_b32 s25, s7, 0xffff
    s_mov_b32 s26, 2621440
    s_mov_b32 s27, 0x00020000
    s_mov_b32 s32, s12
    s_and_b32 s33, s13, 0xffff
    s_mov_b32 s34, 268435456
    s_mov_b32 s35, 0x00020000
    s_add_u32 s8, s12, 3178496
    s_addc_u32 s9, s13, 0
    s_load_dwordx8 s[64:71], s[8:9], 0
    v_lshlrev_b32 v4, 2, v1
    s_lshl_b32 s43, s2, 4
    v_add_u32 v7, s43, v3
    v_mul_u32_u24 v8, 1280, v7
    v_lshl_add_u32 v8, v2, 3, v8
    s_mul_i32 s42, s3, 320
    v_add_u32 v8, s42, v8
    s_waitcnt lgkmcnt(0)
    v_mov_b32 v9, -1
    v_cmp_eq_u32 vcc, s64, v7
    v_mov_b32 v10, 0
    s_nop 0
    v_cndmask_b32 v9, v9, v10, vcc
    v_cmp_eq_u32 vcc, s65, v7
    v_mov_b32 v10, 1
    s_nop 0
    v_cndmask_b32 v9, v9, v10, vcc
    v_cmp_eq_u32 vcc, s66, v7
    v_mov_b32 v10, 2
    s_nop 0
    v_cndmask_b32 v9, v9, v10, vcc
    v_cmp_eq_u32 vcc, s67, v7
    v_mov_b32 v10, 3
    s_nop 0
    v_cndmask_b32 v9, v9, v10, vcc
    v_cmp_eq_u32 vcc, s68, v7
    v_mov_b32 v10, 4
    s_nop 0
    v_cndmask_b32 v9, v9, v10, vcc
    v_cmp_eq_u32 vcc, s69, v7
    v_mov_b32 v10, 5
    s_nop 0
    v_cndmask_b32 v9, v9, v10, vcc
    v_cmp_eq_u32 vcc, s70, v7
    v_mov_b32 v10, 6
    s_nop 0
    v_cndmask_b32 v9, v9, v10, vcc
    v_cmp_eq_u32 vcc, s71, v7
    v_mov_b32 v10, 7
    s_nop 0
    v_cndmask_b32 v9, v9, v10, vcc
    v_and_b32 v10, 7, v9
    v_mul_u32_u24 v10, 1280, v10
    v_lshl_add_u32 v10, v2, 3, v10
    v_add_u32 v10, s42, v10
    v_cmp_gt_i32 s[52:53], 0, v9
    s_mul_i32 s40, s2, 40960
    s_mul_i32 s41, s3, 10240
    s_add_u32 s40, s40, s41
    s_add_u32 s40, s40, 10485760
    s_mov_b32 s47, 3276800
    buffer_load_dword v16, v4, s[32:35], s40 offen offset:0
    buffer_load_dword v17, v4, s[32:35], s40 offen offset:256
    buffer_load_dword v18, v4, s[32:35], s40 offen offset:512
    buffer_load_dword v19, v4, s[32:35], s40 offen offset:768
    s_add_u32 s40, s40, 1024
    buffer_load_dwordx2 v[20:21], v8, s[20:23], 0 offen offset:0
    buffer_load_dwordx2 v[22:23], v8, s[32:35], 0 offen offset:0
    buffer_load_dwordx2 v[24:25], v10, s[32:35], s47 offen offset:0
    buffer_load_dword v28, v4, s[32:35], s40 offen offset:0
    buffer_load_dword v29, v4, s[32:35], s40 offen offset:256
    buffer_load_dword v30, v4, s[32:35], s40 offen offset:512
    buffer_load_dword v31, v4, s[32:35], s40 offen offset:768
    s_add_u32 s40, s40, 1024
    buffer_load_dwordx2 v[32:33], v8, s[20:23], 0 offen offset:32
    buffer_load_dwordx2 v[34:35], v8, s[32:35], 0 offen offset:32
    buffer_load_dwordx2 v[36:37], v10, s[32:35], s47 offen offset:32
    buffer_load_dword v40, v4, s[32:35], s40 offen offset:0
    buffer_load_dword v41, v4, s[32:35], s40 offen offset:256
    buffer_load_dword v42, v4, s[32:35], s40 offen offset:512
    buffer_load_dword v43, v4, s[32:35], s40 offen offset:768
    s_add_u32 s40, s40, 1024
    buffer_load_dwordx2 v[44:45], v8, s[20:23], 0 offen offset:64
    buffer_load_dwordx2 v[46:47], v8, s[32:35], 0 offen offset:64
    buffer_load_dwordx2 v[48:49], v10, s[32:35], s47 offen offset:64
    buffer_load_dword v52, v4, s[32:35], s40 offen offset:0
    buffer_load_dword v53, v4, s[32:35], s40 offen offset:256
    buffer_load_dword v54, v4, s[32:35], s40 offen offset:512
    buffer_load_dword v55, v4, s[32:35], s40 offen offset:768
    s_add_u32 s40, s40, 1024
    buffer_load_dwordx2 v[56:57], v8, s[20:23], 0 offen offset:96
    buffer_load_dwordx2 v[58:59], v8, s[32:35], 0 offen offset:96
    buffer_load_dwordx2 v[60:61], v10, s[32:35], s47 offen offset:96
    buffer_load_dword v64, v4, s[32:35], s40 offen offset:0
    buffer_load_dword v65, v4, s[32:35], s40 offen offset:256
    buffer_load_dword v66, v4, s[32:35], s40 offen offset:512
    buffer_load_dword v67, v4, s[32:35], s40 offen offset:768
    s_add_u32 s40, s40, 1024
    buffer_load_dwordx2 v[68:69], v8, s[20:23], 0 offen offset:128
    buffer_load_dwordx2 v[70:71], v8, s[32:35], 0 offen offset:128
    buffer_load_dwordx2 v[72:73], v10, s[32:35], s47 offen offset:128
    buffer_load_dword v76, v4, s[32:35], s40 offen offset:0
    buffer_load_dword v77, v4, s[32:35], s40 offen offset:256
    buffer_load_dword v78, v4, s[32:35], s40 offen offset:512
    buffer_load_dword v79, v4, s[32:35], s40 offen offset:768
    s_add_u32 s40, s40, 1024
    buffer_load_dwordx2 v[80:81], v8, s[20:23], 0 offen offset:160
    buffer_load_dwordx2 v[82:83], v8, s[32:35], 0 offen offset:160
    buffer_load_dwordx2 v[84:85], v10, s[32:35], s47 offen offset:160
    buffer_load_dword v88, v4, s[32:35], s40 offen offset:0
    buffer_load_dword v89, v4, s[32:35], s40 offen offset:256
    buffer_load_dword v90, v4, s[32:35], s40 offen offset:512
    buffer_load_dword v91, v4, s[32:35], s40 offen offset:768
    s_add_u32 s40, s40, 1024
    buffer_load_dwordx2 v[92:93], v8, s[20:23], 0 offen offset:192
    buffer_load_dwordx2 v[94:95], v8, s[32:35], 0 offen offset:192
    buffer_load_dwordx2 v[96:97], v10, s[32:35], s47 offen offset:192
    buffer_load_dword v100, v4, s[32:35], s40 offen offset:0
    buffer_load_dword v101, v4, s[32:35], s40 offen offset:256
    buffer_load_dword v102, v4, s[32:35], s40 offen offset:512
    buffer_load_dword v103, v4, s[32:35], s40 offen offset:768
    s_add_u32 s40, s40, 1024
    buffer_load_dwordx2 v[104:105], v8, s[20:23], 0 offen offset:224
    buffer_load_dwordx2 v[106:107], v8, s[32:35], 0 offen offset:224
    buffer_load_dwordx2 v[108:109], v10, s[32:35], s47 offen offset:224
    buffer_load_dword v112, v4, s[32:35], s40 offen offset:0
    buffer_load_dword v113, v4, s[32:35], s40 offen offset:256
    buffer_load_dword v114, v4, s[32:35], s40 offen offset:512
    buffer_load_dword v115, v4, s[32:35], s40 offen offset:768
    s_add_u32 s40, s40, 1024
    buffer_load_dwordx2 v[116:117], v8, s[20:23], 0 offen offset:256
    buffer_load_dwordx2 v[118:119], v8, s[32:35], 0 offen offset:256
    buffer_load_dwordx2 v[120:121], v10, s[32:35], s47 offen offset:256
    buffer_load_dword v124, v4, s[32:35], s40 offen offset:0
    buffer_load_dword v125, v4, s[32:35], s40 offen offset:256
    buffer_load_dword v126, v4, s[32:35], s40 offen offset:512
    buffer_load_dword v127, v4, s[32:35], s40 offen offset:768
    s_add_u32 s40, s40, 1024
    buffer_load_dwordx2 v[128:129], v8, s[20:23], 0 offen offset:288
    buffer_load_dwordx2 v[130:131], v8, s[32:35], 0 offen offset:288
    buffer_load_dwordx2 v[132:133], v10, s[32:35], s47 offen offset:288
    v_mov_b32 v11, 0
    s_waitcnt vmcnt(63)
    v_cvt_pk_bf16_f32 v16, v16, v17
    v_cvt_pk_bf16_f32 v17, v18, v19
    v_cndmask_b32 v24, v24, v11, s[52:53]
    v_cndmask_b32 v25, v25, v11, s[52:53]
    v_lshlrev_b32 v12, 16, v16
    v_lshlrev_b32 v13, 16, v20
    v_add_f32 v12, v13, v12
    v_and_b32 v14, 0xffff0000, v16
    v_and_b32 v15, 0xffff0000, v20
    v_add_f32 v14, v15, v14
    v_cvt_pk_bf16_f32 v12, v12, v14
    v_lshlrev_b32 v13, 16, v22
    v_lshlrev_b32 v14, 16, v24
    v_add_f32 v13, v13, v14
    v_and_b32 v14, 0xffff0000, v22
    v_and_b32 v15, 0xffff0000, v24
    v_add_f32 v14, v14, v15
    v_cvt_pk_bf16_f32 v13, v13, v14
    v_lshlrev_b32 v14, 16, v12
    v_lshlrev_b32 v15, 16, v13
    v_add_f32 v14, v14, v15
    v_and_b32 v12, 0xffff0000, v12
    v_and_b32 v13, 0xffff0000, v13
    v_add_f32 v12, v12, v13
    v_cvt_pk_bf16_f32 v26, v14, v12
    v_lshlrev_b32 v12, 16, v17
    v_lshlrev_b32 v13, 16, v21
    v_add_f32 v12, v13, v12
    v_and_b32 v14, 0xffff0000, v17
    v_and_b32 v15, 0xffff0000, v21
    v_add_f32 v14, v15, v14
    v_cvt_pk_bf16_f32 v12, v12, v14
    v_lshlrev_b32 v13, 16, v23
    v_lshlrev_b32 v14, 16, v25
    v_add_f32 v13, v13, v14
    v_and_b32 v14, 0xffff0000, v23
    v_and_b32 v15, 0xffff0000, v25
    v_add_f32 v14, v14, v15
    v_cvt_pk_bf16_f32 v13, v13, v14
    v_lshlrev_b32 v14, 16, v12
    v_lshlrev_b32 v15, 16, v13
    v_add_f32 v14, v14, v15
    v_and_b32 v12, 0xffff0000, v12
    v_and_b32 v13, 0xffff0000, v13
    v_add_f32 v12, v12, v13
    v_cvt_pk_bf16_f32 v27, v14, v12
    buffer_store_dwordx2 v[26:27], v8, s[24:27], 0 offen offset:0
    s_waitcnt vmcnt(56)
    v_cvt_pk_bf16_f32 v28, v28, v29
    v_cvt_pk_bf16_f32 v29, v30, v31
    v_cndmask_b32 v36, v36, v11, s[52:53]
    v_cndmask_b32 v37, v37, v11, s[52:53]
    v_lshlrev_b32 v12, 16, v28
    v_lshlrev_b32 v13, 16, v32
    v_add_f32 v12, v13, v12
    v_and_b32 v14, 0xffff0000, v28
    v_and_b32 v15, 0xffff0000, v32
    v_add_f32 v14, v15, v14
    v_cvt_pk_bf16_f32 v12, v12, v14
    v_lshlrev_b32 v13, 16, v34
    v_lshlrev_b32 v14, 16, v36
    v_add_f32 v13, v13, v14
    v_and_b32 v14, 0xffff0000, v34
    v_and_b32 v15, 0xffff0000, v36
    v_add_f32 v14, v14, v15
    v_cvt_pk_bf16_f32 v13, v13, v14
    v_lshlrev_b32 v14, 16, v12
    v_lshlrev_b32 v15, 16, v13
    v_add_f32 v14, v14, v15
    v_and_b32 v12, 0xffff0000, v12
    v_and_b32 v13, 0xffff0000, v13
    v_add_f32 v12, v12, v13
    v_cvt_pk_bf16_f32 v38, v14, v12
    v_lshlrev_b32 v12, 16, v29
    v_lshlrev_b32 v13, 16, v33
    v_add_f32 v12, v13, v12
    v_and_b32 v14, 0xffff0000, v29
    v_and_b32 v15, 0xffff0000, v33
    v_add_f32 v14, v15, v14
    v_cvt_pk_bf16_f32 v12, v12, v14
    v_lshlrev_b32 v13, 16, v35
    v_lshlrev_b32 v14, 16, v37
    v_add_f32 v13, v13, v14
    v_and_b32 v14, 0xffff0000, v35
    v_and_b32 v15, 0xffff0000, v37
    v_add_f32 v14, v14, v15
    v_cvt_pk_bf16_f32 v13, v13, v14
    v_lshlrev_b32 v14, 16, v12
    v_lshlrev_b32 v15, 16, v13
    v_add_f32 v14, v14, v15
    v_and_b32 v12, 0xffff0000, v12
    v_and_b32 v13, 0xffff0000, v13
    v_add_f32 v12, v12, v13
    v_cvt_pk_bf16_f32 v39, v14, v12
    buffer_store_dwordx2 v[38:39], v8, s[24:27], 0 offen offset:32
    s_waitcnt vmcnt(49)
    v_cvt_pk_bf16_f32 v40, v40, v41
    v_cvt_pk_bf16_f32 v41, v42, v43
    v_cndmask_b32 v48, v48, v11, s[52:53]
    v_cndmask_b32 v49, v49, v11, s[52:53]
    v_lshlrev_b32 v12, 16, v40
    v_lshlrev_b32 v13, 16, v44
    v_add_f32 v12, v13, v12
    v_and_b32 v14, 0xffff0000, v40
    v_and_b32 v15, 0xffff0000, v44
    v_add_f32 v14, v15, v14
    v_cvt_pk_bf16_f32 v12, v12, v14
    v_lshlrev_b32 v13, 16, v46
    v_lshlrev_b32 v14, 16, v48
    v_add_f32 v13, v13, v14
    v_and_b32 v14, 0xffff0000, v46
    v_and_b32 v15, 0xffff0000, v48
    v_add_f32 v14, v14, v15
    v_cvt_pk_bf16_f32 v13, v13, v14
    v_lshlrev_b32 v14, 16, v12
    v_lshlrev_b32 v15, 16, v13
    v_add_f32 v14, v14, v15
    v_and_b32 v12, 0xffff0000, v12
    v_and_b32 v13, 0xffff0000, v13
    v_add_f32 v12, v12, v13
    v_cvt_pk_bf16_f32 v50, v14, v12
    v_lshlrev_b32 v12, 16, v41
    v_lshlrev_b32 v13, 16, v45
    v_add_f32 v12, v13, v12
    v_and_b32 v14, 0xffff0000, v41
    v_and_b32 v15, 0xffff0000, v45
    v_add_f32 v14, v15, v14
    v_cvt_pk_bf16_f32 v12, v12, v14
    v_lshlrev_b32 v13, 16, v47
    v_lshlrev_b32 v14, 16, v49
    v_add_f32 v13, v13, v14
    v_and_b32 v14, 0xffff0000, v47
    v_and_b32 v15, 0xffff0000, v49
    v_add_f32 v14, v14, v15
    v_cvt_pk_bf16_f32 v13, v13, v14
    v_lshlrev_b32 v14, 16, v12
    v_lshlrev_b32 v15, 16, v13
    v_add_f32 v14, v14, v15
    v_and_b32 v12, 0xffff0000, v12
    v_and_b32 v13, 0xffff0000, v13
    v_add_f32 v12, v12, v13
    v_cvt_pk_bf16_f32 v51, v14, v12
    buffer_store_dwordx2 v[50:51], v8, s[24:27], 0 offen offset:64
    s_waitcnt vmcnt(42)
    v_cvt_pk_bf16_f32 v52, v52, v53
    v_cvt_pk_bf16_f32 v53, v54, v55
    v_cndmask_b32 v60, v60, v11, s[52:53]
    v_cndmask_b32 v61, v61, v11, s[52:53]
    v_lshlrev_b32 v12, 16, v52
    v_lshlrev_b32 v13, 16, v56
    v_add_f32 v12, v13, v12
    v_and_b32 v14, 0xffff0000, v52
    v_and_b32 v15, 0xffff0000, v56
    v_add_f32 v14, v15, v14
    v_cvt_pk_bf16_f32 v12, v12, v14
    v_lshlrev_b32 v13, 16, v58
    v_lshlrev_b32 v14, 16, v60
    v_add_f32 v13, v13, v14
    v_and_b32 v14, 0xffff0000, v58
    v_and_b32 v15, 0xffff0000, v60
    v_add_f32 v14, v14, v15
    v_cvt_pk_bf16_f32 v13, v13, v14
    v_lshlrev_b32 v14, 16, v12
    v_lshlrev_b32 v15, 16, v13
    v_add_f32 v14, v14, v15
    v_and_b32 v12, 0xffff0000, v12
    v_and_b32 v13, 0xffff0000, v13
    v_add_f32 v12, v12, v13
    v_cvt_pk_bf16_f32 v62, v14, v12
    v_lshlrev_b32 v12, 16, v53
    v_lshlrev_b32 v13, 16, v57
    v_add_f32 v12, v13, v12
    v_and_b32 v14, 0xffff0000, v53
    v_and_b32 v15, 0xffff0000, v57
    v_add_f32 v14, v15, v14
    v_cvt_pk_bf16_f32 v12, v12, v14
    v_lshlrev_b32 v13, 16, v59
    v_lshlrev_b32 v14, 16, v61
    v_add_f32 v13, v13, v14
    v_and_b32 v14, 0xffff0000, v59
    v_and_b32 v15, 0xffff0000, v61
    v_add_f32 v14, v14, v15
    v_cvt_pk_bf16_f32 v13, v13, v14
    v_lshlrev_b32 v14, 16, v12
    v_lshlrev_b32 v15, 16, v13
    v_add_f32 v14, v14, v15
    v_and_b32 v12, 0xffff0000, v12
    v_and_b32 v13, 0xffff0000, v13
    v_add_f32 v12, v12, v13
    v_cvt_pk_bf16_f32 v63, v14, v12
    buffer_store_dwordx2 v[62:63], v8, s[24:27], 0 offen offset:96
    s_waitcnt vmcnt(35)
    v_cvt_pk_bf16_f32 v64, v64, v65
    v_cvt_pk_bf16_f32 v65, v66, v67
    v_cndmask_b32 v72, v72, v11, s[52:53]
    v_cndmask_b32 v73, v73, v11, s[52:53]
    v_lshlrev_b32 v12, 16, v64
    v_lshlrev_b32 v13, 16, v68
    v_add_f32 v12, v13, v12
    v_and_b32 v14, 0xffff0000, v64
    v_and_b32 v15, 0xffff0000, v68
    v_add_f32 v14, v15, v14
    v_cvt_pk_bf16_f32 v12, v12, v14
    v_lshlrev_b32 v13, 16, v70
    v_lshlrev_b32 v14, 16, v72
    v_add_f32 v13, v13, v14
    v_and_b32 v14, 0xffff0000, v70
    v_and_b32 v15, 0xffff0000, v72
    v_add_f32 v14, v14, v15
    v_cvt_pk_bf16_f32 v13, v13, v14
    v_lshlrev_b32 v14, 16, v12
    v_lshlrev_b32 v15, 16, v13
    v_add_f32 v14, v14, v15
    v_and_b32 v12, 0xffff0000, v12
    v_and_b32 v13, 0xffff0000, v13
    v_add_f32 v12, v12, v13
    v_cvt_pk_bf16_f32 v74, v14, v12
    v_lshlrev_b32 v12, 16, v65
    v_lshlrev_b32 v13, 16, v69
    v_add_f32 v12, v13, v12
    v_and_b32 v14, 0xffff0000, v65
    v_and_b32 v15, 0xffff0000, v69
    v_add_f32 v14, v15, v14
    v_cvt_pk_bf16_f32 v12, v12, v14
    v_lshlrev_b32 v13, 16, v71
    v_lshlrev_b32 v14, 16, v73
    v_add_f32 v13, v13, v14
    v_and_b32 v14, 0xffff0000, v71
    v_and_b32 v15, 0xffff0000, v73
    v_add_f32 v14, v14, v15
    v_cvt_pk_bf16_f32 v13, v13, v14
    v_lshlrev_b32 v14, 16, v12
    v_lshlrev_b32 v15, 16, v13
    v_add_f32 v14, v14, v15
    v_and_b32 v12, 0xffff0000, v12
    v_and_b32 v13, 0xffff0000, v13
    v_add_f32 v12, v12, v13
    v_cvt_pk_bf16_f32 v75, v14, v12
    buffer_store_dwordx2 v[74:75], v8, s[24:27], 0 offen offset:128
    s_waitcnt vmcnt(28)
    v_cvt_pk_bf16_f32 v76, v76, v77
    v_cvt_pk_bf16_f32 v77, v78, v79
    v_cndmask_b32 v84, v84, v11, s[52:53]
    v_cndmask_b32 v85, v85, v11, s[52:53]
    v_lshlrev_b32 v12, 16, v76
    v_lshlrev_b32 v13, 16, v80
    v_add_f32 v12, v13, v12
    v_and_b32 v14, 0xffff0000, v76
    v_and_b32 v15, 0xffff0000, v80
    v_add_f32 v14, v15, v14
    v_cvt_pk_bf16_f32 v12, v12, v14
    v_lshlrev_b32 v13, 16, v82
    v_lshlrev_b32 v14, 16, v84
    v_add_f32 v13, v13, v14
    v_and_b32 v14, 0xffff0000, v82
    v_and_b32 v15, 0xffff0000, v84
    v_add_f32 v14, v14, v15
    v_cvt_pk_bf16_f32 v13, v13, v14
    v_lshlrev_b32 v14, 16, v12
    v_lshlrev_b32 v15, 16, v13
    v_add_f32 v14, v14, v15
    v_and_b32 v12, 0xffff0000, v12
    v_and_b32 v13, 0xffff0000, v13
    v_add_f32 v12, v12, v13
    v_cvt_pk_bf16_f32 v86, v14, v12
    v_lshlrev_b32 v12, 16, v77
    v_lshlrev_b32 v13, 16, v81
    v_add_f32 v12, v13, v12
    v_and_b32 v14, 0xffff0000, v77
    v_and_b32 v15, 0xffff0000, v81
    v_add_f32 v14, v15, v14
    v_cvt_pk_bf16_f32 v12, v12, v14
    v_lshlrev_b32 v13, 16, v83
    v_lshlrev_b32 v14, 16, v85
    v_add_f32 v13, v13, v14
    v_and_b32 v14, 0xffff0000, v83
    v_and_b32 v15, 0xffff0000, v85
    v_add_f32 v14, v14, v15
    v_cvt_pk_bf16_f32 v13, v13, v14
    v_lshlrev_b32 v14, 16, v12
    v_lshlrev_b32 v15, 16, v13
    v_add_f32 v14, v14, v15
    v_and_b32 v12, 0xffff0000, v12
    v_and_b32 v13, 0xffff0000, v13
    v_add_f32 v12, v12, v13
    v_cvt_pk_bf16_f32 v87, v14, v12
    buffer_store_dwordx2 v[86:87], v8, s[24:27], 0 offen offset:160
    s_waitcnt vmcnt(21)
    v_cvt_pk_bf16_f32 v88, v88, v89
    v_cvt_pk_bf16_f32 v89, v90, v91
    v_cndmask_b32 v96, v96, v11, s[52:53]
    v_cndmask_b32 v97, v97, v11, s[52:53]
    v_lshlrev_b32 v12, 16, v88
    v_lshlrev_b32 v13, 16, v92
    v_add_f32 v12, v13, v12
    v_and_b32 v14, 0xffff0000, v88
    v_and_b32 v15, 0xffff0000, v92
    v_add_f32 v14, v15, v14
    v_cvt_pk_bf16_f32 v12, v12, v14
    v_lshlrev_b32 v13, 16, v94
    v_lshlrev_b32 v14, 16, v96
    v_add_f32 v13, v13, v14
    v_and_b32 v14, 0xffff0000, v94
    v_and_b32 v15, 0xffff0000, v96
    v_add_f32 v14, v14, v15
    v_cvt_pk_bf16_f32 v13, v13, v14
    v_lshlrev_b32 v14, 16, v12
    v_lshlrev_b32 v15, 16, v13
    v_add_f32 v14, v14, v15
    v_and_b32 v12, 0xffff0000, v12
    v_and_b32 v13, 0xffff0000, v13
    v_add_f32 v12, v12, v13
    v_cvt_pk_bf16_f32 v98, v14, v12
    v_lshlrev_b32 v12, 16, v89
    v_lshlrev_b32 v13, 16, v93
    v_add_f32 v12, v13, v12
    v_and_b32 v14, 0xffff0000, v89
    v_and_b32 v15, 0xffff0000, v93
    v_add_f32 v14, v15, v14
    v_cvt_pk_bf16_f32 v12, v12, v14
    v_lshlrev_b32 v13, 16, v95
    v_lshlrev_b32 v14, 16, v97
    v_add_f32 v13, v13, v14
    v_and_b32 v14, 0xffff0000, v95
    v_and_b32 v15, 0xffff0000, v97
    v_add_f32 v14, v14, v15
    v_cvt_pk_bf16_f32 v13, v13, v14
    v_lshlrev_b32 v14, 16, v12
    v_lshlrev_b32 v15, 16, v13
    v_add_f32 v14, v14, v15
    v_and_b32 v12, 0xffff0000, v12
    v_and_b32 v13, 0xffff0000, v13
    v_add_f32 v12, v12, v13
    v_cvt_pk_bf16_f32 v99, v14, v12
    buffer_store_dwordx2 v[98:99], v8, s[24:27], 0 offen offset:192
    s_waitcnt vmcnt(14)
    v_cvt_pk_bf16_f32 v100, v100, v101
    v_cvt_pk_bf16_f32 v101, v102, v103
    v_cndmask_b32 v108, v108, v11, s[52:53]
    v_cndmask_b32 v109, v109, v11, s[52:53]
    v_lshlrev_b32 v12, 16, v100
    v_lshlrev_b32 v13, 16, v104
    v_add_f32 v12, v13, v12
    v_and_b32 v14, 0xffff0000, v100
    v_and_b32 v15, 0xffff0000, v104
    v_add_f32 v14, v15, v14
    v_cvt_pk_bf16_f32 v12, v12, v14
    v_lshlrev_b32 v13, 16, v106
    v_lshlrev_b32 v14, 16, v108
    v_add_f32 v13, v13, v14
    v_and_b32 v14, 0xffff0000, v106
    v_and_b32 v15, 0xffff0000, v108
    v_add_f32 v14, v14, v15
    v_cvt_pk_bf16_f32 v13, v13, v14
    v_lshlrev_b32 v14, 16, v12
    v_lshlrev_b32 v15, 16, v13
    v_add_f32 v14, v14, v15
    v_and_b32 v12, 0xffff0000, v12
    v_and_b32 v13, 0xffff0000, v13
    v_add_f32 v12, v12, v13
    v_cvt_pk_bf16_f32 v110, v14, v12
    v_lshlrev_b32 v12, 16, v101
    v_lshlrev_b32 v13, 16, v105
    v_add_f32 v12, v13, v12
    v_and_b32 v14, 0xffff0000, v101
    v_and_b32 v15, 0xffff0000, v105
    v_add_f32 v14, v15, v14
    v_cvt_pk_bf16_f32 v12, v12, v14
    v_lshlrev_b32 v13, 16, v107
    v_lshlrev_b32 v14, 16, v109
    v_add_f32 v13, v13, v14
    v_and_b32 v14, 0xffff0000, v107
    v_and_b32 v15, 0xffff0000, v109
    v_add_f32 v14, v14, v15
    v_cvt_pk_bf16_f32 v13, v13, v14
    v_lshlrev_b32 v14, 16, v12
    v_lshlrev_b32 v15, 16, v13
    v_add_f32 v14, v14, v15
    v_and_b32 v12, 0xffff0000, v12
    v_and_b32 v13, 0xffff0000, v13
    v_add_f32 v12, v12, v13
    v_cvt_pk_bf16_f32 v111, v14, v12
    buffer_store_dwordx2 v[110:111], v8, s[24:27], 0 offen offset:224
    s_waitcnt vmcnt(7)
    v_cvt_pk_bf16_f32 v112, v112, v113
    v_cvt_pk_bf16_f32 v113, v114, v115
    v_cndmask_b32 v120, v120, v11, s[52:53]
    v_cndmask_b32 v121, v121, v11, s[52:53]
    v_lshlrev_b32 v12, 16, v112
    v_lshlrev_b32 v13, 16, v116
    v_add_f32 v12, v13, v12
    v_and_b32 v14, 0xffff0000, v112
    v_and_b32 v15, 0xffff0000, v116
    v_add_f32 v14, v15, v14
    v_cvt_pk_bf16_f32 v12, v12, v14
    v_lshlrev_b32 v13, 16, v118
    v_lshlrev_b32 v14, 16, v120
    v_add_f32 v13, v13, v14
    v_and_b32 v14, 0xffff0000, v118
    v_and_b32 v15, 0xffff0000, v120
    v_add_f32 v14, v14, v15
    v_cvt_pk_bf16_f32 v13, v13, v14
    v_lshlrev_b32 v14, 16, v12
    v_lshlrev_b32 v15, 16, v13
    v_add_f32 v14, v14, v15
    v_and_b32 v12, 0xffff0000, v12
    v_and_b32 v13, 0xffff0000, v13
    v_add_f32 v12, v12, v13
    v_cvt_pk_bf16_f32 v122, v14, v12
    v_lshlrev_b32 v12, 16, v113
    v_lshlrev_b32 v13, 16, v117
    v_add_f32 v12, v13, v12
    v_and_b32 v14, 0xffff0000, v113
    v_and_b32 v15, 0xffff0000, v117
    v_add_f32 v14, v15, v14
    v_cvt_pk_bf16_f32 v12, v12, v14
    v_lshlrev_b32 v13, 16, v119
    v_lshlrev_b32 v14, 16, v121
    v_add_f32 v13, v13, v14
    v_and_b32 v14, 0xffff0000, v119
    v_and_b32 v15, 0xffff0000, v121
    v_add_f32 v14, v14, v15
    v_cvt_pk_bf16_f32 v13, v13, v14
    v_lshlrev_b32 v14, 16, v12
    v_lshlrev_b32 v15, 16, v13
    v_add_f32 v14, v14, v15
    v_and_b32 v12, 0xffff0000, v12
    v_and_b32 v13, 0xffff0000, v13
    v_add_f32 v12, v12, v13
    v_cvt_pk_bf16_f32 v123, v14, v12
    buffer_store_dwordx2 v[122:123], v8, s[24:27], 0 offen offset:256
    s_waitcnt vmcnt(0)
    v_cvt_pk_bf16_f32 v124, v124, v125
    v_cvt_pk_bf16_f32 v125, v126, v127
    v_cndmask_b32 v132, v132, v11, s[52:53]
    v_cndmask_b32 v133, v133, v11, s[52:53]
    v_lshlrev_b32 v12, 16, v124
    v_lshlrev_b32 v13, 16, v128
    v_add_f32 v12, v13, v12
    v_and_b32 v14, 0xffff0000, v124
    v_and_b32 v15, 0xffff0000, v128
    v_add_f32 v14, v15, v14
    v_cvt_pk_bf16_f32 v12, v12, v14
    v_lshlrev_b32 v13, 16, v130
    v_lshlrev_b32 v14, 16, v132
    v_add_f32 v13, v13, v14
    v_and_b32 v14, 0xffff0000, v130
    v_and_b32 v15, 0xffff0000, v132
    v_add_f32 v14, v14, v15
    v_cvt_pk_bf16_f32 v13, v13, v14
    v_lshlrev_b32 v14, 16, v12
    v_lshlrev_b32 v15, 16, v13
    v_add_f32 v14, v14, v15
    v_and_b32 v12, 0xffff0000, v12
    v_and_b32 v13, 0xffff0000, v13
    v_add_f32 v12, v12, v13
    v_cvt_pk_bf16_f32 v134, v14, v12
    v_lshlrev_b32 v12, 16, v125
    v_lshlrev_b32 v13, 16, v129
    v_add_f32 v12, v13, v12
    v_and_b32 v14, 0xffff0000, v125
    v_and_b32 v15, 0xffff0000, v129
    v_add_f32 v14, v15, v14
    v_cvt_pk_bf16_f32 v12, v12, v14
    v_lshlrev_b32 v13, 16, v131
    v_lshlrev_b32 v14, 16, v133
    v_add_f32 v13, v13, v14
    v_and_b32 v14, 0xffff0000, v131
    v_and_b32 v15, 0xffff0000, v133
    v_add_f32 v14, v14, v15
    v_cvt_pk_bf16_f32 v13, v13, v14
    v_lshlrev_b32 v14, 16, v12
    v_lshlrev_b32 v15, 16, v13
    v_add_f32 v14, v14, v15
    v_and_b32 v12, 0xffff0000, v12
    v_and_b32 v13, 0xffff0000, v13
    v_add_f32 v12, v12, v13
    v_cvt_pk_bf16_f32 v135, v14, v12
    buffer_store_dwordx2 v[134:135], v8, s[24:27], 0 offen offset:288
    s_nop 3
fi_done:
    s_endpgm
.section .rodata,"a"
.p2align 6
.p2align 6
.amdhsa_kernel prep_kernel
  .amdhsa_next_free_vgpr 64
  .amdhsa_next_free_sgpr 48
  .amdhsa_accum_offset 64
  .amdhsa_group_segment_fixed_size 0
  .amdhsa_kernarg_size 120
  .amdhsa_user_sgpr_count 2
  .amdhsa_user_sgpr_kernarg_segment_ptr 1
  .amdhsa_system_sgpr_workgroup_id_x 1
  .amdhsa_float_denorm_mode_32 3
  .amdhsa_float_denorm_mode_16_64 3
.end_amdhsa_kernel
.p2align 6
.amdhsa_kernel chain_kernel
  .amdhsa_next_free_vgpr 512
  .amdhsa_next_free_sgpr 80
  .amdhsa_accum_offset 256
  .amdhsa_group_segment_fixed_size 0
  .amdhsa_kernarg_size 120
  .amdhsa_user_sgpr_count 2
  .amdhsa_user_sgpr_kernarg_segment_ptr 1
  .amdhsa_system_sgpr_workgroup_id_x 1
  .amdhsa_float_denorm_mode_32 3
  .amdhsa_float_denorm_mode_16_64 3
.end_amdhsa_kernel
.p2align 6
.amdhsa_kernel final_kernel
  .amdhsa_next_free_vgpr 144
  .amdhsa_next_free_sgpr 80
  .amdhsa_accum_offset 144
  .amdhsa_group_segment_fixed_size 0
  .amdhsa_kernarg_size 120
  .amdhsa_user_sgpr_count 2
  .amdhsa_user_sgpr_kernarg_segment_ptr 1
  .amdhsa_system_sgpr_workgroup_id_x 1
  .amdhsa_float_denorm_mode_32 3
  .amdhsa_float_denorm_mode_16_64 3
.end_amdhsa_kernel
```
